```python
import torch

def _softmax(x, axis=-1):
    return torch.softmax(x, dim=axis)

def _gelu(x):
    return torch.nn.functional.gelu(x, approximate='tanh')

def _silu(x):
    return torch.nn.functional.silu(x)

def _sigmoid(x):
    return torch.sigmoid(x)

def _layernorm(x, axis=-1, eps=1e-05):
    m = x.mean(dim=axis, keepdim=True)
    v = x.var(dim=axis, keepdim=True, unbiased=False)
    return (x - m) / torch.sqrt(v + eps)

def _scatter_add(tgt, idx, src, axis=0):
    return tgt.clone().index_add_(axis, idx, src)

def _segment_sum(src, seg, n):
    out = torch.zeros((n,) + src.shape[1:], dtype=src.dtype)
    return out.index_add_(0, seg, src)

def _pad(x, pw):
    flat = tuple((v for pair in reversed(pw) for v in pair))
    return torch.nn.functional.pad(x, flat)
kernel_name = 'concat_heads__memory_aug_recurrent_mem_tr__grouped_kv_mqa__prompt'

def setup_inputs():

    _w = lambda a: (lambda t: t.to(torch.bfloat16) if t.is_floating_point() else t)(torch.as_tensor(a))

    def _A_setup():
        B, S, Dm = (1, 2048, 576)
        H, Dh = (32, 128)
        M, seg = (8, 32)
        seg = min(seg, S)
        S = S // seg * seg
        return {'x': _w((lambda *s: torch.randn(*s, dtype=torch.bfloat16) * 0.05)(B, S, Dm)), 'mem0': _w((lambda *s: torch.randn(*s, dtype=torch.bfloat16) * 0.8)(B, M, Dm)), 'Wq': _w((lambda *s: torch.randn(*s, dtype=torch.bfloat16) * 1.6)(Dm, H, Dh) * Dm ** (-0.5)), 'Wk': _w((lambda *s: torch.randn(*s, dtype=torch.bfloat16) * 1.6)(Dm, H, Dh) * Dm ** (-0.5)), 'Wv': _w((lambda *s: torch.randn(*s, dtype=torch.bfloat16) * 0.8)(Dm, H, Dh) * Dm ** (-0.5)), 'Wo': _w((lambda *s: torch.randn(*s, dtype=torch.bfloat16) * 0.8)(H, Dh, Dm) * (H * Dh) ** (-0.5)), 'seg_len': seg}
    _A_in = _A_setup()

    def _B_setup():
        B, S, D, H = (1, 2048, 576, 32)
        Dh = D // H
        return {'x': _w((lambda *s: torch.randn(*s, dtype=torch.bfloat16) * 0.05)(B, S, D)), 'wq': _w((lambda *s: torch.randn(*s, dtype=torch.bfloat16) * 1.6)(D, H * Dh)), 'wk': _w((lambda *s: torch.randn(*s, dtype=torch.bfloat16) * 1.6)(D, Dh)), 'wv': _w((lambda *s: torch.randn(*s, dtype=torch.bfloat16) * 0.05)(D, Dh)), 'wo': _w((lambda *s: torch.randn(*s, dtype=torch.bfloat16) * 0.05)(H * Dh, D))}
    _B_in = _B_setup()
    return {'A_x': _A_in['x'], 'A_mem0': _A_in['mem0'], 'A_Wq': _A_in['Wq'], 'A_Wk': _A_in['Wk'], 'A_Wv': _A_in['Wv'], 'A_Wo': _A_in['Wo'], 'A_seg_len': _A_in['seg_len'], 'B_x': _B_in['x'], 'B_wq': _B_in['wq'], 'B_wk': _B_in['wk'], 'B_wv': _B_in['wv'], 'B_wo': _B_in['wo']}

def reference(A_x, A_mem0, A_Wq, A_Wk, A_Wv, A_Wo, A_seg_len, B_x, B_wq, B_wk, B_wv, B_wo):

    def _A_ref(x, mem0, Wq, Wk, Wv, Wo, seg_len):
        B, S, Dm = x.shape
        H, Dh = (Wq.shape[1], Wq.shape[2])
        M = mem0.shape[1]
        scale = Dh ** (-0.5)
        n_seg = S // seg_len
        L = M + seg_len
        idx = torch.arange(L)
        mask = (idx[:, None] < M) | (idx[:, None] >= idx[None, :])
        mem = mem0
        outs = []
        for s in range(n_seg):
            xs = x[:, s * seg_len:(s + 1) * seg_len, :].clone()
            h = torch.concatenate([mem, xs], axis=1)
            q = torch.einsum('btd,dhe->bhte', h, Wq)
            k = torch.einsum('btd,dhe->bhte', h, Wk)
            v = torch.einsum('btd,dhe->bhte', h, Wv)
            scores = torch.einsum('bhqe,bhke->bhqk', q, k) * scale
            scores = torch.where(mask[None, None], scores, -1000000000.0)
            p = _softmax(scores, axis=-1)
            o = torch.einsum('bhqk,bhke->bhqe', p, v)
            o = torch.einsum('bhte,hed->btd', o, Wo)
            mem = o[:, :M, :].clone()
            outs.append(o[:, M:, :])
        return torch.concatenate(outs, axis=1)

    def _B_ref(x, wq, wk, wv, wo):
        B, S, D = x.shape
        H = 32
        Dh = D // H
        q = (lambda x, *d: x.permute(*d))((x @ wq).reshape(B, S, H, Dh), 0, 2, 1, 3)
        k = x @ wk
        v = x @ wv
        scores = torch.einsum('bhqd,bkd->bhqk', q, k) * Dh ** (-0.5)
        p = _softmax(scores, axis=-1)
        o = torch.einsum('bhqk,bkd->bhqd', p, v)
        return (lambda x, *d: x.permute(*d))(o, 0, 2, 1, 3).reshape(B, S, H * Dh) @ wo
    a = _A_ref(A_x, A_mem0, A_Wq, A_Wk, A_Wv, A_Wo, A_seg_len)
    b = _B_ref(B_x, B_wq, B_wk, B_wv, B_wo)
    return torch.concatenate([a, b], axis=-1)
```

```asm
; @launch grid=(256,1,1) block=(256,1,1) lds=163840
.amdgcn_target "amdgcn-amd-amdhsa--gfx950"
.text
.globl concat_heads__memory_aug_recurrent_mem_tr__grouped_kv_mqa__prompt_kernel
.p2align 8
.type concat_heads__memory_aug_recurrent_mem_tr__grouped_kv_mqa__prompt_kernel,@function
concat_heads__memory_aug_recurrent_mem_tr__grouped_kv_mqa__prompt_kernel:
s_cmp_lt_u32 s2, 256
s_cbranch_scc1 K_GO
s_endpgm
K_GO:
s_load_dwordx2 s[4:5], s[0:1], 112
s_load_dwordx2 s[20:21], s[0:1], 104
s_getreg_b32 s3, hwreg(HW_REG_XCC_ID, 0, 4)
s_waitcnt lgkmcnt(0)
s_mov_b32 s8, s4
s_mov_b32 s9, s5
s_mov_b32 s10, 268435456
s_mov_b32 s11, 0x00020000
s_mov_b32 s12, s20
s_mov_b32 s13, s21
s_mov_b32 s14, 256
s_mov_b32 s15, 0x00020000
v_lshrrev_b32 v1, 6, v0
v_and_b32 v0, 63, v0
s_nop 0
v_readfirstlane_b32 s17, v1
v_lshlrev_b32 v0, 4, v0
s_mov_b32 s6, s2
s_cmp_eq_u32 s17, 0
s_cbranch_scc0 K_TK1
s_mov_b64 exec, 1
v_mov_b32 v2, 1
v_mov_b32 v3, 0
s_mov_b32 s22, -1
s_cmp_eq_u32 s3, 0
s_cbranch_scc0 K_TB
buffer_atomic_add v2, v3, s[12:15], 0 offen sc0
s_waitcnt vmcnt(0)
v_readfirstlane_b32 s22, v2
s_cmp_lt_u32 s22, 32
s_cbranch_scc1 K_TW
K_TB:
v_mov_b32 v2, 1
buffer_atomic_add v2, v3, s[12:15], 0 offen offset:64 sc0
s_waitcnt vmcnt(0)
v_readfirstlane_b32 s23, v2
s_mov_b32 s22, -1
s_cmp_lt_u32 s23, 224
s_cbranch_scc1 K_TB2
s_sub_u32 s22, 255, s23
K_TB2:
s_cmp_eq_u32 s23, 0
s_cbranch_scc0 K_TW2
s_mov_b64 exec, -1
s_load_dwordx2 s[4:5], s[0:1], 8
s_waitcnt lgkmcnt(0)
s_mov_b32 s24, s4
s_mov_b32 s25, s5
s_mov_b32 s26, 9216
s_mov_b32 s27, 0x00020000
v_bfe_u32 v8, v0, 4, 4
v_lshrrev_b32 v9, 2, v8
v_lshlrev_b32 v9, 1, v9
v_and_b32 v10, 1, v8
v_add_u32 v9, v9, v10
v_mul_u32_u24 v9, 1152, v9
v_bfe_u32 v10, v8, 1, 1
v_lshl_add_u32 v9, v10, 4, v9
v_lshrrev_b32 v10, 8, v0
v_lshl_add_u32 v9, v10, 5, v9
buffer_load_dwordx4 v[16:19], v9, s[24:27], 0 offen offset:0
buffer_load_dwordx4 v[20:23], v9, s[24:27], 0 offen offset:128
buffer_load_dwordx4 v[24:27], v9, s[24:27], 0 offen offset:256
buffer_load_dwordx4 v[28:31], v9, s[24:27], 0 offen offset:384
buffer_load_dwordx4 v[32:35], v9, s[24:27], 0 offen offset:512
buffer_load_dwordx4 v[36:39], v9, s[24:27], 0 offen offset:640
buffer_load_dwordx4 v[40:43], v9, s[24:27], 0 offen offset:768
buffer_load_dwordx4 v[44:47], v9, s[24:27], 0 offen offset:896
buffer_load_dwordx4 v[48:51], v9, s[24:27], 0 offen offset:1024
v_mov_b32 v12, -1
v_mov_b32 v13, -1
v_mov_b32 v14, -1
v_mov_b32 v15, -1
s_mov_b32 s28, 795648
buffer_store_dwordx4 v[12:15], v0, s[8:11], s28 offen sc1
s_mov_b32 s28, 796672
buffer_store_dwordx4 v[12:15], v0, s[8:11], s28 offen sc1
s_mov_b32 s28, 797696
buffer_store_dwordx4 v[12:15], v0, s[8:11], s28 offen sc1
s_mov_b32 s28, 798720
buffer_store_dwordx4 v[12:15], v0, s[8:11], s28 offen sc1
s_mov_b32 s28, 799744
buffer_store_dwordx4 v[12:15], v0, s[8:11], s28 offen sc1
s_mov_b32 s28, 800768
buffer_store_dwordx4 v[12:15], v0, s[8:11], s28 offen sc1
s_mov_b32 s28, 801792
buffer_store_dwordx4 v[12:15], v0, s[8:11], s28 offen sc1
s_mov_b32 s28, 802816
buffer_store_dwordx4 v[12:15], v0, s[8:11], s28 offen sc1
s_mov_b32 s28, 803840
buffer_store_dwordx4 v[12:15], v0, s[8:11], s28 offen sc1
s_mov_b32 s28, 804864
buffer_store_dwordx4 v[12:15], v0, s[8:11], s28 offen sc1
s_mov_b32 s28, 805888
buffer_store_dwordx4 v[12:15], v0, s[8:11], s28 offen sc1
s_mov_b32 s28, 806912
buffer_store_dwordx4 v[12:15], v0, s[8:11], s28 offen sc1
s_mov_b32 s28, 807936
buffer_store_dwordx4 v[12:15], v0, s[8:11], s28 offen sc1
s_mov_b32 s28, 808960
buffer_store_dwordx4 v[12:15], v0, s[8:11], s28 offen sc1
s_mov_b32 s28, 809984
buffer_store_dwordx4 v[12:15], v0, s[8:11], s28 offen sc1
s_mov_b32 s28, 811008
buffer_store_dwordx4 v[12:15], v0, s[8:11], s28 offen sc1
s_mov_b32 s28, 812032
buffer_store_dwordx4 v[12:15], v0, s[8:11], s28 offen sc1
s_mov_b32 s28, 813056
buffer_store_dwordx4 v[12:15], v0, s[8:11], s28 offen sc1
v_and_b32 v8, 7, v8
v_and_b32 v9, 1, v8
v_lshlrev_b32 v9, 4, v9
v_mov_b32 v10, 0x3f80
v_lshlrev_b32 v9, v9, v10
v_lshrrev_b32 v8, 1, v8
v_cmp_eq_u32 vcc, 0, v8
s_nop 1
v_cndmask_b32 v56, 0, v9, vcc
v_cmp_eq_u32 vcc, 1, v8
s_nop 1
v_cndmask_b32 v57, 0, v9, vcc
v_cmp_eq_u32 vcc, 2, v8
s_nop 1
v_cndmask_b32 v58, 0, v9, vcc
v_cmp_eq_u32 vcc, 3, v8
s_nop 1
v_cndmask_b32 v59, 0, v9, vcc
s_mov_b32 s28, 815104
buffer_store_dwordx4 v[56:59], v0, s[8:11], s28 offen sc1
s_waitcnt vmcnt(19)
s_mov_b32 s28, 786432
buffer_store_dwordx4 v[16:19], v0, s[8:11], s28 offen sc1
s_mov_b32 s28, 787456
buffer_store_dwordx4 v[20:23], v0, s[8:11], s28 offen sc1
s_mov_b32 s28, 788480
buffer_store_dwordx4 v[24:27], v0, s[8:11], s28 offen sc1
s_mov_b32 s28, 789504
buffer_store_dwordx4 v[28:31], v0, s[8:11], s28 offen sc1
s_mov_b32 s28, 790528
buffer_store_dwordx4 v[32:35], v0, s[8:11], s28 offen sc1
s_mov_b32 s28, 791552
buffer_store_dwordx4 v[36:39], v0, s[8:11], s28 offen sc1
s_mov_b32 s28, 792576
buffer_store_dwordx4 v[40:43], v0, s[8:11], s28 offen sc1
s_mov_b32 s28, 793600
buffer_store_dwordx4 v[44:47], v0, s[8:11], s28 offen sc1
s_mov_b32 s28, 794624
buffer_store_dwordx4 v[48:51], v0, s[8:11], s28 offen sc1
s_waitcnt vmcnt(0)
s_mov_b64 exec, 1
s_memrealtime s[24:25]
s_waitcnt lgkmcnt(0)
s_or_b32 s24, s24, 1
v_mov_b32 v2, s24
buffer_store_dword v2, v3, s[12:15], 0 offen offset:128 sc1
s_branch K_TW2
K_TW:
s_mov_b32 s23, -1
K_TW2:
v_mov_b32 v4, s22
v_mov_b32 v5, s23
ds_write_b64 v3, v[4:5]
s_waitcnt lgkmcnt(0)
s_mov_b64 exec, -1
K_TK1:
s_barrier
v_mov_b32 v3, 0
ds_read_b64 v[4:5], v3
s_waitcnt lgkmcnt(0)
v_readfirstlane_b32 s22, v4
v_readfirstlane_b32 s23, v5
s_barrier
s_cmp_eq_u32 s23, -1
s_cbranch_scc1 K_ROK
s_cmp_lt_u32 s23, 256
s_cbranch_scc1 K_ROK
s_endpgm
K_ROK:
s_cmp_eq_u32 s22, -1
s_cbranch_scc1 K_BULK
s_branch K_CHAIN
K_BULK:
s_and_b32 s16, s23, 31
s_lshr_b32 s50, s23, 5
s_mov_b32 s51, s23
s_mov_b32 s88, s12
s_mov_b32 s89, s13
s_mov_b32 s90, s14
s_mov_b32 s91, s15
s_mul_i32 s40, s51, 21504
s_mul_i32 s41, s17, 5376
s_add_u32 s40, s40, s41
s_load_dwordx2 s[4:5], s[0:1], 16
s_waitcnt lgkmcnt(0)
s_mov_b32 s12, s4
s_mov_b32 s13, s5
s_mov_b32 s14, 4718592
s_mov_b32 s15, 0x00020000
buffer_load_dwordx4 v[8:11], v0, s[12:15], s40 offen offset:0
buffer_load_dwordx4 v[8:11], v0, s[12:15], s40 offen offset:1024
buffer_load_dwordx4 v[8:11], v0, s[12:15], s40 offen offset:2048
buffer_load_dwordx4 v[8:11], v0, s[12:15], s40 offen offset:3072
s_add_u32 s42, s40, 4096
buffer_load_dwordx4 v[8:11], v0, s[12:15], s42 offen
s_add_u32 s42, s40, 5120
buffer_load_dwordx4 v[8:11], v0, s[12:15], s42 offen
s_load_dwordx2 s[4:5], s[0:1], 24
s_waitcnt lgkmcnt(0)
s_mov_b32 s12, s4
s_mov_b32 s13, s5
s_mov_b32 s14, 4718592
s_mov_b32 s15, 0x00020000
buffer_load_dwordx4 v[8:11], v0, s[12:15], s40 offen offset:0
buffer_load_dwordx4 v[8:11], v0, s[12:15], s40 offen offset:1024
buffer_load_dwordx4 v[8:11], v0, s[12:15], s40 offen offset:2048
buffer_load_dwordx4 v[8:11], v0, s[12:15], s40 offen offset:3072
s_add_u32 s42, s40, 4096
buffer_load_dwordx4 v[8:11], v0, s[12:15], s42 offen
s_add_u32 s42, s40, 5120
buffer_load_dwordx4 v[8:11], v0, s[12:15], s42 offen
s_load_dwordx2 s[4:5], s[0:1], 32
s_waitcnt lgkmcnt(0)
s_mov_b32 s12, s4
s_mov_b32 s13, s5
s_mov_b32 s14, 4718592
s_mov_b32 s15, 0x00020000
buffer_load_dwordx4 v[8:11], v0, s[12:15], s40 offen offset:0
buffer_load_dwordx4 v[8:11], v0, s[12:15], s40 offen offset:1024
buffer_load_dwordx4 v[8:11], v0, s[12:15], s40 offen offset:2048
buffer_load_dwordx4 v[8:11], v0, s[12:15], s40 offen offset:3072
s_add_u32 s42, s40, 4096
buffer_load_dwordx4 v[8:11], v0, s[12:15], s42 offen
s_add_u32 s42, s40, 5120
buffer_load_dwordx4 v[8:11], v0, s[12:15], s42 offen
s_load_dwordx2 s[4:5], s[0:1], 40
s_waitcnt lgkmcnt(0)
s_mov_b32 s12, s4
s_mov_b32 s13, s5
s_mov_b32 s14, 4718592
s_mov_b32 s15, 0x00020000
buffer_load_dwordx4 v[8:11], v0, s[12:15], s40 offen offset:0
buffer_load_dwordx4 v[8:11], v0, s[12:15], s40 offen offset:1024
buffer_load_dwordx4 v[8:11], v0, s[12:15], s40 offen offset:2048
buffer_load_dwordx4 v[8:11], v0, s[12:15], s40 offen offset:3072
s_add_u32 s42, s40, 4096
buffer_load_dwordx4 v[8:11], v0, s[12:15], s42 offen
s_add_u32 s42, s40, 5120
buffer_load_dwordx4 v[8:11], v0, s[12:15], s42 offen
s_lshl_b32 s6, s51, 0
s_add_u32 s6, s6, 256
s_cmp_lt_u32 s50, 2
s_cbranch_scc1 K_AP
s_lshl_b32 s28, s16, 8
s_load_dwordx2 s[4:5], s[0:1], 24
s_waitcnt lgkmcnt(0)
s_add_u32 s52, s4, s28
s_addc_u32 s53, s5, 0
s_sub_u32 s54, 4718592, s28
s_mov_b32 s55, 0x00020000
s_load_dwordx2 s[4:5], s[0:1], 32
s_waitcnt lgkmcnt(0)
s_add_u32 s56, s4, s28
s_addc_u32 s57, s5, 0
s_sub_u32 s58, 4718592, s28
s_mov_b32 s59, 0x00020000
v_lshrrev_b32 v24, 8, v0
v_and_b32 v25, 1, v24
s_lshl_b32 s28, s17, 1
v_or_b32 v25, s28, v25
v_bfe_u32 v26, v0, 5, 3
v_xor_b32 v26, v26, v25
v_lshlrev_b32 v26, 5, v26
v_lshl_add_u32 v26, v24, 13, v26
v_and_b32 v27, 16, v0
v_add_u32 v23, v26, v27
s_lshl_b32 s28, s17, 15
s_add_u32 s28, s28, 0
s_lshl_b32 s29, s17, 10
s_add_u32 s29, s29, 0
s_mov_b32 s30, 0
DM_1:
s_mov_b32 m0, s29
s_add_u32 s29, s29, 4096
buffer_load_dwordx4 v23, s[52:55], s28 offen lds
s_add_u32 s28, s28, 131072
s_add_u32 s30, s30, 1
s_cmp_lt_u32 s30, 20
s_cbranch_scc1 DM_1
s_lshl_b32 s28, s17, 15
s_add_u32 s28, s28, 2621440
s_lshl_b32 s29, s17, 10
s_add_u32 s29, s29, 81920
s_mov_b32 s30, 0
DM_2:
s_mov_b32 m0, s29
s_add_u32 s29, s29, 4096
buffer_load_dwordx4 v23, s[52:55], s28 offen lds
s_add_u32 s28, s28, 131072
s_add_u32 s30, s30, 1
s_cmp_lt_u32 s30, 16
s_cbranch_scc1 DM_2
s_waitcnt vmcnt(16)
s_barrier
v_lshrrev_b32 v24, 8, v0
v_bfe_u32 v25, v0, 6, 2
v_bfe_u32 v26, v0, 4, 2
v_lshl_add_u32 v27, v24, 3, v25
v_lshlrev_b32 v27, 8, v27
v_lshl_add_u32 v27, v26, 3, v27
v_add_u32 v27, 0, v27
v_and_b32 v28, 1, v25
v_and_b32 v29, 1, v24
v_lshl_add_u32 v28, v29, 2, v28
v_or_b32 v29, 2, v28
s_lshl_b32 s28, s17, 1
s_add_u32 s29, s28, 0
v_xor_b32 v30, s29, v28
v_lshl_add_u32 v30, v30, 5, v27
v_xor_b32 v31, s29, v29
v_lshl_add_u32 v31, v31, 5, v27
v_add_u32 v31, 1024, v31
ds_read_b64_tr_b16 a[0:1], v30 offset:0
ds_read_b64_tr_b16 a[2:3], v31 offset:0
ds_read_b64_tr_b16 a[4:5], v30 offset:8192
ds_read_b64_tr_b16 a[6:7], v31 offset:8192
ds_read_b64_tr_b16 a[8:9], v30 offset:16384
ds_read_b64_tr_b16 a[10:11], v31 offset:16384
ds_read_b64_tr_b16 a[12:13], v30 offset:24576
ds_read_b64_tr_b16 a[14:15], v31 offset:24576
ds_read_b64_tr_b16 a[16:17], v30 offset:32768
ds_read_b64_tr_b16 a[18:19], v31 offset:32768
ds_read_b64_tr_b16 a[20:21], v30 offset:40960
ds_read_b64_tr_b16 a[22:23], v31 offset:40960
ds_read_b64_tr_b16 a[24:25], v30 offset:49152
ds_read_b64_tr_b16 a[26:27], v31 offset:49152
ds_read_b64_tr_b16 a[28:29], v30 offset:57344
ds_read_b64_tr_b16 a[30:31], v31 offset:57344
s_waitcnt lgkmcnt(0)
v_add_u32 v30, 65536, v30
v_add_u32 v31, 65536, v31
ds_read_b64_tr_b16 a[32:33], v30 offset:0
ds_read_b64_tr_b16 a[34:35], v31 offset:0
ds_read_b64_tr_b16 a[36:37], v30 offset:8192
ds_read_b64_tr_b16 a[38:39], v31 offset:8192
s_waitcnt lgkmcnt(0)
s_add_u32 s29, s28, 1
v_xor_b32 v30, s29, v28
v_lshl_add_u32 v30, v30, 5, v27
v_xor_b32 v31, s29, v29
v_lshl_add_u32 v31, v31, 5, v27
v_add_u32 v31, 1024, v31
ds_read_b64_tr_b16 a[72:73], v30 offset:0
ds_read_b64_tr_b16 a[74:75], v31 offset:0
ds_read_b64_tr_b16 a[76:77], v30 offset:8192
ds_read_b64_tr_b16 a[78:79], v31 offset:8192
ds_read_b64_tr_b16 a[80:81], v30 offset:16384
ds_read_b64_tr_b16 a[82:83], v31 offset:16384
ds_read_b64_tr_b16 a[84:85], v30 offset:24576
ds_read_b64_tr_b16 a[86:87], v31 offset:24576
ds_read_b64_tr_b16 a[88:89], v30 offset:32768
ds_read_b64_tr_b16 a[90:91], v31 offset:32768
ds_read_b64_tr_b16 a[92:93], v30 offset:40960
ds_read_b64_tr_b16 a[94:95], v31 offset:40960
ds_read_b64_tr_b16 a[96:97], v30 offset:49152
ds_read_b64_tr_b16 a[98:99], v31 offset:49152
ds_read_b64_tr_b16 a[100:101], v30 offset:57344
ds_read_b64_tr_b16 a[102:103], v31 offset:57344
s_waitcnt lgkmcnt(0)
v_add_u32 v30, 65536, v30
v_add_u32 v31, 65536, v31
ds_read_b64_tr_b16 a[104:105], v30 offset:0
ds_read_b64_tr_b16 a[106:107], v31 offset:0
ds_read_b64_tr_b16 a[108:109], v30 offset:8192
ds_read_b64_tr_b16 a[110:111], v31 offset:8192
s_waitcnt lgkmcnt(0)
s_waitcnt lgkmcnt(0)
s_barrier
s_lshl_b32 s28, s17, 15
s_add_u32 s28, s28, 0
s_lshl_b32 s29, s17, 10
s_add_u32 s29, s29, 0
s_mov_b32 s30, 0
DM_3:
s_mov_b32 m0, s29
s_add_u32 s29, s29, 4096
buffer_load_dwordx4 v23, s[56:59], s28 offen lds
s_add_u32 s28, s28, 131072
s_add_u32 s30, s30, 1
s_cmp_lt_u32 s30, 20
s_cbranch_scc1 DM_3
s_waitcnt vmcnt(20)
s_barrier
v_lshrrev_b32 v24, 8, v0
v_bfe_u32 v25, v0, 6, 2
v_bfe_u32 v26, v0, 4, 2
v_lshl_add_u32 v27, v24, 3, v25
v_lshlrev_b32 v27, 8, v27
v_lshl_add_u32 v27, v26, 3, v27
v_add_u32 v27, 81920, v27
v_and_b32 v28, 1, v25
v_and_b32 v29, 1, v24
v_lshl_add_u32 v28, v29, 2, v28
v_or_b32 v29, 2, v28
s_lshl_b32 s28, s17, 1
s_add_u32 s29, s28, 0
v_xor_b32 v30, s29, v28
v_lshl_add_u32 v30, v30, 5, v27
v_xor_b32 v31, s29, v29
v_lshl_add_u32 v31, v31, 5, v27
v_add_u32 v31, 1024, v31
ds_read_b64_tr_b16 a[40:41], v30 offset:0
ds_read_b64_tr_b16 a[42:43], v31 offset:0
ds_read_b64_tr_b16 a[44:45], v30 offset:8192
ds_read_b64_tr_b16 a[46:47], v31 offset:8192
ds_read_b64_tr_b16 a[48:49], v30 offset:16384
ds_read_b64_tr_b16 a[50:51], v31 offset:16384
ds_read_b64_tr_b16 a[52:53], v30 offset:24576
ds_read_b64_tr_b16 a[54:55], v31 offset:24576
ds_read_b64_tr_b16 a[56:57], v30 offset:32768
ds_read_b64_tr_b16 a[58:59], v31 offset:32768
ds_read_b64_tr_b16 a[60:61], v30 offset:40960
ds_read_b64_tr_b16 a[62:63], v31 offset:40960
ds_read_b64_tr_b16 a[64:65], v30 offset:49152
ds_read_b64_tr_b16 a[66:67], v31 offset:49152
ds_read_b64_tr_b16 a[68:69], v30 offset:57344
ds_read_b64_tr_b16 a[70:71], v31 offset:57344
s_waitcnt lgkmcnt(0)
s_add_u32 s29, s28, 1
v_xor_b32 v30, s29, v28
v_lshl_add_u32 v30, v30, 5, v27
v_xor_b32 v31, s29, v29
v_lshl_add_u32 v31, v31, 5, v27
v_add_u32 v31, 1024, v31
ds_read_b64_tr_b16 a[112:113], v30 offset:0
ds_read_b64_tr_b16 a[114:115], v31 offset:0
ds_read_b64_tr_b16 a[116:117], v30 offset:8192
ds_read_b64_tr_b16 a[118:119], v31 offset:8192
ds_read_b64_tr_b16 a[120:121], v30 offset:16384
ds_read_b64_tr_b16 a[122:123], v31 offset:16384
ds_read_b64_tr_b16 a[124:125], v30 offset:24576
ds_read_b64_tr_b16 a[126:127], v31 offset:24576
ds_read_b64_tr_b16 a[128:129], v30 offset:32768
ds_read_b64_tr_b16 a[130:131], v31 offset:32768
ds_read_b64_tr_b16 a[132:133], v30 offset:40960
ds_read_b64_tr_b16 a[134:135], v31 offset:40960
ds_read_b64_tr_b16 a[136:137], v30 offset:49152
ds_read_b64_tr_b16 a[138:139], v31 offset:49152
ds_read_b64_tr_b16 a[140:141], v30 offset:57344
ds_read_b64_tr_b16 a[142:143], v31 offset:57344
s_waitcnt lgkmcnt(0)
s_waitcnt lgkmcnt(0)
s_barrier
s_lshl_b32 s28, s17, 15
s_add_u32 s28, s28, 2621440
s_lshl_b32 s29, s17, 10
s_add_u32 s29, s29, 81920
s_mov_b32 s30, 0
DM_4:
s_mov_b32 m0, s29
s_add_u32 s29, s29, 4096
buffer_load_dwordx4 v23, s[56:59], s28 offen lds
s_add_u32 s28, s28, 131072
s_add_u32 s30, s30, 1
s_cmp_lt_u32 s30, 16
s_cbranch_scc1 DM_4
s_waitcnt vmcnt(16)
s_barrier
v_lshrrev_b32 v24, 8, v0
v_bfe_u32 v25, v0, 6, 2
v_bfe_u32 v26, v0, 4, 2
v_lshl_add_u32 v27, v24, 3, v25
v_lshlrev_b32 v27, 8, v27
v_lshl_add_u32 v27, v26, 3, v27
v_add_u32 v27, 0, v27
v_and_b32 v28, 1, v25
v_and_b32 v29, 1, v24
v_lshl_add_u32 v28, v29, 2, v28
v_or_b32 v29, 2, v28
s_lshl_b32 s28, s17, 1
s_add_u32 s29, s28, 0
v_xor_b32 v30, s29, v28
v_lshl_add_u32 v30, v30, 5, v27
v_xor_b32 v31, s29, v29
v_lshl_add_u32 v31, v31, 5, v27
v_add_u32 v31, 1024, v31
ds_read_b64_tr_b16 a[144:145], v30 offset:0
ds_read_b64_tr_b16 a[146:147], v31 offset:0
ds_read_b64_tr_b16 a[148:149], v30 offset:8192
ds_read_b64_tr_b16 a[150:151], v31 offset:8192
ds_read_b64_tr_b16 a[152:153], v30 offset:16384
ds_read_b64_tr_b16 a[154:155], v31 offset:16384
ds_read_b64_tr_b16 a[156:157], v30 offset:24576
ds_read_b64_tr_b16 a[158:159], v31 offset:24576
ds_read_b64_tr_b16 a[160:161], v30 offset:32768
ds_read_b64_tr_b16 a[162:163], v31 offset:32768
ds_read_b64_tr_b16 a[164:165], v30 offset:40960
ds_read_b64_tr_b16 a[166:167], v31 offset:40960
ds_read_b64_tr_b16 a[168:169], v30 offset:49152
ds_read_b64_tr_b16 a[170:171], v31 offset:49152
ds_read_b64_tr_b16 a[172:173], v30 offset:57344
ds_read_b64_tr_b16 a[174:175], v31 offset:57344
s_waitcnt lgkmcnt(0)
v_add_u32 v30, 65536, v30
v_add_u32 v31, 65536, v31
ds_read_b64_tr_b16 a[176:177], v30 offset:0
ds_read_b64_tr_b16 a[178:179], v31 offset:0
ds_read_b64_tr_b16 a[180:181], v30 offset:8192
ds_read_b64_tr_b16 a[182:183], v31 offset:8192
s_waitcnt lgkmcnt(0)
s_add_u32 s29, s28, 1
v_xor_b32 v30, s29, v28
v_lshl_add_u32 v30, v30, 5, v27
v_xor_b32 v31, s29, v29
v_lshl_add_u32 v31, v31, 5, v27
v_add_u32 v31, 1024, v31
ds_read_b64_tr_b16 a[216:217], v30 offset:0
ds_read_b64_tr_b16 a[218:219], v31 offset:0
ds_read_b64_tr_b16 a[220:221], v30 offset:8192
ds_read_b64_tr_b16 a[222:223], v31 offset:8192
ds_read_b64_tr_b16 a[224:225], v30 offset:16384
ds_read_b64_tr_b16 a[226:227], v31 offset:16384
ds_read_b64_tr_b16 a[228:229], v30 offset:24576
ds_read_b64_tr_b16 a[230:231], v31 offset:24576
ds_read_b64_tr_b16 a[232:233], v30 offset:32768
ds_read_b64_tr_b16 a[234:235], v31 offset:32768
ds_read_b64_tr_b16 a[236:237], v30 offset:40960
ds_read_b64_tr_b16 a[238:239], v31 offset:40960
ds_read_b64_tr_b16 a[240:241], v30 offset:49152
ds_read_b64_tr_b16 a[242:243], v31 offset:49152
ds_read_b64_tr_b16 a[244:245], v30 offset:57344
ds_read_b64_tr_b16 a[246:247], v31 offset:57344
s_waitcnt lgkmcnt(0)
v_add_u32 v30, 65536, v30
v_add_u32 v31, 65536, v31
ds_read_b64_tr_b16 a[248:249], v30 offset:0
ds_read_b64_tr_b16 a[250:251], v31 offset:0
ds_read_b64_tr_b16 a[252:253], v30 offset:8192
ds_read_b64_tr_b16 a[254:255], v31 offset:8192
s_waitcnt lgkmcnt(0)
s_waitcnt lgkmcnt(0)
s_barrier
s_waitcnt vmcnt(0)
s_barrier
v_lshrrev_b32 v24, 8, v0
v_bfe_u32 v25, v0, 6, 2
v_bfe_u32 v26, v0, 4, 2
v_lshl_add_u32 v27, v24, 3, v25
v_lshlrev_b32 v27, 8, v27
v_lshl_add_u32 v27, v26, 3, v27
v_add_u32 v27, 81920, v27
v_and_b32 v28, 1, v25
v_and_b32 v29, 1, v24
v_lshl_add_u32 v28, v29, 2, v28
v_or_b32 v29, 2, v28
s_lshl_b32 s28, s17, 1
s_add_u32 s29, s28, 0
v_xor_b32 v30, s29, v28
v_lshl_add_u32 v30, v30, 5, v27
v_xor_b32 v31, s29, v29
v_lshl_add_u32 v31, v31, 5, v27
v_add_u32 v31, 1024, v31
ds_read_b64_tr_b16 a[184:185], v30 offset:0
ds_read_b64_tr_b16 a[186:187], v31 offset:0
ds_read_b64_tr_b16 a[188:189], v30 offset:8192
ds_read_b64_tr_b16 a[190:191], v31 offset:8192
ds_read_b64_tr_b16 a[192:193], v30 offset:16384
ds_read_b64_tr_b16 a[194:195], v31 offset:16384
ds_read_b64_tr_b16 a[196:197], v30 offset:24576
ds_read_b64_tr_b16 a[198:199], v31 offset:24576
ds_read_b64_tr_b16 a[200:201], v30 offset:32768
ds_read_b64_tr_b16 a[202:203], v31 offset:32768
ds_read_b64_tr_b16 a[204:205], v30 offset:40960
ds_read_b64_tr_b16 a[206:207], v31 offset:40960
ds_read_b64_tr_b16 a[208:209], v30 offset:49152
ds_read_b64_tr_b16 a[210:211], v31 offset:49152
ds_read_b64_tr_b16 a[212:213], v30 offset:57344
ds_read_b64_tr_b16 a[214:215], v31 offset:57344
s_waitcnt lgkmcnt(0)
s_add_u32 s29, s28, 1
v_xor_b32 v30, s29, v28
v_lshl_add_u32 v30, v30, 5, v27
v_xor_b32 v31, s29, v29
v_lshl_add_u32 v31, v31, 5, v27
v_add_u32 v31, 1024, v31
ds_read_b64_tr_b16 v[224:225], v30 offset:0
ds_read_b64_tr_b16 v[226:227], v31 offset:0
ds_read_b64_tr_b16 v[228:229], v30 offset:8192
ds_read_b64_tr_b16 v[230:231], v31 offset:8192
ds_read_b64_tr_b16 v[232:233], v30 offset:16384
ds_read_b64_tr_b16 v[234:235], v31 offset:16384
ds_read_b64_tr_b16 v[236:237], v30 offset:24576
ds_read_b64_tr_b16 v[238:239], v31 offset:24576
ds_read_b64_tr_b16 v[240:241], v30 offset:32768
ds_read_b64_tr_b16 v[242:243], v31 offset:32768
ds_read_b64_tr_b16 v[244:245], v30 offset:40960
ds_read_b64_tr_b16 v[246:247], v31 offset:40960
ds_read_b64_tr_b16 v[248:249], v30 offset:49152
ds_read_b64_tr_b16 v[250:251], v31 offset:49152
ds_read_b64_tr_b16 v[252:253], v30 offset:57344
ds_read_b64_tr_b16 v[254:255], v31 offset:57344
s_waitcnt lgkmcnt(0)
s_waitcnt lgkmcnt(0)
s_barrier
v_mov_b32 v3, 0
s_mov_b32 s35, 4000000
NW_5:
buffer_load_dword v2, v3, s[88:91], 0 offen offset:128 sc1
s_waitcnt vmcnt(0)
v_readfirstlane_b32 s7, v2
s_cmp_lg_u32 s7, 0
s_cbranch_scc1 NW_5k
s_sub_u32 s35, s35, 1
s_cbranch_scc1 K_END
s_sleep 2
s_branch NW_5
NW_5k:
s_load_dwordx2 s[4:5], s[0:1], 0
s_waitcnt lgkmcnt(0)
s_mov_b32 s20, s4
s_mov_b32 s21, s5
s_mov_b32 s22, 2359296
s_mov_b32 s23, 0x00020000
v_bfe_u32 v2, v0, 4, 4
v_mul_u32_u24 v2, 1152, v2
v_lshrrev_b32 v3, 8, v0
v_lshl_add_u32 v2, v3, 4, v2
s_mov_b32 s24, s50
s_mul_i32 s25, s24, 36864
s_mov_b32 s26, 0
s_mul_i32 s28, s17, 576
s_cmp_ge_u32 s17, 2
s_cselect_b32 s29, 17280, 0
s_add_u32 s28, s28, s29
s_add_u32 s28, s28, s25
s_mul_i32 s29, s17, 9216
s_add_u32 m0, s29, s26
s_nop 0
buffer_load_dwordx4 v2, s[20:23], s28 offen offset:0 lds
s_add_u32 m0, m0, 960
s_nop 0
buffer_load_dwordx4 v2, s[20:23], s28 offen offset:64 lds
s_add_u32 m0, m0, 960
s_nop 0
buffer_load_dwordx4 v2, s[20:23], s28 offen offset:128 lds
s_add_u32 m0, m0, 960
s_nop 0
buffer_load_dwordx4 v2, s[20:23], s28 offen offset:192 lds
s_add_u32 m0, m0, 960
s_nop 0
buffer_load_dwordx4 v2, s[20:23], s28 offen offset:256 lds
s_add_u32 m0, m0, 960
s_nop 0
buffer_load_dwordx4 v2, s[20:23], s28 offen offset:320 lds
s_add_u32 m0, m0, 960
s_nop 0
buffer_load_dwordx4 v2, s[20:23], s28 offen offset:384 lds
s_add_u32 m0, m0, 960
s_nop 0
buffer_load_dwordx4 v2, s[20:23], s28 offen offset:448 lds
s_add_u32 m0, m0, 960
s_nop 0
buffer_load_dwordx4 v2, s[20:23], s28 offen offset:512 lds
s_mov_b32 s34, 0
s_waitcnt vmcnt(0)
s_lshl_b32 s39, s16, 5
s_lshl_b32 s41, s50, 2
s_add_u32 s39, s39, s41
s_add_u32 s39, s39, 819200
PL_6:
s_cmp_eq_u32 s34, 1
s_cbranch_scc0 PW0_9
s_waitcnt vmcnt(0)
PW0_9:
s_waitcnt vmcnt(4)
s_barrier
s_cmp_ge_u32 s34, 1
s_cbranch_scc0 PNF_10
s_cmp_eq_u32 s17, 0
s_cbranch_scc0 PNF_10
s_add_u32 s41, s34, s7
s_sub_u32 s41, s41, 1
s_cmp_eq_u32 s34, 1
s_cselect_b32 s40, 1, 0
s_add_u32 s41, s41, s40
v_mov_b32 v4, s41
v_mov_b32 v5, 0
s_mov_b64 exec, 1
buffer_store_dword v4, v5, s[8:11], s39 offen sc1
s_mov_b64 exec, -1
PNF_10:
s_add_u32 s35, s24, 7
s_cmp_lt_u32 s35, 64
s_cbranch_scc0 PN_7
s_mul_i32 s25, s35, 36864
s_xor_b32 s36, s26, 36864
s_mul_i32 s28, s17, 576
s_cmp_ge_u32 s17, 2
s_cselect_b32 s29, 17280, 0
s_add_u32 s28, s28, s29
s_add_u32 s28, s28, s25
s_mul_i32 s29, s17, 9216
s_add_u32 m0, s29, s36
s_nop 0
buffer_load_dwordx4 v2, s[20:23], s28 offen offset:0 lds
s_add_u32 m0, m0, 960
s_nop 0
buffer_load_dwordx4 v2, s[20:23], s28 offen offset:64 lds
s_add_u32 m0, m0, 960
s_nop 0
buffer_load_dwordx4 v2, s[20:23], s28 offen offset:128 lds
s_add_u32 m0, m0, 960
s_nop 0
buffer_load_dwordx4 v2, s[20:23], s28 offen offset:192 lds
s_add_u32 m0, m0, 960
s_nop 0
buffer_load_dwordx4 v2, s[20:23], s28 offen offset:256 lds
s_add_u32 m0, m0, 960
s_nop 0
buffer_load_dwordx4 v2, s[20:23], s28 offen offset:320 lds
s_add_u32 m0, m0, 960
s_nop 0
buffer_load_dwordx4 v2, s[20:23], s28 offen offset:384 lds
s_add_u32 m0, m0, 960
s_nop 0
buffer_load_dwordx4 v2, s[20:23], s28 offen offset:448 lds
s_add_u32 m0, m0, 960
s_nop 0
buffer_load_dwordx4 v2, s[20:23], s28 offen offset:512 lds
PN_7:
v_add_u32 v3, s26, v0
ds_read_b128 v[40:43], v3 offset:0
ds_read_b128 v[44:47], v3 offset:18432
ds_read_b128 v[48:51], v3 offset:1024
ds_read_b128 v[52:55], v3 offset:19456
ds_read_b128 v[56:59], v3 offset:2048
ds_read_b128 v[60:63], v3 offset:20480
s_waitcnt lgkmcnt(4)
v_mfma_f32_16x16x32_bf16 v[8:11], a[0:3], v[40:43], 0
v_mfma_f32_16x16x32_bf16 v[12:15], a[0:3], v[44:47], 0
v_mfma_f32_16x16x32_bf16 v[16:19], a[72:75], v[40:43], 0
v_mfma_f32_16x16x32_bf16 v[20:23], a[72:75], v[44:47], 0
v_mfma_f32_16x16x32_bf16 v[24:27], v[40:43], a[144:147], 0
v_mfma_f32_16x16x32_bf16 v[28:31], v[40:43], a[216:219], 0
v_mfma_f32_16x16x32_bf16 v[32:35], v[44:47], a[144:147], 0
v_mfma_f32_16x16x32_bf16 v[36:39], v[44:47], a[216:219], 0
ds_read_b128 v[40:43], v3 offset:3072
ds_read_b128 v[44:47], v3 offset:21504
s_waitcnt lgkmcnt(4)
v_mfma_f32_16x16x32_bf16 v[8:11], a[4:7], v[48:51], v[8:11]
v_mfma_f32_16x16x32_bf16 v[12:15], a[4:7], v[52:55], v[12:15]
v_mfma_f32_16x16x32_bf16 v[16:19], a[76:79], v[48:51], v[16:19]
v_mfma_f32_16x16x32_bf16 v[20:23], a[76:79], v[52:55], v[20:23]
v_mfma_f32_16x16x32_bf16 v[24:27], v[48:51], a[148:151], v[24:27]
v_mfma_f32_16x16x32_bf16 v[28:31], v[48:51], a[220:223], v[28:31]
v_mfma_f32_16x16x32_bf16 v[32:35], v[52:55], a[148:151], v[32:35]
v_mfma_f32_16x16x32_bf16 v[36:39], v[52:55], a[220:223], v[36:39]
ds_read_b128 v[48:51], v3 offset:4096
ds_read_b128 v[52:55], v3 offset:22528
s_waitcnt lgkmcnt(4)
v_mfma_f32_16x16x32_bf16 v[8:11], a[8:11], v[56:59], v[8:11]
v_mfma_f32_16x16x32_bf16 v[12:15], a[8:11], v[60:63], v[12:15]
v_mfma_f32_16x16x32_bf16 v[16:19], a[80:83], v[56:59], v[16:19]
v_mfma_f32_16x16x32_bf16 v[20:23], a[80:83], v[60:63], v[20:23]
v_mfma_f32_16x16x32_bf16 v[24:27], v[56:59], a[152:155], v[24:27]
v_mfma_f32_16x16x32_bf16 v[28:31], v[56:59], a[224:227], v[28:31]
v_mfma_f32_16x16x32_bf16 v[32:35], v[60:63], a[152:155], v[32:35]
v_mfma_f32_16x16x32_bf16 v[36:39], v[60:63], a[224:227], v[36:39]
ds_read_b128 v[56:59], v3 offset:5120
ds_read_b128 v[60:63], v3 offset:23552
s_waitcnt lgkmcnt(4)
v_mfma_f32_16x16x32_bf16 v[8:11], a[12:15], v[40:43], v[8:11]
v_mfma_f32_16x16x32_bf16 v[12:15], a[12:15], v[44:47], v[12:15]
v_mfma_f32_16x16x32_bf16 v[16:19], a[84:87], v[40:43], v[16:19]
v_mfma_f32_16x16x32_bf16 v[20:23], a[84:87], v[44:47], v[20:23]
v_mfma_f32_16x16x32_bf16 v[24:27], v[40:43], a[156:159], v[24:27]
v_mfma_f32_16x16x32_bf16 v[28:31], v[40:43], a[228:231], v[28:31]
v_mfma_f32_16x16x32_bf16 v[32:35], v[44:47], a[156:159], v[32:35]
v_mfma_f32_16x16x32_bf16 v[36:39], v[44:47], a[228:231], v[36:39]
ds_read_b128 v[40:43], v3 offset:6144
ds_read_b128 v[44:47], v3 offset:24576
s_waitcnt lgkmcnt(4)
v_mfma_f32_16x16x32_bf16 v[8:11], a[16:19], v[48:51], v[8:11]
v_mfma_f32_16x16x32_bf16 v[12:15], a[16:19], v[52:55], v[12:15]
v_mfma_f32_16x16x32_bf16 v[16:19], a[88:91], v[48:51], v[16:19]
v_mfma_f32_16x16x32_bf16 v[20:23], a[88:91], v[52:55], v[20:23]
v_mfma_f32_16x16x32_bf16 v[24:27], v[48:51], a[160:163], v[24:27]
v_mfma_f32_16x16x32_bf16 v[28:31], v[48:51], a[232:235], v[28:31]
v_mfma_f32_16x16x32_bf16 v[32:35], v[52:55], a[160:163], v[32:35]
v_mfma_f32_16x16x32_bf16 v[36:39], v[52:55], a[232:235], v[36:39]
ds_read_b128 v[48:51], v3 offset:7168
ds_read_b128 v[52:55], v3 offset:25600
s_waitcnt lgkmcnt(4)
v_mfma_f32_16x16x32_bf16 v[8:11], a[20:23], v[56:59], v[8:11]
v_mfma_f32_16x16x32_bf16 v[12:15], a[20:23], v[60:63], v[12:15]
v_mfma_f32_16x16x32_bf16 v[16:19], a[92:95], v[56:59], v[16:19]
v_mfma_f32_16x16x32_bf16 v[20:23], a[92:95], v[60:63], v[20:23]
v_mfma_f32_16x16x32_bf16 v[24:27], v[56:59], a[164:167], v[24:27]
v_mfma_f32_16x16x32_bf16 v[28:31], v[56:59], a[236:239], v[28:31]
v_mfma_f32_16x16x32_bf16 v[32:35], v[60:63], a[164:167], v[32:35]
v_mfma_f32_16x16x32_bf16 v[36:39], v[60:63], a[236:239], v[36:39]
ds_read_b128 v[56:59], v3 offset:8192
ds_read_b128 v[60:63], v3 offset:26624
s_waitcnt lgkmcnt(4)
v_mfma_f32_16x16x32_bf16 v[8:11], a[24:27], v[40:43], v[8:11]
v_mfma_f32_16x16x32_bf16 v[12:15], a[24:27], v[44:47], v[12:15]
v_mfma_f32_16x16x32_bf16 v[16:19], a[96:99], v[40:43], v[16:19]
v_mfma_f32_16x16x32_bf16 v[20:23], a[96:99], v[44:47], v[20:23]
v_mfma_f32_16x16x32_bf16 v[24:27], v[40:43], a[168:171], v[24:27]
v_mfma_f32_16x16x32_bf16 v[28:31], v[40:43], a[240:243], v[28:31]
v_mfma_f32_16x16x32_bf16 v[32:35], v[44:47], a[168:171], v[32:35]
v_mfma_f32_16x16x32_bf16 v[36:39], v[44:47], a[240:243], v[36:39]
ds_read_b128 v[40:43], v3 offset:9216
ds_read_b128 v[44:47], v3 offset:27648
s_waitcnt lgkmcnt(4)
v_mfma_f32_16x16x32_bf16 v[8:11], a[28:31], v[48:51], v[8:11]
v_mfma_f32_16x16x32_bf16 v[12:15], a[28:31], v[52:55], v[12:15]
v_mfma_f32_16x16x32_bf16 v[16:19], a[100:103], v[48:51], v[16:19]
v_mfma_f32_16x16x32_bf16 v[20:23], a[100:103], v[52:55], v[20:23]
v_mfma_f32_16x16x32_bf16 v[24:27], v[48:51], a[172:175], v[24:27]
v_mfma_f32_16x16x32_bf16 v[28:31], v[48:51], a[244:247], v[28:31]
v_mfma_f32_16x16x32_bf16 v[32:35], v[52:55], a[172:175], v[32:35]
v_mfma_f32_16x16x32_bf16 v[36:39], v[52:55], a[244:247], v[36:39]
ds_read_b128 v[48:51], v3 offset:10240
ds_read_b128 v[52:55], v3 offset:28672
s_waitcnt lgkmcnt(4)
v_mfma_f32_16x16x32_bf16 v[8:11], a[32:35], v[56:59], v[8:11]
v_mfma_f32_16x16x32_bf16 v[12:15], a[32:35], v[60:63], v[12:15]
v_mfma_f32_16x16x32_bf16 v[16:19], a[104:107], v[56:59], v[16:19]
v_mfma_f32_16x16x32_bf16 v[20:23], a[104:107], v[60:63], v[20:23]
v_mfma_f32_16x16x32_bf16 v[24:27], v[56:59], a[176:179], v[24:27]
v_mfma_f32_16x16x32_bf16 v[28:31], v[56:59], a[248:251], v[28:31]
v_mfma_f32_16x16x32_bf16 v[32:35], v[60:63], a[176:179], v[32:35]
v_mfma_f32_16x16x32_bf16 v[36:39], v[60:63], a[248:251], v[36:39]
ds_read_b128 v[56:59], v3 offset:11264
ds_read_b128 v[60:63], v3 offset:29696
s_waitcnt lgkmcnt(4)
v_mfma_f32_16x16x32_bf16 v[8:11], a[36:39], v[40:43], v[8:11]
v_mfma_f32_16x16x32_bf16 v[12:15], a[36:39], v[44:47], v[12:15]
v_mfma_f32_16x16x32_bf16 v[16:19], a[108:111], v[40:43], v[16:19]
v_mfma_f32_16x16x32_bf16 v[20:23], a[108:111], v[44:47], v[20:23]
v_mfma_f32_16x16x32_bf16 v[24:27], v[40:43], a[180:183], v[24:27]
v_mfma_f32_16x16x32_bf16 v[28:31], v[40:43], a[252:255], v[28:31]
v_mfma_f32_16x16x32_bf16 v[32:35], v[44:47], a[180:183], v[32:35]
v_mfma_f32_16x16x32_bf16 v[36:39], v[44:47], a[252:255], v[36:39]
ds_read_b128 v[40:43], v3 offset:12288
ds_read_b128 v[44:47], v3 offset:30720
s_waitcnt lgkmcnt(4)
v_mfma_f32_16x16x32_bf16 v[8:11], a[40:43], v[48:51], v[8:11]
v_mfma_f32_16x16x32_bf16 v[12:15], a[40:43], v[52:55], v[12:15]
v_mfma_f32_16x16x32_bf16 v[16:19], a[112:115], v[48:51], v[16:19]
v_mfma_f32_16x16x32_bf16 v[20:23], a[112:115], v[52:55], v[20:23]
v_mfma_f32_16x16x32_bf16 v[24:27], v[48:51], a[184:187], v[24:27]
v_mfma_f32_16x16x32_bf16 v[28:31], v[48:51], v[224:227], v[28:31]
v_mfma_f32_16x16x32_bf16 v[32:35], v[52:55], a[184:187], v[32:35]
v_mfma_f32_16x16x32_bf16 v[36:39], v[52:55], v[224:227], v[36:39]
ds_read_b128 v[48:51], v3 offset:13312
ds_read_b128 v[52:55], v3 offset:31744
s_waitcnt lgkmcnt(4)
v_mfma_f32_16x16x32_bf16 v[8:11], a[44:47], v[56:59], v[8:11]
v_mfma_f32_16x16x32_bf16 v[12:15], a[44:47], v[60:63], v[12:15]
v_mfma_f32_16x16x32_bf16 v[16:19], a[116:119], v[56:59], v[16:19]
v_mfma_f32_16x16x32_bf16 v[20:23], a[116:119], v[60:63], v[20:23]
v_mfma_f32_16x16x32_bf16 v[24:27], v[56:59], a[188:191], v[24:27]
v_mfma_f32_16x16x32_bf16 v[28:31], v[56:59], v[228:231], v[28:31]
v_mfma_f32_16x16x32_bf16 v[32:35], v[60:63], a[188:191], v[32:35]
v_mfma_f32_16x16x32_bf16 v[36:39], v[60:63], v[228:231], v[36:39]
ds_read_b128 v[56:59], v3 offset:14336
ds_read_b128 v[60:63], v3 offset:32768
s_waitcnt lgkmcnt(4)
v_mfma_f32_16x16x32_bf16 v[8:11], a[48:51], v[40:43], v[8:11]
v_mfma_f32_16x16x32_bf16 v[12:15], a[48:51], v[44:47], v[12:15]
v_mfma_f32_16x16x32_bf16 v[16:19], a[120:123], v[40:43], v[16:19]
v_mfma_f32_16x16x32_bf16 v[20:23], a[120:123], v[44:47], v[20:23]
v_mfma_f32_16x16x32_bf16 v[24:27], v[40:43], a[192:195], v[24:27]
v_mfma_f32_16x16x32_bf16 v[28:31], v[40:43], v[232:235], v[28:31]
v_mfma_f32_16x16x32_bf16 v[32:35], v[44:47], a[192:195], v[32:35]
v_mfma_f32_16x16x32_bf16 v[36:39], v[44:47], v[232:235], v[36:39]
ds_read_b128 v[40:43], v3 offset:15360
ds_read_b128 v[44:47], v3 offset:33792
s_waitcnt lgkmcnt(4)
v_mfma_f32_16x16x32_bf16 v[8:11], a[52:55], v[48:51], v[8:11]
v_mfma_f32_16x16x32_bf16 v[12:15], a[52:55], v[52:55], v[12:15]
v_mfma_f32_16x16x32_bf16 v[16:19], a[124:127], v[48:51], v[16:19]
v_mfma_f32_16x16x32_bf16 v[20:23], a[124:127], v[52:55], v[20:23]
v_mfma_f32_16x16x32_bf16 v[24:27], v[48:51], a[196:199], v[24:27]
v_mfma_f32_16x16x32_bf16 v[28:31], v[48:51], v[236:239], v[28:31]
v_mfma_f32_16x16x32_bf16 v[32:35], v[52:55], a[196:199], v[32:35]
v_mfma_f32_16x16x32_bf16 v[36:39], v[52:55], v[236:239], v[36:39]
ds_read_b128 v[48:51], v3 offset:16384
ds_read_b128 v[52:55], v3 offset:34816
s_waitcnt lgkmcnt(4)
v_mfma_f32_16x16x32_bf16 v[8:11], a[56:59], v[56:59], v[8:11]
v_mfma_f32_16x16x32_bf16 v[12:15], a[56:59], v[60:63], v[12:15]
v_mfma_f32_16x16x32_bf16 v[16:19], a[128:131], v[56:59], v[16:19]
v_mfma_f32_16x16x32_bf16 v[20:23], a[128:131], v[60:63], v[20:23]
v_mfma_f32_16x16x32_bf16 v[24:27], v[56:59], a[200:203], v[24:27]
v_mfma_f32_16x16x32_bf16 v[28:31], v[56:59], v[240:243], v[28:31]
v_mfma_f32_16x16x32_bf16 v[32:35], v[60:63], a[200:203], v[32:35]
v_mfma_f32_16x16x32_bf16 v[36:39], v[60:63], v[240:243], v[36:39]
ds_read_b128 v[56:59], v3 offset:17408
ds_read_b128 v[60:63], v3 offset:35840
s_waitcnt lgkmcnt(4)
v_mfma_f32_16x16x32_bf16 v[8:11], a[60:63], v[40:43], v[8:11]
v_mfma_f32_16x16x32_bf16 v[12:15], a[60:63], v[44:47], v[12:15]
v_mfma_f32_16x16x32_bf16 v[16:19], a[132:135], v[40:43], v[16:19]
v_mfma_f32_16x16x32_bf16 v[20:23], a[132:135], v[44:47], v[20:23]
v_mfma_f32_16x16x32_bf16 v[24:27], v[40:43], a[204:207], v[24:27]
v_mfma_f32_16x16x32_bf16 v[28:31], v[40:43], v[244:247], v[28:31]
v_mfma_f32_16x16x32_bf16 v[32:35], v[44:47], a[204:207], v[32:35]
v_mfma_f32_16x16x32_bf16 v[36:39], v[44:47], v[244:247], v[36:39]
s_waitcnt lgkmcnt(2)
v_mfma_f32_16x16x32_bf16 v[8:11], a[64:67], v[48:51], v[8:11]
v_mfma_f32_16x16x32_bf16 v[12:15], a[64:67], v[52:55], v[12:15]
v_mfma_f32_16x16x32_bf16 v[16:19], a[136:139], v[48:51], v[16:19]
v_mfma_f32_16x16x32_bf16 v[20:23], a[136:139], v[52:55], v[20:23]
v_mfma_f32_16x16x32_bf16 v[24:27], v[48:51], a[208:211], v[24:27]
v_mfma_f32_16x16x32_bf16 v[28:31], v[48:51], v[248:251], v[28:31]
v_mfma_f32_16x16x32_bf16 v[32:35], v[52:55], a[208:211], v[32:35]
v_mfma_f32_16x16x32_bf16 v[36:39], v[52:55], v[248:251], v[36:39]
s_waitcnt lgkmcnt(0)
v_mfma_f32_16x16x32_bf16 v[8:11], a[68:71], v[56:59], v[8:11]
v_mfma_f32_16x16x32_bf16 v[12:15], a[68:71], v[60:63], v[12:15]
v_mfma_f32_16x16x32_bf16 v[16:19], a[140:143], v[56:59], v[16:19]
v_mfma_f32_16x16x32_bf16 v[20:23], a[140:143], v[60:63], v[20:23]
v_mfma_f32_16x16x32_bf16 v[24:27], v[56:59], a[212:215], v[24:27]
v_mfma_f32_16x16x32_bf16 v[28:31], v[56:59], v[252:255], v[28:31]
v_mfma_f32_16x16x32_bf16 v[32:35], v[60:63], a[212:215], v[32:35]
v_mfma_f32_16x16x32_bf16 v[36:39], v[60:63], v[252:255], v[36:39]
s_lshl_b32 s35, s24, 5
s_add_u32 s35, s35, s16
s_lshl_b32 s35, s35, 14
s_add_u32 s35, s35, 1048576
s_lshl_b32 s36, s17, 10
s_add_u32 s36, s36, s35
s_lshl_b32 s37, s17, 11
s_add_u32 s37, s37, s35
s_add_u32 s37, s37, 8192
s_nop 4
v_cvt_pk_bf16_f32 v64, v8, v9
v_cvt_pk_bf16_f32 v65, v10, v11
v_cvt_pk_bf16_f32 v66, v16, v17
v_cvt_pk_bf16_f32 v67, v18, v19
s_add_u32 s38, s36, 0
buffer_store_dwordx4 v[64:67], v0, s[8:11], s38 offen sc1
v_cvt_pk_bf16_f32 v68, v12, v13
v_cvt_pk_bf16_f32 v69, v14, v15
v_cvt_pk_bf16_f32 v70, v20, v21
v_cvt_pk_bf16_f32 v71, v22, v23
s_add_u32 s38, s36, 4096
buffer_store_dwordx4 v[68:71], v0, s[8:11], s38 offen sc1
v_cvt_pk_bf16_f32 v72, v24, v25
v_cvt_pk_bf16_f32 v73, v26, v27
v_cvt_pk_bf16_f32 v74, v32, v33
v_cvt_pk_bf16_f32 v75, v34, v35
buffer_store_dwordx4 v[72:75], v0, s[8:11], s37 offen offset:0 sc1
v_cvt_pk_bf16_f32 v76, v28, v29
v_cvt_pk_bf16_f32 v77, v30, v31
v_cvt_pk_bf16_f32 v78, v36, v37
v_cvt_pk_bf16_f32 v79, v38, v39
buffer_store_dwordx4 v[76:79], v0, s[8:11], s37 offen offset:1024 sc1
s_xor_b32 s26, s26, 36864
s_add_u32 s34, s34, 1
s_add_u32 s24, s24, 7
s_cmp_lt_u32 s24, 64
s_cbranch_scc1 PL_6
s_waitcnt vmcnt(0)
s_barrier
s_cmp_eq_u32 s17, 0
s_cbranch_scc0 PE_8
s_add_u32 s41, s7, 16
v_mov_b32 v3, s41
v_mov_b32 v4, 0
s_mov_b64 exec, 1
buffer_store_dword v3, v4, s[8:11], s39 offen sc1
s_mov_b64 exec, -1
PE_8:
s_cmp_eq_u32 s50, 2
s_cbranch_scc1 K_WB1
s_branch K_B2
K_AP:
s_lshl_b32 s28, s16, 8
s_load_dwordx2 s[4:5], s[0:1], 24
s_waitcnt lgkmcnt(0)
s_add_u32 s52, s4, s28
s_addc_u32 s53, s5, 0
s_sub_u32 s54, 4718592, s28
s_mov_b32 s55, 0x00020000
s_load_dwordx2 s[4:5], s[0:1], 32
s_waitcnt lgkmcnt(0)
s_add_u32 s56, s4, s28
s_addc_u32 s57, s5, 0
s_sub_u32 s58, 4718592, s28
s_mov_b32 s59, 0x00020000
s_load_dwordx2 s[4:5], s[0:1], 16
s_waitcnt lgkmcnt(0)
s_add_u32 s84, s4, s28
s_addc_u32 s85, s5, 0
s_sub_u32 s86, 4718592, s28
s_mov_b32 s87, 0x00020000
v_lshrrev_b32 v24, 8, v0
v_and_b32 v25, 1, v24
s_lshl_b32 s28, s17, 1
v_or_b32 v25, s28, v25
v_bfe_u32 v26, v0, 5, 3
v_xor_b32 v26, v26, v25
v_lshlrev_b32 v26, 5, v26
v_lshl_add_u32 v26, v24, 13, v26
v_and_b32 v27, 16, v0
v_add_u32 v23, v26, v27
s_lshl_b32 s28, s17, 15
s_add_u32 s28, s28, 0
s_lshl_b32 s29, s17, 10
s_add_u32 s29, s29, 0
s_mov_b32 s30, 0
DM_11:
s_mov_b32 m0, s29
s_add_u32 s29, s29, 4096
buffer_load_dwordx4 v23, s[52:55], s28 offen lds
s_add_u32 s28, s28, 131072
s_add_u32 s30, s30, 1
s_cmp_lt_u32 s30, 20
s_cbranch_scc1 DM_11
s_lshl_b32 s28, s17, 15
s_add_u32 s28, s28, 2621440
s_lshl_b32 s29, s17, 10
s_add_u32 s29, s29, 81920
s_mov_b32 s30, 0
DM_12:
s_mov_b32 m0, s29
s_add_u32 s29, s29, 4096
buffer_load_dwordx4 v23, s[52:55], s28 offen lds
s_add_u32 s28, s28, 131072
s_add_u32 s30, s30, 1
s_cmp_lt_u32 s30, 16
s_cbranch_scc1 DM_12
s_waitcnt vmcnt(16)
s_barrier
v_lshrrev_b32 v24, 8, v0
v_bfe_u32 v25, v0, 6, 2
v_bfe_u32 v26, v0, 4, 2
v_lshl_add_u32 v27, v24, 3, v25
v_lshlrev_b32 v27, 8, v27
v_lshl_add_u32 v27, v26, 3, v27
v_add_u32 v27, 0, v27
v_and_b32 v28, 1, v25
v_and_b32 v29, 1, v24
v_lshl_add_u32 v28, v29, 2, v28
v_or_b32 v29, 2, v28
s_lshl_b32 s28, s17, 1
s_add_u32 s29, s28, 0
v_xor_b32 v30, s29, v28
v_lshl_add_u32 v30, v30, 5, v27
v_xor_b32 v31, s29, v29
v_lshl_add_u32 v31, v31, 5, v27
v_add_u32 v31, 1024, v31
ds_read_b64_tr_b16 a[144:145], v30 offset:0
ds_read_b64_tr_b16 a[146:147], v31 offset:0
ds_read_b64_tr_b16 a[148:149], v30 offset:8192
ds_read_b64_tr_b16 a[150:151], v31 offset:8192
ds_read_b64_tr_b16 a[152:153], v30 offset:16384
ds_read_b64_tr_b16 a[154:155], v31 offset:16384
ds_read_b64_tr_b16 a[156:157], v30 offset:24576
ds_read_b64_tr_b16 a[158:159], v31 offset:24576
ds_read_b64_tr_b16 a[160:161], v30 offset:32768
ds_read_b64_tr_b16 a[162:163], v31 offset:32768
ds_read_b64_tr_b16 a[164:165], v30 offset:40960
ds_read_b64_tr_b16 a[166:167], v31 offset:40960
ds_read_b64_tr_b16 a[168:169], v30 offset:49152
ds_read_b64_tr_b16 a[170:171], v31 offset:49152
ds_read_b64_tr_b16 a[172:173], v30 offset:57344
ds_read_b64_tr_b16 a[174:175], v31 offset:57344
s_waitcnt lgkmcnt(0)
v_add_u32 v30, 65536, v30
v_add_u32 v31, 65536, v31
ds_read_b64_tr_b16 a[176:177], v30 offset:0
ds_read_b64_tr_b16 a[178:179], v31 offset:0
ds_read_b64_tr_b16 a[180:181], v30 offset:8192
ds_read_b64_tr_b16 a[182:183], v31 offset:8192
s_waitcnt lgkmcnt(0)
s_add_u32 s29, s28, 1
v_xor_b32 v30, s29, v28
v_lshl_add_u32 v30, v30, 5, v27
v_xor_b32 v31, s29, v29
v_lshl_add_u32 v31, v31, 5, v27
v_add_u32 v31, 1024, v31
ds_read_b64_tr_b16 a[216:217], v30 offset:0
ds_read_b64_tr_b16 a[218:219], v31 offset:0
ds_read_b64_tr_b16 a[220:221], v30 offset:8192
ds_read_b64_tr_b16 a[222:223], v31 offset:8192
ds_read_b64_tr_b16 a[224:225], v30 offset:16384
ds_read_b64_tr_b16 a[226:227], v31 offset:16384
ds_read_b64_tr_b16 a[228:229], v30 offset:24576
ds_read_b64_tr_b16 a[230:231], v31 offset:24576
ds_read_b64_tr_b16 a[232:233], v30 offset:32768
ds_read_b64_tr_b16 a[234:235], v31 offset:32768
ds_read_b64_tr_b16 a[236:237], v30 offset:40960
ds_read_b64_tr_b16 a[238:239], v31 offset:40960
ds_read_b64_tr_b16 a[240:241], v30 offset:49152
ds_read_b64_tr_b16 a[242:243], v31 offset:49152
ds_read_b64_tr_b16 a[244:245], v30 offset:57344
ds_read_b64_tr_b16 a[246:247], v31 offset:57344
s_waitcnt lgkmcnt(0)
v_add_u32 v30, 65536, v30
v_add_u32 v31, 65536, v31
ds_read_b64_tr_b16 a[248:249], v30 offset:0
ds_read_b64_tr_b16 a[250:251], v31 offset:0
ds_read_b64_tr_b16 a[252:253], v30 offset:8192
ds_read_b64_tr_b16 a[254:255], v31 offset:8192
s_waitcnt lgkmcnt(0)
s_waitcnt lgkmcnt(0)
s_barrier
s_lshl_b32 s28, s17, 15
s_add_u32 s28, s28, 0
s_lshl_b32 s29, s17, 10
s_add_u32 s29, s29, 0
s_mov_b32 s30, 0
DM_13:
s_mov_b32 m0, s29
s_add_u32 s29, s29, 4096
buffer_load_dwordx4 v23, s[56:59], s28 offen lds
s_add_u32 s28, s28, 131072
s_add_u32 s30, s30, 1
s_cmp_lt_u32 s30, 20
s_cbranch_scc1 DM_13
s_waitcnt vmcnt(20)
s_barrier
v_lshrrev_b32 v24, 8, v0
v_bfe_u32 v25, v0, 6, 2
v_bfe_u32 v26, v0, 4, 2
v_lshl_add_u32 v27, v24, 3, v25
v_lshlrev_b32 v27, 8, v27
v_lshl_add_u32 v27, v26, 3, v27
v_add_u32 v27, 81920, v27
v_and_b32 v28, 1, v25
v_and_b32 v29, 1, v24
v_lshl_add_u32 v28, v29, 2, v28
v_or_b32 v29, 2, v28
s_lshl_b32 s28, s17, 1
s_add_u32 s29, s28, 0
v_xor_b32 v30, s29, v28
v_lshl_add_u32 v30, v30, 5, v27
v_xor_b32 v31, s29, v29
v_lshl_add_u32 v31, v31, 5, v27
v_add_u32 v31, 1024, v31
ds_read_b64_tr_b16 a[184:185], v30 offset:0
ds_read_b64_tr_b16 a[186:187], v31 offset:0
ds_read_b64_tr_b16 a[188:189], v30 offset:8192
ds_read_b64_tr_b16 a[190:191], v31 offset:8192
ds_read_b64_tr_b16 a[192:193], v30 offset:16384
ds_read_b64_tr_b16 a[194:195], v31 offset:16384
ds_read_b64_tr_b16 a[196:197], v30 offset:24576
ds_read_b64_tr_b16 a[198:199], v31 offset:24576
ds_read_b64_tr_b16 a[200:201], v30 offset:32768
ds_read_b64_tr_b16 a[202:203], v31 offset:32768
ds_read_b64_tr_b16 a[204:205], v30 offset:40960
ds_read_b64_tr_b16 a[206:207], v31 offset:40960
ds_read_b64_tr_b16 a[208:209], v30 offset:49152
ds_read_b64_tr_b16 a[210:211], v31 offset:49152
ds_read_b64_tr_b16 a[212:213], v30 offset:57344
ds_read_b64_tr_b16 a[214:215], v31 offset:57344
s_waitcnt lgkmcnt(0)
s_add_u32 s29, s28, 1
v_xor_b32 v30, s29, v28
v_lshl_add_u32 v30, v30, 5, v27
v_xor_b32 v31, s29, v29
v_lshl_add_u32 v31, v31, 5, v27
v_add_u32 v31, 1024, v31
ds_read_b64_tr_b16 v[80:81], v30 offset:0
ds_read_b64_tr_b16 v[82:83], v31 offset:0
ds_read_b64_tr_b16 v[84:85], v30 offset:8192
ds_read_b64_tr_b16 v[86:87], v31 offset:8192
ds_read_b64_tr_b16 v[88:89], v30 offset:16384
ds_read_b64_tr_b16 v[90:91], v31 offset:16384
ds_read_b64_tr_b16 v[92:93], v30 offset:24576
ds_read_b64_tr_b16 v[94:95], v31 offset:24576
ds_read_b64_tr_b16 v[96:97], v30 offset:32768
ds_read_b64_tr_b16 v[98:99], v31 offset:32768
ds_read_b64_tr_b16 v[100:101], v30 offset:40960
ds_read_b64_tr_b16 v[102:103], v31 offset:40960
ds_read_b64_tr_b16 v[104:105], v30 offset:49152
ds_read_b64_tr_b16 v[106:107], v31 offset:49152
ds_read_b64_tr_b16 v[108:109], v30 offset:57344
ds_read_b64_tr_b16 v[110:111], v31 offset:57344
s_waitcnt lgkmcnt(0)
s_waitcnt lgkmcnt(0)
s_barrier
s_lshl_b32 s28, s17, 15
s_add_u32 s28, s28, 2621440
s_lshl_b32 s29, s17, 10
s_add_u32 s29, s29, 81920
s_mov_b32 s30, 0
DM_14:
s_mov_b32 m0, s29
s_add_u32 s29, s29, 4096
buffer_load_dwordx4 v23, s[56:59], s28 offen lds
s_add_u32 s28, s28, 131072
s_add_u32 s30, s30, 1
s_cmp_lt_u32 s30, 16
s_cbranch_scc1 DM_14
s_waitcnt vmcnt(16)
s_barrier
v_lshrrev_b32 v24, 8, v0
v_bfe_u32 v25, v0, 6, 2
v_bfe_u32 v26, v0, 4, 2
v_lshl_add_u32 v27, v24, 3, v25
v_lshlrev_b32 v27, 8, v27
v_lshl_add_u32 v27, v26, 3, v27
v_add_u32 v27, 0, v27
v_and_b32 v28, 1, v25
v_and_b32 v29, 1, v24
v_lshl_add_u32 v28, v29, 2, v28
v_or_b32 v29, 2, v28
s_lshl_b32 s28, s17, 1
s_add_u32 s29, s28, 0
v_xor_b32 v30, s29, v28
v_lshl_add_u32 v30, v30, 5, v27
v_xor_b32 v31, s29, v29
v_lshl_add_u32 v31, v31, 5, v27
v_add_u32 v31, 1024, v31
ds_read_b64_tr_b16 v[112:113], v30 offset:0
ds_read_b64_tr_b16 v[114:115], v31 offset:0
ds_read_b64_tr_b16 v[116:117], v30 offset:8192
ds_read_b64_tr_b16 v[118:119], v31 offset:8192
ds_read_b64_tr_b16 v[120:121], v30 offset:16384
ds_read_b64_tr_b16 v[122:123], v31 offset:16384
ds_read_b64_tr_b16 v[124:125], v30 offset:24576
ds_read_b64_tr_b16 v[126:127], v31 offset:24576
ds_read_b64_tr_b16 v[128:129], v30 offset:32768
ds_read_b64_tr_b16 v[130:131], v31 offset:32768
ds_read_b64_tr_b16 v[132:133], v30 offset:40960
ds_read_b64_tr_b16 v[134:135], v31 offset:40960
ds_read_b64_tr_b16 v[136:137], v30 offset:49152
ds_read_b64_tr_b16 v[138:139], v31 offset:49152
ds_read_b64_tr_b16 v[140:141], v30 offset:57344
ds_read_b64_tr_b16 v[142:143], v31 offset:57344
s_waitcnt lgkmcnt(0)
v_add_u32 v30, 65536, v30
v_add_u32 v31, 65536, v31
ds_read_b64_tr_b16 v[144:145], v30 offset:0
ds_read_b64_tr_b16 v[146:147], v31 offset:0
ds_read_b64_tr_b16 v[148:149], v30 offset:8192
ds_read_b64_tr_b16 v[150:151], v31 offset:8192
s_waitcnt lgkmcnt(0)
s_add_u32 s29, s28, 1
v_xor_b32 v30, s29, v28
v_lshl_add_u32 v30, v30, 5, v27
v_xor_b32 v31, s29, v29
v_lshl_add_u32 v31, v31, 5, v27
v_add_u32 v31, 1024, v31
ds_read_b64_tr_b16 v[184:185], v30 offset:0
ds_read_b64_tr_b16 v[186:187], v31 offset:0
ds_read_b64_tr_b16 v[188:189], v30 offset:8192
ds_read_b64_tr_b16 v[190:191], v31 offset:8192
ds_read_b64_tr_b16 v[192:193], v30 offset:16384
ds_read_b64_tr_b16 v[194:195], v31 offset:16384
ds_read_b64_tr_b16 v[196:197], v30 offset:24576
ds_read_b64_tr_b16 v[198:199], v31 offset:24576
ds_read_b64_tr_b16 v[200:201], v30 offset:32768
ds_read_b64_tr_b16 v[202:203], v31 offset:32768
ds_read_b64_tr_b16 v[204:205], v30 offset:40960
ds_read_b64_tr_b16 v[206:207], v31 offset:40960
ds_read_b64_tr_b16 v[208:209], v30 offset:49152
ds_read_b64_tr_b16 v[210:211], v31 offset:49152
ds_read_b64_tr_b16 v[212:213], v30 offset:57344
ds_read_b64_tr_b16 v[214:215], v31 offset:57344
s_waitcnt lgkmcnt(0)
v_add_u32 v30, 65536, v30
v_add_u32 v31, 65536, v31
ds_read_b64_tr_b16 v[216:217], v30 offset:0
ds_read_b64_tr_b16 v[218:219], v31 offset:0
ds_read_b64_tr_b16 v[220:221], v30 offset:8192
ds_read_b64_tr_b16 v[222:223], v31 offset:8192
s_waitcnt lgkmcnt(0)
s_waitcnt lgkmcnt(0)
s_barrier
s_lshl_b32 s28, s17, 15
s_add_u32 s28, s28, 0
s_lshl_b32 s29, s17, 10
s_add_u32 s29, s29, 0
s_mov_b32 s30, 0
DM_15:
s_mov_b32 m0, s29
s_add_u32 s29, s29, 4096
buffer_load_dwordx4 v23, s[84:87], s28 offen lds
s_add_u32 s28, s28, 131072
s_add_u32 s30, s30, 1
s_cmp_lt_u32 s30, 20
s_cbranch_scc1 DM_15
s_waitcnt vmcnt(20)
s_barrier
v_lshrrev_b32 v24, 8, v0
v_bfe_u32 v25, v0, 6, 2
v_bfe_u32 v26, v0, 4, 2
v_lshl_add_u32 v27, v24, 3, v25
v_lshlrev_b32 v27, 8, v27
v_lshl_add_u32 v27, v26, 3, v27
v_add_u32 v27, 81920, v27
v_and_b32 v28, 1, v25
v_and_b32 v29, 1, v24
v_lshl_add_u32 v28, v29, 2, v28
v_or_b32 v29, 2, v28
s_lshl_b32 s28, s17, 1
s_add_u32 s29, s28, 0
v_xor_b32 v30, s29, v28
v_lshl_add_u32 v30, v30, 5, v27
v_xor_b32 v31, s29, v29
v_lshl_add_u32 v31, v31, 5, v27
v_add_u32 v31, 1024, v31
ds_read_b64_tr_b16 v[152:153], v30 offset:0
ds_read_b64_tr_b16 v[154:155], v31 offset:0
ds_read_b64_tr_b16 v[156:157], v30 offset:8192
ds_read_b64_tr_b16 v[158:159], v31 offset:8192
ds_read_b64_tr_b16 v[160:161], v30 offset:16384
ds_read_b64_tr_b16 v[162:163], v31 offset:16384
ds_read_b64_tr_b16 v[164:165], v30 offset:24576
ds_read_b64_tr_b16 v[166:167], v31 offset:24576
ds_read_b64_tr_b16 v[168:169], v30 offset:32768
ds_read_b64_tr_b16 v[170:171], v31 offset:32768
ds_read_b64_tr_b16 v[172:173], v30 offset:40960
ds_read_b64_tr_b16 v[174:175], v31 offset:40960
ds_read_b64_tr_b16 v[176:177], v30 offset:49152
ds_read_b64_tr_b16 v[178:179], v31 offset:49152
ds_read_b64_tr_b16 v[180:181], v30 offset:57344
ds_read_b64_tr_b16 v[182:183], v31 offset:57344
s_waitcnt lgkmcnt(0)
s_add_u32 s29, s28, 1
v_xor_b32 v30, s29, v28
v_lshl_add_u32 v30, v30, 5, v27
v_xor_b32 v31, s29, v29
v_lshl_add_u32 v31, v31, 5, v27
v_add_u32 v31, 1024, v31
ds_read_b64_tr_b16 v[224:225], v30 offset:0
ds_read_b64_tr_b16 v[226:227], v31 offset:0
ds_read_b64_tr_b16 v[228:229], v30 offset:8192
ds_read_b64_tr_b16 v[230:231], v31 offset:8192
ds_read_b64_tr_b16 v[232:233], v30 offset:16384
ds_read_b64_tr_b16 v[234:235], v31 offset:16384
ds_read_b64_tr_b16 v[236:237], v30 offset:24576
ds_read_b64_tr_b16 v[238:239], v31 offset:24576
ds_read_b64_tr_b16 v[240:241], v30 offset:32768
ds_read_b64_tr_b16 v[242:243], v31 offset:32768
ds_read_b64_tr_b16 v[244:245], v30 offset:40960
ds_read_b64_tr_b16 v[246:247], v31 offset:40960
ds_read_b64_tr_b16 v[248:249], v30 offset:49152
ds_read_b64_tr_b16 v[250:251], v31 offset:49152
ds_read_b64_tr_b16 v[252:253], v30 offset:57344
ds_read_b64_tr_b16 v[254:255], v31 offset:57344
s_waitcnt lgkmcnt(0)
s_waitcnt lgkmcnt(0)
s_barrier
s_lshl_b32 s28, s17, 15
s_add_u32 s28, s28, 2621440
s_lshl_b32 s29, s17, 10
s_add_u32 s29, s29, 81920
s_mov_b32 s30, 0
DM_16:
s_mov_b32 m0, s29
s_add_u32 s29, s29, 4096
buffer_load_dwordx4 v23, s[84:87], s28 offen lds
s_add_u32 s28, s28, 131072
s_add_u32 s30, s30, 1
s_cmp_lt_u32 s30, 16
s_cbranch_scc1 DM_16
s_waitcnt vmcnt(16)
s_barrier
v_lshrrev_b32 v24, 8, v0
v_bfe_u32 v25, v0, 6, 2
v_bfe_u32 v26, v0, 4, 2
v_lshl_add_u32 v27, v24, 3, v25
v_lshlrev_b32 v27, 8, v27
v_lshl_add_u32 v27, v26, 3, v27
v_add_u32 v27, 0, v27
v_and_b32 v28, 1, v25
v_and_b32 v29, 1, v24
v_lshl_add_u32 v28, v29, 2, v28
v_or_b32 v29, 2, v28
s_lshl_b32 s28, s17, 1
s_add_u32 s29, s28, 0
v_xor_b32 v30, s29, v28
v_lshl_add_u32 v30, v30, 5, v27
v_xor_b32 v31, s29, v29
v_lshl_add_u32 v31, v31, 5, v27
v_add_u32 v31, 1024, v31
ds_read_b64_tr_b16 a[0:1], v30 offset:0
ds_read_b64_tr_b16 a[2:3], v31 offset:0
ds_read_b64_tr_b16 a[4:5], v30 offset:8192
ds_read_b64_tr_b16 a[6:7], v31 offset:8192
ds_read_b64_tr_b16 a[8:9], v30 offset:16384
ds_read_b64_tr_b16 a[10:11], v31 offset:16384
ds_read_b64_tr_b16 a[12:13], v30 offset:24576
ds_read_b64_tr_b16 a[14:15], v31 offset:24576
ds_read_b64_tr_b16 a[16:17], v30 offset:32768
ds_read_b64_tr_b16 a[18:19], v31 offset:32768
ds_read_b64_tr_b16 a[20:21], v30 offset:40960
ds_read_b64_tr_b16 a[22:23], v31 offset:40960
ds_read_b64_tr_b16 a[24:25], v30 offset:49152
ds_read_b64_tr_b16 a[26:27], v31 offset:49152
ds_read_b64_tr_b16 a[28:29], v30 offset:57344
ds_read_b64_tr_b16 a[30:31], v31 offset:57344
s_waitcnt lgkmcnt(0)
v_add_u32 v30, 65536, v30
v_add_u32 v31, 65536, v31
ds_read_b64_tr_b16 a[32:33], v30 offset:0
ds_read_b64_tr_b16 a[34:35], v31 offset:0
ds_read_b64_tr_b16 a[36:37], v30 offset:8192
ds_read_b64_tr_b16 a[38:39], v31 offset:8192
s_waitcnt lgkmcnt(0)
s_add_u32 s29, s28, 1
v_xor_b32 v30, s29, v28
v_lshl_add_u32 v30, v30, 5, v27
v_xor_b32 v31, s29, v29
v_lshl_add_u32 v31, v31, 5, v27
v_add_u32 v31, 1024, v31
ds_read_b64_tr_b16 a[72:73], v30 offset:0
ds_read_b64_tr_b16 a[74:75], v31 offset:0
ds_read_b64_tr_b16 a[76:77], v30 offset:8192
ds_read_b64_tr_b16 a[78:79], v31 offset:8192
ds_read_b64_tr_b16 a[80:81], v30 offset:16384
ds_read_b64_tr_b16 a[82:83], v31 offset:16384
ds_read_b64_tr_b16 a[84:85], v30 offset:24576
ds_read_b64_tr_b16 a[86:87], v31 offset:24576
ds_read_b64_tr_b16 a[88:89], v30 offset:32768
ds_read_b64_tr_b16 a[90:91], v31 offset:32768
ds_read_b64_tr_b16 a[92:93], v30 offset:40960
ds_read_b64_tr_b16 a[94:95], v31 offset:40960
ds_read_b64_tr_b16 a[96:97], v30 offset:49152
ds_read_b64_tr_b16 a[98:99], v31 offset:49152
ds_read_b64_tr_b16 a[100:101], v30 offset:57344
ds_read_b64_tr_b16 a[102:103], v31 offset:57344
s_waitcnt lgkmcnt(0)
v_add_u32 v30, 65536, v30
v_add_u32 v31, 65536, v31
ds_read_b64_tr_b16 a[104:105], v30 offset:0
ds_read_b64_tr_b16 a[106:107], v31 offset:0
ds_read_b64_tr_b16 a[108:109], v30 offset:8192
ds_read_b64_tr_b16 a[110:111], v31 offset:8192
s_waitcnt lgkmcnt(0)
s_waitcnt lgkmcnt(0)
s_barrier
s_waitcnt vmcnt(0)
s_barrier
v_lshrrev_b32 v24, 8, v0
v_bfe_u32 v25, v0, 6, 2
v_bfe_u32 v26, v0, 4, 2
v_lshl_add_u32 v27, v24, 3, v25
v_lshlrev_b32 v27, 8, v27
v_lshl_add_u32 v27, v26, 3, v27
v_add_u32 v27, 81920, v27
v_and_b32 v28, 1, v25
v_and_b32 v29, 1, v24
v_lshl_add_u32 v28, v29, 2, v28
v_or_b32 v29, 2, v28
s_lshl_b32 s28, s17, 1
s_add_u32 s29, s28, 0
v_xor_b32 v30, s29, v28
v_lshl_add_u32 v30, v30, 5, v27
v_xor_b32 v31, s29, v29
v_lshl_add_u32 v31, v31, 5, v27
v_add_u32 v31, 1024, v31
ds_read_b64_tr_b16 a[40:41], v30 offset:0
ds_read_b64_tr_b16 a[42:43], v31 offset:0
ds_read_b64_tr_b16 a[44:45], v30 offset:8192
ds_read_b64_tr_b16 a[46:47], v31 offset:8192
ds_read_b64_tr_b16 a[48:49], v30 offset:16384
ds_read_b64_tr_b16 a[50:51], v31 offset:16384
ds_read_b64_tr_b16 a[52:53], v30 offset:24576
ds_read_b64_tr_b16 a[54:55], v31 offset:24576
ds_read_b64_tr_b16 a[56:57], v30 offset:32768
ds_read_b64_tr_b16 a[58:59], v31 offset:32768
ds_read_b64_tr_b16 a[60:61], v30 offset:40960
ds_read_b64_tr_b16 a[62:63], v31 offset:40960
ds_read_b64_tr_b16 a[64:65], v30 offset:49152
ds_read_b64_tr_b16 a[66:67], v31 offset:49152
ds_read_b64_tr_b16 a[68:69], v30 offset:57344
ds_read_b64_tr_b16 a[70:71], v31 offset:57344
s_waitcnt lgkmcnt(0)
s_add_u32 s29, s28, 1
v_xor_b32 v30, s29, v28
v_lshl_add_u32 v30, v30, 5, v27
v_xor_b32 v31, s29, v29
v_lshl_add_u32 v31, v31, 5, v27
v_add_u32 v31, 1024, v31
ds_read_b64_tr_b16 a[112:113], v30 offset:0
ds_read_b64_tr_b16 a[114:115], v31 offset:0
ds_read_b64_tr_b16 a[116:117], v30 offset:8192
ds_read_b64_tr_b16 a[118:119], v31 offset:8192
ds_read_b64_tr_b16 a[120:121], v30 offset:16384
ds_read_b64_tr_b16 a[122:123], v31 offset:16384
ds_read_b64_tr_b16 a[124:125], v30 offset:24576
ds_read_b64_tr_b16 a[126:127], v31 offset:24576
ds_read_b64_tr_b16 a[128:129], v30 offset:32768
ds_read_b64_tr_b16 a[130:131], v31 offset:32768
ds_read_b64_tr_b16 a[132:133], v30 offset:40960
ds_read_b64_tr_b16 a[134:135], v31 offset:40960
ds_read_b64_tr_b16 a[136:137], v30 offset:49152
ds_read_b64_tr_b16 a[138:139], v31 offset:49152
ds_read_b64_tr_b16 a[140:141], v30 offset:57344
ds_read_b64_tr_b16 a[142:143], v31 offset:57344
s_waitcnt lgkmcnt(0)
s_waitcnt lgkmcnt(0)
s_barrier
v_mov_b32 v3, 0
s_mov_b32 s35, 4000000
NW_17:
buffer_load_dword v2, v3, s[88:91], 0 offen offset:128 sc1
s_waitcnt vmcnt(0)
v_readfirstlane_b32 s7, v2
s_cmp_lg_u32 s7, 0
s_cbranch_scc1 NW_17k
s_sub_u32 s35, s35, 1
s_cbranch_scc1 K_END
s_sleep 2
s_branch NW_17
NW_17k:
s_load_dwordx2 s[4:5], s[0:1], 0
s_waitcnt lgkmcnt(0)
s_mov_b32 s20, s4
s_mov_b32 s21, s5
s_mov_b32 s22, 2359296
s_mov_b32 s23, 0x00020000
v_bfe_u32 v2, v0, 4, 4
v_mul_u32_u24 v2, 1152, v2
v_lshrrev_b32 v3, 8, v0
v_lshl_add_u32 v2, v3, 4, v2
s_mov_b32 s24, s50
s_mul_i32 s25, s24, 36864
s_mov_b32 s26, 0
s_mul_i32 s28, s17, 576
s_cmp_ge_u32 s17, 2
s_cselect_b32 s29, 17280, 0
s_add_u32 s28, s28, s29
s_add_u32 s28, s28, s25
s_mul_i32 s29, s17, 9216
s_add_u32 m0, s29, s26
s_nop 0
buffer_load_dwordx4 v2, s[20:23], s28 offen offset:0 lds
s_add_u32 m0, m0, 960
s_nop 0
buffer_load_dwordx4 v2, s[20:23], s28 offen offset:64 lds
s_add_u32 m0, m0, 960
s_nop 0
buffer_load_dwordx4 v2, s[20:23], s28 offen offset:128 lds
s_add_u32 m0, m0, 960
s_nop 0
buffer_load_dwordx4 v2, s[20:23], s28 offen offset:192 lds
s_add_u32 m0, m0, 960
s_nop 0
buffer_load_dwordx4 v2, s[20:23], s28 offen offset:256 lds
s_add_u32 m0, m0, 960
s_nop 0
buffer_load_dwordx4 v2, s[20:23], s28 offen offset:320 lds
s_add_u32 m0, m0, 960
s_nop 0
buffer_load_dwordx4 v2, s[20:23], s28 offen offset:384 lds
s_add_u32 m0, m0, 960
s_nop 0
buffer_load_dwordx4 v2, s[20:23], s28 offen offset:448 lds
s_add_u32 m0, m0, 960
s_nop 0
buffer_load_dwordx4 v2, s[20:23], s28 offen offset:512 lds
s_mov_b32 s34, 0
s_waitcnt vmcnt(0)
s_lshl_b32 s39, s16, 5
s_lshl_b32 s41, s50, 2
s_add_u32 s39, s39, s41
s_add_u32 s39, s39, 819200
PL_18:
s_cmp_eq_u32 s34, 1
s_cbranch_scc0 PW0_21
s_waitcnt vmcnt(0)
PW0_21:
s_waitcnt vmcnt(4)
s_barrier
s_cmp_ge_u32 s34, 1
s_cbranch_scc0 PNF_22
s_cmp_eq_u32 s17, 0
s_cbranch_scc0 PNF_22
s_add_u32 s41, s34, s7
s_sub_u32 s41, s41, 1
s_cmp_eq_u32 s34, 1
s_cselect_b32 s40, 1, 0
s_add_u32 s41, s41, s40
v_mov_b32 v4, s41
v_mov_b32 v5, 0
s_mov_b64 exec, 1
buffer_store_dword v4, v5, s[8:11], s39 offen sc1
s_mov_b64 exec, -1
PNF_22:
s_add_u32 s35, s24, 7
s_cmp_lt_u32 s35, 64
s_cbranch_scc0 PN_19
s_mul_i32 s25, s35, 36864
s_xor_b32 s36, s26, 36864
s_mul_i32 s28, s17, 576
s_cmp_ge_u32 s17, 2
s_cselect_b32 s29, 17280, 0
s_add_u32 s28, s28, s29
s_add_u32 s28, s28, s25
s_mul_i32 s29, s17, 9216
s_add_u32 m0, s29, s36
s_nop 0
buffer_load_dwordx4 v2, s[20:23], s28 offen offset:0 lds
s_add_u32 m0, m0, 960
s_nop 0
buffer_load_dwordx4 v2, s[20:23], s28 offen offset:64 lds
s_add_u32 m0, m0, 960
s_nop 0
buffer_load_dwordx4 v2, s[20:23], s28 offen offset:128 lds
s_add_u32 m0, m0, 960
s_nop 0
buffer_load_dwordx4 v2, s[20:23], s28 offen offset:192 lds
s_add_u32 m0, m0, 960
s_nop 0
buffer_load_dwordx4 v2, s[20:23], s28 offen offset:256 lds
s_add_u32 m0, m0, 960
s_nop 0
buffer_load_dwordx4 v2, s[20:23], s28 offen offset:320 lds
s_add_u32 m0, m0, 960
s_nop 0
buffer_load_dwordx4 v2, s[20:23], s28 offen offset:384 lds
s_add_u32 m0, m0, 960
s_nop 0
buffer_load_dwordx4 v2, s[20:23], s28 offen offset:448 lds
s_add_u32 m0, m0, 960
s_nop 0
buffer_load_dwordx4 v2, s[20:23], s28 offen offset:512 lds
PN_19:
v_add_u32 v3, s26, v0
ds_read_b128 v[40:43], v3 offset:0
ds_read_b128 v[44:47], v3 offset:18432
ds_read_b128 v[48:51], v3 offset:1024
ds_read_b128 v[52:55], v3 offset:19456
ds_read_b128 v[56:59], v3 offset:2048
ds_read_b128 v[60:63], v3 offset:20480
s_waitcnt lgkmcnt(4)
v_mfma_f32_16x16x32_bf16 v[8:11], a[144:147], v[40:43], 0
v_mfma_f32_16x16x32_bf16 v[12:15], a[144:147], v[44:47], 0
v_mfma_f32_16x16x32_bf16 v[16:19], a[216:219], v[40:43], 0
v_mfma_f32_16x16x32_bf16 v[20:23], a[216:219], v[44:47], 0
v_mfma_f32_16x16x32_bf16 v[24:27], v[40:43], v[112:115], 0
v_mfma_f32_16x16x32_bf16 v[28:31], v[40:43], v[184:187], 0
v_mfma_f32_16x16x32_bf16 v[32:35], v[44:47], v[112:115], 0
v_mfma_f32_16x16x32_bf16 v[36:39], v[44:47], v[184:187], 0
ds_read_b128 v[40:43], v3 offset:3072
ds_read_b128 v[44:47], v3 offset:21504
s_waitcnt lgkmcnt(4)
v_mfma_f32_16x16x32_bf16 v[8:11], a[148:151], v[48:51], v[8:11]
v_mfma_f32_16x16x32_bf16 v[12:15], a[148:151], v[52:55], v[12:15]
v_mfma_f32_16x16x32_bf16 v[16:19], a[220:223], v[48:51], v[16:19]
v_mfma_f32_16x16x32_bf16 v[20:23], a[220:223], v[52:55], v[20:23]
v_mfma_f32_16x16x32_bf16 v[24:27], v[48:51], v[116:119], v[24:27]
v_mfma_f32_16x16x32_bf16 v[28:31], v[48:51], v[188:191], v[28:31]
v_mfma_f32_16x16x32_bf16 v[32:35], v[52:55], v[116:119], v[32:35]
v_mfma_f32_16x16x32_bf16 v[36:39], v[52:55], v[188:191], v[36:39]
ds_read_b128 v[48:51], v3 offset:4096
ds_read_b128 v[52:55], v3 offset:22528
s_waitcnt lgkmcnt(4)
v_mfma_f32_16x16x32_bf16 v[8:11], a[152:155], v[56:59], v[8:11]
v_mfma_f32_16x16x32_bf16 v[12:15], a[152:155], v[60:63], v[12:15]
v_mfma_f32_16x16x32_bf16 v[16:19], a[224:227], v[56:59], v[16:19]
v_mfma_f32_16x16x32_bf16 v[20:23], a[224:227], v[60:63], v[20:23]
v_mfma_f32_16x16x32_bf16 v[24:27], v[56:59], v[120:123], v[24:27]
v_mfma_f32_16x16x32_bf16 v[28:31], v[56:59], v[192:195], v[28:31]
v_mfma_f32_16x16x32_bf16 v[32:35], v[60:63], v[120:123], v[32:35]
v_mfma_f32_16x16x32_bf16 v[36:39], v[60:63], v[192:195], v[36:39]
ds_read_b128 v[56:59], v3 offset:5120
ds_read_b128 v[60:63], v3 offset:23552
s_waitcnt lgkmcnt(4)
v_mfma_f32_16x16x32_bf16 v[8:11], a[156:159], v[40:43], v[8:11]
v_mfma_f32_16x16x32_bf16 v[12:15], a[156:159], v[44:47], v[12:15]
v_mfma_f32_16x16x32_bf16 v[16:19], a[228:231], v[40:43], v[16:19]
v_mfma_f32_16x16x32_bf16 v[20:23], a[228:231], v[44:47], v[20:23]
v_mfma_f32_16x16x32_bf16 v[24:27], v[40:43], v[124:127], v[24:27]
v_mfma_f32_16x16x32_bf16 v[28:31], v[40:43], v[196:199], v[28:31]
v_mfma_f32_16x16x32_bf16 v[32:35], v[44:47], v[124:127], v[32:35]
v_mfma_f32_16x16x32_bf16 v[36:39], v[44:47], v[196:199], v[36:39]
ds_read_b128 v[40:43], v3 offset:6144
ds_read_b128 v[44:47], v3 offset:24576
s_waitcnt lgkmcnt(4)
v_mfma_f32_16x16x32_bf16 v[8:11], a[160:163], v[48:51], v[8:11]
v_mfma_f32_16x16x32_bf16 v[12:15], a[160:163], v[52:55], v[12:15]
v_mfma_f32_16x16x32_bf16 v[16:19], a[232:235], v[48:51], v[16:19]
v_mfma_f32_16x16x32_bf16 v[20:23], a[232:235], v[52:55], v[20:23]
v_mfma_f32_16x16x32_bf16 v[24:27], v[48:51], v[128:131], v[24:27]
v_mfma_f32_16x16x32_bf16 v[28:31], v[48:51], v[200:203], v[28:31]
v_mfma_f32_16x16x32_bf16 v[32:35], v[52:55], v[128:131], v[32:35]
v_mfma_f32_16x16x32_bf16 v[36:39], v[52:55], v[200:203], v[36:39]
ds_read_b128 v[48:51], v3 offset:7168
ds_read_b128 v[52:55], v3 offset:25600
s_waitcnt lgkmcnt(4)
v_mfma_f32_16x16x32_bf16 v[8:11], a[164:167], v[56:59], v[8:11]
v_mfma_f32_16x16x32_bf16 v[12:15], a[164:167], v[60:63], v[12:15]
v_mfma_f32_16x16x32_bf16 v[16:19], a[236:239], v[56:59], v[16:19]
v_mfma_f32_16x16x32_bf16 v[20:23], a[236:239], v[60:63], v[20:23]
v_mfma_f32_16x16x32_bf16 v[24:27], v[56:59], v[132:135], v[24:27]
v_mfma_f32_16x16x32_bf16 v[28:31], v[56:59], v[204:207], v[28:31]
v_mfma_f32_16x16x32_bf16 v[32:35], v[60:63], v[132:135], v[32:35]
v_mfma_f32_16x16x32_bf16 v[36:39], v[60:63], v[204:207], v[36:39]
ds_read_b128 v[56:59], v3 offset:8192
ds_read_b128 v[60:63], v3 offset:26624
s_waitcnt lgkmcnt(4)
v_mfma_f32_16x16x32_bf16 v[8:11], a[168:171], v[40:43], v[8:11]
v_mfma_f32_16x16x32_bf16 v[12:15], a[168:171], v[44:47], v[12:15]
v_mfma_f32_16x16x32_bf16 v[16:19], a[240:243], v[40:43], v[16:19]
v_mfma_f32_16x16x32_bf16 v[20:23], a[240:243], v[44:47], v[20:23]
v_mfma_f32_16x16x32_bf16 v[24:27], v[40:43], v[136:139], v[24:27]
v_mfma_f32_16x16x32_bf16 v[28:31], v[40:43], v[208:211], v[28:31]
v_mfma_f32_16x16x32_bf16 v[32:35], v[44:47], v[136:139], v[32:35]
v_mfma_f32_16x16x32_bf16 v[36:39], v[44:47], v[208:211], v[36:39]
ds_read_b128 v[40:43], v3 offset:9216
ds_read_b128 v[44:47], v3 offset:27648
s_waitcnt lgkmcnt(4)
v_mfma_f32_16x16x32_bf16 v[8:11], a[172:175], v[48:51], v[8:11]
v_mfma_f32_16x16x32_bf16 v[12:15], a[172:175], v[52:55], v[12:15]
v_mfma_f32_16x16x32_bf16 v[16:19], a[244:247], v[48:51], v[16:19]
v_mfma_f32_16x16x32_bf16 v[20:23], a[244:247], v[52:55], v[20:23]
v_mfma_f32_16x16x32_bf16 v[24:27], v[48:51], v[140:143], v[24:27]
v_mfma_f32_16x16x32_bf16 v[28:31], v[48:51], v[212:215], v[28:31]
v_mfma_f32_16x16x32_bf16 v[32:35], v[52:55], v[140:143], v[32:35]
v_mfma_f32_16x16x32_bf16 v[36:39], v[52:55], v[212:215], v[36:39]
ds_read_b128 v[48:51], v3 offset:10240
ds_read_b128 v[52:55], v3 offset:28672
s_waitcnt lgkmcnt(4)
v_mfma_f32_16x16x32_bf16 v[8:11], a[176:179], v[56:59], v[8:11]
v_mfma_f32_16x16x32_bf16 v[12:15], a[176:179], v[60:63], v[12:15]
v_mfma_f32_16x16x32_bf16 v[16:19], a[248:251], v[56:59], v[16:19]
v_mfma_f32_16x16x32_bf16 v[20:23], a[248:251], v[60:63], v[20:23]
v_mfma_f32_16x16x32_bf16 v[24:27], v[56:59], v[144:147], v[24:27]
v_mfma_f32_16x16x32_bf16 v[28:31], v[56:59], v[216:219], v[28:31]
v_mfma_f32_16x16x32_bf16 v[32:35], v[60:63], v[144:147], v[32:35]
v_mfma_f32_16x16x32_bf16 v[36:39], v[60:63], v[216:219], v[36:39]
ds_read_b128 v[56:59], v3 offset:11264
ds_read_b128 v[60:63], v3 offset:29696
s_waitcnt lgkmcnt(4)
v_mfma_f32_16x16x32_bf16 v[8:11], a[180:183], v[40:43], v[8:11]
v_mfma_f32_16x16x32_bf16 v[12:15], a[180:183], v[44:47], v[12:15]
v_mfma_f32_16x16x32_bf16 v[16:19], a[252:255], v[40:43], v[16:19]
v_mfma_f32_16x16x32_bf16 v[20:23], a[252:255], v[44:47], v[20:23]
v_mfma_f32_16x16x32_bf16 v[24:27], v[40:43], v[148:151], v[24:27]
v_mfma_f32_16x16x32_bf16 v[28:31], v[40:43], v[220:223], v[28:31]
v_mfma_f32_16x16x32_bf16 v[32:35], v[44:47], v[148:151], v[32:35]
v_mfma_f32_16x16x32_bf16 v[36:39], v[44:47], v[220:223], v[36:39]
ds_read_b128 v[40:43], v3 offset:12288
ds_read_b128 v[44:47], v3 offset:30720
s_waitcnt lgkmcnt(4)
v_mfma_f32_16x16x32_bf16 v[8:11], a[184:187], v[48:51], v[8:11]
v_mfma_f32_16x16x32_bf16 v[12:15], a[184:187], v[52:55], v[12:15]
v_mfma_f32_16x16x32_bf16 v[16:19], v[80:83], v[48:51], v[16:19]
v_mfma_f32_16x16x32_bf16 v[20:23], v[80:83], v[52:55], v[20:23]
v_mfma_f32_16x16x32_bf16 v[24:27], v[48:51], v[152:155], v[24:27]
v_mfma_f32_16x16x32_bf16 v[28:31], v[48:51], v[224:227], v[28:31]
v_mfma_f32_16x16x32_bf16 v[32:35], v[52:55], v[152:155], v[32:35]
v_mfma_f32_16x16x32_bf16 v[36:39], v[52:55], v[224:227], v[36:39]
ds_read_b128 v[48:51], v3 offset:13312
ds_read_b128 v[52:55], v3 offset:31744
s_waitcnt lgkmcnt(4)
v_mfma_f32_16x16x32_bf16 v[8:11], a[188:191], v[56:59], v[8:11]
v_mfma_f32_16x16x32_bf16 v[12:15], a[188:191], v[60:63], v[12:15]
v_mfma_f32_16x16x32_bf16 v[16:19], v[84:87], v[56:59], v[16:19]
v_mfma_f32_16x16x32_bf16 v[20:23], v[84:87], v[60:63], v[20:23]
v_mfma_f32_16x16x32_bf16 v[24:27], v[56:59], v[156:159], v[24:27]
v_mfma_f32_16x16x32_bf16 v[28:31], v[56:59], v[228:231], v[28:31]
v_mfma_f32_16x16x32_bf16 v[32:35], v[60:63], v[156:159], v[32:35]
v_mfma_f32_16x16x32_bf16 v[36:39], v[60:63], v[228:231], v[36:39]
ds_read_b128 v[56:59], v3 offset:14336
ds_read_b128 v[60:63], v3 offset:32768
s_waitcnt lgkmcnt(4)
v_mfma_f32_16x16x32_bf16 v[8:11], a[192:195], v[40:43], v[8:11]
v_mfma_f32_16x16x32_bf16 v[12:15], a[192:195], v[44:47], v[12:15]
v_mfma_f32_16x16x32_bf16 v[16:19], v[88:91], v[40:43], v[16:19]
v_mfma_f32_16x16x32_bf16 v[20:23], v[88:91], v[44:47], v[20:23]
v_mfma_f32_16x16x32_bf16 v[24:27], v[40:43], v[160:163], v[24:27]
v_mfma_f32_16x16x32_bf16 v[28:31], v[40:43], v[232:235], v[28:31]
v_mfma_f32_16x16x32_bf16 v[32:35], v[44:47], v[160:163], v[32:35]
v_mfma_f32_16x16x32_bf16 v[36:39], v[44:47], v[232:235], v[36:39]
ds_read_b128 v[40:43], v3 offset:15360
ds_read_b128 v[44:47], v3 offset:33792
s_waitcnt lgkmcnt(4)
v_mfma_f32_16x16x32_bf16 v[8:11], a[196:199], v[48:51], v[8:11]
v_mfma_f32_16x16x32_bf16 v[12:15], a[196:199], v[52:55], v[12:15]
v_mfma_f32_16x16x32_bf16 v[16:19], v[92:95], v[48:51], v[16:19]
v_mfma_f32_16x16x32_bf16 v[20:23], v[92:95], v[52:55], v[20:23]
v_mfma_f32_16x16x32_bf16 v[24:27], v[48:51], v[164:167], v[24:27]
v_mfma_f32_16x16x32_bf16 v[28:31], v[48:51], v[236:239], v[28:31]
v_mfma_f32_16x16x32_bf16 v[32:35], v[52:55], v[164:167], v[32:35]
v_mfma_f32_16x16x32_bf16 v[36:39], v[52:55], v[236:239], v[36:39]
ds_read_b128 v[48:51], v3 offset:16384
ds_read_b128 v[52:55], v3 offset:34816
s_waitcnt lgkmcnt(4)
v_mfma_f32_16x16x32_bf16 v[8:11], a[200:203], v[56:59], v[8:11]
v_mfma_f32_16x16x32_bf16 v[12:15], a[200:203], v[60:63], v[12:15]
v_mfma_f32_16x16x32_bf16 v[16:19], v[96:99], v[56:59], v[16:19]
v_mfma_f32_16x16x32_bf16 v[20:23], v[96:99], v[60:63], v[20:23]
v_mfma_f32_16x16x32_bf16 v[24:27], v[56:59], v[168:171], v[24:27]
v_mfma_f32_16x16x32_bf16 v[28:31], v[56:59], v[240:243], v[28:31]
v_mfma_f32_16x16x32_bf16 v[32:35], v[60:63], v[168:171], v[32:35]
v_mfma_f32_16x16x32_bf16 v[36:39], v[60:63], v[240:243], v[36:39]
ds_read_b128 v[56:59], v3 offset:17408
ds_read_b128 v[60:63], v3 offset:35840
s_waitcnt lgkmcnt(4)
v_mfma_f32_16x16x32_bf16 v[8:11], a[204:207], v[40:43], v[8:11]
v_mfma_f32_16x16x32_bf16 v[12:15], a[204:207], v[44:47], v[12:15]
v_mfma_f32_16x16x32_bf16 v[16:19], v[100:103], v[40:43], v[16:19]
v_mfma_f32_16x16x32_bf16 v[20:23], v[100:103], v[44:47], v[20:23]
v_mfma_f32_16x16x32_bf16 v[24:27], v[40:43], v[172:175], v[24:27]
v_mfma_f32_16x16x32_bf16 v[28:31], v[40:43], v[244:247], v[28:31]
v_mfma_f32_16x16x32_bf16 v[32:35], v[44:47], v[172:175], v[32:35]
v_mfma_f32_16x16x32_bf16 v[36:39], v[44:47], v[244:247], v[36:39]
s_waitcnt lgkmcnt(2)
v_mfma_f32_16x16x32_bf16 v[8:11], a[208:211], v[48:51], v[8:11]
v_mfma_f32_16x16x32_bf16 v[12:15], a[208:211], v[52:55], v[12:15]
v_mfma_f32_16x16x32_bf16 v[16:19], v[104:107], v[48:51], v[16:19]
v_mfma_f32_16x16x32_bf16 v[20:23], v[104:107], v[52:55], v[20:23]
v_mfma_f32_16x16x32_bf16 v[24:27], v[48:51], v[176:179], v[24:27]
v_mfma_f32_16x16x32_bf16 v[28:31], v[48:51], v[248:251], v[28:31]
v_mfma_f32_16x16x32_bf16 v[32:35], v[52:55], v[176:179], v[32:35]
v_mfma_f32_16x16x32_bf16 v[36:39], v[52:55], v[248:251], v[36:39]
s_waitcnt lgkmcnt(0)
v_mfma_f32_16x16x32_bf16 v[8:11], a[212:215], v[56:59], v[8:11]
v_mfma_f32_16x16x32_bf16 v[12:15], a[212:215], v[60:63], v[12:15]
v_mfma_f32_16x16x32_bf16 v[16:19], v[108:111], v[56:59], v[16:19]
v_mfma_f32_16x16x32_bf16 v[20:23], v[108:111], v[60:63], v[20:23]
v_mfma_f32_16x16x32_bf16 v[24:27], v[56:59], v[180:183], v[24:27]
v_mfma_f32_16x16x32_bf16 v[28:31], v[56:59], v[252:255], v[28:31]
v_mfma_f32_16x16x32_bf16 v[32:35], v[60:63], v[180:183], v[32:35]
v_mfma_f32_16x16x32_bf16 v[36:39], v[60:63], v[252:255], v[36:39]
s_lshl_b32 s35, s24, 5
s_add_u32 s35, s35, s16
s_lshl_b32 s35, s35, 14
s_add_u32 s35, s35, 1048576
s_lshl_b32 s36, s17, 10
s_add_u32 s36, s36, s35
s_lshl_b32 s37, s17, 11
s_add_u32 s37, s37, s35
s_add_u32 s37, s37, 8192
s_nop 4
v_cvt_pk_bf16_f32 v64, v8, v9
v_cvt_pk_bf16_f32 v65, v10, v11
v_cvt_pk_bf16_f32 v66, v16, v17
v_cvt_pk_bf16_f32 v67, v18, v19
s_add_u32 s38, s36, 0
buffer_store_dwordx4 v[64:67], v0, s[8:11], s38 offen sc1
v_cvt_pk_bf16_f32 v68, v12, v13
v_cvt_pk_bf16_f32 v69, v14, v15
v_cvt_pk_bf16_f32 v70, v20, v21
v_cvt_pk_bf16_f32 v71, v22, v23
s_add_u32 s38, s36, 4096
buffer_store_dwordx4 v[68:71], v0, s[8:11], s38 offen sc1
v_cvt_pk_bf16_f32 v72, v24, v25
v_cvt_pk_bf16_f32 v73, v26, v27
v_cvt_pk_bf16_f32 v74, v32, v33
v_cvt_pk_bf16_f32 v75, v34, v35
buffer_store_dwordx4 v[72:75], v0, s[8:11], s37 offen offset:0 sc1
v_cvt_pk_bf16_f32 v76, v28, v29
v_cvt_pk_bf16_f32 v77, v30, v31
v_cvt_pk_bf16_f32 v78, v36, v37
v_cvt_pk_bf16_f32 v79, v38, v39
buffer_store_dwordx4 v[76:79], v0, s[8:11], s37 offen offset:1024 sc1
s_xor_b32 s26, s26, 36864
s_add_u32 s34, s34, 1
s_add_u32 s24, s24, 7
s_cmp_lt_u32 s24, 64
s_cbranch_scc1 PL_18
s_waitcnt vmcnt(0)
s_barrier
s_cmp_eq_u32 s17, 0
s_cbranch_scc0 PE_20
s_add_u32 s41, s7, 16
v_mov_b32 v3, s41
v_mov_b32 v4, 0
s_mov_b64 exec, 1
buffer_store_dword v3, v4, s[8:11], s39 offen sc1
s_mov_b64 exec, -1
PE_20:
s_lshl_b32 s28, s16, 5
s_add_u32 s28, s28, 819200
s_add_u32 s29, s7, 16
v_lshrrev_b32 v2, 2, v0
v_cmp_gt_u32 vcc, 28, v2
s_nop 1
v_cndmask_b32 v2, 0, v2, vcc
s_mov_b32 s35, 4000000
PW_23:
buffer_load_dword v3, v2, s[8:11], s28 offen sc1
s_waitcnt vmcnt(0)
v_cmp_ne_u32 vcc, s29, v3
s_cbranch_vccz PW_23k
s_sub_u32 s35, s35, 1
s_cbranch_scc1 K_END
s_sleep 4
s_branch PW_23
PW_23k:
s_load_dwordx2 s[4:5], s[0:1], 0
s_waitcnt lgkmcnt(0)
s_mov_b32 s20, s4
s_mov_b32 s21, s5
s_mov_b32 s22, 2359296
s_mov_b32 s23, 0x00020000
v_bfe_u32 v28, v0, 4, 4
v_lshrrev_b32 v29, 8, v0
v_mul_u32_u24 v2, 1152, v28
v_lshl_add_u32 v2, v29, 4, v2
s_lshl_b32 s28, s17, 10
s_add_u32 s29, s28, 73728
v_add_u32 v4, s29, v0
s_add_u32 s29, s28, 81920
v_add_u32 v7, s29, v0
s_and_b32 s28, s17, 1
s_lshl_b32 s28, s28, 12
s_add_u32 s28, s28, 73728
v_add_u32 v5, s28, v0
s_lshr_b32 s34, s17, 1
v_lshrrev_b32 v30, 1, v0
s_lshl_b32 s28, s17, 10
s_add_u32 s28, s28, 86016
v_add_u32 v8, s28, v30
s_lshl_b32 s28, s34, 11
s_add_u32 s28, s28, 86016
v_add_u32 v9, s28, v30
v_and_b32 v30, 7, v28
v_lshrrev_b32 v31, 1, v30
v_lshlrev_b32 v31, 2, v31
v_and_b32 v30, 1, v30
v_add_u32 v31, v31, v30
v_and_b32 v30, 1, v29
v_lshl_add_u32 v31, v30, 1, v31
v_lshlrev_b32 v31, 4, v31
v_lshrrev_b32 v30, 1, v29
v_lshl_add_u32 v6, v30, 8, v31
s_and_b32 s28, s17, 1
s_lshl_b32 s28, s28, 4
v_add_u32 v30, s28, v28
v_lshlrev_b32 v31, 2, v29
v_mov_b32 v32, 0xf149f2ca
v_add_u32 v33, 0, v31
v_cmp_gt_u32 vcc, v33, v30
s_nop 1
v_cndmask_b32 v16, 0, v32, vcc
v_add_u32 v33, 1, v31
v_cmp_gt_u32 vcc, v33, v30
s_nop 1
v_cndmask_b32 v17, 0, v32, vcc
v_add_u32 v33, 2, v31
v_cmp_gt_u32 vcc, v33, v30
s_nop 1
v_cndmask_b32 v18, 0, v32, vcc
v_add_u32 v33, 3, v31
v_cmp_gt_u32 vcc, v33, v30
s_nop 1
v_cndmask_b32 v19, 0, v32, vcc
v_add_u32 v33, 16, v31
v_cmp_gt_u32 vcc, v33, v30
s_nop 1
v_cndmask_b32 v20, 0, v32, vcc
v_add_u32 v33, 17, v31
v_cmp_gt_u32 vcc, v33, v30
s_nop 1
v_cndmask_b32 v21, 0, v32, vcc
v_add_u32 v33, 18, v31
v_cmp_gt_u32 vcc, v33, v30
s_nop 1
v_cndmask_b32 v22, 0, v32, vcc
v_add_u32 v33, 19, v31
v_cmp_gt_u32 vcc, v33, v30
s_nop 1
v_cndmask_b32 v23, 0, v32, vcc
v_cmp_lt_u32 vcc, 1, v29
s_nop 1
v_cndmask_b32 v24, 0, v32, vcc
v_cndmask_b32 v25, 0, v32, vcc
v_cndmask_b32 v26, 0, v32, vcc
v_cndmask_b32 v27, 0, v32, vcc
v_mov_b32 v12, 0x3f803f80
v_mov_b32 v13, 0x3f803f80
v_mov_b32 v14, 0x3f803f80
v_mov_b32 v15, 0x3f803f80
s_mov_b32 s44, 0x21800000
s_mov_b32 s45, 0x5f800000
s_mov_b32 s24, s50
s_mul_i32 s25, s24, 36864
s_mov_b32 s26, 0
s_mov_b32 s42, 90112
s_mov_b32 s19, 0
s_mul_i32 s28, s17, 576
s_cmp_ge_u32 s17, 2
s_cselect_b32 s29, 17280, 0
s_add_u32 s28, s28, s29
s_add_u32 s28, s28, s25
s_mul_i32 s29, s17, 9216
s_add_u32 m0, s29, s26
s_nop 0
buffer_load_dwordx4 v2, s[20:23], s28 offen offset:0 lds
s_add_u32 m0, m0, 960
s_nop 0
buffer_load_dwordx4 v2, s[20:23], s28 offen offset:64 lds
s_add_u32 m0, m0, 960
s_nop 0
buffer_load_dwordx4 v2, s[20:23], s28 offen offset:128 lds
s_add_u32 m0, m0, 960
s_nop 0
buffer_load_dwordx4 v2, s[20:23], s28 offen offset:192 lds
s_add_u32 m0, m0, 960
s_nop 0
buffer_load_dwordx4 v2, s[20:23], s28 offen offset:256 lds
s_add_u32 m0, m0, 960
s_nop 0
buffer_load_dwordx4 v2, s[20:23], s28 offen offset:320 lds
s_add_u32 m0, m0, 960
s_nop 0
buffer_load_dwordx4 v2, s[20:23], s28 offen offset:384 lds
s_add_u32 m0, m0, 960
s_nop 0
buffer_load_dwordx4 v2, s[20:23], s28 offen offset:448 lds
s_add_u32 m0, m0, 960
s_nop 0
buffer_load_dwordx4 v2, s[20:23], s28 offen offset:512 lds
s_lshl_b32 s28, s24, 5
s_add_u32 s28, s28, s16
s_lshl_b32 s28, s28, 14
s_add_u32 s28, s28, 1048576
s_lshl_b32 s29, s17, 12
s_add_u32 s28, s28, s29
s_add_u32 s29, s29, s42
s_mov_b32 m0, s29
s_nop 0
buffer_load_dwordx4 v0, s[8:11], s28 offen offset:0 lds
buffer_load_dwordx4 v0, s[8:11], s28 offen offset:1024 lds
buffer_load_dwordx4 v0, s[8:11], s28 offen offset:2048 lds
buffer_load_dwordx4 v0, s[8:11], s28 offen offset:3072 lds
s_mov_b32 s46, -1
AL_24:
s_waitcnt vmcnt(0) lgkmcnt(0)
s_barrier
s_cmp_eq_u32 s46, -1
s_cbranch_scc1 ANP_30
s_cmp_eq_u32 s17, 0
s_cbranch_scc0 ANF_31
s_lshl_b32 s28, s46, 7
s_lshl_b32 s29, s16, 2
s_add_u32 s28, s28, s29
s_add_u32 s28, s28, 827392
v_mov_b32 v10, s7
v_mov_b32 v11, 0
s_mov_b64 exec, 1
buffer_store_dword v10, v11, s[8:11], s28 offen sc1
s_mov_b64 exec, -1
ANF_31:
ANP_30:
s_add_u32 s37, s24, 2
s_cmp_lt_u32 s37, 64
s_cbranch_scc0 AN_25
s_mul_i32 s25, s37, 36864
s_xor_b32 s36, s26, 36864
s_xor_b32 s38, s42, 49152
s_mul_i32 s28, s17, 576
s_cmp_ge_u32 s17, 2
s_cselect_b32 s29, 17280, 0
s_add_u32 s28, s28, s29
s_add_u32 s28, s28, s25
s_mul_i32 s29, s17, 9216
s_add_u32 m0, s29, s36
s_nop 0
buffer_load_dwordx4 v2, s[20:23], s28 offen offset:0 lds
s_add_u32 m0, m0, 960
s_nop 0
buffer_load_dwordx4 v2, s[20:23], s28 offen offset:64 lds
s_add_u32 m0, m0, 960
s_nop 0
buffer_load_dwordx4 v2, s[20:23], s28 offen offset:128 lds
s_add_u32 m0, m0, 960
s_nop 0
buffer_load_dwordx4 v2, s[20:23], s28 offen offset:192 lds
s_add_u32 m0, m0, 960
s_nop 0
buffer_load_dwordx4 v2, s[20:23], s28 offen offset:256 lds
s_add_u32 m0, m0, 960
s_nop 0
buffer_load_dwordx4 v2, s[20:23], s28 offen offset:320 lds
s_add_u32 m0, m0, 960
s_nop 0
buffer_load_dwordx4 v2, s[20:23], s28 offen offset:384 lds
s_add_u32 m0, m0, 960
s_nop 0
buffer_load_dwordx4 v2, s[20:23], s28 offen offset:448 lds
s_add_u32 m0, m0, 960
s_nop 0
buffer_load_dwordx4 v2, s[20:23], s28 offen offset:512 lds
s_lshl_b32 s28, s37, 5
s_add_u32 s28, s28, s16
s_lshl_b32 s28, s28, 14
s_add_u32 s28, s28, 1048576
s_lshl_b32 s29, s17, 12
s_add_u32 s28, s28, s29
s_add_u32 s29, s29, s38
s_mov_b32 m0, s29
s_nop 0
buffer_load_dwordx4 v0, s[8:11], s28 offen offset:0 lds
buffer_load_dwordx4 v0, s[8:11], s28 offen offset:1024 lds
buffer_load_dwordx4 v0, s[8:11], s28 offen offset:2048 lds
buffer_load_dwordx4 v0, s[8:11], s28 offen offset:3072 lds
AN_25:
v_add_u32 v3, s26, v0
ds_read_b128 v[28:31], v3 offset:0
ds_read_b128 v[32:35], v3 offset:18432
ds_read_b128 v[36:39], v3 offset:1024
ds_read_b128 v[40:43], v3 offset:19456
ds_read_b128 v[44:47], v3 offset:2048
ds_read_b128 v[48:51], v3 offset:20480
s_waitcnt lgkmcnt(4)
v_mfma_f32_16x16x32_bf16 v[52:55], a[0:3], v[28:31], 0
v_mfma_f32_16x16x32_bf16 v[56:59], a[0:3], v[32:35], 0
v_mfma_f32_16x16x32_bf16 v[60:63], a[72:75], v[28:31], 0
v_mfma_f32_16x16x32_bf16 v[64:67], a[72:75], v[32:35], 0
ds_read_b128 v[28:31], v3 offset:3072
ds_read_b128 v[32:35], v3 offset:21504
s_waitcnt lgkmcnt(4)
v_mfma_f32_16x16x32_bf16 v[52:55], a[4:7], v[36:39], v[52:55]
v_mfma_f32_16x16x32_bf16 v[56:59], a[4:7], v[40:43], v[56:59]
v_mfma_f32_16x16x32_bf16 v[60:63], a[76:79], v[36:39], v[60:63]
v_mfma_f32_16x16x32_bf16 v[64:67], a[76:79], v[40:43], v[64:67]
ds_read_b128 v[36:39], v3 offset:4096
ds_read_b128 v[40:43], v3 offset:22528
s_waitcnt lgkmcnt(4)
v_mfma_f32_16x16x32_bf16 v[52:55], a[8:11], v[44:47], v[52:55]
v_mfma_f32_16x16x32_bf16 v[56:59], a[8:11], v[48:51], v[56:59]
v_mfma_f32_16x16x32_bf16 v[60:63], a[80:83], v[44:47], v[60:63]
v_mfma_f32_16x16x32_bf16 v[64:67], a[80:83], v[48:51], v[64:67]
ds_read_b128 v[44:47], v3 offset:5120
ds_read_b128 v[48:51], v3 offset:23552
s_waitcnt lgkmcnt(4)
v_mfma_f32_16x16x32_bf16 v[52:55], a[12:15], v[28:31], v[52:55]
v_mfma_f32_16x16x32_bf16 v[56:59], a[12:15], v[32:35], v[56:59]
v_mfma_f32_16x16x32_bf16 v[60:63], a[84:87], v[28:31], v[60:63]
v_mfma_f32_16x16x32_bf16 v[64:67], a[84:87], v[32:35], v[64:67]
ds_read_b128 v[28:31], v3 offset:6144
ds_read_b128 v[32:35], v3 offset:24576
s_waitcnt lgkmcnt(4)
v_mfma_f32_16x16x32_bf16 v[52:55], a[16:19], v[36:39], v[52:55]
v_mfma_f32_16x16x32_bf16 v[56:59], a[16:19], v[40:43], v[56:59]
v_mfma_f32_16x16x32_bf16 v[60:63], a[88:91], v[36:39], v[60:63]
v_mfma_f32_16x16x32_bf16 v[64:67], a[88:91], v[40:43], v[64:67]
ds_read_b128 v[36:39], v3 offset:7168
ds_read_b128 v[40:43], v3 offset:25600
s_waitcnt lgkmcnt(4)
v_mfma_f32_16x16x32_bf16 v[52:55], a[20:23], v[44:47], v[52:55]
v_mfma_f32_16x16x32_bf16 v[56:59], a[20:23], v[48:51], v[56:59]
v_mfma_f32_16x16x32_bf16 v[60:63], a[92:95], v[44:47], v[60:63]
v_mfma_f32_16x16x32_bf16 v[64:67], a[92:95], v[48:51], v[64:67]
ds_read_b128 v[44:47], v3 offset:8192
ds_read_b128 v[48:51], v3 offset:26624
s_waitcnt lgkmcnt(4)
v_mfma_f32_16x16x32_bf16 v[52:55], a[24:27], v[28:31], v[52:55]
v_mfma_f32_16x16x32_bf16 v[56:59], a[24:27], v[32:35], v[56:59]
v_mfma_f32_16x16x32_bf16 v[60:63], a[96:99], v[28:31], v[60:63]
v_mfma_f32_16x16x32_bf16 v[64:67], a[96:99], v[32:35], v[64:67]
ds_read_b128 v[28:31], v3 offset:9216
ds_read_b128 v[32:35], v3 offset:27648
s_waitcnt lgkmcnt(4)
v_mfma_f32_16x16x32_bf16 v[52:55], a[28:31], v[36:39], v[52:55]
v_mfma_f32_16x16x32_bf16 v[56:59], a[28:31], v[40:43], v[56:59]
v_mfma_f32_16x16x32_bf16 v[60:63], a[100:103], v[36:39], v[60:63]
v_mfma_f32_16x16x32_bf16 v[64:67], a[100:103], v[40:43], v[64:67]
ds_read_b128 v[36:39], v3 offset:10240
ds_read_b128 v[40:43], v3 offset:28672
s_waitcnt lgkmcnt(4)
v_mfma_f32_16x16x32_bf16 v[52:55], a[32:35], v[44:47], v[52:55]
v_mfma_f32_16x16x32_bf16 v[56:59], a[32:35], v[48:51], v[56:59]
v_mfma_f32_16x16x32_bf16 v[60:63], a[104:107], v[44:47], v[60:63]
v_mfma_f32_16x16x32_bf16 v[64:67], a[104:107], v[48:51], v[64:67]
ds_read_b128 v[44:47], v3 offset:11264
ds_read_b128 v[48:51], v3 offset:29696
s_waitcnt lgkmcnt(4)
v_mfma_f32_16x16x32_bf16 v[52:55], a[36:39], v[28:31], v[52:55]
v_mfma_f32_16x16x32_bf16 v[56:59], a[36:39], v[32:35], v[56:59]
v_mfma_f32_16x16x32_bf16 v[60:63], a[108:111], v[28:31], v[60:63]
v_mfma_f32_16x16x32_bf16 v[64:67], a[108:111], v[32:35], v[64:67]
ds_read_b128 v[28:31], v3 offset:12288
ds_read_b128 v[32:35], v3 offset:30720
s_waitcnt lgkmcnt(4)
v_mfma_f32_16x16x32_bf16 v[52:55], a[40:43], v[36:39], v[52:55]
v_mfma_f32_16x16x32_bf16 v[56:59], a[40:43], v[40:43], v[56:59]
v_mfma_f32_16x16x32_bf16 v[60:63], a[112:115], v[36:39], v[60:63]
v_mfma_f32_16x16x32_bf16 v[64:67], a[112:115], v[40:43], v[64:67]
ds_read_b128 v[36:39], v3 offset:13312
ds_read_b128 v[40:43], v3 offset:31744
s_waitcnt lgkmcnt(4)
v_mfma_f32_16x16x32_bf16 v[52:55], a[44:47], v[44:47], v[52:55]
v_mfma_f32_16x16x32_bf16 v[56:59], a[44:47], v[48:51], v[56:59]
v_mfma_f32_16x16x32_bf16 v[60:63], a[116:119], v[44:47], v[60:63]
v_mfma_f32_16x16x32_bf16 v[64:67], a[116:119], v[48:51], v[64:67]
ds_read_b128 v[44:47], v3 offset:14336
ds_read_b128 v[48:51], v3 offset:32768
s_waitcnt lgkmcnt(4)
v_mfma_f32_16x16x32_bf16 v[52:55], a[48:51], v[28:31], v[52:55]
v_mfma_f32_16x16x32_bf16 v[56:59], a[48:51], v[32:35], v[56:59]
v_mfma_f32_16x16x32_bf16 v[60:63], a[120:123], v[28:31], v[60:63]
v_mfma_f32_16x16x32_bf16 v[64:67], a[120:123], v[32:35], v[64:67]
ds_read_b128 v[28:31], v3 offset:15360
ds_read_b128 v[32:35], v3 offset:33792
s_waitcnt lgkmcnt(4)
v_mfma_f32_16x16x32_bf16 v[52:55], a[52:55], v[36:39], v[52:55]
v_mfma_f32_16x16x32_bf16 v[56:59], a[52:55], v[40:43], v[56:59]
v_mfma_f32_16x16x32_bf16 v[60:63], a[124:127], v[36:39], v[60:63]
v_mfma_f32_16x16x32_bf16 v[64:67], a[124:127], v[40:43], v[64:67]
ds_read_b128 v[36:39], v3 offset:16384
ds_read_b128 v[40:43], v3 offset:34816
s_waitcnt lgkmcnt(4)
v_mfma_f32_16x16x32_bf16 v[52:55], a[56:59], v[44:47], v[52:55]
v_mfma_f32_16x16x32_bf16 v[56:59], a[56:59], v[48:51], v[56:59]
v_mfma_f32_16x16x32_bf16 v[60:63], a[128:131], v[44:47], v[60:63]
v_mfma_f32_16x16x32_bf16 v[64:67], a[128:131], v[48:51], v[64:67]
ds_read_b128 v[44:47], v3 offset:17408
ds_read_b128 v[48:51], v3 offset:35840
s_waitcnt lgkmcnt(4)
v_mfma_f32_16x16x32_bf16 v[52:55], a[60:63], v[28:31], v[52:55]
v_mfma_f32_16x16x32_bf16 v[56:59], a[60:63], v[32:35], v[56:59]
v_mfma_f32_16x16x32_bf16 v[60:63], a[132:135], v[28:31], v[60:63]
v_mfma_f32_16x16x32_bf16 v[64:67], a[132:135], v[32:35], v[64:67]
s_waitcnt lgkmcnt(2)
v_mfma_f32_16x16x32_bf16 v[52:55], a[64:67], v[36:39], v[52:55]
v_mfma_f32_16x16x32_bf16 v[56:59], a[64:67], v[40:43], v[56:59]
v_mfma_f32_16x16x32_bf16 v[60:63], a[136:139], v[36:39], v[60:63]
v_mfma_f32_16x16x32_bf16 v[64:67], a[136:139], v[40:43], v[64:67]
s_waitcnt lgkmcnt(0)
v_mfma_f32_16x16x32_bf16 v[52:55], a[68:71], v[44:47], v[52:55]
v_mfma_f32_16x16x32_bf16 v[56:59], a[68:71], v[48:51], v[56:59]
v_mfma_f32_16x16x32_bf16 v[60:63], a[140:143], v[44:47], v[60:63]
v_mfma_f32_16x16x32_bf16 v[64:67], a[140:143], v[48:51], v[64:67]
s_mov_b32 s29, 0x3e0293ee
s_nop 6
v_mul_f32 v52, s29, v52
v_mul_f32 v53, s29, v53
v_mul_f32 v54, s29, v54
v_mul_f32 v55, s29, v55
v_cvt_pk_bf16_f32 v28, v52, v53
v_cvt_pk_bf16_f32 v29, v54, v55
v_mul_f32 v60, s29, v60
v_mul_f32 v61, s29, v61
v_mul_f32 v62, s29, v62
v_mul_f32 v63, s29, v63
v_cvt_pk_bf16_f32 v30, v60, v61
v_cvt_pk_bf16_f32 v31, v62, v63
ds_write_b128 v4, v[28:31] offset:0
v_mul_f32 v56, s29, v56
v_mul_f32 v57, s29, v57
v_mul_f32 v58, s29, v58
v_mul_f32 v59, s29, v59
v_cvt_pk_bf16_f32 v32, v56, v57
v_cvt_pk_bf16_f32 v33, v58, v59
v_mul_f32 v64, s29, v64
v_mul_f32 v65, s29, v65
v_mul_f32 v66, s29, v66
v_mul_f32 v67, s29, v67
v_cvt_pk_bf16_f32 v34, v64, v65
v_cvt_pk_bf16_f32 v35, v66, v67
ds_write_b128 v4, v[32:35] offset:4096
s_mov_b32 s28, 820224
s_mov_b32 s35, 2000000
v_lshrrev_b32 v10, 2, v0
v_cmp_gt_u32 vcc, 36, v10
s_nop 1
v_cndmask_b32 v10, 0, v10, vcc
s_add_u32 s29, s7, s24
s_add_u32 s29, s29, 1
s_sub_u32 s30, 63, s24
AW_32:
buffer_load_dword v11, v10, s[8:11], s28 offen sc1
s_waitcnt vmcnt(0)
v_subrev_u32 v11, s29, v11
v_cmp_lt_u32 vcc, s30, v11
s_cbranch_vccz AK_33
s_sub_u32 s35, s35, 1
s_cbranch_scc1 AF_27
s_sleep 4
s_branch AW_32
AK_33:
s_lshl_b32 s41, s24, 14
s_add_u32 s41, s41, 34603008
s_lshl_b32 s28, s17, 9
s_add_u32 s28, s28, s41
s_lshl_b32 s29, s17, 10
s_add_u32 s29, s29, 122880
s_mov_b32 m0, s29
s_add_u32 s29, s29, 4096
buffer_load_dwordx4 v6, s[8:11], s28 offen lds
s_add_u32 s28, s28, 2048
s_mov_b32 m0, s29
s_add_u32 s29, s29, 4096
buffer_load_dwordx4 v6, s[8:11], s28 offen lds
s_add_u32 s28, s28, 2048
s_mov_b32 m0, s29
s_add_u32 s29, s29, 4096
buffer_load_dwordx4 v6, s[8:11], s28 offen lds
s_add_u32 s28, s28, 2048
s_mov_b32 m0, s29
s_add_u32 s29, s29, 4096
buffer_load_dwordx4 v6, s[8:11], s28 offen lds
s_add_u32 s28, s28, 2048
s_cmp_lt_u32 s17, 2
s_cbranch_scc0 ANM_34
s_mov_b32 m0, s29
s_add_u32 s29, s29, 4096
buffer_load_dwordx4 v6, s[8:11], s28 offen lds
s_add_u32 s28, s28, 2048
ANM_34:
s_waitcnt vmcnt(0) lgkmcnt(0)
s_barrier
v_add_u32 v10, 122880, v0
ds_read_b128 v[28:31], v10 offset:0
ds_read_b128 v[32:35], v10 offset:1024
ds_read_b128 v[36:39], v10 offset:2048
s_waitcnt lgkmcnt(2)
v_mfma_f32_16x16x32_bf16 v[40:43], a[144:147], v[28:31], 0
v_mfma_f32_16x16x32_bf16 v[48:51], v[28:31], v[112:115], 0
v_mfma_f32_16x16x32_bf16 v[44:47], a[216:219], v[28:31], 0
v_mfma_f32_16x16x32_bf16 v[52:55], v[28:31], v[184:187], 0
ds_read_b128 v[28:31], v10 offset:3072
s_waitcnt lgkmcnt(2)
v_mfma_f32_16x16x32_bf16 v[40:43], a[148:151], v[32:35], v[40:43]
v_mfma_f32_16x16x32_bf16 v[48:51], v[32:35], v[116:119], v[48:51]
v_mfma_f32_16x16x32_bf16 v[44:47], a[220:223], v[32:35], v[44:47]
v_mfma_f32_16x16x32_bf16 v[52:55], v[32:35], v[188:191], v[52:55]
ds_read_b128 v[32:35], v10 offset:4096
s_waitcnt lgkmcnt(2)
v_mfma_f32_16x16x32_bf16 v[40:43], a[152:155], v[36:39], v[40:43]
v_mfma_f32_16x16x32_bf16 v[48:51], v[36:39], v[120:123], v[48:51]
v_mfma_f32_16x16x32_bf16 v[44:47], a[224:227], v[36:39], v[44:47]
v_mfma_f32_16x16x32_bf16 v[52:55], v[36:39], v[192:195], v[52:55]
ds_read_b128 v[36:39], v10 offset:5120
s_waitcnt lgkmcnt(2)
v_mfma_f32_16x16x32_bf16 v[40:43], a[156:159], v[28:31], v[40:43]
v_mfma_f32_16x16x32_bf16 v[48:51], v[28:31], v[124:127], v[48:51]
v_mfma_f32_16x16x32_bf16 v[44:47], a[228:231], v[28:31], v[44:47]
v_mfma_f32_16x16x32_bf16 v[52:55], v[28:31], v[196:199], v[52:55]
ds_read_b128 v[28:31], v10 offset:6144
s_waitcnt lgkmcnt(2)
v_mfma_f32_16x16x32_bf16 v[40:43], a[160:163], v[32:35], v[40:43]
v_mfma_f32_16x16x32_bf16 v[48:51], v[32:35], v[128:131], v[48:51]
v_mfma_f32_16x16x32_bf16 v[44:47], a[232:235], v[32:35], v[44:47]
v_mfma_f32_16x16x32_bf16 v[52:55], v[32:35], v[200:203], v[52:55]
ds_read_b128 v[32:35], v10 offset:7168
s_waitcnt lgkmcnt(2)
v_mfma_f32_16x16x32_bf16 v[40:43], a[164:167], v[36:39], v[40:43]
v_mfma_f32_16x16x32_bf16 v[48:51], v[36:39], v[132:135], v[48:51]
v_mfma_f32_16x16x32_bf16 v[44:47], a[236:239], v[36:39], v[44:47]
v_mfma_f32_16x16x32_bf16 v[52:55], v[36:39], v[204:207], v[52:55]
ds_read_b128 v[36:39], v10 offset:8192
s_waitcnt lgkmcnt(2)
v_mfma_f32_16x16x32_bf16 v[40:43], a[168:171], v[28:31], v[40:43]
v_mfma_f32_16x16x32_bf16 v[48:51], v[28:31], v[136:139], v[48:51]
v_mfma_f32_16x16x32_bf16 v[44:47], a[240:243], v[28:31], v[44:47]
v_mfma_f32_16x16x32_bf16 v[52:55], v[28:31], v[208:211], v[52:55]
ds_read_b128 v[28:31], v10 offset:9216
s_waitcnt lgkmcnt(2)
v_mfma_f32_16x16x32_bf16 v[40:43], a[172:175], v[32:35], v[40:43]
v_mfma_f32_16x16x32_bf16 v[48:51], v[32:35], v[140:143], v[48:51]
v_mfma_f32_16x16x32_bf16 v[44:47], a[244:247], v[32:35], v[44:47]
v_mfma_f32_16x16x32_bf16 v[52:55], v[32:35], v[212:215], v[52:55]
ds_read_b128 v[32:35], v10 offset:10240
s_waitcnt lgkmcnt(2)
v_mfma_f32_16x16x32_bf16 v[40:43], a[176:179], v[36:39], v[40:43]
v_mfma_f32_16x16x32_bf16 v[48:51], v[36:39], v[144:147], v[48:51]
v_mfma_f32_16x16x32_bf16 v[44:47], a[248:251], v[36:39], v[44:47]
v_mfma_f32_16x16x32_bf16 v[52:55], v[36:39], v[216:219], v[52:55]
ds_read_b128 v[36:39], v10 offset:11264
s_waitcnt lgkmcnt(2)
v_mfma_f32_16x16x32_bf16 v[40:43], a[180:183], v[28:31], v[40:43]
v_mfma_f32_16x16x32_bf16 v[48:51], v[28:31], v[148:151], v[48:51]
v_mfma_f32_16x16x32_bf16 v[44:47], a[252:255], v[28:31], v[44:47]
v_mfma_f32_16x16x32_bf16 v[52:55], v[28:31], v[220:223], v[52:55]
ds_read_b128 v[28:31], v10 offset:12288
s_waitcnt lgkmcnt(2)
v_mfma_f32_16x16x32_bf16 v[40:43], a[184:187], v[32:35], v[40:43]
v_mfma_f32_16x16x32_bf16 v[48:51], v[32:35], v[152:155], v[48:51]
v_mfma_f32_16x16x32_bf16 v[44:47], v[80:83], v[32:35], v[44:47]
v_mfma_f32_16x16x32_bf16 v[52:55], v[32:35], v[224:227], v[52:55]
ds_read_b128 v[32:35], v10 offset:13312
s_waitcnt lgkmcnt(2)
v_mfma_f32_16x16x32_bf16 v[40:43], a[188:191], v[36:39], v[40:43]
v_mfma_f32_16x16x32_bf16 v[48:51], v[36:39], v[156:159], v[48:51]
v_mfma_f32_16x16x32_bf16 v[44:47], v[84:87], v[36:39], v[44:47]
v_mfma_f32_16x16x32_bf16 v[52:55], v[36:39], v[228:231], v[52:55]
ds_read_b128 v[36:39], v10 offset:14336
s_waitcnt lgkmcnt(2)
v_mfma_f32_16x16x32_bf16 v[40:43], a[192:195], v[28:31], v[40:43]
v_mfma_f32_16x16x32_bf16 v[48:51], v[28:31], v[160:163], v[48:51]
v_mfma_f32_16x16x32_bf16 v[44:47], v[88:91], v[28:31], v[44:47]
v_mfma_f32_16x16x32_bf16 v[52:55], v[28:31], v[232:235], v[52:55]
ds_read_b128 v[28:31], v10 offset:15360
s_waitcnt lgkmcnt(2)
v_mfma_f32_16x16x32_bf16 v[40:43], a[196:199], v[32:35], v[40:43]
v_mfma_f32_16x16x32_bf16 v[48:51], v[32:35], v[164:167], v[48:51]
v_mfma_f32_16x16x32_bf16 v[44:47], v[92:95], v[32:35], v[44:47]
v_mfma_f32_16x16x32_bf16 v[52:55], v[32:35], v[236:239], v[52:55]
ds_read_b128 v[32:35], v10 offset:16384
s_waitcnt lgkmcnt(2)
v_mfma_f32_16x16x32_bf16 v[40:43], a[200:203], v[36:39], v[40:43]
v_mfma_f32_16x16x32_bf16 v[48:51], v[36:39], v[168:171], v[48:51]
v_mfma_f32_16x16x32_bf16 v[44:47], v[96:99], v[36:39], v[44:47]
v_mfma_f32_16x16x32_bf16 v[52:55], v[36:39], v[240:243], v[52:55]
ds_read_b128 v[36:39], v10 offset:17408
s_waitcnt lgkmcnt(2)
v_mfma_f32_16x16x32_bf16 v[40:43], a[204:207], v[28:31], v[40:43]
v_mfma_f32_16x16x32_bf16 v[48:51], v[28:31], v[172:175], v[48:51]
v_mfma_f32_16x16x32_bf16 v[44:47], v[100:103], v[28:31], v[44:47]
v_mfma_f32_16x16x32_bf16 v[52:55], v[28:31], v[244:247], v[52:55]
s_waitcnt lgkmcnt(1)
v_mfma_f32_16x16x32_bf16 v[40:43], a[208:211], v[32:35], v[40:43]
v_mfma_f32_16x16x32_bf16 v[48:51], v[32:35], v[176:179], v[48:51]
v_mfma_f32_16x16x32_bf16 v[44:47], v[104:107], v[32:35], v[44:47]
v_mfma_f32_16x16x32_bf16 v[52:55], v[32:35], v[248:251], v[52:55]
s_waitcnt lgkmcnt(0)
v_mfma_f32_16x16x32_bf16 v[40:43], a[212:215], v[36:39], v[40:43]
v_mfma_f32_16x16x32_bf16 v[48:51], v[36:39], v[180:183], v[48:51]
v_mfma_f32_16x16x32_bf16 v[44:47], v[108:111], v[36:39], v[44:47]
v_mfma_f32_16x16x32_bf16 v[52:55], v[36:39], v[252:255], v[52:55]
s_nop 7
v_cvt_pk_bf16_f32 v56, v40, v41
v_cvt_pk_bf16_f32 v57, v42, v43
v_cvt_pk_bf16_f32 v58, v44, v45
v_cvt_pk_bf16_f32 v59, v46, v47
ds_write_b128 v7, v[56:59]
v_cvt_pk_bf16_f32 v48, v48, v49
v_cvt_pk_bf16_f32 v49, v50, v51
ds_write_b64 v8, v[48:49] offset:0
v_cvt_pk_bf16_f32 v52, v52, v53
v_cvt_pk_bf16_f32 v53, v54, v55
ds_write_b64 v8, v[52:53] offset:512
s_waitcnt lgkmcnt(0)
s_barrier
ds_read_b128 v[28:31], v5 offset:0
ds_read_b128 v[32:35], v5 offset:1024
ds_read_b128 v[36:39], v5 offset:2048
ds_read_b128 v[40:43], v5 offset:3072
v_add_u32 v3, s42, v0
v_add_u32 v10, 81920, v0
ds_read_b128 v[44:47], v10 offset:0
ds_read_b128 v[48:51], v10 offset:1024
ds_read_b128 v[52:55], v10 offset:2048
s_waitcnt lgkmcnt(2)
v_mfma_f32_16x16x32_bf16 v[56:59], v[44:47], v[28:31], v[24:27]
ds_read_b128 v[44:47], v10 offset:3072
s_waitcnt lgkmcnt(2)
v_mfma_f32_16x16x32_bf16 v[56:59], v[48:51], v[32:35], v[56:59]
ds_read_b128 v[48:51], v3 offset:0
s_waitcnt lgkmcnt(2)
v_mfma_f32_16x16x32_bf16 v[56:59], v[52:55], v[36:39], v[56:59]
ds_read_b128 v[52:55], v3 offset:1024
s_waitcnt lgkmcnt(2)
v_mfma_f32_16x16x32_bf16 v[56:59], v[44:47], v[40:43], v[56:59]
ds_read_b128 v[44:47], v3 offset:2048
s_waitcnt lgkmcnt(2)
v_mfma_f32_16x16x32_bf16 v[60:63], v[48:51], v[28:31], v[16:19]
ds_read_b128 v[48:51], v3 offset:3072
s_waitcnt lgkmcnt(2)
v_mfma_f32_16x16x32_bf16 v[60:63], v[52:55], v[32:35], v[60:63]
ds_read_b128 v[52:55], v3 offset:4096
s_waitcnt lgkmcnt(2)
v_mfma_f32_16x16x32_bf16 v[60:63], v[44:47], v[36:39], v[60:63]
ds_read_b128 v[44:47], v3 offset:5120
s_waitcnt lgkmcnt(2)
v_mfma_f32_16x16x32_bf16 v[60:63], v[48:51], v[40:43], v[60:63]
ds_read_b128 v[48:51], v3 offset:6144
s_waitcnt lgkmcnt(2)
v_mfma_f32_16x16x32_bf16 v[64:67], v[52:55], v[28:31], v[20:23]
ds_read_b128 v[52:55], v3 offset:7168
s_waitcnt lgkmcnt(2)
v_mfma_f32_16x16x32_bf16 v[64:67], v[44:47], v[32:35], v[64:67]
s_waitcnt lgkmcnt(1)
v_mfma_f32_16x16x32_bf16 v[64:67], v[48:51], v[36:39], v[64:67]
s_waitcnt lgkmcnt(0)
v_mfma_f32_16x16x32_bf16 v[64:67], v[52:55], v[40:43], v[64:67]
s_nop 7
s_nop 0
v_exp_f32 v56, v56
v_exp_f32 v57, v57
v_exp_f32 v58, v58
v_exp_f32 v59, v59
v_exp_f32 v60, v60
v_exp_f32 v61, v61
v_exp_f32 v62, v62
v_exp_f32 v63, v63
v_exp_f32 v64, v64
v_exp_f32 v65, v65
v_exp_f32 v66, v66
v_exp_f32 v67, v67
s_nop 0
v_cvt_pk_bf16_f32 v72, v56, v57
v_cvt_pk_bf16_f32 v73, v58, v59
v_cvt_pk_bf16_f32 v68, v60, v61
v_cvt_pk_bf16_f32 v69, v62, v63
v_cvt_pk_bf16_f32 v70, v64, v65
v_cvt_pk_bf16_f32 v71, v66, v67
s_lshl_b32 s28, s34, 12
s_add_u32 s28, s28, 8192
v_add_u32 v11, s28, v3
ds_read_b128 v[44:47], v11 offset:0
ds_read_b128 v[48:51], v11 offset:1024
ds_read_b128 v[52:55], v11 offset:2048
ds_read_b64 v[56:57], v9 offset:0
ds_read_b64 v[58:59], v9 offset:512
ds_read_b64 v[60:61], v9 offset:1024
ds_read_b64 v[62:63], v9 offset:1536
v_mfma_f32_16x16x32_bf16 v[76:79], v[12:15], v[68:71], 0
s_waitcnt lgkmcnt(0)
v_mfma_f32_16x16x32_bf16 v[28:31], v[44:47], v[68:71], 0
v_mfma_f32_16x16x32_bf16 v[32:35], v[48:51], v[68:71], 0
v_mfma_f32_16x16x32_bf16 v[36:39], v[52:55], v[68:71], 0
ds_read_b128 v[44:47], v11 offset:3072
s_waitcnt lgkmcnt(0)
v_mfma_f32_16x16x32_bf16 v[40:43], v[44:47], v[68:71], 0
s_nop 7
v_mfma_f32_16x16x16_bf16 v[76:79], v[12:13], v[72:73], v[76:79]
v_mfma_f32_16x16x16_bf16 v[28:31], v[56:57], v[72:73], v[28:31]
v_mfma_f32_16x16x16_bf16 v[32:35], v[58:59], v[72:73], v[32:35]
v_mfma_f32_16x16x16_bf16 v[36:39], v[60:61], v[72:73], v[36:39]
v_mfma_f32_16x16x16_bf16 v[40:43], v[62:63], v[72:73], v[40:43]
s_nop 7
v_mov_b32 v10, s45
v_med3_f32 v10, v76, s44, v10
v_cmp_neq_f32 vcc, v10, v76
s_cbranch_vccnz AS_28
AB_29:
v_rcp_f32 v10, v76
s_nop 0
s_lshl_b32 s28, s24, 1
s_and_b32 s29, s17, 1
s_add_u32 s28, s28, s29
s_lshl_b32 s28, s28, 7
s_lshl_b32 s29, s16, 2
s_add_u32 s28, s28, s29
s_lshl_b32 s29, s34, 1
s_add_u32 s28, s28, s29
s_lshl_b32 s28, s28, 10
s_add_u32 s43, s28, 35667968
v_mul_f32 v28, v28, v10
v_mul_f32 v29, v29, v10
v_mul_f32 v30, v30, v10
v_mul_f32 v31, v31, v10
v_cvt_pk_bf16_f32 v64, v28, v29
v_cvt_pk_bf16_f32 v65, v30, v31
v_mul_f32 v32, v32, v10
v_mul_f32 v33, v33, v10
v_mul_f32 v34, v34, v10
v_mul_f32 v35, v35, v10
v_cvt_pk_bf16_f32 v66, v32, v33
v_cvt_pk_bf16_f32 v67, v34, v35
buffer_store_dwordx4 v[64:67], v0, s[8:11], s43 offen offset:0 sc1
v_mul_f32 v36, v36, v10
v_mul_f32 v37, v37, v10
v_mul_f32 v38, v38, v10
v_mul_f32 v39, v39, v10
v_cvt_pk_bf16_f32 v68, v36, v37
v_cvt_pk_bf16_f32 v69, v38, v39
v_mul_f32 v40, v40, v10
v_mul_f32 v41, v41, v10
v_mul_f32 v42, v42, v10
v_mul_f32 v43, v43, v10
v_cvt_pk_bf16_f32 v70, v40, v41
v_cvt_pk_bf16_f32 v71, v42, v43
buffer_store_dwordx4 v[68:71], v0, s[8:11], s43 offen offset:1024 sc1
s_mov_b32 s46, s24
s_xor_b32 s26, s26, 36864
s_xor_b32 s42, s42, 49152
s_add_u32 s24, s24, 2
s_cmp_lt_u32 s24, 64
s_cbranch_scc1 AL_24
s_waitcnt vmcnt(0)
s_barrier
s_cmp_eq_u32 s17, 0
s_cbranch_scc0 ANF_35
s_lshl_b32 s28, s46, 7
s_lshl_b32 s29, s16, 2
s_add_u32 s28, s28, s29
s_add_u32 s28, s28, 827392
v_mov_b32 v10, s7
v_mov_b32 v11, 0
s_mov_b64 exec, 1
buffer_store_dword v10, v11, s[8:11], s28 offen sc1
s_mov_b64 exec, -1
ANF_35:
s_branch AE_26
AS_28:
s_nop 7
ds_read_b128 v[28:31], v5 offset:0
ds_read_b128 v[32:35], v5 offset:1024
ds_read_b128 v[36:39], v5 offset:2048
ds_read_b128 v[40:43], v5 offset:3072
v_add_u32 v10, 81920, v0
s_waitcnt lgkmcnt(0)
ds_read_b128 v[44:47], v10 offset:0
ds_read_b128 v[48:51], v10 offset:1024
ds_read_b128 v[52:55], v10 offset:2048
s_waitcnt lgkmcnt(2)
v_mfma_f32_16x16x32_bf16 v[56:59], v[44:47], v[28:31], v[24:27]
ds_read_b128 v[44:47], v10 offset:3072
s_waitcnt lgkmcnt(2)
v_mfma_f32_16x16x32_bf16 v[56:59], v[48:51], v[32:35], v[56:59]
ds_read_b128 v[48:51], v3 offset:0
s_waitcnt lgkmcnt(2)
v_mfma_f32_16x16x32_bf16 v[56:59], v[52:55], v[36:39], v[56:59]
ds_read_b128 v[52:55], v3 offset:1024
s_waitcnt lgkmcnt(2)
v_mfma_f32_16x16x32_bf16 v[56:59], v[44:47], v[40:43], v[56:59]
ds_read_b128 v[44:47], v3 offset:2048
s_waitcnt lgkmcnt(2)
v_mfma_f32_16x16x32_bf16 v[60:63], v[48:51], v[28:31], v[16:19]
ds_read_b128 v[48:51], v3 offset:3072
s_waitcnt lgkmcnt(2)
v_mfma_f32_16x16x32_bf16 v[60:63], v[52:55], v[32:35], v[60:63]
ds_read_b128 v[52:55], v3 offset:4096
s_waitcnt lgkmcnt(2)
v_mfma_f32_16x16x32_bf16 v[60:63], v[44:47], v[36:39], v[60:63]
ds_read_b128 v[44:47], v3 offset:5120
s_waitcnt lgkmcnt(2)
v_mfma_f32_16x16x32_bf16 v[60:63], v[48:51], v[40:43], v[60:63]
ds_read_b128 v[48:51], v3 offset:6144
s_waitcnt lgkmcnt(2)
v_mfma_f32_16x16x32_bf16 v[64:67], v[52:55], v[28:31], v[20:23]
ds_read_b128 v[52:55], v3 offset:7168
s_waitcnt lgkmcnt(2)
v_mfma_f32_16x16x32_bf16 v[64:67], v[44:47], v[32:35], v[64:67]
s_waitcnt lgkmcnt(1)
v_mfma_f32_16x16x32_bf16 v[64:67], v[48:51], v[36:39], v[64:67]
s_waitcnt lgkmcnt(0)
v_mfma_f32_16x16x32_bf16 v[64:67], v[52:55], v[40:43], v[64:67]
s_nop 7
s_nop 0
v_max3_f32 v10, v56, v57, v58
v_max3_f32 v10, v59, v60, v10
v_max3_f32 v10, v61, v62, v10
v_max3_f32 v10, v63, v64, v10
v_max3_f32 v10, v65, v66, v10
v_max_f32 v10, v67, v10
v_mov_b32 v11, v10
s_nop 1
v_permlane32_swap_b32 v11, v10
s_nop 1
v_max_f32 v10, v10, v11
v_mov_b32 v11, v10
s_nop 1
v_permlane16_swap_b32 v11, v10
s_nop 1
v_max_f32 v10, v10, v11
v_sub_f32 v56, v56, v10
v_sub_f32 v57, v57, v10
v_sub_f32 v58, v58, v10
v_sub_f32 v59, v59, v10
v_sub_f32 v60, v60, v10
v_sub_f32 v61, v61, v10
v_sub_f32 v62, v62, v10
v_sub_f32 v63, v63, v10
v_sub_f32 v64, v64, v10
v_sub_f32 v65, v65, v10
v_sub_f32 v66, v66, v10
v_sub_f32 v67, v67, v10
v_exp_f32 v56, v56
v_exp_f32 v57, v57
v_exp_f32 v58, v58
v_exp_f32 v59, v59
v_exp_f32 v60, v60
v_exp_f32 v61, v61
v_exp_f32 v62, v62
v_exp_f32 v63, v63
v_exp_f32 v64, v64
v_exp_f32 v65, v65
v_exp_f32 v66, v66
v_exp_f32 v67, v67
s_nop 0
v_cvt_pk_bf16_f32 v72, v56, v57
v_cvt_pk_bf16_f32 v73, v58, v59
v_cvt_pk_bf16_f32 v68, v60, v61
v_cvt_pk_bf16_f32 v69, v62, v63
v_cvt_pk_bf16_f32 v70, v64, v65
v_cvt_pk_bf16_f32 v71, v66, v67
s_lshl_b32 s28, s34, 12
s_add_u32 s28, s28, 8192
v_add_u32 v11, s28, v3
ds_read_b128 v[44:47], v11 offset:0
ds_read_b128 v[48:51], v11 offset:1024
ds_read_b128 v[52:55], v11 offset:2048
ds_read_b64 v[56:57], v9 offset:0
ds_read_b64 v[58:59], v9 offset:512
ds_read_b64 v[60:61], v9 offset:1024
ds_read_b64 v[62:63], v9 offset:1536
v_mfma_f32_16x16x32_bf16 v[76:79], v[12:15], v[68:71], 0
s_waitcnt lgkmcnt(0)
v_mfma_f32_16x16x32_bf16 v[28:31], v[44:47], v[68:71], 0
v_mfma_f32_16x16x32_bf16 v[32:35], v[48:51], v[68:71], 0
v_mfma_f32_16x16x32_bf16 v[36:39], v[52:55], v[68:71], 0
ds_read_b128 v[44:47], v11 offset:3072
s_waitcnt lgkmcnt(0)
v_mfma_f32_16x16x32_bf16 v[40:43], v[44:47], v[68:71], 0
s_nop 7
v_mfma_f32_16x16x16_bf16 v[76:79], v[12:13], v[72:73], v[76:79]
v_mfma_f32_16x16x16_bf16 v[28:31], v[56:57], v[72:73], v[28:31]
v_mfma_f32_16x16x16_bf16 v[32:35], v[58:59], v[72:73], v[32:35]
v_mfma_f32_16x16x16_bf16 v[36:39], v[60:61], v[72:73], v[36:39]
v_mfma_f32_16x16x16_bf16 v[40:43], v[62:63], v[72:73], v[40:43]
s_nop 7
s_branch AB_29
AF_27:
s_mov_b32 s19, 1
AE_26:
s_branch K_END
K_WB1:
s_sub_u32 s52, s51, 64
s_cmp_lt_u32 s52, 24
s_cbranch_scc0 K_B1
s_cmp_ge_u32 s52, 12
s_cselect_b32 s54, 1, 0
s_mul_i32 s53, s54, 12
s_sub_u32 s53, s52, s53
s_mov_b32 s24, s53
s_mov_b32 s25, s54
s_mov_b32 s19, 0
s_mul_i32 s28, s24, 96
s_mul_i32 s29, s17, 1179648
s_add_u32 s28, s28, s29
s_load_dwordx2 s[4:5], s[0:1], 40
s_waitcnt lgkmcnt(0)
s_add_u32 s12, s4, s28
s_addc_u32 s13, s5, 0
s_sub_u32 s14, 4718592, s28
s_mov_b32 s15, 0x00020000
v_lshrrev_b32 v2, 4, v0
s_mul_i32 s30, s17, 24576
v_lshrrev_b32 v4, 8, v0
v_bfe_u32 v5, v0, 6, 2
v_bfe_u32 v6, v0, 4, 2
v_lshl_add_u32 v4, v4, 2, v5
v_mul_u32_u24 v4, 96, v4
v_lshl_add_u32 v4, v6, 3, v4
v_add_u32 v4, s30, v4
v_add_u32 v3, 0, v2
v_mul_u32_u24 v5, 43691, v3
v_lshrrev_b32 v5, 18, v5
v_mul_u32_u24 v6, 6, v5
v_sub_u32 v6, v3, v6
v_mul_u32_u24 v5, 1152, v5
v_lshl_add_u32 v5, v6, 4, v5
s_add_u32 s31, s30, 0
s_mov_b32 m0, s31
s_mov_b32 s33, 0
buffer_load_dwordx4 v5, s[12:15], s33 offen lds
v_add_u32 v3, 64, v2
v_mul_u32_u24 v5, 43691, v3
v_lshrrev_b32 v5, 18, v5
v_mul_u32_u24 v6, 6, v5
v_sub_u32 v6, v3, v6
v_mul_u32_u24 v5, 1152, v5
v_lshl_add_u32 v5, v6, 4, v5
s_add_u32 s31, s30, 1024
s_mov_b32 m0, s31
s_mov_b32 s33, 0
buffer_load_dwordx4 v5, s[12:15], s33 offen lds
v_add_u32 v3, 128, v2
v_mul_u32_u24 v5, 43691, v3
v_lshrrev_b32 v5, 18, v5
v_mul_u32_u24 v6, 6, v5
v_sub_u32 v6, v3, v6
v_mul_u32_u24 v5, 1152, v5
v_lshl_add_u32 v5, v6, 4, v5
s_add_u32 s31, s30, 2048
s_mov_b32 m0, s31
s_mov_b32 s33, 0
buffer_load_dwordx4 v5, s[12:15], s33 offen lds
v_add_u32 v3, 192, v2
v_mul_u32_u24 v5, 43691, v3
v_lshrrev_b32 v5, 18, v5
v_mul_u32_u24 v6, 6, v5
v_sub_u32 v6, v3, v6
v_mul_u32_u24 v5, 1152, v5
v_lshl_add_u32 v5, v6, 4, v5
s_add_u32 s31, s30, 3072
s_mov_b32 m0, s31
s_mov_b32 s33, 0
buffer_load_dwordx4 v5, s[12:15], s33 offen lds
v_add_u32 v3, 256, v2
v_mul_u32_u24 v5, 43691, v3
v_lshrrev_b32 v5, 18, v5
v_mul_u32_u24 v6, 6, v5
v_sub_u32 v6, v3, v6
v_mul_u32_u24 v5, 1152, v5
v_lshl_add_u32 v5, v6, 4, v5
s_add_u32 s31, s30, 4096
s_mov_b32 m0, s31
s_mov_b32 s33, 0
buffer_load_dwordx4 v5, s[12:15], s33 offen lds
v_add_u32 v3, 320, v2
v_mul_u32_u24 v5, 43691, v3
v_lshrrev_b32 v5, 18, v5
v_mul_u32_u24 v6, 6, v5
v_sub_u32 v6, v3, v6
v_mul_u32_u24 v5, 1152, v5
v_lshl_add_u32 v5, v6, 4, v5
s_add_u32 s31, s30, 5120
s_mov_b32 m0, s31
s_mov_b32 s33, 0
buffer_load_dwordx4 v5, s[12:15], s33 offen lds
v_add_u32 v3, 384, v2
v_mul_u32_u24 v5, 43691, v3
v_lshrrev_b32 v5, 18, v5
v_mul_u32_u24 v6, 6, v5
v_sub_u32 v6, v3, v6
v_mul_u32_u24 v5, 1152, v5
v_lshl_add_u32 v5, v6, 4, v5
s_add_u32 s31, s30, 6144
s_mov_b32 m0, s31
s_mov_b32 s33, 0
buffer_load_dwordx4 v5, s[12:15], s33 offen lds
v_add_u32 v3, 448, v2
v_mul_u32_u24 v5, 43691, v3
v_lshrrev_b32 v5, 18, v5
v_mul_u32_u24 v6, 6, v5
v_sub_u32 v6, v3, v6
v_mul_u32_u24 v5, 1152, v5
v_lshl_add_u32 v5, v6, 4, v5
s_add_u32 s31, s30, 7168
s_mov_b32 m0, s31
s_mov_b32 s33, 0
buffer_load_dwordx4 v5, s[12:15], s33 offen lds
v_add_u32 v3, 512, v2
v_mul_u32_u24 v5, 43691, v3
v_lshrrev_b32 v5, 18, v5
v_mul_u32_u24 v6, 6, v5
v_sub_u32 v6, v3, v6
v_mul_u32_u24 v5, 1152, v5
v_lshl_add_u32 v5, v6, 4, v5
s_add_u32 s31, s30, 8192
s_mov_b32 m0, s31
s_mov_b32 s33, 0
buffer_load_dwordx4 v5, s[12:15], s33 offen lds
v_add_u32 v3, 576, v2
v_mul_u32_u24 v5, 43691, v3
v_lshrrev_b32 v5, 18, v5
v_mul_u32_u24 v6, 6, v5
v_sub_u32 v6, v3, v6
v_mul_u32_u24 v5, 1152, v5
v_lshl_add_u32 v5, v6, 4, v5
s_add_u32 s31, s30, 9216
s_mov_b32 m0, s31
s_mov_b32 s33, 0
buffer_load_dwordx4 v5, s[12:15], s33 offen lds
v_add_u32 v3, 640, v2
v_mul_u32_u24 v5, 43691, v3
v_lshrrev_b32 v5, 18, v5
v_mul_u32_u24 v6, 6, v5
v_sub_u32 v6, v3, v6
v_mul_u32_u24 v5, 1152, v5
v_lshl_add_u32 v5, v6, 4, v5
s_add_u32 s31, s30, 10240
s_mov_b32 m0, s31
s_mov_b32 s33, 0
buffer_load_dwordx4 v5, s[12:15], s33 offen lds
v_add_u32 v3, 704, v2
v_mul_u32_u24 v5, 43691, v3
v_lshrrev_b32 v5, 18, v5
v_mul_u32_u24 v6, 6, v5
v_sub_u32 v6, v3, v6
v_mul_u32_u24 v5, 1152, v5
v_lshl_add_u32 v5, v6, 4, v5
s_add_u32 s31, s30, 11264
s_mov_b32 m0, s31
s_mov_b32 s33, 0
buffer_load_dwordx4 v5, s[12:15], s33 offen lds
v_add_u32 v3, 768, v2
v_mul_u32_u24 v5, 43691, v3
v_lshrrev_b32 v5, 18, v5
v_mul_u32_u24 v6, 6, v5
v_sub_u32 v6, v3, v6
v_mul_u32_u24 v5, 1152, v5
v_lshl_add_u32 v5, v6, 4, v5
s_add_u32 s31, s30, 12288
s_mov_b32 m0, s31
s_mov_b32 s33, 0
buffer_load_dwordx4 v5, s[12:15], s33 offen lds
v_add_u32 v3, 832, v2
v_mul_u32_u24 v5, 43691, v3
v_lshrrev_b32 v5, 18, v5
v_mul_u32_u24 v6, 6, v5
v_sub_u32 v6, v3, v6
v_mul_u32_u24 v5, 1152, v5
v_lshl_add_u32 v5, v6, 4, v5
s_add_u32 s31, s30, 13312
s_mov_b32 m0, s31
s_mov_b32 s33, 0
buffer_load_dwordx4 v5, s[12:15], s33 offen lds
v_add_u32 v3, 896, v2
v_mul_u32_u24 v5, 43691, v3
v_lshrrev_b32 v5, 18, v5
v_mul_u32_u24 v6, 6, v5
v_sub_u32 v6, v3, v6
v_mul_u32_u24 v5, 1152, v5
v_lshl_add_u32 v5, v6, 4, v5
s_add_u32 s31, s30, 14336
s_mov_b32 m0, s31
s_mov_b32 s33, 0
buffer_load_dwordx4 v5, s[12:15], s33 offen lds
v_add_u32 v3, 960, v2
v_mul_u32_u24 v5, 43691, v3
v_lshrrev_b32 v5, 18, v5
v_mul_u32_u24 v6, 6, v5
v_sub_u32 v6, v3, v6
v_mul_u32_u24 v5, 1152, v5
v_lshl_add_u32 v5, v6, 4, v5
s_add_u32 s31, s30, 15360
s_mov_b32 m0, s31
s_mov_b32 s33, 0
buffer_load_dwordx4 v5, s[12:15], s33 offen lds
v_add_u32 v3, 1024, v2
v_mul_u32_u24 v5, 43691, v3
v_lshrrev_b32 v5, 18, v5
v_mul_u32_u24 v6, 6, v5
v_sub_u32 v6, v3, v6
v_mul_u32_u24 v5, 1152, v5
v_lshl_add_u32 v5, v6, 4, v5
s_add_u32 s31, s30, 16384
s_mov_b32 m0, s31
s_mov_b32 s33, 0
buffer_load_dwordx4 v5, s[12:15], s33 offen lds
v_add_u32 v3, 1088, v2
v_mul_u32_u24 v5, 43691, v3
v_lshrrev_b32 v5, 18, v5
v_mul_u32_u24 v6, 6, v5
v_sub_u32 v6, v3, v6
v_mul_u32_u24 v5, 1152, v5
v_lshl_add_u32 v5, v6, 4, v5
s_add_u32 s31, s30, 17408
s_mov_b32 m0, s31
s_mov_b32 s33, 0
buffer_load_dwordx4 v5, s[12:15], s33 offen lds
v_add_u32 v3, 1152, v2
v_mul_u32_u24 v5, 43691, v3
v_lshrrev_b32 v5, 18, v5
v_mul_u32_u24 v6, 6, v5
v_sub_u32 v6, v3, v6
v_mul_u32_u24 v5, 1152, v5
v_lshl_add_u32 v5, v6, 4, v5
s_add_u32 s31, s30, 18432
s_mov_b32 m0, s31
s_mov_b32 s33, 0
buffer_load_dwordx4 v5, s[12:15], s33 offen lds
v_add_u32 v3, 1216, v2
v_mul_u32_u24 v5, 43691, v3
v_lshrrev_b32 v5, 18, v5
v_mul_u32_u24 v6, 6, v5
v_sub_u32 v6, v3, v6
v_mul_u32_u24 v5, 1152, v5
v_lshl_add_u32 v5, v6, 4, v5
s_add_u32 s31, s30, 19456
s_mov_b32 m0, s31
s_mov_b32 s33, 0
buffer_load_dwordx4 v5, s[12:15], s33 offen lds
v_add_u32 v3, 1280, v2
v_mul_u32_u24 v5, 43691, v3
v_lshrrev_b32 v5, 18, v5
v_mul_u32_u24 v6, 6, v5
v_sub_u32 v6, v3, v6
v_mul_u32_u24 v5, 1152, v5
v_lshl_add_u32 v5, v6, 4, v5
s_add_u32 s31, s30, 20480
s_mov_b32 m0, s31
s_mov_b32 s33, 0
buffer_load_dwordx4 v5, s[12:15], s33 offen lds
v_add_u32 v3, 1344, v2
v_mul_u32_u24 v5, 43691, v3
v_lshrrev_b32 v5, 18, v5
v_mul_u32_u24 v6, 6, v5
v_sub_u32 v6, v3, v6
v_mul_u32_u24 v5, 1152, v5
v_lshl_add_u32 v5, v6, 4, v5
s_add_u32 s31, s30, 21504
s_mov_b32 m0, s31
s_mov_b32 s33, 0
buffer_load_dwordx4 v5, s[12:15], s33 offen lds
v_add_u32 v3, 1408, v2
v_mul_u32_u24 v5, 43691, v3
v_lshrrev_b32 v5, 18, v5
v_mul_u32_u24 v6, 6, v5
v_sub_u32 v6, v3, v6
v_mul_u32_u24 v5, 1152, v5
v_lshl_add_u32 v5, v6, 4, v5
s_add_u32 s31, s30, 22528
s_mov_b32 m0, s31
s_mov_b32 s33, 0
buffer_load_dwordx4 v5, s[12:15], s33 offen lds
v_add_u32 v3, 1472, v2
v_mul_u32_u24 v5, 43691, v3
v_lshrrev_b32 v5, 18, v5
v_mul_u32_u24 v6, 6, v5
v_sub_u32 v6, v3, v6
v_mul_u32_u24 v5, 1152, v5
v_lshl_add_u32 v5, v6, 4, v5
s_add_u32 s31, s30, 23552
s_mov_b32 m0, s31
s_mov_b32 s33, 0
buffer_load_dwordx4 v5, s[12:15], s33 offen lds
s_waitcnt vmcnt(0)
ds_read_b64_tr_b16 a[0:1], v4 offset:0
ds_read_b64_tr_b16 a[2:3], v4 offset:1536
ds_read_b64_tr_b16 a[128:129], v4 offset:32
ds_read_b64_tr_b16 a[130:131], v4 offset:1568
ds_read_b64_tr_b16 v[128:129], v4 offset:64
ds_read_b64_tr_b16 v[130:131], v4 offset:1600
s_waitcnt lgkmcnt(0)
ds_read_b64_tr_b16 a[4:5], v4 offset:3072
ds_read_b64_tr_b16 a[6:7], v4 offset:4608
ds_read_b64_tr_b16 a[132:133], v4 offset:3104
ds_read_b64_tr_b16 a[134:135], v4 offset:4640
ds_read_b64_tr_b16 v[132:133], v4 offset:3136
ds_read_b64_tr_b16 v[134:135], v4 offset:4672
s_waitcnt lgkmcnt(0)
ds_read_b64_tr_b16 a[8:9], v4 offset:6144
ds_read_b64_tr_b16 a[10:11], v4 offset:7680
ds_read_b64_tr_b16 a[136:137], v4 offset:6176
ds_read_b64_tr_b16 a[138:139], v4 offset:7712
ds_read_b64_tr_b16 v[136:137], v4 offset:6208
ds_read_b64_tr_b16 v[138:139], v4 offset:7744
s_waitcnt lgkmcnt(0)
ds_read_b64_tr_b16 a[12:13], v4 offset:9216
ds_read_b64_tr_b16 a[14:15], v4 offset:10752
ds_read_b64_tr_b16 a[140:141], v4 offset:9248
ds_read_b64_tr_b16 a[142:143], v4 offset:10784
ds_read_b64_tr_b16 v[140:141], v4 offset:9280
ds_read_b64_tr_b16 v[142:143], v4 offset:10816
s_waitcnt lgkmcnt(0)
ds_read_b64_tr_b16 a[16:17], v4 offset:12288
ds_read_b64_tr_b16 a[18:19], v4 offset:13824
ds_read_b64_tr_b16 a[144:145], v4 offset:12320
ds_read_b64_tr_b16 a[146:147], v4 offset:13856
ds_read_b64_tr_b16 v[144:145], v4 offset:12352
ds_read_b64_tr_b16 v[146:147], v4 offset:13888
s_waitcnt lgkmcnt(0)
ds_read_b64_tr_b16 a[20:21], v4 offset:15360
ds_read_b64_tr_b16 a[22:23], v4 offset:16896
ds_read_b64_tr_b16 a[148:149], v4 offset:15392
ds_read_b64_tr_b16 a[150:151], v4 offset:16928
ds_read_b64_tr_b16 v[148:149], v4 offset:15424
ds_read_b64_tr_b16 v[150:151], v4 offset:16960
s_waitcnt lgkmcnt(0)
ds_read_b64_tr_b16 a[24:25], v4 offset:18432
ds_read_b64_tr_b16 a[26:27], v4 offset:19968
ds_read_b64_tr_b16 a[152:153], v4 offset:18464
ds_read_b64_tr_b16 a[154:155], v4 offset:20000
ds_read_b64_tr_b16 v[152:153], v4 offset:18496
ds_read_b64_tr_b16 v[154:155], v4 offset:20032
s_waitcnt lgkmcnt(0)
ds_read_b64_tr_b16 a[28:29], v4 offset:21504
ds_read_b64_tr_b16 a[30:31], v4 offset:23040
ds_read_b64_tr_b16 a[156:157], v4 offset:21536
ds_read_b64_tr_b16 a[158:159], v4 offset:23072
ds_read_b64_tr_b16 v[156:157], v4 offset:21568
ds_read_b64_tr_b16 v[158:159], v4 offset:23104
s_waitcnt lgkmcnt(0)
v_add_u32 v3, 0, v2
v_mul_u32_u24 v5, 43691, v3
v_lshrrev_b32 v5, 18, v5
v_mul_u32_u24 v6, 6, v5
v_sub_u32 v6, v3, v6
v_mul_u32_u24 v5, 1152, v5
v_lshl_add_u32 v5, v6, 4, v5
s_add_u32 s31, s30, 0
s_mov_b32 m0, s31
s_mov_b32 s33, 294912
buffer_load_dwordx4 v5, s[12:15], s33 offen lds
v_add_u32 v3, 64, v2
v_mul_u32_u24 v5, 43691, v3
v_lshrrev_b32 v5, 18, v5
v_mul_u32_u24 v6, 6, v5
v_sub_u32 v6, v3, v6
v_mul_u32_u24 v5, 1152, v5
v_lshl_add_u32 v5, v6, 4, v5
s_add_u32 s31, s30, 1024
s_mov_b32 m0, s31
s_mov_b32 s33, 294912
buffer_load_dwordx4 v5, s[12:15], s33 offen lds
v_add_u32 v3, 128, v2
v_mul_u32_u24 v5, 43691, v3
v_lshrrev_b32 v5, 18, v5
v_mul_u32_u24 v6, 6, v5
v_sub_u32 v6, v3, v6
v_mul_u32_u24 v5, 1152, v5
v_lshl_add_u32 v5, v6, 4, v5
s_add_u32 s31, s30, 2048
s_mov_b32 m0, s31
s_mov_b32 s33, 294912
buffer_load_dwordx4 v5, s[12:15], s33 offen lds
v_add_u32 v3, 192, v2
v_mul_u32_u24 v5, 43691, v3
v_lshrrev_b32 v5, 18, v5
v_mul_u32_u24 v6, 6, v5
v_sub_u32 v6, v3, v6
v_mul_u32_u24 v5, 1152, v5
v_lshl_add_u32 v5, v6, 4, v5
s_add_u32 s31, s30, 3072
s_mov_b32 m0, s31
s_mov_b32 s33, 294912
buffer_load_dwordx4 v5, s[12:15], s33 offen lds
v_add_u32 v3, 256, v2
v_mul_u32_u24 v5, 43691, v3
v_lshrrev_b32 v5, 18, v5
v_mul_u32_u24 v6, 6, v5
v_sub_u32 v6, v3, v6
v_mul_u32_u24 v5, 1152, v5
v_lshl_add_u32 v5, v6, 4, v5
s_add_u32 s31, s30, 4096
s_mov_b32 m0, s31
s_mov_b32 s33, 294912
buffer_load_dwordx4 v5, s[12:15], s33 offen lds
v_add_u32 v3, 320, v2
v_mul_u32_u24 v5, 43691, v3
v_lshrrev_b32 v5, 18, v5
v_mul_u32_u24 v6, 6, v5
v_sub_u32 v6, v3, v6
v_mul_u32_u24 v5, 1152, v5
v_lshl_add_u32 v5, v6, 4, v5
s_add_u32 s31, s30, 5120
s_mov_b32 m0, s31
s_mov_b32 s33, 294912
buffer_load_dwordx4 v5, s[12:15], s33 offen lds
v_add_u32 v3, 384, v2
v_mul_u32_u24 v5, 43691, v3
v_lshrrev_b32 v5, 18, v5
v_mul_u32_u24 v6, 6, v5
v_sub_u32 v6, v3, v6
v_mul_u32_u24 v5, 1152, v5
v_lshl_add_u32 v5, v6, 4, v5
s_add_u32 s31, s30, 6144
s_mov_b32 m0, s31
s_mov_b32 s33, 294912
buffer_load_dwordx4 v5, s[12:15], s33 offen lds
v_add_u32 v3, 448, v2
v_mul_u32_u24 v5, 43691, v3
v_lshrrev_b32 v5, 18, v5
v_mul_u32_u24 v6, 6, v5
v_sub_u32 v6, v3, v6
v_mul_u32_u24 v5, 1152, v5
v_lshl_add_u32 v5, v6, 4, v5
s_add_u32 s31, s30, 7168
s_mov_b32 m0, s31
s_mov_b32 s33, 294912
buffer_load_dwordx4 v5, s[12:15], s33 offen lds
v_add_u32 v3, 512, v2
v_mul_u32_u24 v5, 43691, v3
v_lshrrev_b32 v5, 18, v5
v_mul_u32_u24 v6, 6, v5
v_sub_u32 v6, v3, v6
v_mul_u32_u24 v5, 1152, v5
v_lshl_add_u32 v5, v6, 4, v5
s_add_u32 s31, s30, 8192
s_mov_b32 m0, s31
s_mov_b32 s33, 294912
buffer_load_dwordx4 v5, s[12:15], s33 offen lds
v_add_u32 v3, 576, v2
v_mul_u32_u24 v5, 43691, v3
v_lshrrev_b32 v5, 18, v5
v_mul_u32_u24 v6, 6, v5
v_sub_u32 v6, v3, v6
v_mul_u32_u24 v5, 1152, v5
v_lshl_add_u32 v5, v6, 4, v5
s_add_u32 s31, s30, 9216
s_mov_b32 m0, s31
s_mov_b32 s33, 294912
buffer_load_dwordx4 v5, s[12:15], s33 offen lds
v_add_u32 v3, 640, v2
v_mul_u32_u24 v5, 43691, v3
v_lshrrev_b32 v5, 18, v5
v_mul_u32_u24 v6, 6, v5
v_sub_u32 v6, v3, v6
v_mul_u32_u24 v5, 1152, v5
v_lshl_add_u32 v5, v6, 4, v5
s_add_u32 s31, s30, 10240
s_mov_b32 m0, s31
s_mov_b32 s33, 294912
buffer_load_dwordx4 v5, s[12:15], s33 offen lds
v_add_u32 v3, 704, v2
v_mul_u32_u24 v5, 43691, v3
v_lshrrev_b32 v5, 18, v5
v_mul_u32_u24 v6, 6, v5
v_sub_u32 v6, v3, v6
v_mul_u32_u24 v5, 1152, v5
v_lshl_add_u32 v5, v6, 4, v5
s_add_u32 s31, s30, 11264
s_mov_b32 m0, s31
s_mov_b32 s33, 294912
buffer_load_dwordx4 v5, s[12:15], s33 offen lds
v_add_u32 v3, 768, v2
v_mul_u32_u24 v5, 43691, v3
v_lshrrev_b32 v5, 18, v5
v_mul_u32_u24 v6, 6, v5
v_sub_u32 v6, v3, v6
v_mul_u32_u24 v5, 1152, v5
v_lshl_add_u32 v5, v6, 4, v5
s_add_u32 s31, s30, 12288
s_mov_b32 m0, s31
s_mov_b32 s33, 294912
buffer_load_dwordx4 v5, s[12:15], s33 offen lds
v_add_u32 v3, 832, v2
v_mul_u32_u24 v5, 43691, v3
v_lshrrev_b32 v5, 18, v5
v_mul_u32_u24 v6, 6, v5
v_sub_u32 v6, v3, v6
v_mul_u32_u24 v5, 1152, v5
v_lshl_add_u32 v5, v6, 4, v5
s_add_u32 s31, s30, 13312
s_mov_b32 m0, s31
s_mov_b32 s33, 294912
buffer_load_dwordx4 v5, s[12:15], s33 offen lds
v_add_u32 v3, 896, v2
v_mul_u32_u24 v5, 43691, v3
v_lshrrev_b32 v5, 18, v5
v_mul_u32_u24 v6, 6, v5
v_sub_u32 v6, v3, v6
v_mul_u32_u24 v5, 1152, v5
v_lshl_add_u32 v5, v6, 4, v5
s_add_u32 s31, s30, 14336
s_mov_b32 m0, s31
s_mov_b32 s33, 294912
buffer_load_dwordx4 v5, s[12:15], s33 offen lds
v_add_u32 v3, 960, v2
v_mul_u32_u24 v5, 43691, v3
v_lshrrev_b32 v5, 18, v5
v_mul_u32_u24 v6, 6, v5
v_sub_u32 v6, v3, v6
v_mul_u32_u24 v5, 1152, v5
v_lshl_add_u32 v5, v6, 4, v5
s_add_u32 s31, s30, 15360
s_mov_b32 m0, s31
s_mov_b32 s33, 294912
buffer_load_dwordx4 v5, s[12:15], s33 offen lds
v_add_u32 v3, 1024, v2
v_mul_u32_u24 v5, 43691, v3
v_lshrrev_b32 v5, 18, v5
v_mul_u32_u24 v6, 6, v5
v_sub_u32 v6, v3, v6
v_mul_u32_u24 v5, 1152, v5
v_lshl_add_u32 v5, v6, 4, v5
s_add_u32 s31, s30, 16384
s_mov_b32 m0, s31
s_mov_b32 s33, 294912
buffer_load_dwordx4 v5, s[12:15], s33 offen lds
v_add_u32 v3, 1088, v2
v_mul_u32_u24 v5, 43691, v3
v_lshrrev_b32 v5, 18, v5
v_mul_u32_u24 v6, 6, v5
v_sub_u32 v6, v3, v6
v_mul_u32_u24 v5, 1152, v5
v_lshl_add_u32 v5, v6, 4, v5
s_add_u32 s31, s30, 17408
s_mov_b32 m0, s31
s_mov_b32 s33, 294912
buffer_load_dwordx4 v5, s[12:15], s33 offen lds
v_add_u32 v3, 1152, v2
v_mul_u32_u24 v5, 43691, v3
v_lshrrev_b32 v5, 18, v5
v_mul_u32_u24 v6, 6, v5
v_sub_u32 v6, v3, v6
v_mul_u32_u24 v5, 1152, v5
v_lshl_add_u32 v5, v6, 4, v5
s_add_u32 s31, s30, 18432
s_mov_b32 m0, s31
s_mov_b32 s33, 294912
buffer_load_dwordx4 v5, s[12:15], s33 offen lds
v_add_u32 v3, 1216, v2
v_mul_u32_u24 v5, 43691, v3
v_lshrrev_b32 v5, 18, v5
v_mul_u32_u24 v6, 6, v5
v_sub_u32 v6, v3, v6
v_mul_u32_u24 v5, 1152, v5
v_lshl_add_u32 v5, v6, 4, v5
s_add_u32 s31, s30, 19456
s_mov_b32 m0, s31
s_mov_b32 s33, 294912
buffer_load_dwordx4 v5, s[12:15], s33 offen lds
v_add_u32 v3, 1280, v2
v_mul_u32_u24 v5, 43691, v3
v_lshrrev_b32 v5, 18, v5
v_mul_u32_u24 v6, 6, v5
v_sub_u32 v6, v3, v6
v_mul_u32_u24 v5, 1152, v5
v_lshl_add_u32 v5, v6, 4, v5
s_add_u32 s31, s30, 20480
s_mov_b32 m0, s31
s_mov_b32 s33, 294912
buffer_load_dwordx4 v5, s[12:15], s33 offen lds
v_add_u32 v3, 1344, v2
v_mul_u32_u24 v5, 43691, v3
v_lshrrev_b32 v5, 18, v5
v_mul_u32_u24 v6, 6, v5
v_sub_u32 v6, v3, v6
v_mul_u32_u24 v5, 1152, v5
v_lshl_add_u32 v5, v6, 4, v5
s_add_u32 s31, s30, 21504
s_mov_b32 m0, s31
s_mov_b32 s33, 294912
buffer_load_dwordx4 v5, s[12:15], s33 offen lds
v_add_u32 v3, 1408, v2
v_mul_u32_u24 v5, 43691, v3
v_lshrrev_b32 v5, 18, v5
v_mul_u32_u24 v6, 6, v5
v_sub_u32 v6, v3, v6
v_mul_u32_u24 v5, 1152, v5
v_lshl_add_u32 v5, v6, 4, v5
s_add_u32 s31, s30, 22528
s_mov_b32 m0, s31
s_mov_b32 s33, 294912
buffer_load_dwordx4 v5, s[12:15], s33 offen lds
v_add_u32 v3, 1472, v2
v_mul_u32_u24 v5, 43691, v3
v_lshrrev_b32 v5, 18, v5
v_mul_u32_u24 v6, 6, v5
v_sub_u32 v6, v3, v6
v_mul_u32_u24 v5, 1152, v5
v_lshl_add_u32 v5, v6, 4, v5
s_add_u32 s31, s30, 23552
s_mov_b32 m0, s31
s_mov_b32 s33, 294912
buffer_load_dwordx4 v5, s[12:15], s33 offen lds
s_waitcnt vmcnt(0)
ds_read_b64_tr_b16 a[32:33], v4 offset:0
ds_read_b64_tr_b16 a[34:35], v4 offset:1536
ds_read_b64_tr_b16 a[160:161], v4 offset:32
ds_read_b64_tr_b16 a[162:163], v4 offset:1568
ds_read_b64_tr_b16 v[160:161], v4 offset:64
ds_read_b64_tr_b16 v[162:163], v4 offset:1600
s_waitcnt lgkmcnt(0)
ds_read_b64_tr_b16 a[36:37], v4 offset:3072
ds_read_b64_tr_b16 a[38:39], v4 offset:4608
ds_read_b64_tr_b16 a[164:165], v4 offset:3104
ds_read_b64_tr_b16 a[166:167], v4 offset:4640
ds_read_b64_tr_b16 v[164:165], v4 offset:3136
ds_read_b64_tr_b16 v[166:167], v4 offset:4672
s_waitcnt lgkmcnt(0)
ds_read_b64_tr_b16 a[40:41], v4 offset:6144
ds_read_b64_tr_b16 a[42:43], v4 offset:7680
ds_read_b64_tr_b16 a[168:169], v4 offset:6176
ds_read_b64_tr_b16 a[170:171], v4 offset:7712
ds_read_b64_tr_b16 v[168:169], v4 offset:6208
ds_read_b64_tr_b16 v[170:171], v4 offset:7744
s_waitcnt lgkmcnt(0)
ds_read_b64_tr_b16 a[44:45], v4 offset:9216
ds_read_b64_tr_b16 a[46:47], v4 offset:10752
ds_read_b64_tr_b16 a[172:173], v4 offset:9248
ds_read_b64_tr_b16 a[174:175], v4 offset:10784
ds_read_b64_tr_b16 v[172:173], v4 offset:9280
ds_read_b64_tr_b16 v[174:175], v4 offset:10816
s_waitcnt lgkmcnt(0)
ds_read_b64_tr_b16 a[48:49], v4 offset:12288
ds_read_b64_tr_b16 a[50:51], v4 offset:13824
ds_read_b64_tr_b16 a[176:177], v4 offset:12320
ds_read_b64_tr_b16 a[178:179], v4 offset:13856
ds_read_b64_tr_b16 v[176:177], v4 offset:12352
ds_read_b64_tr_b16 v[178:179], v4 offset:13888
s_waitcnt lgkmcnt(0)
ds_read_b64_tr_b16 a[52:53], v4 offset:15360
ds_read_b64_tr_b16 a[54:55], v4 offset:16896
ds_read_b64_tr_b16 a[180:181], v4 offset:15392
ds_read_b64_tr_b16 a[182:183], v4 offset:16928
ds_read_b64_tr_b16 v[180:181], v4 offset:15424
ds_read_b64_tr_b16 v[182:183], v4 offset:16960
s_waitcnt lgkmcnt(0)
ds_read_b64_tr_b16 a[56:57], v4 offset:18432
ds_read_b64_tr_b16 a[58:59], v4 offset:19968
ds_read_b64_tr_b16 a[184:185], v4 offset:18464
ds_read_b64_tr_b16 a[186:187], v4 offset:20000
ds_read_b64_tr_b16 v[184:185], v4 offset:18496
ds_read_b64_tr_b16 v[186:187], v4 offset:20032
s_waitcnt lgkmcnt(0)
ds_read_b64_tr_b16 a[60:61], v4 offset:21504
ds_read_b64_tr_b16 a[62:63], v4 offset:23040
ds_read_b64_tr_b16 a[188:189], v4 offset:21536
ds_read_b64_tr_b16 a[190:191], v4 offset:23072
ds_read_b64_tr_b16 v[188:189], v4 offset:21568
ds_read_b64_tr_b16 v[190:191], v4 offset:23104
s_waitcnt lgkmcnt(0)
v_add_u32 v3, 0, v2
v_mul_u32_u24 v5, 43691, v3
v_lshrrev_b32 v5, 18, v5
v_mul_u32_u24 v6, 6, v5
v_sub_u32 v6, v3, v6
v_mul_u32_u24 v5, 1152, v5
v_lshl_add_u32 v5, v6, 4, v5
s_add_u32 s31, s30, 0
s_mov_b32 m0, s31
s_mov_b32 s33, 589824
buffer_load_dwordx4 v5, s[12:15], s33 offen lds
v_add_u32 v3, 64, v2
v_mul_u32_u24 v5, 43691, v3
v_lshrrev_b32 v5, 18, v5
v_mul_u32_u24 v6, 6, v5
v_sub_u32 v6, v3, v6
v_mul_u32_u24 v5, 1152, v5
v_lshl_add_u32 v5, v6, 4, v5
s_add_u32 s31, s30, 1024
s_mov_b32 m0, s31
s_mov_b32 s33, 589824
buffer_load_dwordx4 v5, s[12:15], s33 offen lds
v_add_u32 v3, 128, v2
v_mul_u32_u24 v5, 43691, v3
v_lshrrev_b32 v5, 18, v5
v_mul_u32_u24 v6, 6, v5
v_sub_u32 v6, v3, v6
v_mul_u32_u24 v5, 1152, v5
v_lshl_add_u32 v5, v6, 4, v5
s_add_u32 s31, s30, 2048
s_mov_b32 m0, s31
s_mov_b32 s33, 589824
buffer_load_dwordx4 v5, s[12:15], s33 offen lds
v_add_u32 v3, 192, v2
v_mul_u32_u24 v5, 43691, v3
v_lshrrev_b32 v5, 18, v5
v_mul_u32_u24 v6, 6, v5
v_sub_u32 v6, v3, v6
v_mul_u32_u24 v5, 1152, v5
v_lshl_add_u32 v5, v6, 4, v5
s_add_u32 s31, s30, 3072
s_mov_b32 m0, s31
s_mov_b32 s33, 589824
buffer_load_dwordx4 v5, s[12:15], s33 offen lds
v_add_u32 v3, 256, v2
v_mul_u32_u24 v5, 43691, v3
v_lshrrev_b32 v5, 18, v5
v_mul_u32_u24 v6, 6, v5
v_sub_u32 v6, v3, v6
v_mul_u32_u24 v5, 1152, v5
v_lshl_add_u32 v5, v6, 4, v5
s_add_u32 s31, s30, 4096
s_mov_b32 m0, s31
s_mov_b32 s33, 589824
buffer_load_dwordx4 v5, s[12:15], s33 offen lds
v_add_u32 v3, 320, v2
v_mul_u32_u24 v5, 43691, v3
v_lshrrev_b32 v5, 18, v5
v_mul_u32_u24 v6, 6, v5
v_sub_u32 v6, v3, v6
v_mul_u32_u24 v5, 1152, v5
v_lshl_add_u32 v5, v6, 4, v5
s_add_u32 s31, s30, 5120
s_mov_b32 m0, s31
s_mov_b32 s33, 589824
buffer_load_dwordx4 v5, s[12:15], s33 offen lds
v_add_u32 v3, 384, v2
v_mul_u32_u24 v5, 43691, v3
v_lshrrev_b32 v5, 18, v5
v_mul_u32_u24 v6, 6, v5
v_sub_u32 v6, v3, v6
v_mul_u32_u24 v5, 1152, v5
v_lshl_add_u32 v5, v6, 4, v5
s_add_u32 s31, s30, 6144
s_mov_b32 m0, s31
s_mov_b32 s33, 589824
buffer_load_dwordx4 v5, s[12:15], s33 offen lds
v_add_u32 v3, 448, v2
v_mul_u32_u24 v5, 43691, v3
v_lshrrev_b32 v5, 18, v5
v_mul_u32_u24 v6, 6, v5
v_sub_u32 v6, v3, v6
v_mul_u32_u24 v5, 1152, v5
v_lshl_add_u32 v5, v6, 4, v5
s_add_u32 s31, s30, 7168
s_mov_b32 m0, s31
s_mov_b32 s33, 589824
buffer_load_dwordx4 v5, s[12:15], s33 offen lds
v_add_u32 v3, 512, v2
v_mul_u32_u24 v5, 43691, v3
v_lshrrev_b32 v5, 18, v5
v_mul_u32_u24 v6, 6, v5
v_sub_u32 v6, v3, v6
v_mul_u32_u24 v5, 1152, v5
v_lshl_add_u32 v5, v6, 4, v5
s_add_u32 s31, s30, 8192
s_mov_b32 m0, s31
s_mov_b32 s33, 589824
buffer_load_dwordx4 v5, s[12:15], s33 offen lds
v_add_u32 v3, 576, v2
v_mul_u32_u24 v5, 43691, v3
v_lshrrev_b32 v5, 18, v5
v_mul_u32_u24 v6, 6, v5
v_sub_u32 v6, v3, v6
v_mul_u32_u24 v5, 1152, v5
v_lshl_add_u32 v5, v6, 4, v5
s_add_u32 s31, s30, 9216
s_mov_b32 m0, s31
s_mov_b32 s33, 589824
buffer_load_dwordx4 v5, s[12:15], s33 offen lds
v_add_u32 v3, 640, v2
v_mul_u32_u24 v5, 43691, v3
v_lshrrev_b32 v5, 18, v5
v_mul_u32_u24 v6, 6, v5
v_sub_u32 v6, v3, v6
v_mul_u32_u24 v5, 1152, v5
v_lshl_add_u32 v5, v6, 4, v5
s_add_u32 s31, s30, 10240
s_mov_b32 m0, s31
s_mov_b32 s33, 589824
buffer_load_dwordx4 v5, s[12:15], s33 offen lds
v_add_u32 v3, 704, v2
v_mul_u32_u24 v5, 43691, v3
v_lshrrev_b32 v5, 18, v5
v_mul_u32_u24 v6, 6, v5
v_sub_u32 v6, v3, v6
v_mul_u32_u24 v5, 1152, v5
v_lshl_add_u32 v5, v6, 4, v5
s_add_u32 s31, s30, 11264
s_mov_b32 m0, s31
s_mov_b32 s33, 589824
buffer_load_dwordx4 v5, s[12:15], s33 offen lds
v_add_u32 v3, 768, v2
v_mul_u32_u24 v5, 43691, v3
v_lshrrev_b32 v5, 18, v5
v_mul_u32_u24 v6, 6, v5
v_sub_u32 v6, v3, v6
v_mul_u32_u24 v5, 1152, v5
v_lshl_add_u32 v5, v6, 4, v5
s_add_u32 s31, s30, 12288
s_mov_b32 m0, s31
s_mov_b32 s33, 589824
buffer_load_dwordx4 v5, s[12:15], s33 offen lds
v_add_u32 v3, 832, v2
v_mul_u32_u24 v5, 43691, v3
v_lshrrev_b32 v5, 18, v5
v_mul_u32_u24 v6, 6, v5
v_sub_u32 v6, v3, v6
v_mul_u32_u24 v5, 1152, v5
v_lshl_add_u32 v5, v6, 4, v5
s_add_u32 s31, s30, 13312
s_mov_b32 m0, s31
s_mov_b32 s33, 589824
buffer_load_dwordx4 v5, s[12:15], s33 offen lds
v_add_u32 v3, 896, v2
v_mul_u32_u24 v5, 43691, v3
v_lshrrev_b32 v5, 18, v5
v_mul_u32_u24 v6, 6, v5
v_sub_u32 v6, v3, v6
v_mul_u32_u24 v5, 1152, v5
v_lshl_add_u32 v5, v6, 4, v5
s_add_u32 s31, s30, 14336
s_mov_b32 m0, s31
s_mov_b32 s33, 589824
buffer_load_dwordx4 v5, s[12:15], s33 offen lds
v_add_u32 v3, 960, v2
v_mul_u32_u24 v5, 43691, v3
v_lshrrev_b32 v5, 18, v5
v_mul_u32_u24 v6, 6, v5
v_sub_u32 v6, v3, v6
v_mul_u32_u24 v5, 1152, v5
v_lshl_add_u32 v5, v6, 4, v5
s_add_u32 s31, s30, 15360
s_mov_b32 m0, s31
s_mov_b32 s33, 589824
buffer_load_dwordx4 v5, s[12:15], s33 offen lds
v_add_u32 v3, 1024, v2
v_mul_u32_u24 v5, 43691, v3
v_lshrrev_b32 v5, 18, v5
v_mul_u32_u24 v6, 6, v5
v_sub_u32 v6, v3, v6
v_mul_u32_u24 v5, 1152, v5
v_lshl_add_u32 v5, v6, 4, v5
s_add_u32 s31, s30, 16384
s_mov_b32 m0, s31
s_mov_b32 s33, 589824
buffer_load_dwordx4 v5, s[12:15], s33 offen lds
v_add_u32 v3, 1088, v2
v_mul_u32_u24 v5, 43691, v3
v_lshrrev_b32 v5, 18, v5
v_mul_u32_u24 v6, 6, v5
v_sub_u32 v6, v3, v6
v_mul_u32_u24 v5, 1152, v5
v_lshl_add_u32 v5, v6, 4, v5
s_add_u32 s31, s30, 17408
s_mov_b32 m0, s31
s_mov_b32 s33, 589824
buffer_load_dwordx4 v5, s[12:15], s33 offen lds
v_add_u32 v3, 1152, v2
v_mul_u32_u24 v5, 43691, v3
v_lshrrev_b32 v5, 18, v5
v_mul_u32_u24 v6, 6, v5
v_sub_u32 v6, v3, v6
v_mul_u32_u24 v5, 1152, v5
v_lshl_add_u32 v5, v6, 4, v5
s_add_u32 s31, s30, 18432
s_mov_b32 m0, s31
s_mov_b32 s33, 589824
buffer_load_dwordx4 v5, s[12:15], s33 offen lds
v_add_u32 v3, 1216, v2
v_mul_u32_u24 v5, 43691, v3
v_lshrrev_b32 v5, 18, v5
v_mul_u32_u24 v6, 6, v5
v_sub_u32 v6, v3, v6
v_mul_u32_u24 v5, 1152, v5
v_lshl_add_u32 v5, v6, 4, v5
s_add_u32 s31, s30, 19456
s_mov_b32 m0, s31
s_mov_b32 s33, 589824
buffer_load_dwordx4 v5, s[12:15], s33 offen lds
v_add_u32 v3, 1280, v2
v_mul_u32_u24 v5, 43691, v3
v_lshrrev_b32 v5, 18, v5
v_mul_u32_u24 v6, 6, v5
v_sub_u32 v6, v3, v6
v_mul_u32_u24 v5, 1152, v5
v_lshl_add_u32 v5, v6, 4, v5
s_add_u32 s31, s30, 20480
s_mov_b32 m0, s31
s_mov_b32 s33, 589824
buffer_load_dwordx4 v5, s[12:15], s33 offen lds
v_add_u32 v3, 1344, v2
v_mul_u32_u24 v5, 43691, v3
v_lshrrev_b32 v5, 18, v5
v_mul_u32_u24 v6, 6, v5
v_sub_u32 v6, v3, v6
v_mul_u32_u24 v5, 1152, v5
v_lshl_add_u32 v5, v6, 4, v5
s_add_u32 s31, s30, 21504
s_mov_b32 m0, s31
s_mov_b32 s33, 589824
buffer_load_dwordx4 v5, s[12:15], s33 offen lds
v_add_u32 v3, 1408, v2
v_mul_u32_u24 v5, 43691, v3
v_lshrrev_b32 v5, 18, v5
v_mul_u32_u24 v6, 6, v5
v_sub_u32 v6, v3, v6
v_mul_u32_u24 v5, 1152, v5
v_lshl_add_u32 v5, v6, 4, v5
s_add_u32 s31, s30, 22528
s_mov_b32 m0, s31
s_mov_b32 s33, 589824
buffer_load_dwordx4 v5, s[12:15], s33 offen lds
v_add_u32 v3, 1472, v2
v_mul_u32_u24 v5, 43691, v3
v_lshrrev_b32 v5, 18, v5
v_mul_u32_u24 v6, 6, v5
v_sub_u32 v6, v3, v6
v_mul_u32_u24 v5, 1152, v5
v_lshl_add_u32 v5, v6, 4, v5
s_add_u32 s31, s30, 23552
s_mov_b32 m0, s31
s_mov_b32 s33, 589824
buffer_load_dwordx4 v5, s[12:15], s33 offen lds
s_waitcnt vmcnt(0)
ds_read_b64_tr_b16 a[64:65], v4 offset:0
ds_read_b64_tr_b16 a[66:67], v4 offset:1536
ds_read_b64_tr_b16 a[192:193], v4 offset:32
ds_read_b64_tr_b16 a[194:195], v4 offset:1568
ds_read_b64_tr_b16 v[192:193], v4 offset:64
ds_read_b64_tr_b16 v[194:195], v4 offset:1600
s_waitcnt lgkmcnt(0)
ds_read_b64_tr_b16 a[68:69], v4 offset:3072
ds_read_b64_tr_b16 a[70:71], v4 offset:4608
ds_read_b64_tr_b16 a[196:197], v4 offset:3104
ds_read_b64_tr_b16 a[198:199], v4 offset:4640
ds_read_b64_tr_b16 v[196:197], v4 offset:3136
ds_read_b64_tr_b16 v[198:199], v4 offset:4672
s_waitcnt lgkmcnt(0)
ds_read_b64_tr_b16 a[72:73], v4 offset:6144
ds_read_b64_tr_b16 a[74:75], v4 offset:7680
ds_read_b64_tr_b16 a[200:201], v4 offset:6176
ds_read_b64_tr_b16 a[202:203], v4 offset:7712
ds_read_b64_tr_b16 v[200:201], v4 offset:6208
ds_read_b64_tr_b16 v[202:203], v4 offset:7744
s_waitcnt lgkmcnt(0)
ds_read_b64_tr_b16 a[76:77], v4 offset:9216
ds_read_b64_tr_b16 a[78:79], v4 offset:10752
ds_read_b64_tr_b16 a[204:205], v4 offset:9248
ds_read_b64_tr_b16 a[206:207], v4 offset:10784
ds_read_b64_tr_b16 v[204:205], v4 offset:9280
ds_read_b64_tr_b16 v[206:207], v4 offset:10816
s_waitcnt lgkmcnt(0)
ds_read_b64_tr_b16 a[80:81], v4 offset:12288
ds_read_b64_tr_b16 a[82:83], v4 offset:13824
ds_read_b64_tr_b16 a[208:209], v4 offset:12320
ds_read_b64_tr_b16 a[210:211], v4 offset:13856
ds_read_b64_tr_b16 v[208:209], v4 offset:12352
ds_read_b64_tr_b16 v[210:211], v4 offset:13888
s_waitcnt lgkmcnt(0)
ds_read_b64_tr_b16 a[84:85], v4 offset:15360
ds_read_b64_tr_b16 a[86:87], v4 offset:16896
ds_read_b64_tr_b16 a[212:213], v4 offset:15392
ds_read_b64_tr_b16 a[214:215], v4 offset:16928
ds_read_b64_tr_b16 v[212:213], v4 offset:15424
ds_read_b64_tr_b16 v[214:215], v4 offset:16960
s_waitcnt lgkmcnt(0)
ds_read_b64_tr_b16 a[88:89], v4 offset:18432
ds_read_b64_tr_b16 a[90:91], v4 offset:19968
ds_read_b64_tr_b16 a[216:217], v4 offset:18464
ds_read_b64_tr_b16 a[218:219], v4 offset:20000
ds_read_b64_tr_b16 v[216:217], v4 offset:18496
ds_read_b64_tr_b16 v[218:219], v4 offset:20032
s_waitcnt lgkmcnt(0)
ds_read_b64_tr_b16 a[92:93], v4 offset:21504
ds_read_b64_tr_b16 a[94:95], v4 offset:23040
ds_read_b64_tr_b16 a[220:221], v4 offset:21536
ds_read_b64_tr_b16 a[222:223], v4 offset:23072
ds_read_b64_tr_b16 v[220:221], v4 offset:21568
ds_read_b64_tr_b16 v[222:223], v4 offset:23104
s_waitcnt lgkmcnt(0)
v_add_u32 v3, 0, v2
v_mul_u32_u24 v5, 43691, v3
v_lshrrev_b32 v5, 18, v5
v_mul_u32_u24 v6, 6, v5
v_sub_u32 v6, v3, v6
v_mul_u32_u24 v5, 1152, v5
v_lshl_add_u32 v5, v6, 4, v5
s_add_u32 s31, s30, 0
s_mov_b32 m0, s31
s_mov_b32 s33, 884736
buffer_load_dwordx4 v5, s[12:15], s33 offen lds
v_add_u32 v3, 64, v2
v_mul_u32_u24 v5, 43691, v3
v_lshrrev_b32 v5, 18, v5
v_mul_u32_u24 v6, 6, v5
v_sub_u32 v6, v3, v6
v_mul_u32_u24 v5, 1152, v5
v_lshl_add_u32 v5, v6, 4, v5
s_add_u32 s31, s30, 1024
s_mov_b32 m0, s31
s_mov_b32 s33, 884736
buffer_load_dwordx4 v5, s[12:15], s33 offen lds
v_add_u32 v3, 128, v2
v_mul_u32_u24 v5, 43691, v3
v_lshrrev_b32 v5, 18, v5
v_mul_u32_u24 v6, 6, v5
v_sub_u32 v6, v3, v6
v_mul_u32_u24 v5, 1152, v5
v_lshl_add_u32 v5, v6, 4, v5
s_add_u32 s31, s30, 2048
s_mov_b32 m0, s31
s_mov_b32 s33, 884736
buffer_load_dwordx4 v5, s[12:15], s33 offen lds
v_add_u32 v3, 192, v2
v_mul_u32_u24 v5, 43691, v3
v_lshrrev_b32 v5, 18, v5
v_mul_u32_u24 v6, 6, v5
v_sub_u32 v6, v3, v6
v_mul_u32_u24 v5, 1152, v5
v_lshl_add_u32 v5, v6, 4, v5
s_add_u32 s31, s30, 3072
s_mov_b32 m0, s31
s_mov_b32 s33, 884736
buffer_load_dwordx4 v5, s[12:15], s33 offen lds
v_add_u32 v3, 256, v2
v_mul_u32_u24 v5, 43691, v3
v_lshrrev_b32 v5, 18, v5
v_mul_u32_u24 v6, 6, v5
v_sub_u32 v6, v3, v6
v_mul_u32_u24 v5, 1152, v5
v_lshl_add_u32 v5, v6, 4, v5
s_add_u32 s31, s30, 4096
s_mov_b32 m0, s31
s_mov_b32 s33, 884736
buffer_load_dwordx4 v5, s[12:15], s33 offen lds
v_add_u32 v3, 320, v2
v_mul_u32_u24 v5, 43691, v3
v_lshrrev_b32 v5, 18, v5
v_mul_u32_u24 v6, 6, v5
v_sub_u32 v6, v3, v6
v_mul_u32_u24 v5, 1152, v5
v_lshl_add_u32 v5, v6, 4, v5
s_add_u32 s31, s30, 5120
s_mov_b32 m0, s31
s_mov_b32 s33, 884736
buffer_load_dwordx4 v5, s[12:15], s33 offen lds
v_add_u32 v3, 384, v2
v_mul_u32_u24 v5, 43691, v3
v_lshrrev_b32 v5, 18, v5
v_mul_u32_u24 v6, 6, v5
v_sub_u32 v6, v3, v6
v_mul_u32_u24 v5, 1152, v5
v_lshl_add_u32 v5, v6, 4, v5
s_add_u32 s31, s30, 6144
s_mov_b32 m0, s31
s_mov_b32 s33, 884736
buffer_load_dwordx4 v5, s[12:15], s33 offen lds
v_add_u32 v3, 448, v2
v_mul_u32_u24 v5, 43691, v3
v_lshrrev_b32 v5, 18, v5
v_mul_u32_u24 v6, 6, v5
v_sub_u32 v6, v3, v6
v_mul_u32_u24 v5, 1152, v5
v_lshl_add_u32 v5, v6, 4, v5
s_add_u32 s31, s30, 7168
s_mov_b32 m0, s31
s_mov_b32 s33, 884736
buffer_load_dwordx4 v5, s[12:15], s33 offen lds
v_add_u32 v3, 512, v2
v_mul_u32_u24 v5, 43691, v3
v_lshrrev_b32 v5, 18, v5
v_mul_u32_u24 v6, 6, v5
v_sub_u32 v6, v3, v6
v_mul_u32_u24 v5, 1152, v5
v_lshl_add_u32 v5, v6, 4, v5
s_add_u32 s31, s30, 8192
s_mov_b32 m0, s31
s_mov_b32 s33, 884736
buffer_load_dwordx4 v5, s[12:15], s33 offen lds
v_add_u32 v3, 576, v2
v_mul_u32_u24 v5, 43691, v3
v_lshrrev_b32 v5, 18, v5
v_mul_u32_u24 v6, 6, v5
v_sub_u32 v6, v3, v6
v_mul_u32_u24 v5, 1152, v5
v_lshl_add_u32 v5, v6, 4, v5
s_add_u32 s31, s30, 9216
s_mov_b32 m0, s31
s_mov_b32 s33, 884736
buffer_load_dwordx4 v5, s[12:15], s33 offen lds
v_add_u32 v3, 640, v2
v_mul_u32_u24 v5, 43691, v3
v_lshrrev_b32 v5, 18, v5
v_mul_u32_u24 v6, 6, v5
v_sub_u32 v6, v3, v6
v_mul_u32_u24 v5, 1152, v5
v_lshl_add_u32 v5, v6, 4, v5
s_add_u32 s31, s30, 10240
s_mov_b32 m0, s31
s_mov_b32 s33, 884736
buffer_load_dwordx4 v5, s[12:15], s33 offen lds
v_add_u32 v3, 704, v2
v_mul_u32_u24 v5, 43691, v3
v_lshrrev_b32 v5, 18, v5
v_mul_u32_u24 v6, 6, v5
v_sub_u32 v6, v3, v6
v_mul_u32_u24 v5, 1152, v5
v_lshl_add_u32 v5, v6, 4, v5
s_add_u32 s31, s30, 11264
s_mov_b32 m0, s31
s_mov_b32 s33, 884736
buffer_load_dwordx4 v5, s[12:15], s33 offen lds
v_add_u32 v3, 768, v2
v_mul_u32_u24 v5, 43691, v3
v_lshrrev_b32 v5, 18, v5
v_mul_u32_u24 v6, 6, v5
v_sub_u32 v6, v3, v6
v_mul_u32_u24 v5, 1152, v5
v_lshl_add_u32 v5, v6, 4, v5
s_add_u32 s31, s30, 12288
s_mov_b32 m0, s31
s_mov_b32 s33, 884736
buffer_load_dwordx4 v5, s[12:15], s33 offen lds
v_add_u32 v3, 832, v2
v_mul_u32_u24 v5, 43691, v3
v_lshrrev_b32 v5, 18, v5
v_mul_u32_u24 v6, 6, v5
v_sub_u32 v6, v3, v6
v_mul_u32_u24 v5, 1152, v5
v_lshl_add_u32 v5, v6, 4, v5
s_add_u32 s31, s30, 13312
s_mov_b32 m0, s31
s_mov_b32 s33, 884736
buffer_load_dwordx4 v5, s[12:15], s33 offen lds
v_add_u32 v3, 896, v2
v_mul_u32_u24 v5, 43691, v3
v_lshrrev_b32 v5, 18, v5
v_mul_u32_u24 v6, 6, v5
v_sub_u32 v6, v3, v6
v_mul_u32_u24 v5, 1152, v5
v_lshl_add_u32 v5, v6, 4, v5
s_add_u32 s31, s30, 14336
s_mov_b32 m0, s31
s_mov_b32 s33, 884736
buffer_load_dwordx4 v5, s[12:15], s33 offen lds
v_add_u32 v3, 960, v2
v_mul_u32_u24 v5, 43691, v3
v_lshrrev_b32 v5, 18, v5
v_mul_u32_u24 v6, 6, v5
v_sub_u32 v6, v3, v6
v_mul_u32_u24 v5, 1152, v5
v_lshl_add_u32 v5, v6, 4, v5
s_add_u32 s31, s30, 15360
s_mov_b32 m0, s31
s_mov_b32 s33, 884736
buffer_load_dwordx4 v5, s[12:15], s33 offen lds
v_add_u32 v3, 1024, v2
v_mul_u32_u24 v5, 43691, v3
v_lshrrev_b32 v5, 18, v5
v_mul_u32_u24 v6, 6, v5
v_sub_u32 v6, v3, v6
v_mul_u32_u24 v5, 1152, v5
v_lshl_add_u32 v5, v6, 4, v5
s_add_u32 s31, s30, 16384
s_mov_b32 m0, s31
s_mov_b32 s33, 884736
buffer_load_dwordx4 v5, s[12:15], s33 offen lds
v_add_u32 v3, 1088, v2
v_mul_u32_u24 v5, 43691, v3
v_lshrrev_b32 v5, 18, v5
v_mul_u32_u24 v6, 6, v5
v_sub_u32 v6, v3, v6
v_mul_u32_u24 v5, 1152, v5
v_lshl_add_u32 v5, v6, 4, v5
s_add_u32 s31, s30, 17408
s_mov_b32 m0, s31
s_mov_b32 s33, 884736
buffer_load_dwordx4 v5, s[12:15], s33 offen lds
v_add_u32 v3, 1152, v2
v_mul_u32_u24 v5, 43691, v3
v_lshrrev_b32 v5, 18, v5
v_mul_u32_u24 v6, 6, v5
v_sub_u32 v6, v3, v6
v_mul_u32_u24 v5, 1152, v5
v_lshl_add_u32 v5, v6, 4, v5
s_add_u32 s31, s30, 18432
s_mov_b32 m0, s31
s_mov_b32 s33, 884736
buffer_load_dwordx4 v5, s[12:15], s33 offen lds
v_add_u32 v3, 1216, v2
v_mul_u32_u24 v5, 43691, v3
v_lshrrev_b32 v5, 18, v5
v_mul_u32_u24 v6, 6, v5
v_sub_u32 v6, v3, v6
v_mul_u32_u24 v5, 1152, v5
v_lshl_add_u32 v5, v6, 4, v5
s_add_u32 s31, s30, 19456
s_mov_b32 m0, s31
s_mov_b32 s33, 884736
buffer_load_dwordx4 v5, s[12:15], s33 offen lds
v_add_u32 v3, 1280, v2
v_mul_u32_u24 v5, 43691, v3
v_lshrrev_b32 v5, 18, v5
v_mul_u32_u24 v6, 6, v5
v_sub_u32 v6, v3, v6
v_mul_u32_u24 v5, 1152, v5
v_lshl_add_u32 v5, v6, 4, v5
s_add_u32 s31, s30, 20480
s_mov_b32 m0, s31
s_mov_b32 s33, 884736
buffer_load_dwordx4 v5, s[12:15], s33 offen lds
v_add_u32 v3, 1344, v2
v_mul_u32_u24 v5, 43691, v3
v_lshrrev_b32 v5, 18, v5
v_mul_u32_u24 v6, 6, v5
v_sub_u32 v6, v3, v6
v_mul_u32_u24 v5, 1152, v5
v_lshl_add_u32 v5, v6, 4, v5
s_add_u32 s31, s30, 21504
s_mov_b32 m0, s31
s_mov_b32 s33, 884736
buffer_load_dwordx4 v5, s[12:15], s33 offen lds
v_add_u32 v3, 1408, v2
v_mul_u32_u24 v5, 43691, v3
v_lshrrev_b32 v5, 18, v5
v_mul_u32_u24 v6, 6, v5
v_sub_u32 v6, v3, v6
v_mul_u32_u24 v5, 1152, v5
v_lshl_add_u32 v5, v6, 4, v5
s_add_u32 s31, s30, 22528
s_mov_b32 m0, s31
s_mov_b32 s33, 884736
buffer_load_dwordx4 v5, s[12:15], s33 offen lds
v_add_u32 v3, 1472, v2
v_mul_u32_u24 v5, 43691, v3
v_lshrrev_b32 v5, 18, v5
v_mul_u32_u24 v6, 6, v5
v_sub_u32 v6, v3, v6
v_mul_u32_u24 v5, 1152, v5
v_lshl_add_u32 v5, v6, 4, v5
s_add_u32 s31, s30, 23552
s_mov_b32 m0, s31
s_mov_b32 s33, 884736
buffer_load_dwordx4 v5, s[12:15], s33 offen lds
s_waitcnt vmcnt(0)
ds_read_b64_tr_b16 a[96:97], v4 offset:0
ds_read_b64_tr_b16 a[98:99], v4 offset:1536
ds_read_b64_tr_b16 a[224:225], v4 offset:32
ds_read_b64_tr_b16 a[226:227], v4 offset:1568
ds_read_b64_tr_b16 v[224:225], v4 offset:64
ds_read_b64_tr_b16 v[226:227], v4 offset:1600
s_waitcnt lgkmcnt(0)
ds_read_b64_tr_b16 a[100:101], v4 offset:3072
ds_read_b64_tr_b16 a[102:103], v4 offset:4608
ds_read_b64_tr_b16 a[228:229], v4 offset:3104
ds_read_b64_tr_b16 a[230:231], v4 offset:4640
ds_read_b64_tr_b16 v[228:229], v4 offset:3136
ds_read_b64_tr_b16 v[230:231], v4 offset:4672
s_waitcnt lgkmcnt(0)
ds_read_b64_tr_b16 a[104:105], v4 offset:6144
ds_read_b64_tr_b16 a[106:107], v4 offset:7680
ds_read_b64_tr_b16 a[232:233], v4 offset:6176
ds_read_b64_tr_b16 a[234:235], v4 offset:7712
ds_read_b64_tr_b16 v[232:233], v4 offset:6208
ds_read_b64_tr_b16 v[234:235], v4 offset:7744
s_waitcnt lgkmcnt(0)
ds_read_b64_tr_b16 a[108:109], v4 offset:9216
ds_read_b64_tr_b16 a[110:111], v4 offset:10752
ds_read_b64_tr_b16 a[236:237], v4 offset:9248
ds_read_b64_tr_b16 a[238:239], v4 offset:10784
ds_read_b64_tr_b16 v[236:237], v4 offset:9280
ds_read_b64_tr_b16 v[238:239], v4 offset:10816
s_waitcnt lgkmcnt(0)
ds_read_b64_tr_b16 a[112:113], v4 offset:12288
ds_read_b64_tr_b16 a[114:115], v4 offset:13824
ds_read_b64_tr_b16 a[240:241], v4 offset:12320
ds_read_b64_tr_b16 a[242:243], v4 offset:13856
ds_read_b64_tr_b16 v[240:241], v4 offset:12352
ds_read_b64_tr_b16 v[242:243], v4 offset:13888
s_waitcnt lgkmcnt(0)
ds_read_b64_tr_b16 a[116:117], v4 offset:15360
ds_read_b64_tr_b16 a[118:119], v4 offset:16896
ds_read_b64_tr_b16 a[244:245], v4 offset:15392
ds_read_b64_tr_b16 a[246:247], v4 offset:16928
ds_read_b64_tr_b16 v[244:245], v4 offset:15424
ds_read_b64_tr_b16 v[246:247], v4 offset:16960
s_waitcnt lgkmcnt(0)
ds_read_b64_tr_b16 a[120:121], v4 offset:18432
ds_read_b64_tr_b16 a[122:123], v4 offset:19968
ds_read_b64_tr_b16 a[248:249], v4 offset:18464
ds_read_b64_tr_b16 a[250:251], v4 offset:20000
ds_read_b64_tr_b16 v[248:249], v4 offset:18496
ds_read_b64_tr_b16 v[250:251], v4 offset:20032
s_waitcnt lgkmcnt(0)
ds_read_b64_tr_b16 a[124:125], v4 offset:21504
ds_read_b64_tr_b16 a[126:127], v4 offset:23040
ds_read_b64_tr_b16 a[252:253], v4 offset:21536
ds_read_b64_tr_b16 a[254:255], v4 offset:23072
ds_read_b64_tr_b16 v[252:253], v4 offset:21568
ds_read_b64_tr_b16 v[254:255], v4 offset:23104
s_waitcnt lgkmcnt(0)
s_load_dwordx2 s[4:5], s[0:1], 96
s_waitcnt lgkmcnt(0)
s_mov_b32 s20, s4
s_mov_b32 s21, s5
s_mov_b32 s22, 4718592
s_mov_b32 s23, 0x00020000
v_bfe_u32 v2, v0, 4, 4
v_mul_u32_u24 v2, 2304, v2
v_lshrrev_b32 v3, 8, v0
v_lshl_add_u32 v7, v3, 3, v2
s_barrier
WL_36:
s_lshl_b32 s28, s25, 7
s_add_u32 s28, s28, 827392
s_mov_b32 s26, 2000000
v_lshrrev_b32 v2, 2, v0
v_and_b32 v2, 127, v2
WW_39:
buffer_load_dword v3, v2, s[8:11], s28 offen sc1
s_waitcnt vmcnt(0)
v_cmp_ne_u32 vcc, s7, v3
s_cbranch_vccz WW_39k
s_sub_u32 s26, s26, 1
s_cbranch_scc1 WF_38
s_sleep 8
s_branch WW_39
WW_39k:
s_lshl_b32 s28, s25, 8
s_lshl_b32 s29, s17, 5
s_add_u32 s28, s28, s29
s_lshl_b32 s28, s28, 10
s_add_u32 s28, s28, 35667968
s_add_u32 s29, s28, 131072
buffer_load_dwordx4 v[8:11], v0, s[8:11], s28 offen offset:0
buffer_load_dwordx4 v[12:15], v0, s[8:11], s29 offen offset:0
buffer_load_dwordx4 v[16:19], v0, s[8:11], s28 offen offset:1024
buffer_load_dwordx4 v[20:23], v0, s[8:11], s29 offen offset:1024
buffer_load_dwordx4 v[24:27], v0, s[8:11], s28 offen offset:2048
buffer_load_dwordx4 v[28:31], v0, s[8:11], s29 offen offset:2048
buffer_load_dwordx4 v[32:35], v0, s[8:11], s28 offen offset:3072
buffer_load_dwordx4 v[36:39], v0, s[8:11], s29 offen offset:3072
s_add_u32 s28, s28, 4096
s_add_u32 s29, s29, 4096
buffer_load_dwordx4 v[40:43], v0, s[8:11], s28 offen offset:0
buffer_load_dwordx4 v[44:47], v0, s[8:11], s29 offen offset:0
buffer_load_dwordx4 v[48:51], v0, s[8:11], s28 offen offset:1024
buffer_load_dwordx4 v[52:55], v0, s[8:11], s29 offen offset:1024
buffer_load_dwordx4 v[56:59], v0, s[8:11], s28 offen offset:2048
buffer_load_dwordx4 v[60:63], v0, s[8:11], s29 offen offset:2048
buffer_load_dwordx4 v[64:67], v0, s[8:11], s28 offen offset:3072
buffer_load_dwordx4 v[68:71], v0, s[8:11], s29 offen offset:3072
s_waitcnt vmcnt(14)
v_mfma_f32_16x16x32_bf16 v[72:75], a[0:3], v[8:11], 0
v_mfma_f32_16x16x32_bf16 v[76:79], a[0:3], v[12:15], 0
v_mfma_f32_16x16x32_bf16 v[80:83], a[128:131], v[8:11], 0
v_mfma_f32_16x16x32_bf16 v[84:87], a[128:131], v[12:15], 0
v_mfma_f32_16x16x32_bf16 v[88:91], v[128:131], v[8:11], 0
v_mfma_f32_16x16x32_bf16 v[92:95], v[128:131], v[12:15], 0
s_add_u32 s28, s28, 4096
s_add_u32 s29, s29, 4096
buffer_load_dwordx4 v[8:11], v0, s[8:11], s28 offen offset:0
buffer_load_dwordx4 v[12:15], v0, s[8:11], s29 offen offset:0
s_waitcnt vmcnt(14)
v_mfma_f32_16x16x32_bf16 v[72:75], a[4:7], v[16:19], v[72:75]
v_mfma_f32_16x16x32_bf16 v[76:79], a[4:7], v[20:23], v[76:79]
v_mfma_f32_16x16x32_bf16 v[80:83], a[132:135], v[16:19], v[80:83]
v_mfma_f32_16x16x32_bf16 v[84:87], a[132:135], v[20:23], v[84:87]
v_mfma_f32_16x16x32_bf16 v[88:91], v[132:135], v[16:19], v[88:91]
v_mfma_f32_16x16x32_bf16 v[92:95], v[132:135], v[20:23], v[92:95]
buffer_load_dwordx4 v[16:19], v0, s[8:11], s28 offen offset:1024
buffer_load_dwordx4 v[20:23], v0, s[8:11], s29 offen offset:1024
s_waitcnt vmcnt(14)
v_mfma_f32_16x16x32_bf16 v[72:75], a[8:11], v[24:27], v[72:75]
v_mfma_f32_16x16x32_bf16 v[76:79], a[8:11], v[28:31], v[76:79]
v_mfma_f32_16x16x32_bf16 v[80:83], a[136:139], v[24:27], v[80:83]
v_mfma_f32_16x16x32_bf16 v[84:87], a[136:139], v[28:31], v[84:87]
v_mfma_f32_16x16x32_bf16 v[88:91], v[136:139], v[24:27], v[88:91]
v_mfma_f32_16x16x32_bf16 v[92:95], v[136:139], v[28:31], v[92:95]
buffer_load_dwordx4 v[24:27], v0, s[8:11], s28 offen offset:2048
buffer_load_dwordx4 v[28:31], v0, s[8:11], s29 offen offset:2048
s_waitcnt vmcnt(14)
v_mfma_f32_16x16x32_bf16 v[72:75], a[12:15], v[32:35], v[72:75]
v_mfma_f32_16x16x32_bf16 v[76:79], a[12:15], v[36:39], v[76:79]
v_mfma_f32_16x16x32_bf16 v[80:83], a[140:143], v[32:35], v[80:83]
v_mfma_f32_16x16x32_bf16 v[84:87], a[140:143], v[36:39], v[84:87]
v_mfma_f32_16x16x32_bf16 v[88:91], v[140:143], v[32:35], v[88:91]
v_mfma_f32_16x16x32_bf16 v[92:95], v[140:143], v[36:39], v[92:95]
buffer_load_dwordx4 v[32:35], v0, s[8:11], s28 offen offset:3072
buffer_load_dwordx4 v[36:39], v0, s[8:11], s29 offen offset:3072
s_waitcnt vmcnt(14)
v_mfma_f32_16x16x32_bf16 v[72:75], a[16:19], v[40:43], v[72:75]
v_mfma_f32_16x16x32_bf16 v[76:79], a[16:19], v[44:47], v[76:79]
v_mfma_f32_16x16x32_bf16 v[80:83], a[144:147], v[40:43], v[80:83]
v_mfma_f32_16x16x32_bf16 v[84:87], a[144:147], v[44:47], v[84:87]
v_mfma_f32_16x16x32_bf16 v[88:91], v[144:147], v[40:43], v[88:91]
v_mfma_f32_16x16x32_bf16 v[92:95], v[144:147], v[44:47], v[92:95]
s_add_u32 s28, s28, 4096
s_add_u32 s29, s29, 4096
buffer_load_dwordx4 v[40:43], v0, s[8:11], s28 offen offset:0
buffer_load_dwordx4 v[44:47], v0, s[8:11], s29 offen offset:0
s_waitcnt vmcnt(14)
v_mfma_f32_16x16x32_bf16 v[72:75], a[20:23], v[48:51], v[72:75]
v_mfma_f32_16x16x32_bf16 v[76:79], a[20:23], v[52:55], v[76:79]
v_mfma_f32_16x16x32_bf16 v[80:83], a[148:151], v[48:51], v[80:83]
v_mfma_f32_16x16x32_bf16 v[84:87], a[148:151], v[52:55], v[84:87]
v_mfma_f32_16x16x32_bf16 v[88:91], v[148:151], v[48:51], v[88:91]
v_mfma_f32_16x16x32_bf16 v[92:95], v[148:151], v[52:55], v[92:95]
buffer_load_dwordx4 v[48:51], v0, s[8:11], s28 offen offset:1024
buffer_load_dwordx4 v[52:55], v0, s[8:11], s29 offen offset:1024
s_waitcnt vmcnt(14)
v_mfma_f32_16x16x32_bf16 v[72:75], a[24:27], v[56:59], v[72:75]
v_mfma_f32_16x16x32_bf16 v[76:79], a[24:27], v[60:63], v[76:79]
v_mfma_f32_16x16x32_bf16 v[80:83], a[152:155], v[56:59], v[80:83]
v_mfma_f32_16x16x32_bf16 v[84:87], a[152:155], v[60:63], v[84:87]
v_mfma_f32_16x16x32_bf16 v[88:91], v[152:155], v[56:59], v[88:91]
v_mfma_f32_16x16x32_bf16 v[92:95], v[152:155], v[60:63], v[92:95]
buffer_load_dwordx4 v[56:59], v0, s[8:11], s28 offen offset:2048
buffer_load_dwordx4 v[60:63], v0, s[8:11], s29 offen offset:2048
s_waitcnt vmcnt(14)
v_mfma_f32_16x16x32_bf16 v[72:75], a[28:31], v[64:67], v[72:75]
v_mfma_f32_16x16x32_bf16 v[76:79], a[28:31], v[68:71], v[76:79]
v_mfma_f32_16x16x32_bf16 v[80:83], a[156:159], v[64:67], v[80:83]
v_mfma_f32_16x16x32_bf16 v[84:87], a[156:159], v[68:71], v[84:87]
v_mfma_f32_16x16x32_bf16 v[88:91], v[156:159], v[64:67], v[88:91]
v_mfma_f32_16x16x32_bf16 v[92:95], v[156:159], v[68:71], v[92:95]
buffer_load_dwordx4 v[64:67], v0, s[8:11], s28 offen offset:3072
buffer_load_dwordx4 v[68:71], v0, s[8:11], s29 offen offset:3072
s_waitcnt vmcnt(14)
v_mfma_f32_16x16x32_bf16 v[72:75], a[32:35], v[8:11], v[72:75]
v_mfma_f32_16x16x32_bf16 v[76:79], a[32:35], v[12:15], v[76:79]
v_mfma_f32_16x16x32_bf16 v[80:83], a[160:163], v[8:11], v[80:83]
v_mfma_f32_16x16x32_bf16 v[84:87], a[160:163], v[12:15], v[84:87]
v_mfma_f32_16x16x32_bf16 v[88:91], v[160:163], v[8:11], v[88:91]
v_mfma_f32_16x16x32_bf16 v[92:95], v[160:163], v[12:15], v[92:95]
s_add_u32 s28, s28, 4096
s_add_u32 s29, s29, 4096
buffer_load_dwordx4 v[8:11], v0, s[8:11], s28 offen offset:0
buffer_load_dwordx4 v[12:15], v0, s[8:11], s29 offen offset:0
s_waitcnt vmcnt(14)
v_mfma_f32_16x16x32_bf16 v[72:75], a[36:39], v[16:19], v[72:75]
v_mfma_f32_16x16x32_bf16 v[76:79], a[36:39], v[20:23], v[76:79]
v_mfma_f32_16x16x32_bf16 v[80:83], a[164:167], v[16:19], v[80:83]
v_mfma_f32_16x16x32_bf16 v[84:87], a[164:167], v[20:23], v[84:87]
v_mfma_f32_16x16x32_bf16 v[88:91], v[164:167], v[16:19], v[88:91]
v_mfma_f32_16x16x32_bf16 v[92:95], v[164:167], v[20:23], v[92:95]
buffer_load_dwordx4 v[16:19], v0, s[8:11], s28 offen offset:1024
buffer_load_dwordx4 v[20:23], v0, s[8:11], s29 offen offset:1024
s_waitcnt vmcnt(14)
v_mfma_f32_16x16x32_bf16 v[72:75], a[40:43], v[24:27], v[72:75]
v_mfma_f32_16x16x32_bf16 v[76:79], a[40:43], v[28:31], v[76:79]
v_mfma_f32_16x16x32_bf16 v[80:83], a[168:171], v[24:27], v[80:83]
v_mfma_f32_16x16x32_bf16 v[84:87], a[168:171], v[28:31], v[84:87]
v_mfma_f32_16x16x32_bf16 v[88:91], v[168:171], v[24:27], v[88:91]
v_mfma_f32_16x16x32_bf16 v[92:95], v[168:171], v[28:31], v[92:95]
buffer_load_dwordx4 v[24:27], v0, s[8:11], s28 offen offset:2048
buffer_load_dwordx4 v[28:31], v0, s[8:11], s29 offen offset:2048
s_waitcnt vmcnt(14)
v_mfma_f32_16x16x32_bf16 v[72:75], a[44:47], v[32:35], v[72:75]
v_mfma_f32_16x16x32_bf16 v[76:79], a[44:47], v[36:39], v[76:79]
v_mfma_f32_16x16x32_bf16 v[80:83], a[172:175], v[32:35], v[80:83]
v_mfma_f32_16x16x32_bf16 v[84:87], a[172:175], v[36:39], v[84:87]
v_mfma_f32_16x16x32_bf16 v[88:91], v[172:175], v[32:35], v[88:91]
v_mfma_f32_16x16x32_bf16 v[92:95], v[172:175], v[36:39], v[92:95]
buffer_load_dwordx4 v[32:35], v0, s[8:11], s28 offen offset:3072
buffer_load_dwordx4 v[36:39], v0, s[8:11], s29 offen offset:3072
s_waitcnt vmcnt(14)
v_mfma_f32_16x16x32_bf16 v[72:75], a[48:51], v[40:43], v[72:75]
v_mfma_f32_16x16x32_bf16 v[76:79], a[48:51], v[44:47], v[76:79]
v_mfma_f32_16x16x32_bf16 v[80:83], a[176:179], v[40:43], v[80:83]
v_mfma_f32_16x16x32_bf16 v[84:87], a[176:179], v[44:47], v[84:87]
v_mfma_f32_16x16x32_bf16 v[88:91], v[176:179], v[40:43], v[88:91]
v_mfma_f32_16x16x32_bf16 v[92:95], v[176:179], v[44:47], v[92:95]
s_add_u32 s28, s28, 4096
s_add_u32 s29, s29, 4096
buffer_load_dwordx4 v[40:43], v0, s[8:11], s28 offen offset:0
buffer_load_dwordx4 v[44:47], v0, s[8:11], s29 offen offset:0
s_waitcnt vmcnt(14)
v_mfma_f32_16x16x32_bf16 v[72:75], a[52:55], v[48:51], v[72:75]
v_mfma_f32_16x16x32_bf16 v[76:79], a[52:55], v[52:55], v[76:79]
v_mfma_f32_16x16x32_bf16 v[80:83], a[180:183], v[48:51], v[80:83]
v_mfma_f32_16x16x32_bf16 v[84:87], a[180:183], v[52:55], v[84:87]
v_mfma_f32_16x16x32_bf16 v[88:91], v[180:183], v[48:51], v[88:91]
v_mfma_f32_16x16x32_bf16 v[92:95], v[180:183], v[52:55], v[92:95]
buffer_load_dwordx4 v[48:51], v0, s[8:11], s28 offen offset:1024
buffer_load_dwordx4 v[52:55], v0, s[8:11], s29 offen offset:1024
s_waitcnt vmcnt(14)
v_mfma_f32_16x16x32_bf16 v[72:75], a[56:59], v[56:59], v[72:75]
v_mfma_f32_16x16x32_bf16 v[76:79], a[56:59], v[60:63], v[76:79]
v_mfma_f32_16x16x32_bf16 v[80:83], a[184:187], v[56:59], v[80:83]
v_mfma_f32_16x16x32_bf16 v[84:87], a[184:187], v[60:63], v[84:87]
v_mfma_f32_16x16x32_bf16 v[88:91], v[184:187], v[56:59], v[88:91]
v_mfma_f32_16x16x32_bf16 v[92:95], v[184:187], v[60:63], v[92:95]
buffer_load_dwordx4 v[56:59], v0, s[8:11], s28 offen offset:2048
buffer_load_dwordx4 v[60:63], v0, s[8:11], s29 offen offset:2048
s_waitcnt vmcnt(14)
v_mfma_f32_16x16x32_bf16 v[72:75], a[60:63], v[64:67], v[72:75]
v_mfma_f32_16x16x32_bf16 v[76:79], a[60:63], v[68:71], v[76:79]
v_mfma_f32_16x16x32_bf16 v[80:83], a[188:191], v[64:67], v[80:83]
v_mfma_f32_16x16x32_bf16 v[84:87], a[188:191], v[68:71], v[84:87]
v_mfma_f32_16x16x32_bf16 v[88:91], v[188:191], v[64:67], v[88:91]
v_mfma_f32_16x16x32_bf16 v[92:95], v[188:191], v[68:71], v[92:95]
buffer_load_dwordx4 v[64:67], v0, s[8:11], s28 offen offset:3072
buffer_load_dwordx4 v[68:71], v0, s[8:11], s29 offen offset:3072
s_waitcnt vmcnt(14)
v_mfma_f32_16x16x32_bf16 v[72:75], a[64:67], v[8:11], v[72:75]
v_mfma_f32_16x16x32_bf16 v[76:79], a[64:67], v[12:15], v[76:79]
v_mfma_f32_16x16x32_bf16 v[80:83], a[192:195], v[8:11], v[80:83]
v_mfma_f32_16x16x32_bf16 v[84:87], a[192:195], v[12:15], v[84:87]
v_mfma_f32_16x16x32_bf16 v[88:91], v[192:195], v[8:11], v[88:91]
v_mfma_f32_16x16x32_bf16 v[92:95], v[192:195], v[12:15], v[92:95]
s_add_u32 s28, s28, 4096
s_add_u32 s29, s29, 4096
buffer_load_dwordx4 v[8:11], v0, s[8:11], s28 offen offset:0
buffer_load_dwordx4 v[12:15], v0, s[8:11], s29 offen offset:0
s_waitcnt vmcnt(14)
v_mfma_f32_16x16x32_bf16 v[72:75], a[68:71], v[16:19], v[72:75]
v_mfma_f32_16x16x32_bf16 v[76:79], a[68:71], v[20:23], v[76:79]
v_mfma_f32_16x16x32_bf16 v[80:83], a[196:199], v[16:19], v[80:83]
v_mfma_f32_16x16x32_bf16 v[84:87], a[196:199], v[20:23], v[84:87]
v_mfma_f32_16x16x32_bf16 v[88:91], v[196:199], v[16:19], v[88:91]
v_mfma_f32_16x16x32_bf16 v[92:95], v[196:199], v[20:23], v[92:95]
buffer_load_dwordx4 v[16:19], v0, s[8:11], s28 offen offset:1024
buffer_load_dwordx4 v[20:23], v0, s[8:11], s29 offen offset:1024
s_waitcnt vmcnt(14)
v_mfma_f32_16x16x32_bf16 v[72:75], a[72:75], v[24:27], v[72:75]
v_mfma_f32_16x16x32_bf16 v[76:79], a[72:75], v[28:31], v[76:79]
v_mfma_f32_16x16x32_bf16 v[80:83], a[200:203], v[24:27], v[80:83]
v_mfma_f32_16x16x32_bf16 v[84:87], a[200:203], v[28:31], v[84:87]
v_mfma_f32_16x16x32_bf16 v[88:91], v[200:203], v[24:27], v[88:91]
v_mfma_f32_16x16x32_bf16 v[92:95], v[200:203], v[28:31], v[92:95]
buffer_load_dwordx4 v[24:27], v0, s[8:11], s28 offen offset:2048
buffer_load_dwordx4 v[28:31], v0, s[8:11], s29 offen offset:2048
s_waitcnt vmcnt(14)
v_mfma_f32_16x16x32_bf16 v[72:75], a[76:79], v[32:35], v[72:75]
v_mfma_f32_16x16x32_bf16 v[76:79], a[76:79], v[36:39], v[76:79]
v_mfma_f32_16x16x32_bf16 v[80:83], a[204:207], v[32:35], v[80:83]
v_mfma_f32_16x16x32_bf16 v[84:87], a[204:207], v[36:39], v[84:87]
v_mfma_f32_16x16x32_bf16 v[88:91], v[204:207], v[32:35], v[88:91]
v_mfma_f32_16x16x32_bf16 v[92:95], v[204:207], v[36:39], v[92:95]
buffer_load_dwordx4 v[32:35], v0, s[8:11], s28 offen offset:3072
buffer_load_dwordx4 v[36:39], v0, s[8:11], s29 offen offset:3072
s_waitcnt vmcnt(14)
v_mfma_f32_16x16x32_bf16 v[72:75], a[80:83], v[40:43], v[72:75]
v_mfma_f32_16x16x32_bf16 v[76:79], a[80:83], v[44:47], v[76:79]
v_mfma_f32_16x16x32_bf16 v[80:83], a[208:211], v[40:43], v[80:83]
v_mfma_f32_16x16x32_bf16 v[84:87], a[208:211], v[44:47], v[84:87]
v_mfma_f32_16x16x32_bf16 v[88:91], v[208:211], v[40:43], v[88:91]
v_mfma_f32_16x16x32_bf16 v[92:95], v[208:211], v[44:47], v[92:95]
s_add_u32 s28, s28, 4096
s_add_u32 s29, s29, 4096
buffer_load_dwordx4 v[40:43], v0, s[8:11], s28 offen offset:0
buffer_load_dwordx4 v[44:47], v0, s[8:11], s29 offen offset:0
s_waitcnt vmcnt(14)
v_mfma_f32_16x16x32_bf16 v[72:75], a[84:87], v[48:51], v[72:75]
v_mfma_f32_16x16x32_bf16 v[76:79], a[84:87], v[52:55], v[76:79]
v_mfma_f32_16x16x32_bf16 v[80:83], a[212:215], v[48:51], v[80:83]
v_mfma_f32_16x16x32_bf16 v[84:87], a[212:215], v[52:55], v[84:87]
v_mfma_f32_16x16x32_bf16 v[88:91], v[212:215], v[48:51], v[88:91]
v_mfma_f32_16x16x32_bf16 v[92:95], v[212:215], v[52:55], v[92:95]
buffer_load_dwordx4 v[48:51], v0, s[8:11], s28 offen offset:1024
buffer_load_dwordx4 v[52:55], v0, s[8:11], s29 offen offset:1024
s_waitcnt vmcnt(14)
v_mfma_f32_16x16x32_bf16 v[72:75], a[88:91], v[56:59], v[72:75]
v_mfma_f32_16x16x32_bf16 v[76:79], a[88:91], v[60:63], v[76:79]
v_mfma_f32_16x16x32_bf16 v[80:83], a[216:219], v[56:59], v[80:83]
v_mfma_f32_16x16x32_bf16 v[84:87], a[216:219], v[60:63], v[84:87]
v_mfma_f32_16x16x32_bf16 v[88:91], v[216:219], v[56:59], v[88:91]
v_mfma_f32_16x16x32_bf16 v[92:95], v[216:219], v[60:63], v[92:95]
buffer_load_dwordx4 v[56:59], v0, s[8:11], s28 offen offset:2048
buffer_load_dwordx4 v[60:63], v0, s[8:11], s29 offen offset:2048
s_waitcnt vmcnt(14)
v_mfma_f32_16x16x32_bf16 v[72:75], a[92:95], v[64:67], v[72:75]
v_mfma_f32_16x16x32_bf16 v[76:79], a[92:95], v[68:71], v[76:79]
v_mfma_f32_16x16x32_bf16 v[80:83], a[220:223], v[64:67], v[80:83]
v_mfma_f32_16x16x32_bf16 v[84:87], a[220:223], v[68:71], v[84:87]
v_mfma_f32_16x16x32_bf16 v[88:91], v[220:223], v[64:67], v[88:91]
v_mfma_f32_16x16x32_bf16 v[92:95], v[220:223], v[68:71], v[92:95]
buffer_load_dwordx4 v[64:67], v0, s[8:11], s28 offen offset:3072
buffer_load_dwordx4 v[68:71], v0, s[8:11], s29 offen offset:3072
s_waitcnt vmcnt(14)
v_mfma_f32_16x16x32_bf16 v[72:75], a[96:99], v[8:11], v[72:75]
v_mfma_f32_16x16x32_bf16 v[76:79], a[96:99], v[12:15], v[76:79]
v_mfma_f32_16x16x32_bf16 v[80:83], a[224:227], v[8:11], v[80:83]
v_mfma_f32_16x16x32_bf16 v[84:87], a[224:227], v[12:15], v[84:87]
v_mfma_f32_16x16x32_bf16 v[88:91], v[224:227], v[8:11], v[88:91]
v_mfma_f32_16x16x32_bf16 v[92:95], v[224:227], v[12:15], v[92:95]
s_waitcnt vmcnt(12)
v_mfma_f32_16x16x32_bf16 v[72:75], a[100:103], v[16:19], v[72:75]
v_mfma_f32_16x16x32_bf16 v[76:79], a[100:103], v[20:23], v[76:79]
v_mfma_f32_16x16x32_bf16 v[80:83], a[228:231], v[16:19], v[80:83]
v_mfma_f32_16x16x32_bf16 v[84:87], a[228:231], v[20:23], v[84:87]
v_mfma_f32_16x16x32_bf16 v[88:91], v[228:231], v[16:19], v[88:91]
v_mfma_f32_16x16x32_bf16 v[92:95], v[228:231], v[20:23], v[92:95]
s_waitcnt vmcnt(10)
v_mfma_f32_16x16x32_bf16 v[72:75], a[104:107], v[24:27], v[72:75]
v_mfma_f32_16x16x32_bf16 v[76:79], a[104:107], v[28:31], v[76:79]
v_mfma_f32_16x16x32_bf16 v[80:83], a[232:235], v[24:27], v[80:83]
v_mfma_f32_16x16x32_bf16 v[84:87], a[232:235], v[28:31], v[84:87]
v_mfma_f32_16x16x32_bf16 v[88:91], v[232:235], v[24:27], v[88:91]
v_mfma_f32_16x16x32_bf16 v[92:95], v[232:235], v[28:31], v[92:95]
s_waitcnt vmcnt(8)
v_mfma_f32_16x16x32_bf16 v[72:75], a[108:111], v[32:35], v[72:75]
v_mfma_f32_16x16x32_bf16 v[76:79], a[108:111], v[36:39], v[76:79]
v_mfma_f32_16x16x32_bf16 v[80:83], a[236:239], v[32:35], v[80:83]
v_mfma_f32_16x16x32_bf16 v[84:87], a[236:239], v[36:39], v[84:87]
v_mfma_f32_16x16x32_bf16 v[88:91], v[236:239], v[32:35], v[88:91]
v_mfma_f32_16x16x32_bf16 v[92:95], v[236:239], v[36:39], v[92:95]
s_waitcnt vmcnt(6)
v_mfma_f32_16x16x32_bf16 v[72:75], a[112:115], v[40:43], v[72:75]
v_mfma_f32_16x16x32_bf16 v[76:79], a[112:115], v[44:47], v[76:79]
v_mfma_f32_16x16x32_bf16 v[80:83], a[240:243], v[40:43], v[80:83]
v_mfma_f32_16x16x32_bf16 v[84:87], a[240:243], v[44:47], v[84:87]
v_mfma_f32_16x16x32_bf16 v[88:91], v[240:243], v[40:43], v[88:91]
v_mfma_f32_16x16x32_bf16 v[92:95], v[240:243], v[44:47], v[92:95]
s_waitcnt vmcnt(4)
v_mfma_f32_16x16x32_bf16 v[72:75], a[116:119], v[48:51], v[72:75]
v_mfma_f32_16x16x32_bf16 v[76:79], a[116:119], v[52:55], v[76:79]
v_mfma_f32_16x16x32_bf16 v[80:83], a[244:247], v[48:51], v[80:83]
v_mfma_f32_16x16x32_bf16 v[84:87], a[244:247], v[52:55], v[84:87]
v_mfma_f32_16x16x32_bf16 v[88:91], v[244:247], v[48:51], v[88:91]
v_mfma_f32_16x16x32_bf16 v[92:95], v[244:247], v[52:55], v[92:95]
s_waitcnt vmcnt(2)
v_mfma_f32_16x16x32_bf16 v[72:75], a[120:123], v[56:59], v[72:75]
v_mfma_f32_16x16x32_bf16 v[76:79], a[120:123], v[60:63], v[76:79]
v_mfma_f32_16x16x32_bf16 v[80:83], a[248:251], v[56:59], v[80:83]
v_mfma_f32_16x16x32_bf16 v[84:87], a[248:251], v[60:63], v[84:87]
v_mfma_f32_16x16x32_bf16 v[88:91], v[248:251], v[56:59], v[88:91]
v_mfma_f32_16x16x32_bf16 v[92:95], v[248:251], v[60:63], v[92:95]
s_waitcnt vmcnt(0)
v_mfma_f32_16x16x32_bf16 v[72:75], a[124:127], v[64:67], v[72:75]
v_mfma_f32_16x16x32_bf16 v[76:79], a[124:127], v[68:71], v[76:79]
v_mfma_f32_16x16x32_bf16 v[80:83], a[252:255], v[64:67], v[80:83]
v_mfma_f32_16x16x32_bf16 v[84:87], a[252:255], v[68:71], v[84:87]
v_mfma_f32_16x16x32_bf16 v[88:91], v[252:255], v[64:67], v[88:91]
v_mfma_f32_16x16x32_bf16 v[92:95], v[252:255], v[68:71], v[92:95]
s_mul_i32 s28, s17, 6144
v_add_u32 v2, s28, v0
s_nop 5
ds_write_b128 v2, v[72:75] offset:0
ds_write_b128 v2, v[76:79] offset:1024
ds_write_b128 v2, v[80:83] offset:2048
ds_write_b128 v2, v[84:87] offset:3072
ds_write_b128 v2, v[88:91] offset:4096
ds_write_b128 v2, v[92:95] offset:5120
s_waitcnt lgkmcnt(0)
s_barrier
s_cmp_lt_u32 s17, 3
s_cbranch_scc0 WN_40
s_lshl_b32 s28, s17, 11
v_add_u32 v2, s28, v0
ds_read_b128 v[96:99], v2 offset:0
ds_read_b128 v[100:103], v2 offset:6144
ds_read_b128 v[104:107], v2 offset:12288
ds_read_b128 v[108:111], v2 offset:18432
ds_read_b128 v[112:115], v2 offset:1024
ds_read_b128 v[116:119], v2 offset:7168
ds_read_b128 v[120:123], v2 offset:13312
ds_read_b128 v[124:127], v2 offset:19456
s_waitcnt lgkmcnt(0)
s_mul_i32 s28, s25, 73728
s_mul_i32 s29, s24, 96
s_add_u32 s28, s28, s29
s_lshl_b32 s29, s17, 5
s_add_u32 s28, s28, s29
v_add_f32 v96, v96, v100
v_add_f32 v104, v104, v108
v_add_f32 v96, v96, v104
v_add_f32 v97, v97, v101
v_add_f32 v105, v105, v109
v_add_f32 v97, v97, v105
v_add_f32 v98, v98, v102
v_add_f32 v106, v106, v110
v_add_f32 v98, v98, v106
v_add_f32 v99, v99, v103
v_add_f32 v107, v107, v111
v_add_f32 v99, v99, v107
v_cvt_pk_bf16_f32 v96, v96, v97
v_cvt_pk_bf16_f32 v97, v98, v99
buffer_store_dwordx2 v[96:97], v7, s[20:23], s28 offen
v_add_f32 v112, v112, v116
v_add_f32 v120, v120, v124
v_add_f32 v112, v112, v120
v_add_f32 v113, v113, v117
v_add_f32 v121, v121, v125
v_add_f32 v113, v113, v121
v_add_f32 v114, v114, v118
v_add_f32 v122, v122, v126
v_add_f32 v114, v114, v122
v_add_f32 v115, v115, v119
v_add_f32 v123, v123, v127
v_add_f32 v115, v115, v123
v_cvt_pk_bf16_f32 v112, v112, v113
v_cvt_pk_bf16_f32 v113, v114, v115
s_add_u32 s28, s28, 36864
buffer_store_dwordx2 v[112:113], v7, s[20:23], s28 offen
WN_40:
s_barrier
s_add_u32 s25, s25, 2
s_cmp_lt_u32 s25, 60
s_cbranch_scc1 WL_36
s_branch WE_37
WF_38:
s_mov_b32 s19, 1
WE_37:
s_branch K_END
K_B1:
s_sub_u32 s53, s52, 24
s_load_dwordx2 s[4:5], s[0:1], 72
s_waitcnt lgkmcnt(0)
s_mov_b32 s12, s4
s_mov_b32 s13, s5
s_mov_b32 s14, 20736
s_mov_b32 s15, 0x00020000
s_lshl_b32 s28, s17, 6
v_lshrrev_b32 v2, 4, v0
v_add_u32 v2, s28, v2
v_and_b32 v3, 15, v2
v_lshrrev_b32 v4, 4, v2
v_mul_u32_u24 v5, 36, v4
v_lshl_add_u32 v5, v3, 2, v5
v_cmp_lt_u32 vcc, 8, v3
v_mov_b32 v6, 0x7ffffff0
s_nop 0
v_cndmask_b32 v5, v5, v6, vcc
v_lshlrev_b32 v6, 2, v2
v_add_u32 v6, 0, v6
s_mov_b32 s28, 0
buffer_load_dword v8, v5, s[12:15], s28 offen
s_mov_b32 s28, 576
buffer_load_dword v9, v5, s[12:15], s28 offen
s_mov_b32 s28, 1152
buffer_load_dword v10, v5, s[12:15], s28 offen
s_mov_b32 s28, 1728
buffer_load_dword v11, v5, s[12:15], s28 offen
s_mov_b32 s28, 2304
buffer_load_dword v12, v5, s[12:15], s28 offen
s_mov_b32 s28, 2880
buffer_load_dword v13, v5, s[12:15], s28 offen
s_waitcnt vmcnt(0)
ds_write_b32 v6, v8 offset:0
ds_write_b32 v6, v9 offset:1024
ds_write_b32 v6, v10 offset:2048
ds_write_b32 v6, v11 offset:3072
ds_write_b32 v6, v12 offset:4096
ds_write_b32 v6, v13 offset:5120
s_mov_b32 s28, 3456
buffer_load_dword v8, v5, s[12:15], s28 offen
s_mov_b32 s28, 4032
buffer_load_dword v9, v5, s[12:15], s28 offen
s_mov_b32 s28, 4608
buffer_load_dword v10, v5, s[12:15], s28 offen
s_mov_b32 s28, 5184
buffer_load_dword v11, v5, s[12:15], s28 offen
s_mov_b32 s28, 5760
buffer_load_dword v12, v5, s[12:15], s28 offen
s_mov_b32 s28, 6336
buffer_load_dword v13, v5, s[12:15], s28 offen
s_waitcnt vmcnt(0)
ds_write_b32 v6, v8 offset:6144
ds_write_b32 v6, v9 offset:7168
ds_write_b32 v6, v10 offset:8192
ds_write_b32 v6, v11 offset:9216
ds_write_b32 v6, v12 offset:10240
ds_write_b32 v6, v13 offset:11264
s_mov_b32 s28, 6912
buffer_load_dword v8, v5, s[12:15], s28 offen
s_mov_b32 s28, 7488
buffer_load_dword v9, v5, s[12:15], s28 offen
s_mov_b32 s28, 8064
buffer_load_dword v10, v5, s[12:15], s28 offen
s_mov_b32 s28, 8640
buffer_load_dword v11, v5, s[12:15], s28 offen
s_mov_b32 s28, 9216
buffer_load_dword v12, v5, s[12:15], s28 offen
s_mov_b32 s28, 9792
buffer_load_dword v13, v5, s[12:15], s28 offen
s_waitcnt vmcnt(0)
ds_write_b32 v6, v8 offset:12288
ds_write_b32 v6, v9 offset:13312
ds_write_b32 v6, v10 offset:14336
ds_write_b32 v6, v11 offset:15360
ds_write_b32 v6, v12 offset:16384
ds_write_b32 v6, v13 offset:17408
s_mov_b32 s28, 10368
buffer_load_dword v8, v5, s[12:15], s28 offen
s_mov_b32 s28, 10944
buffer_load_dword v9, v5, s[12:15], s28 offen
s_mov_b32 s28, 11520
buffer_load_dword v10, v5, s[12:15], s28 offen
s_mov_b32 s28, 12096
buffer_load_dword v11, v5, s[12:15], s28 offen
s_mov_b32 s28, 12672
buffer_load_dword v12, v5, s[12:15], s28 offen
s_mov_b32 s28, 13248
buffer_load_dword v13, v5, s[12:15], s28 offen
s_waitcnt vmcnt(0)
ds_write_b32 v6, v8 offset:18432
ds_write_b32 v6, v9 offset:19456
ds_write_b32 v6, v10 offset:20480
ds_write_b32 v6, v11 offset:21504
ds_write_b32 v6, v12 offset:22528
ds_write_b32 v6, v13 offset:23552
s_mov_b32 s28, 13824
buffer_load_dword v8, v5, s[12:15], s28 offen
s_mov_b32 s28, 14400
buffer_load_dword v9, v5, s[12:15], s28 offen
s_mov_b32 s28, 14976
buffer_load_dword v10, v5, s[12:15], s28 offen
s_mov_b32 s28, 15552
buffer_load_dword v11, v5, s[12:15], s28 offen
s_mov_b32 s28, 16128
buffer_load_dword v12, v5, s[12:15], s28 offen
s_mov_b32 s28, 16704
buffer_load_dword v13, v5, s[12:15], s28 offen
s_waitcnt vmcnt(0)
ds_write_b32 v6, v8 offset:24576
ds_write_b32 v6, v9 offset:25600
ds_write_b32 v6, v10 offset:26624
ds_write_b32 v6, v11 offset:27648
ds_write_b32 v6, v12 offset:28672
ds_write_b32 v6, v13 offset:29696
s_mov_b32 s28, 17280
buffer_load_dword v8, v5, s[12:15], s28 offen
s_mov_b32 s28, 17856
buffer_load_dword v9, v5, s[12:15], s28 offen
s_mov_b32 s28, 18432
buffer_load_dword v10, v5, s[12:15], s28 offen
s_mov_b32 s28, 19008
buffer_load_dword v11, v5, s[12:15], s28 offen
s_mov_b32 s28, 19584
buffer_load_dword v12, v5, s[12:15], s28 offen
s_mov_b32 s28, 20160
buffer_load_dword v13, v5, s[12:15], s28 offen
s_waitcnt vmcnt(0)
ds_write_b32 v6, v8 offset:30720
ds_write_b32 v6, v9 offset:31744
ds_write_b32 v6, v10 offset:32768
ds_write_b32 v6, v11 offset:33792
ds_write_b32 v6, v12 offset:34816
ds_write_b32 v6, v13 offset:35840
s_load_dwordx2 s[4:5], s[0:1], 80
s_waitcnt lgkmcnt(0)
s_mov_b32 s12, s4
s_mov_b32 s13, s5
s_mov_b32 s14, 20736
s_mov_b32 s15, 0x00020000
s_lshl_b32 s28, s17, 6
v_lshrrev_b32 v2, 4, v0
v_add_u32 v2, s28, v2
v_and_b32 v3, 15, v2
v_lshrrev_b32 v4, 4, v2
v_mul_u32_u24 v5, 36, v4
v_lshl_add_u32 v5, v3, 2, v5
v_cmp_lt_u32 vcc, 8, v3
v_mov_b32 v6, 0x7ffffff0
s_nop 0
v_cndmask_b32 v5, v5, v6, vcc
v_lshlrev_b32 v6, 2, v2
v_add_u32 v6, 36864, v6
s_mov_b32 s28, 0
buffer_load_dword v8, v5, s[12:15], s28 offen
s_mov_b32 s28, 576
buffer_load_dword v9, v5, s[12:15], s28 offen
s_mov_b32 s28, 1152
buffer_load_dword v10, v5, s[12:15], s28 offen
s_mov_b32 s28, 1728
buffer_load_dword v11, v5, s[12:15], s28 offen
s_mov_b32 s28, 2304
buffer_load_dword v12, v5, s[12:15], s28 offen
s_mov_b32 s28, 2880
buffer_load_dword v13, v5, s[12:15], s28 offen
s_waitcnt vmcnt(0)
ds_write_b32 v6, v8 offset:0
ds_write_b32 v6, v9 offset:1024
ds_write_b32 v6, v10 offset:2048
ds_write_b32 v6, v11 offset:3072
ds_write_b32 v6, v12 offset:4096
ds_write_b32 v6, v13 offset:5120
s_mov_b32 s28, 3456
buffer_load_dword v8, v5, s[12:15], s28 offen
s_mov_b32 s28, 4032
buffer_load_dword v9, v5, s[12:15], s28 offen
s_mov_b32 s28, 4608
buffer_load_dword v10, v5, s[12:15], s28 offen
s_mov_b32 s28, 5184
buffer_load_dword v11, v5, s[12:15], s28 offen
s_mov_b32 s28, 5760
buffer_load_dword v12, v5, s[12:15], s28 offen
s_mov_b32 s28, 6336
buffer_load_dword v13, v5, s[12:15], s28 offen
s_waitcnt vmcnt(0)
ds_write_b32 v6, v8 offset:6144
ds_write_b32 v6, v9 offset:7168
ds_write_b32 v6, v10 offset:8192
ds_write_b32 v6, v11 offset:9216
ds_write_b32 v6, v12 offset:10240
ds_write_b32 v6, v13 offset:11264
s_mov_b32 s28, 6912
buffer_load_dword v8, v5, s[12:15], s28 offen
s_mov_b32 s28, 7488
buffer_load_dword v9, v5, s[12:15], s28 offen
s_mov_b32 s28, 8064
buffer_load_dword v10, v5, s[12:15], s28 offen
s_mov_b32 s28, 8640
buffer_load_dword v11, v5, s[12:15], s28 offen
s_mov_b32 s28, 9216
buffer_load_dword v12, v5, s[12:15], s28 offen
s_mov_b32 s28, 9792
buffer_load_dword v13, v5, s[12:15], s28 offen
s_waitcnt vmcnt(0)
ds_write_b32 v6, v8 offset:12288
ds_write_b32 v6, v9 offset:13312
ds_write_b32 v6, v10 offset:14336
ds_write_b32 v6, v11 offset:15360
ds_write_b32 v6, v12 offset:16384
ds_write_b32 v6, v13 offset:17408
s_mov_b32 s28, 10368
buffer_load_dword v8, v5, s[12:15], s28 offen
s_mov_b32 s28, 10944
buffer_load_dword v9, v5, s[12:15], s28 offen
s_mov_b32 s28, 11520
buffer_load_dword v10, v5, s[12:15], s28 offen
s_mov_b32 s28, 12096
buffer_load_dword v11, v5, s[12:15], s28 offen
s_mov_b32 s28, 12672
buffer_load_dword v12, v5, s[12:15], s28 offen
s_mov_b32 s28, 13248
buffer_load_dword v13, v5, s[12:15], s28 offen
s_waitcnt vmcnt(0)
ds_write_b32 v6, v8 offset:18432
ds_write_b32 v6, v9 offset:19456
ds_write_b32 v6, v10 offset:20480
ds_write_b32 v6, v11 offset:21504
ds_write_b32 v6, v12 offset:22528
ds_write_b32 v6, v13 offset:23552
s_mov_b32 s28, 13824
buffer_load_dword v8, v5, s[12:15], s28 offen
s_mov_b32 s28, 14400
buffer_load_dword v9, v5, s[12:15], s28 offen
s_mov_b32 s28, 14976
buffer_load_dword v10, v5, s[12:15], s28 offen
s_mov_b32 s28, 15552
buffer_load_dword v11, v5, s[12:15], s28 offen
s_mov_b32 s28, 16128
buffer_load_dword v12, v5, s[12:15], s28 offen
s_mov_b32 s28, 16704
buffer_load_dword v13, v5, s[12:15], s28 offen
s_waitcnt vmcnt(0)
ds_write_b32 v6, v8 offset:24576
ds_write_b32 v6, v9 offset:25600
ds_write_b32 v6, v10 offset:26624
ds_write_b32 v6, v11 offset:27648
ds_write_b32 v6, v12 offset:28672
ds_write_b32 v6, v13 offset:29696
s_mov_b32 s28, 17280
buffer_load_dword v8, v5, s[12:15], s28 offen
s_mov_b32 s28, 17856
buffer_load_dword v9, v5, s[12:15], s28 offen
s_mov_b32 s28, 18432
buffer_load_dword v10, v5, s[12:15], s28 offen
s_mov_b32 s28, 19008
buffer_load_dword v11, v5, s[12:15], s28 offen
s_mov_b32 s28, 19584
buffer_load_dword v12, v5, s[12:15], s28 offen
s_mov_b32 s28, 20160
buffer_load_dword v13, v5, s[12:15], s28 offen
s_waitcnt vmcnt(0)
ds_write_b32 v6, v8 offset:30720
ds_write_b32 v6, v9 offset:31744
ds_write_b32 v6, v10 offset:32768
ds_write_b32 v6, v11 offset:33792
ds_write_b32 v6, v12 offset:34816
ds_write_b32 v6, v13 offset:35840
s_waitcnt lgkmcnt(0)
s_barrier
v_lshrrev_b32 v2, 8, v0
v_bfe_u32 v3, v0, 6, 2
v_bfe_u32 v4, v0, 4, 2
v_lshrrev_b32 v5, 1, v2
v_lshl_add_u32 v5, v5, 3, v3
v_lshlrev_b32 v5, 6, v5
v_and_b32 v6, 1, v2
v_lshl_add_u32 v5, v6, 5, v5
v_lshl_add_u32 v5, v4, 3, v5
ds_read_b64_tr_b16 a[0:1], v5 offset:0
ds_read_b64_tr_b16 a[2:3], v5 offset:256
ds_read_b64_tr_b16 a[4:5], v5 offset:1024
ds_read_b64_tr_b16 a[6:7], v5 offset:1280
ds_read_b64_tr_b16 a[8:9], v5 offset:2048
ds_read_b64_tr_b16 a[10:11], v5 offset:2304
ds_read_b64_tr_b16 a[12:13], v5 offset:3072
ds_read_b64_tr_b16 a[14:15], v5 offset:3328
s_waitcnt lgkmcnt(0)
ds_read_b64_tr_b16 a[16:17], v5 offset:4096
ds_read_b64_tr_b16 a[18:19], v5 offset:4352
ds_read_b64_tr_b16 a[20:21], v5 offset:5120
ds_read_b64_tr_b16 a[22:23], v5 offset:5376
ds_read_b64_tr_b16 a[24:25], v5 offset:6144
ds_read_b64_tr_b16 a[26:27], v5 offset:6400
ds_read_b64_tr_b16 a[28:29], v5 offset:7168
ds_read_b64_tr_b16 a[30:31], v5 offset:7424
s_waitcnt lgkmcnt(0)
ds_read_b64_tr_b16 a[32:33], v5 offset:8192
ds_read_b64_tr_b16 a[34:35], v5 offset:8448
ds_read_b64_tr_b16 a[36:37], v5 offset:9216
ds_read_b64_tr_b16 a[38:39], v5 offset:9472
ds_read_b64_tr_b16 a[40:41], v5 offset:10240
ds_read_b64_tr_b16 a[42:43], v5 offset:10496
ds_read_b64_tr_b16 a[44:45], v5 offset:11264
ds_read_b64_tr_b16 a[46:47], v5 offset:11520
s_waitcnt lgkmcnt(0)
ds_read_b64_tr_b16 a[48:49], v5 offset:12288
ds_read_b64_tr_b16 a[50:51], v5 offset:12544
ds_read_b64_tr_b16 a[52:53], v5 offset:13312
ds_read_b64_tr_b16 a[54:55], v5 offset:13568
ds_read_b64_tr_b16 a[56:57], v5 offset:14336
ds_read_b64_tr_b16 a[58:59], v5 offset:14592
ds_read_b64_tr_b16 a[60:61], v5 offset:15360
ds_read_b64_tr_b16 a[62:63], v5 offset:15616
s_waitcnt lgkmcnt(0)
ds_read_b64_tr_b16 a[64:65], v5 offset:16384
ds_read_b64_tr_b16 a[66:67], v5 offset:16640
ds_read_b64_tr_b16 a[68:69], v5 offset:17408
ds_read_b64_tr_b16 a[70:71], v5 offset:17664
ds_read_b64_tr_b16 a[72:73], v5 offset:18432
ds_read_b64_tr_b16 a[74:75], v5 offset:18688
ds_read_b64_tr_b16 a[76:77], v5 offset:19456
ds_read_b64_tr_b16 a[78:79], v5 offset:19712
s_waitcnt lgkmcnt(0)
ds_read_b64_tr_b16 a[80:81], v5 offset:20480
ds_read_b64_tr_b16 a[82:83], v5 offset:20736
ds_read_b64_tr_b16 a[84:85], v5 offset:21504
ds_read_b64_tr_b16 a[86:87], v5 offset:21760
ds_read_b64_tr_b16 a[88:89], v5 offset:22528
ds_read_b64_tr_b16 a[90:91], v5 offset:22784
ds_read_b64_tr_b16 a[92:93], v5 offset:23552
ds_read_b64_tr_b16 a[94:95], v5 offset:23808
s_waitcnt lgkmcnt(0)
ds_read_b64_tr_b16 a[96:97], v5 offset:24576
ds_read_b64_tr_b16 a[98:99], v5 offset:24832
ds_read_b64_tr_b16 a[100:101], v5 offset:25600
ds_read_b64_tr_b16 a[102:103], v5 offset:25856
ds_read_b64_tr_b16 a[104:105], v5 offset:26624
ds_read_b64_tr_b16 a[106:107], v5 offset:26880
ds_read_b64_tr_b16 a[108:109], v5 offset:27648
ds_read_b64_tr_b16 a[110:111], v5 offset:27904
s_waitcnt lgkmcnt(0)
ds_read_b64_tr_b16 a[112:113], v5 offset:28672
ds_read_b64_tr_b16 a[114:115], v5 offset:28928
ds_read_b64_tr_b16 a[116:117], v5 offset:29696
ds_read_b64_tr_b16 a[118:119], v5 offset:29952
ds_read_b64_tr_b16 a[120:121], v5 offset:30720
ds_read_b64_tr_b16 a[122:123], v5 offset:30976
ds_read_b64_tr_b16 a[124:125], v5 offset:31744
ds_read_b64_tr_b16 a[126:127], v5 offset:32000
s_waitcnt lgkmcnt(0)
ds_read_b64_tr_b16 a[128:129], v5 offset:32768
ds_read_b64_tr_b16 a[130:131], v5 offset:33024
ds_read_b64_tr_b16 a[132:133], v5 offset:33792
ds_read_b64_tr_b16 a[134:135], v5 offset:34048
ds_read_b64_tr_b16 a[136:137], v5 offset:34816
ds_read_b64_tr_b16 a[138:139], v5 offset:35072
ds_read_b64_tr_b16 a[140:141], v5 offset:35840
ds_read_b64_tr_b16 a[142:143], v5 offset:36096
s_waitcnt lgkmcnt(0)
v_add_u32 v5, 36864, v5
ds_read_b64_tr_b16 a[144:145], v5 offset:0
ds_read_b64_tr_b16 a[146:147], v5 offset:256
ds_read_b64_tr_b16 a[148:149], v5 offset:1024
ds_read_b64_tr_b16 a[150:151], v5 offset:1280
ds_read_b64_tr_b16 a[152:153], v5 offset:2048
ds_read_b64_tr_b16 a[154:155], v5 offset:2304
ds_read_b64_tr_b16 a[156:157], v5 offset:3072
ds_read_b64_tr_b16 a[158:159], v5 offset:3328
s_waitcnt lgkmcnt(0)
ds_read_b64_tr_b16 a[160:161], v5 offset:4096
ds_read_b64_tr_b16 a[162:163], v5 offset:4352
ds_read_b64_tr_b16 a[164:165], v5 offset:5120
ds_read_b64_tr_b16 a[166:167], v5 offset:5376
ds_read_b64_tr_b16 a[168:169], v5 offset:6144
ds_read_b64_tr_b16 a[170:171], v5 offset:6400
ds_read_b64_tr_b16 a[172:173], v5 offset:7168
ds_read_b64_tr_b16 a[174:175], v5 offset:7424
s_waitcnt lgkmcnt(0)
ds_read_b64_tr_b16 a[176:177], v5 offset:8192
ds_read_b64_tr_b16 a[178:179], v5 offset:8448
ds_read_b64_tr_b16 a[180:181], v5 offset:9216
ds_read_b64_tr_b16 a[182:183], v5 offset:9472
ds_read_b64_tr_b16 a[184:185], v5 offset:10240
ds_read_b64_tr_b16 a[186:187], v5 offset:10496
ds_read_b64_tr_b16 a[188:189], v5 offset:11264
ds_read_b64_tr_b16 a[190:191], v5 offset:11520
s_waitcnt lgkmcnt(0)
ds_read_b64_tr_b16 a[192:193], v5 offset:12288
ds_read_b64_tr_b16 a[194:195], v5 offset:12544
ds_read_b64_tr_b16 a[196:197], v5 offset:13312
ds_read_b64_tr_b16 a[198:199], v5 offset:13568
ds_read_b64_tr_b16 a[200:201], v5 offset:14336
ds_read_b64_tr_b16 a[202:203], v5 offset:14592
ds_read_b64_tr_b16 a[204:205], v5 offset:15360
ds_read_b64_tr_b16 a[206:207], v5 offset:15616
s_waitcnt lgkmcnt(0)
ds_read_b64_tr_b16 a[208:209], v5 offset:16384
ds_read_b64_tr_b16 a[210:211], v5 offset:16640
ds_read_b64_tr_b16 a[212:213], v5 offset:17408
ds_read_b64_tr_b16 a[214:215], v5 offset:17664
ds_read_b64_tr_b16 a[216:217], v5 offset:18432
ds_read_b64_tr_b16 a[218:219], v5 offset:18688
ds_read_b64_tr_b16 a[220:221], v5 offset:19456
ds_read_b64_tr_b16 a[222:223], v5 offset:19712
s_waitcnt lgkmcnt(0)
ds_read_b64_tr_b16 a[224:225], v5 offset:20480
ds_read_b64_tr_b16 a[226:227], v5 offset:20736
ds_read_b64_tr_b16 a[228:229], v5 offset:21504
ds_read_b64_tr_b16 a[230:231], v5 offset:21760
ds_read_b64_tr_b16 a[232:233], v5 offset:22528
ds_read_b64_tr_b16 a[234:235], v5 offset:22784
ds_read_b64_tr_b16 a[236:237], v5 offset:23552
ds_read_b64_tr_b16 a[238:239], v5 offset:23808
s_waitcnt lgkmcnt(0)
ds_read_b64_tr_b16 a[240:241], v5 offset:24576
ds_read_b64_tr_b16 a[242:243], v5 offset:24832
ds_read_b64_tr_b16 a[244:245], v5 offset:25600
ds_read_b64_tr_b16 a[246:247], v5 offset:25856
ds_read_b64_tr_b16 a[248:249], v5 offset:26624
ds_read_b64_tr_b16 a[250:251], v5 offset:26880
ds_read_b64_tr_b16 a[252:253], v5 offset:27648
ds_read_b64_tr_b16 a[254:255], v5 offset:27904
s_waitcnt lgkmcnt(0)
ds_read_b64_tr_b16 v[224:225], v5 offset:28672
ds_read_b64_tr_b16 v[226:227], v5 offset:28928
ds_read_b64_tr_b16 v[228:229], v5 offset:29696
ds_read_b64_tr_b16 v[230:231], v5 offset:29952
ds_read_b64_tr_b16 v[232:233], v5 offset:30720
ds_read_b64_tr_b16 v[234:235], v5 offset:30976
ds_read_b64_tr_b16 v[236:237], v5 offset:31744
ds_read_b64_tr_b16 v[238:239], v5 offset:32000
s_waitcnt lgkmcnt(0)
ds_read_b64_tr_b16 v[240:241], v5 offset:32768
ds_read_b64_tr_b16 v[242:243], v5 offset:33024
ds_read_b64_tr_b16 v[244:245], v5 offset:33792
ds_read_b64_tr_b16 v[246:247], v5 offset:34048
ds_read_b64_tr_b16 v[248:249], v5 offset:34816
ds_read_b64_tr_b16 v[250:251], v5 offset:35072
ds_read_b64_tr_b16 v[252:253], v5 offset:35840
ds_read_b64_tr_b16 v[254:255], v5 offset:36096
s_waitcnt lgkmcnt(0)
s_waitcnt lgkmcnt(0)
s_load_dwordx2 s[4:5], s[0:1], 56
s_waitcnt lgkmcnt(0)
s_mov_b32 s12, s4
s_mov_b32 s13, s5
s_mov_b32 s14, 2359296
s_mov_b32 s15, 0x00020000
v_bfe_u32 v2, v0, 4, 5
v_mul_u32_u24 v2, 1152, v2
v_lshrrev_b32 v3, 9, v0
v_lshl_add_u32 v2, v3, 4, v2
v_bfe_u32 v7, v0, 4, 5
s_lshl_b32 s30, s53, 3
s_lshl_b32 s31, s17, 1
s_add_u32 s30, s30, s31
s_add_u32 s31, s30, 0
s_mul_i32 s33, s31, 36864
buffer_load_dwordx4 v[16:19], v2, s[12:15], s33 offen offset:0
buffer_load_dwordx4 v[20:23], v2, s[12:15], s33 offen offset:32
buffer_load_dwordx4 v[24:27], v2, s[12:15], s33 offen offset:64
buffer_load_dwordx4 v[28:31], v2, s[12:15], s33 offen offset:96
buffer_load_dwordx4 v[32:35], v2, s[12:15], s33 offen offset:128
buffer_load_dwordx4 v[36:39], v2, s[12:15], s33 offen offset:160
buffer_load_dwordx4 v[40:43], v2, s[12:15], s33 offen offset:192
buffer_load_dwordx4 v[44:47], v2, s[12:15], s33 offen offset:224
buffer_load_dwordx4 v[48:51], v2, s[12:15], s33 offen offset:256
buffer_load_dwordx4 v[52:55], v2, s[12:15], s33 offen offset:288
buffer_load_dwordx4 v[56:59], v2, s[12:15], s33 offen offset:320
buffer_load_dwordx4 v[60:63], v2, s[12:15], s33 offen offset:352
buffer_load_dwordx4 v[64:67], v2, s[12:15], s33 offen offset:384
buffer_load_dwordx4 v[68:71], v2, s[12:15], s33 offen offset:416
buffer_load_dwordx4 v[72:75], v2, s[12:15], s33 offen offset:448
buffer_load_dwordx4 v[76:79], v2, s[12:15], s33 offen offset:480
buffer_load_dwordx4 v[80:83], v2, s[12:15], s33 offen offset:512
buffer_load_dwordx4 v[84:87], v2, s[12:15], s33 offen offset:544
buffer_load_dwordx4 v[88:91], v2, s[12:15], s33 offen offset:576
buffer_load_dwordx4 v[92:95], v2, s[12:15], s33 offen offset:608
buffer_load_dwordx4 v[96:99], v2, s[12:15], s33 offen offset:640
buffer_load_dwordx4 v[100:103], v2, s[12:15], s33 offen offset:672
buffer_load_dwordx4 v[104:107], v2, s[12:15], s33 offen offset:704
buffer_load_dwordx4 v[108:111], v2, s[12:15], s33 offen offset:736
buffer_load_dwordx4 v[112:115], v2, s[12:15], s33 offen offset:768
buffer_load_dwordx4 v[116:119], v2, s[12:15], s33 offen offset:800
buffer_load_dwordx4 v[120:123], v2, s[12:15], s33 offen offset:832
buffer_load_dwordx4 v[124:127], v2, s[12:15], s33 offen offset:864
buffer_load_dwordx4 v[128:131], v2, s[12:15], s33 offen offset:896
buffer_load_dwordx4 v[132:135], v2, s[12:15], s33 offen offset:928
buffer_load_dwordx4 v[136:139], v2, s[12:15], s33 offen offset:960
buffer_load_dwordx4 v[140:143], v2, s[12:15], s33 offen offset:992
buffer_load_dwordx4 v[144:147], v2, s[12:15], s33 offen offset:1024
buffer_load_dwordx4 v[148:151], v2, s[12:15], s33 offen offset:1056
buffer_load_dwordx4 v[152:155], v2, s[12:15], s33 offen offset:1088
buffer_load_dwordx4 v[156:159], v2, s[12:15], s33 offen offset:1120
s_waitcnt vmcnt(0)
v_mfma_f32_32x32x16_bf16 v[160:175], a[0:3], v[16:19], 0
v_mfma_f32_32x32x16_bf16 v[176:191], v[16:19], a[144:147], 0
v_mfma_f32_32x32x16_bf16 v[160:175], a[4:7], v[20:23], v[160:175]
v_mfma_f32_32x32x16_bf16 v[176:191], v[20:23], a[148:151], v[176:191]
v_mfma_f32_32x32x16_bf16 v[160:175], a[8:11], v[24:27], v[160:175]
v_mfma_f32_32x32x16_bf16 v[176:191], v[24:27], a[152:155], v[176:191]
v_mfma_f32_32x32x16_bf16 v[160:175], a[12:15], v[28:31], v[160:175]
v_mfma_f32_32x32x16_bf16 v[176:191], v[28:31], a[156:159], v[176:191]
v_mfma_f32_32x32x16_bf16 v[160:175], a[16:19], v[32:35], v[160:175]
v_mfma_f32_32x32x16_bf16 v[176:191], v[32:35], a[160:163], v[176:191]
v_mfma_f32_32x32x16_bf16 v[160:175], a[20:23], v[36:39], v[160:175]
v_mfma_f32_32x32x16_bf16 v[176:191], v[36:39], a[164:167], v[176:191]
v_mfma_f32_32x32x16_bf16 v[160:175], a[24:27], v[40:43], v[160:175]
v_mfma_f32_32x32x16_bf16 v[176:191], v[40:43], a[168:171], v[176:191]
v_mfma_f32_32x32x16_bf16 v[160:175], a[28:31], v[44:47], v[160:175]
v_mfma_f32_32x32x16_bf16 v[176:191], v[44:47], a[172:175], v[176:191]
v_mfma_f32_32x32x16_bf16 v[160:175], a[32:35], v[48:51], v[160:175]
v_mfma_f32_32x32x16_bf16 v[176:191], v[48:51], a[176:179], v[176:191]
v_mfma_f32_32x32x16_bf16 v[160:175], a[36:39], v[52:55], v[160:175]
v_mfma_f32_32x32x16_bf16 v[176:191], v[52:55], a[180:183], v[176:191]
v_mfma_f32_32x32x16_bf16 v[160:175], a[40:43], v[56:59], v[160:175]
v_mfma_f32_32x32x16_bf16 v[176:191], v[56:59], a[184:187], v[176:191]
v_mfma_f32_32x32x16_bf16 v[160:175], a[44:47], v[60:63], v[160:175]
v_mfma_f32_32x32x16_bf16 v[176:191], v[60:63], a[188:191], v[176:191]
v_mfma_f32_32x32x16_bf16 v[160:175], a[48:51], v[64:67], v[160:175]
v_mfma_f32_32x32x16_bf16 v[176:191], v[64:67], a[192:195], v[176:191]
v_mfma_f32_32x32x16_bf16 v[160:175], a[52:55], v[68:71], v[160:175]
v_mfma_f32_32x32x16_bf16 v[176:191], v[68:71], a[196:199], v[176:191]
v_mfma_f32_32x32x16_bf16 v[160:175], a[56:59], v[72:75], v[160:175]
v_mfma_f32_32x32x16_bf16 v[176:191], v[72:75], a[200:203], v[176:191]
v_mfma_f32_32x32x16_bf16 v[160:175], a[60:63], v[76:79], v[160:175]
v_mfma_f32_32x32x16_bf16 v[176:191], v[76:79], a[204:207], v[176:191]
v_mfma_f32_32x32x16_bf16 v[160:175], a[64:67], v[80:83], v[160:175]
v_mfma_f32_32x32x16_bf16 v[176:191], v[80:83], a[208:211], v[176:191]
v_mfma_f32_32x32x16_bf16 v[160:175], a[68:71], v[84:87], v[160:175]
v_mfma_f32_32x32x16_bf16 v[176:191], v[84:87], a[212:215], v[176:191]
v_mfma_f32_32x32x16_bf16 v[160:175], a[72:75], v[88:91], v[160:175]
v_mfma_f32_32x32x16_bf16 v[176:191], v[88:91], a[216:219], v[176:191]
v_mfma_f32_32x32x16_bf16 v[160:175], a[76:79], v[92:95], v[160:175]
v_mfma_f32_32x32x16_bf16 v[176:191], v[92:95], a[220:223], v[176:191]
v_mfma_f32_32x32x16_bf16 v[160:175], a[80:83], v[96:99], v[160:175]
v_mfma_f32_32x32x16_bf16 v[176:191], v[96:99], a[224:227], v[176:191]
v_mfma_f32_32x32x16_bf16 v[160:175], a[84:87], v[100:103], v[160:175]
v_mfma_f32_32x32x16_bf16 v[176:191], v[100:103], a[228:231], v[176:191]
v_mfma_f32_32x32x16_bf16 v[160:175], a[88:91], v[104:107], v[160:175]
v_mfma_f32_32x32x16_bf16 v[176:191], v[104:107], a[232:235], v[176:191]
v_mfma_f32_32x32x16_bf16 v[160:175], a[92:95], v[108:111], v[160:175]
v_mfma_f32_32x32x16_bf16 v[176:191], v[108:111], a[236:239], v[176:191]
v_mfma_f32_32x32x16_bf16 v[160:175], a[96:99], v[112:115], v[160:175]
v_mfma_f32_32x32x16_bf16 v[176:191], v[112:115], a[240:243], v[176:191]
v_mfma_f32_32x32x16_bf16 v[160:175], a[100:103], v[116:119], v[160:175]
v_mfma_f32_32x32x16_bf16 v[176:191], v[116:119], a[244:247], v[176:191]
v_mfma_f32_32x32x16_bf16 v[160:175], a[104:107], v[120:123], v[160:175]
v_mfma_f32_32x32x16_bf16 v[176:191], v[120:123], a[248:251], v[176:191]
v_mfma_f32_32x32x16_bf16 v[160:175], a[108:111], v[124:127], v[160:175]
v_mfma_f32_32x32x16_bf16 v[176:191], v[124:127], a[252:255], v[176:191]
v_mfma_f32_32x32x16_bf16 v[160:175], a[112:115], v[128:131], v[160:175]
v_mfma_f32_32x32x16_bf16 v[176:191], v[128:131], v[224:227], v[176:191]
v_mfma_f32_32x32x16_bf16 v[160:175], a[116:119], v[132:135], v[160:175]
v_mfma_f32_32x32x16_bf16 v[176:191], v[132:135], v[228:231], v[176:191]
v_mfma_f32_32x32x16_bf16 v[160:175], a[120:123], v[136:139], v[160:175]
v_mfma_f32_32x32x16_bf16 v[176:191], v[136:139], v[232:235], v[176:191]
v_mfma_f32_32x32x16_bf16 v[160:175], a[124:127], v[140:143], v[160:175]
v_mfma_f32_32x32x16_bf16 v[176:191], v[140:143], v[236:239], v[176:191]
v_mfma_f32_32x32x16_bf16 v[160:175], a[128:131], v[144:147], v[160:175]
v_mfma_f32_32x32x16_bf16 v[176:191], v[144:147], v[240:243], v[176:191]
v_mfma_f32_32x32x16_bf16 v[160:175], a[132:135], v[148:151], v[160:175]
v_mfma_f32_32x32x16_bf16 v[176:191], v[148:151], v[244:247], v[176:191]
v_mfma_f32_32x32x16_bf16 v[160:175], a[136:139], v[152:155], v[160:175]
v_mfma_f32_32x32x16_bf16 v[176:191], v[152:155], v[248:251], v[176:191]
v_mfma_f32_32x32x16_bf16 v[160:175], a[140:143], v[156:159], v[160:175]
v_mfma_f32_32x32x16_bf16 v[176:191], v[156:159], v[252:255], v[176:191]
s_nop 15
s_mov_b32 s34, 0x3eae1a93
v_mul_f32 v160, s34, v160
v_mul_f32 v161, s34, v161
v_mul_f32 v162, s34, v162
v_mul_f32 v163, s34, v163
v_mul_f32 v164, s34, v164
v_mul_f32 v165, s34, v165
v_mul_f32 v166, s34, v166
v_mul_f32 v167, s34, v167
v_mul_f32 v168, s34, v168
v_mul_f32 v169, s34, v169
v_mul_f32 v170, s34, v170
v_mul_f32 v171, s34, v171
v_mul_f32 v172, s34, v172
v_mul_f32 v173, s34, v173
v_mul_f32 v174, s34, v174
v_mul_f32 v175, s34, v175
v_cvt_pk_bf16_f32 v192, v160, v161
v_cvt_pk_bf16_f32 v193, v162, v163
v_cvt_pk_bf16_f32 v194, v164, v165
v_cvt_pk_bf16_f32 v195, v166, v167
v_cvt_pk_bf16_f32 v196, v168, v169
v_cvt_pk_bf16_f32 v197, v170, v171
v_cvt_pk_bf16_f32 v198, v172, v173
v_cvt_pk_bf16_f32 v199, v174, v175
v_mov_b32 v8, 0x3f80
s_mov_b32 exec_hi, 0
v_mov_b32 v197, v8
s_mov_b32 exec_hi, -1
s_lshl_b32 s33, s31, 11
s_add_u32 s33, s33, 52445184
buffer_store_dwordx4 v[192:195], v0, s[8:11], s33 offen sc1
buffer_store_dwordx4 v[196:199], v0, s[8:11], s33 offen offset:1024 sc1
v_cvt_pk_bf16_f32 v200, v176, v177
v_cvt_pk_bf16_f32 v201, v178, v179
v_cvt_pk_bf16_f32 v202, v180, v181
v_cvt_pk_bf16_f32 v203, v182, v183
v_cvt_pk_bf16_f32 v204, v184, v185
v_cvt_pk_bf16_f32 v205, v186, v187
v_cvt_pk_bf16_f32 v206, v188, v189
v_cvt_pk_bf16_f32 v207, v190, v191
v_cmp_eq_u32 vcc, 18, v7
v_mov_b32 v8, 0x3f803f80
s_nop 0
v_cndmask_b32 v200, v200, v8, vcc
v_cndmask_b32 v201, v201, v8, vcc
v_cndmask_b32 v202, v202, v8, vcc
v_cndmask_b32 v203, v203, v8, vcc
v_cndmask_b32 v204, v204, v8, vcc
v_cndmask_b32 v205, v205, v8, vcc
v_cndmask_b32 v206, v206, v8, vcc
v_cndmask_b32 v207, v207, v8, vcc
s_lshl_b32 s33, s31, 11
s_add_u32 s33, s33, 52576256
buffer_store_dwordx4 v[200:203], v0, s[8:11], s33 offen sc1
buffer_store_dwordx4 v[204:207], v0, s[8:11], s33 offen offset:1024 sc1
s_nop 1
s_add_u32 s31, s30, 1
s_mul_i32 s33, s31, 36864
buffer_load_dwordx4 v[16:19], v2, s[12:15], s33 offen offset:0
buffer_load_dwordx4 v[20:23], v2, s[12:15], s33 offen offset:32
buffer_load_dwordx4 v[24:27], v2, s[12:15], s33 offen offset:64
buffer_load_dwordx4 v[28:31], v2, s[12:15], s33 offen offset:96
buffer_load_dwordx4 v[32:35], v2, s[12:15], s33 offen offset:128
buffer_load_dwordx4 v[36:39], v2, s[12:15], s33 offen offset:160
buffer_load_dwordx4 v[40:43], v2, s[12:15], s33 offen offset:192
buffer_load_dwordx4 v[44:47], v2, s[12:15], s33 offen offset:224
buffer_load_dwordx4 v[48:51], v2, s[12:15], s33 offen offset:256
buffer_load_dwordx4 v[52:55], v2, s[12:15], s33 offen offset:288
buffer_load_dwordx4 v[56:59], v2, s[12:15], s33 offen offset:320
buffer_load_dwordx4 v[60:63], v2, s[12:15], s33 offen offset:352
buffer_load_dwordx4 v[64:67], v2, s[12:15], s33 offen offset:384
buffer_load_dwordx4 v[68:71], v2, s[12:15], s33 offen offset:416
buffer_load_dwordx4 v[72:75], v2, s[12:15], s33 offen offset:448
buffer_load_dwordx4 v[76:79], v2, s[12:15], s33 offen offset:480
buffer_load_dwordx4 v[80:83], v2, s[12:15], s33 offen offset:512
buffer_load_dwordx4 v[84:87], v2, s[12:15], s33 offen offset:544
buffer_load_dwordx4 v[88:91], v2, s[12:15], s33 offen offset:576
buffer_load_dwordx4 v[92:95], v2, s[12:15], s33 offen offset:608
buffer_load_dwordx4 v[96:99], v2, s[12:15], s33 offen offset:640
buffer_load_dwordx4 v[100:103], v2, s[12:15], s33 offen offset:672
buffer_load_dwordx4 v[104:107], v2, s[12:15], s33 offen offset:704
buffer_load_dwordx4 v[108:111], v2, s[12:15], s33 offen offset:736
buffer_load_dwordx4 v[112:115], v2, s[12:15], s33 offen offset:768
buffer_load_dwordx4 v[116:119], v2, s[12:15], s33 offen offset:800
buffer_load_dwordx4 v[120:123], v2, s[12:15], s33 offen offset:832
buffer_load_dwordx4 v[124:127], v2, s[12:15], s33 offen offset:864
buffer_load_dwordx4 v[128:131], v2, s[12:15], s33 offen offset:896
buffer_load_dwordx4 v[132:135], v2, s[12:15], s33 offen offset:928
buffer_load_dwordx4 v[136:139], v2, s[12:15], s33 offen offset:960
buffer_load_dwordx4 v[140:143], v2, s[12:15], s33 offen offset:992
buffer_load_dwordx4 v[144:147], v2, s[12:15], s33 offen offset:1024
buffer_load_dwordx4 v[148:151], v2, s[12:15], s33 offen offset:1056
buffer_load_dwordx4 v[152:155], v2, s[12:15], s33 offen offset:1088
buffer_load_dwordx4 v[156:159], v2, s[12:15], s33 offen offset:1120
s_waitcnt vmcnt(0)
v_mfma_f32_32x32x16_bf16 v[160:175], a[0:3], v[16:19], 0
v_mfma_f32_32x32x16_bf16 v[176:191], v[16:19], a[144:147], 0
v_mfma_f32_32x32x16_bf16 v[160:175], a[4:7], v[20:23], v[160:175]
v_mfma_f32_32x32x16_bf16 v[176:191], v[20:23], a[148:151], v[176:191]
v_mfma_f32_32x32x16_bf16 v[160:175], a[8:11], v[24:27], v[160:175]
v_mfma_f32_32x32x16_bf16 v[176:191], v[24:27], a[152:155], v[176:191]
v_mfma_f32_32x32x16_bf16 v[160:175], a[12:15], v[28:31], v[160:175]
v_mfma_f32_32x32x16_bf16 v[176:191], v[28:31], a[156:159], v[176:191]
v_mfma_f32_32x32x16_bf16 v[160:175], a[16:19], v[32:35], v[160:175]
v_mfma_f32_32x32x16_bf16 v[176:191], v[32:35], a[160:163], v[176:191]
v_mfma_f32_32x32x16_bf16 v[160:175], a[20:23], v[36:39], v[160:175]
v_mfma_f32_32x32x16_bf16 v[176:191], v[36:39], a[164:167], v[176:191]
v_mfma_f32_32x32x16_bf16 v[160:175], a[24:27], v[40:43], v[160:175]
v_mfma_f32_32x32x16_bf16 v[176:191], v[40:43], a[168:171], v[176:191]
v_mfma_f32_32x32x16_bf16 v[160:175], a[28:31], v[44:47], v[160:175]
v_mfma_f32_32x32x16_bf16 v[176:191], v[44:47], a[172:175], v[176:191]
v_mfma_f32_32x32x16_bf16 v[160:175], a[32:35], v[48:51], v[160:175]
v_mfma_f32_32x32x16_bf16 v[176:191], v[48:51], a[176:179], v[176:191]
v_mfma_f32_32x32x16_bf16 v[160:175], a[36:39], v[52:55], v[160:175]
v_mfma_f32_32x32x16_bf16 v[176:191], v[52:55], a[180:183], v[176:191]
v_mfma_f32_32x32x16_bf16 v[160:175], a[40:43], v[56:59], v[160:175]
v_mfma_f32_32x32x16_bf16 v[176:191], v[56:59], a[184:187], v[176:191]
v_mfma_f32_32x32x16_bf16 v[160:175], a[44:47], v[60:63], v[160:175]
v_mfma_f32_32x32x16_bf16 v[176:191], v[60:63], a[188:191], v[176:191]
v_mfma_f32_32x32x16_bf16 v[160:175], a[48:51], v[64:67], v[160:175]
v_mfma_f32_32x32x16_bf16 v[176:191], v[64:67], a[192:195], v[176:191]
v_mfma_f32_32x32x16_bf16 v[160:175], a[52:55], v[68:71], v[160:175]
v_mfma_f32_32x32x16_bf16 v[176:191], v[68:71], a[196:199], v[176:191]
v_mfma_f32_32x32x16_bf16 v[160:175], a[56:59], v[72:75], v[160:175]
v_mfma_f32_32x32x16_bf16 v[176:191], v[72:75], a[200:203], v[176:191]
v_mfma_f32_32x32x16_bf16 v[160:175], a[60:63], v[76:79], v[160:175]
v_mfma_f32_32x32x16_bf16 v[176:191], v[76:79], a[204:207], v[176:191]
v_mfma_f32_32x32x16_bf16 v[160:175], a[64:67], v[80:83], v[160:175]
v_mfma_f32_32x32x16_bf16 v[176:191], v[80:83], a[208:211], v[176:191]
v_mfma_f32_32x32x16_bf16 v[160:175], a[68:71], v[84:87], v[160:175]
v_mfma_f32_32x32x16_bf16 v[176:191], v[84:87], a[212:215], v[176:191]
v_mfma_f32_32x32x16_bf16 v[160:175], a[72:75], v[88:91], v[160:175]
v_mfma_f32_32x32x16_bf16 v[176:191], v[88:91], a[216:219], v[176:191]
v_mfma_f32_32x32x16_bf16 v[160:175], a[76:79], v[92:95], v[160:175]
v_mfma_f32_32x32x16_bf16 v[176:191], v[92:95], a[220:223], v[176:191]
v_mfma_f32_32x32x16_bf16 v[160:175], a[80:83], v[96:99], v[160:175]
v_mfma_f32_32x32x16_bf16 v[176:191], v[96:99], a[224:227], v[176:191]
v_mfma_f32_32x32x16_bf16 v[160:175], a[84:87], v[100:103], v[160:175]
v_mfma_f32_32x32x16_bf16 v[176:191], v[100:103], a[228:231], v[176:191]
v_mfma_f32_32x32x16_bf16 v[160:175], a[88:91], v[104:107], v[160:175]
v_mfma_f32_32x32x16_bf16 v[176:191], v[104:107], a[232:235], v[176:191]
v_mfma_f32_32x32x16_bf16 v[160:175], a[92:95], v[108:111], v[160:175]
v_mfma_f32_32x32x16_bf16 v[176:191], v[108:111], a[236:239], v[176:191]
v_mfma_f32_32x32x16_bf16 v[160:175], a[96:99], v[112:115], v[160:175]
v_mfma_f32_32x32x16_bf16 v[176:191], v[112:115], a[240:243], v[176:191]
v_mfma_f32_32x32x16_bf16 v[160:175], a[100:103], v[116:119], v[160:175]
v_mfma_f32_32x32x16_bf16 v[176:191], v[116:119], a[244:247], v[176:191]
v_mfma_f32_32x32x16_bf16 v[160:175], a[104:107], v[120:123], v[160:175]
v_mfma_f32_32x32x16_bf16 v[176:191], v[120:123], a[248:251], v[176:191]
v_mfma_f32_32x32x16_bf16 v[160:175], a[108:111], v[124:127], v[160:175]
v_mfma_f32_32x32x16_bf16 v[176:191], v[124:127], a[252:255], v[176:191]
v_mfma_f32_32x32x16_bf16 v[160:175], a[112:115], v[128:131], v[160:175]
v_mfma_f32_32x32x16_bf16 v[176:191], v[128:131], v[224:227], v[176:191]
v_mfma_f32_32x32x16_bf16 v[160:175], a[116:119], v[132:135], v[160:175]
v_mfma_f32_32x32x16_bf16 v[176:191], v[132:135], v[228:231], v[176:191]
v_mfma_f32_32x32x16_bf16 v[160:175], a[120:123], v[136:139], v[160:175]
v_mfma_f32_32x32x16_bf16 v[176:191], v[136:139], v[232:235], v[176:191]
v_mfma_f32_32x32x16_bf16 v[160:175], a[124:127], v[140:143], v[160:175]
v_mfma_f32_32x32x16_bf16 v[176:191], v[140:143], v[236:239], v[176:191]
v_mfma_f32_32x32x16_bf16 v[160:175], a[128:131], v[144:147], v[160:175]
v_mfma_f32_32x32x16_bf16 v[176:191], v[144:147], v[240:243], v[176:191]
v_mfma_f32_32x32x16_bf16 v[160:175], a[132:135], v[148:151], v[160:175]
v_mfma_f32_32x32x16_bf16 v[176:191], v[148:151], v[244:247], v[176:191]
v_mfma_f32_32x32x16_bf16 v[160:175], a[136:139], v[152:155], v[160:175]
v_mfma_f32_32x32x16_bf16 v[176:191], v[152:155], v[248:251], v[176:191]
v_mfma_f32_32x32x16_bf16 v[160:175], a[140:143], v[156:159], v[160:175]
v_mfma_f32_32x32x16_bf16 v[176:191], v[156:159], v[252:255], v[176:191]
s_nop 15
s_mov_b32 s34, 0x3eae1a93
v_mul_f32 v160, s34, v160
v_mul_f32 v161, s34, v161
v_mul_f32 v162, s34, v162
v_mul_f32 v163, s34, v163
v_mul_f32 v164, s34, v164
v_mul_f32 v165, s34, v165
v_mul_f32 v166, s34, v166
v_mul_f32 v167, s34, v167
v_mul_f32 v168, s34, v168
v_mul_f32 v169, s34, v169
v_mul_f32 v170, s34, v170
v_mul_f32 v171, s34, v171
v_mul_f32 v172, s34, v172
v_mul_f32 v173, s34, v173
v_mul_f32 v174, s34, v174
v_mul_f32 v175, s34, v175
v_cvt_pk_bf16_f32 v192, v160, v161
v_cvt_pk_bf16_f32 v193, v162, v163
v_cvt_pk_bf16_f32 v194, v164, v165
v_cvt_pk_bf16_f32 v195, v166, v167
v_cvt_pk_bf16_f32 v196, v168, v169
v_cvt_pk_bf16_f32 v197, v170, v171
v_cvt_pk_bf16_f32 v198, v172, v173
v_cvt_pk_bf16_f32 v199, v174, v175
v_mov_b32 v8, 0x3f80
s_mov_b32 exec_hi, 0
v_mov_b32 v197, v8
s_mov_b32 exec_hi, -1
s_lshl_b32 s33, s31, 11
s_add_u32 s33, s33, 52445184
buffer_store_dwordx4 v[192:195], v0, s[8:11], s33 offen sc1
buffer_store_dwordx4 v[196:199], v0, s[8:11], s33 offen offset:1024 sc1
v_cvt_pk_bf16_f32 v200, v176, v177
v_cvt_pk_bf16_f32 v201, v178, v179
v_cvt_pk_bf16_f32 v202, v180, v181
v_cvt_pk_bf16_f32 v203, v182, v183
v_cvt_pk_bf16_f32 v204, v184, v185
v_cvt_pk_bf16_f32 v205, v186, v187
v_cvt_pk_bf16_f32 v206, v188, v189
v_cvt_pk_bf16_f32 v207, v190, v191
v_cmp_eq_u32 vcc, 18, v7
v_mov_b32 v8, 0x3f803f80
s_nop 0
v_cndmask_b32 v200, v200, v8, vcc
v_cndmask_b32 v201, v201, v8, vcc
v_cndmask_b32 v202, v202, v8, vcc
v_cndmask_b32 v203, v203, v8, vcc
v_cndmask_b32 v204, v204, v8, vcc
v_cndmask_b32 v205, v205, v8, vcc
v_cndmask_b32 v206, v206, v8, vcc
v_cndmask_b32 v207, v207, v8, vcc
s_lshl_b32 s33, s31, 11
s_add_u32 s33, s33, 52576256
buffer_store_dwordx4 v[200:203], v0, s[8:11], s33 offen sc1
buffer_store_dwordx4 v[204:207], v0, s[8:11], s33 offen offset:1024 sc1
s_nop 1
s_waitcnt vmcnt(0)
s_barrier
s_cmp_eq_u32 s17, 0
s_cbranch_scc0 B1E_41
s_lshl_b32 s28, s53, 2
s_add_u32 s28, s28, 835584
v_mov_b32 v3, s7
v_mov_b32 v4, 0
s_mov_b64 exec, 1
buffer_store_dword v3, v4, s[8:11], s28 offen sc1
s_mov_b64 exec, -1
B1E_41:
s_branch K_END
K_B2:
s_sub_u32 s53, s51, 96
s_mov_b32 s24, s53
s_mov_b32 s19, 0
v_mov_b32 v8, 0
v_mov_b32 v9, 0
v_mov_b32 v10, 0
v_mov_b32 v11, 0
s_lshl_b32 s28, s17, 13
s_add_u32 s28, s28, 110592
v_add_u32 v2, s28, v0
ds_write_b128 v2, v[8:11] offset:0
ds_write_b128 v2, v[8:11] offset:1024
ds_write_b128 v2, v[8:11] offset:2048
ds_write_b128 v2, v[8:11] offset:3072
ds_write_b128 v2, v[8:11] offset:4096
ds_write_b128 v2, v[8:11] offset:5120
ds_write_b128 v2, v[8:11] offset:6144
ds_write_b128 v2, v[8:11] offset:7168
s_waitcnt lgkmcnt(0)
s_barrier
s_load_dwordx2 s[4:5], s[0:1], 64
s_waitcnt lgkmcnt(0)
s_mov_b32 s12, s4
s_mov_b32 s13, s5
s_mov_b32 s14, 663552
s_mov_b32 s15, 0x00020000
s_load_dwordx2 s[4:5], s[0:1], 56
s_waitcnt lgkmcnt(0)
s_mov_b32 s20, s4
s_mov_b32 s21, s5
s_mov_b32 s22, 2359296
s_mov_b32 s23, 0x00020000
v_bfe_u32 v5, v0, 4, 4
v_mul_u32_u24 v5, 1152, v5
v_lshrrev_b32 v6, 8, v0
v_lshl_add_u32 v5, v6, 4, v5
s_mul_i32 s30, s24, 18432
buffer_load_dwordx4 v[16:19], v5, s[20:23], s30 offen offset:0
buffer_load_dwordx4 v[20:23], v5, s[20:23], s30 offen offset:64
buffer_load_dwordx4 v[24:27], v5, s[20:23], s30 offen offset:128
buffer_load_dwordx4 v[28:31], v5, s[20:23], s30 offen offset:192
buffer_load_dwordx4 v[32:35], v5, s[20:23], s30 offen offset:256
buffer_load_dwordx4 v[36:39], v5, s[20:23], s30 offen offset:320
buffer_load_dwordx4 v[40:43], v5, s[20:23], s30 offen offset:384
buffer_load_dwordx4 v[44:47], v5, s[20:23], s30 offen offset:448
buffer_load_dwordx4 v[48:51], v5, s[20:23], s30 offen offset:512
buffer_load_dwordx4 v[52:55], v5, s[20:23], s30 offen offset:576
buffer_load_dwordx4 v[56:59], v5, s[20:23], s30 offen offset:640
buffer_load_dwordx4 v[60:63], v5, s[20:23], s30 offen offset:704
buffer_load_dwordx4 v[64:67], v5, s[20:23], s30 offen offset:768
buffer_load_dwordx4 v[68:71], v5, s[20:23], s30 offen offset:832
buffer_load_dwordx4 v[72:75], v5, s[20:23], s30 offen offset:896
buffer_load_dwordx4 v[76:79], v5, s[20:23], s30 offen offset:960
buffer_load_dwordx4 v[80:83], v5, s[20:23], s30 offen offset:1024
buffer_load_dwordx4 v[84:87], v5, s[20:23], s30 offen offset:1088
v_lshrrev_b32 v2, 8, v0
v_bfe_u32 v3, v0, 6, 2
v_bfe_u32 v4, v0, 4, 2
v_lshl_add_u32 v2, v2, 3, v3
v_mul_u32_u24 v2, 1152, v2
v_lshl_add_u32 v2, v4, 3, v2
s_mul_i32 s28, s17, 288
v_add_u32 v2, s28, v2
v_add_u32 v3, 36864, v2
v_add_u32 v4, 73728, v2
s_mul_i32 s28, s17, 9216
s_add_u32 s29, s28, 0
s_add_u32 s28, s28, 0
s_mov_b32 m0, s28
s_add_u32 s28, s28, 1024
buffer_load_dwordx4 v0, s[12:15], s29 offen lds
s_add_u32 s29, s29, 1024
s_mov_b32 m0, s28
s_add_u32 s28, s28, 1024
buffer_load_dwordx4 v0, s[12:15], s29 offen lds
s_add_u32 s29, s29, 1024
s_mov_b32 m0, s28
s_add_u32 s28, s28, 1024
buffer_load_dwordx4 v0, s[12:15], s29 offen lds
s_add_u32 s29, s29, 1024
s_mov_b32 m0, s28
s_add_u32 s28, s28, 1024
buffer_load_dwordx4 v0, s[12:15], s29 offen lds
s_add_u32 s29, s29, 1024
s_mov_b32 m0, s28
s_add_u32 s28, s28, 1024
buffer_load_dwordx4 v0, s[12:15], s29 offen lds
s_add_u32 s29, s29, 1024
s_mov_b32 m0, s28
s_add_u32 s28, s28, 1024
buffer_load_dwordx4 v0, s[12:15], s29 offen lds
s_add_u32 s29, s29, 1024
s_mov_b32 m0, s28
s_add_u32 s28, s28, 1024
buffer_load_dwordx4 v0, s[12:15], s29 offen lds
s_add_u32 s29, s29, 1024
s_mov_b32 m0, s28
s_add_u32 s28, s28, 1024
buffer_load_dwordx4 v0, s[12:15], s29 offen lds
s_add_u32 s29, s29, 1024
s_mov_b32 m0, s28
s_add_u32 s28, s28, 1024
buffer_load_dwordx4 v0, s[12:15], s29 offen lds
s_add_u32 s29, s29, 1024
s_mul_i32 s28, s17, 9216
s_add_u32 s29, s28, 36864
s_add_u32 s28, s28, 36864
s_mov_b32 m0, s28
s_add_u32 s28, s28, 1024
buffer_load_dwordx4 v0, s[12:15], s29 offen lds
s_add_u32 s29, s29, 1024
s_mov_b32 m0, s28
s_add_u32 s28, s28, 1024
buffer_load_dwordx4 v0, s[12:15], s29 offen lds
s_add_u32 s29, s29, 1024
s_mov_b32 m0, s28
s_add_u32 s28, s28, 1024
buffer_load_dwordx4 v0, s[12:15], s29 offen lds
s_add_u32 s29, s29, 1024
s_mov_b32 m0, s28
s_add_u32 s28, s28, 1024
buffer_load_dwordx4 v0, s[12:15], s29 offen lds
s_add_u32 s29, s29, 1024
s_mov_b32 m0, s28
s_add_u32 s28, s28, 1024
buffer_load_dwordx4 v0, s[12:15], s29 offen lds
s_add_u32 s29, s29, 1024
s_mov_b32 m0, s28
s_add_u32 s28, s28, 1024
buffer_load_dwordx4 v0, s[12:15], s29 offen lds
s_add_u32 s29, s29, 1024
s_mov_b32 m0, s28
s_add_u32 s28, s28, 1024
buffer_load_dwordx4 v0, s[12:15], s29 offen lds
s_add_u32 s29, s29, 1024
s_mov_b32 m0, s28
s_add_u32 s28, s28, 1024
buffer_load_dwordx4 v0, s[12:15], s29 offen lds
s_add_u32 s29, s29, 1024
s_mov_b32 m0, s28
s_add_u32 s28, s28, 1024
buffer_load_dwordx4 v0, s[12:15], s29 offen lds
s_add_u32 s29, s29, 1024
s_waitcnt vmcnt(9)
s_barrier
s_mul_i32 s28, s17, 9216
s_add_u32 s29, s28, 73728
s_add_u32 s28, s28, 73728
s_mov_b32 m0, s28
s_add_u32 s28, s28, 1024
buffer_load_dwordx4 v0, s[12:15], s29 offen lds
s_add_u32 s29, s29, 1024
s_mov_b32 m0, s28
s_add_u32 s28, s28, 1024
buffer_load_dwordx4 v0, s[12:15], s29 offen lds
s_add_u32 s29, s29, 1024
s_mov_b32 m0, s28
s_add_u32 s28, s28, 1024
buffer_load_dwordx4 v0, s[12:15], s29 offen lds
s_add_u32 s29, s29, 1024
s_mov_b32 m0, s28
s_add_u32 s28, s28, 1024
buffer_load_dwordx4 v0, s[12:15], s29 offen lds
s_add_u32 s29, s29, 1024
s_mov_b32 m0, s28
s_add_u32 s28, s28, 1024
buffer_load_dwordx4 v0, s[12:15], s29 offen lds
s_add_u32 s29, s29, 1024
s_mov_b32 m0, s28
s_add_u32 s28, s28, 1024
buffer_load_dwordx4 v0, s[12:15], s29 offen lds
s_add_u32 s29, s29, 1024
s_mov_b32 m0, s28
s_add_u32 s28, s28, 1024
buffer_load_dwordx4 v0, s[12:15], s29 offen lds
s_add_u32 s29, s29, 1024
s_mov_b32 m0, s28
s_add_u32 s28, s28, 1024
buffer_load_dwordx4 v0, s[12:15], s29 offen lds
s_add_u32 s29, s29, 1024
s_mov_b32 m0, s28
s_add_u32 s28, s28, 1024
buffer_load_dwordx4 v0, s[12:15], s29 offen lds
s_add_u32 s29, s29, 1024
ds_read_b64_tr_b16 v[124:125], v2 offset:0
ds_read_b64_tr_b16 v[126:127], v2 offset:4608
ds_read_b64_tr_b16 v[128:129], v2 offset:32
ds_read_b64_tr_b16 v[130:131], v2 offset:4640
ds_read_b64_tr_b16 v[132:133], v2 offset:64
ds_read_b64_tr_b16 v[134:135], v2 offset:4672
ds_read_b64_tr_b16 v[136:137], v2 offset:96
ds_read_b64_tr_b16 v[138:139], v2 offset:4704
ds_read_b64_tr_b16 v[140:141], v2 offset:128
ds_read_b64_tr_b16 v[142:143], v2 offset:4736
ds_read_b64_tr_b16 v[144:145], v2 offset:160
ds_read_b64_tr_b16 v[146:147], v2 offset:4768
ds_read_b64_tr_b16 v[148:149], v2 offset:192
ds_read_b64_tr_b16 v[150:151], v2 offset:4800
ds_read_b64_tr_b16 v[152:153], v2 offset:224
ds_read_b64_tr_b16 v[154:155], v2 offset:4832
ds_read_b64_tr_b16 v[156:157], v2 offset:256
ds_read_b64_tr_b16 v[158:159], v2 offset:4864
s_waitcnt lgkmcnt(15)
v_mfma_f32_16x16x32_bf16 v[88:91], v[124:127], v[16:19], 0
s_waitcnt lgkmcnt(14)
v_mfma_f32_16x16x32_bf16 v[92:95], v[128:131], v[16:19], 0
s_waitcnt lgkmcnt(12)
v_mfma_f32_16x16x32_bf16 v[96:99], v[132:135], v[16:19], 0
s_waitcnt lgkmcnt(10)
v_mfma_f32_16x16x32_bf16 v[100:103], v[136:139], v[16:19], 0
s_waitcnt lgkmcnt(8)
v_mfma_f32_16x16x32_bf16 v[104:107], v[140:143], v[16:19], 0
s_waitcnt lgkmcnt(6)
v_mfma_f32_16x16x32_bf16 v[108:111], v[144:147], v[16:19], 0
s_waitcnt lgkmcnt(4)
v_mfma_f32_16x16x32_bf16 v[112:115], v[148:151], v[16:19], 0
s_waitcnt lgkmcnt(2)
v_mfma_f32_16x16x32_bf16 v[116:119], v[152:155], v[16:19], 0
s_waitcnt lgkmcnt(0)
v_mfma_f32_16x16x32_bf16 v[120:123], v[156:159], v[16:19], 0
s_waitcnt vmcnt(9)
s_barrier
s_mul_i32 s28, s17, 9216
s_add_u32 s29, s28, 110592
s_add_u32 s28, s28, 0
s_mov_b32 m0, s28
s_add_u32 s28, s28, 1024
buffer_load_dwordx4 v0, s[12:15], s29 offen lds
s_add_u32 s29, s29, 1024
s_mov_b32 m0, s28
s_add_u32 s28, s28, 1024
buffer_load_dwordx4 v0, s[12:15], s29 offen lds
s_add_u32 s29, s29, 1024
s_mov_b32 m0, s28
s_add_u32 s28, s28, 1024
buffer_load_dwordx4 v0, s[12:15], s29 offen lds
s_add_u32 s29, s29, 1024
s_mov_b32 m0, s28
s_add_u32 s28, s28, 1024
buffer_load_dwordx4 v0, s[12:15], s29 offen lds
s_add_u32 s29, s29, 1024
s_mov_b32 m0, s28
s_add_u32 s28, s28, 1024
buffer_load_dwordx4 v0, s[12:15], s29 offen lds
s_add_u32 s29, s29, 1024
s_mov_b32 m0, s28
s_add_u32 s28, s28, 1024
buffer_load_dwordx4 v0, s[12:15], s29 offen lds
s_add_u32 s29, s29, 1024
s_mov_b32 m0, s28
s_add_u32 s28, s28, 1024
buffer_load_dwordx4 v0, s[12:15], s29 offen lds
s_add_u32 s29, s29, 1024
s_mov_b32 m0, s28
s_add_u32 s28, s28, 1024
buffer_load_dwordx4 v0, s[12:15], s29 offen lds
s_add_u32 s29, s29, 1024
s_mov_b32 m0, s28
s_add_u32 s28, s28, 1024
buffer_load_dwordx4 v0, s[12:15], s29 offen lds
s_add_u32 s29, s29, 1024
ds_read_b64_tr_b16 v[124:125], v3 offset:0
ds_read_b64_tr_b16 v[126:127], v3 offset:4608
ds_read_b64_tr_b16 v[128:129], v3 offset:32
ds_read_b64_tr_b16 v[130:131], v3 offset:4640
ds_read_b64_tr_b16 v[132:133], v3 offset:64
ds_read_b64_tr_b16 v[134:135], v3 offset:4672
ds_read_b64_tr_b16 v[136:137], v3 offset:96
ds_read_b64_tr_b16 v[138:139], v3 offset:4704
ds_read_b64_tr_b16 v[140:141], v3 offset:128
ds_read_b64_tr_b16 v[142:143], v3 offset:4736
ds_read_b64_tr_b16 v[144:145], v3 offset:160
ds_read_b64_tr_b16 v[146:147], v3 offset:4768
ds_read_b64_tr_b16 v[148:149], v3 offset:192
ds_read_b64_tr_b16 v[150:151], v3 offset:4800
ds_read_b64_tr_b16 v[152:153], v3 offset:224
ds_read_b64_tr_b16 v[154:155], v3 offset:4832
ds_read_b64_tr_b16 v[156:157], v3 offset:256
ds_read_b64_tr_b16 v[158:159], v3 offset:4864
s_waitcnt lgkmcnt(15)
v_mfma_f32_16x16x32_bf16 v[88:91], v[124:127], v[20:23], v[88:91]
s_waitcnt lgkmcnt(14)
v_mfma_f32_16x16x32_bf16 v[92:95], v[128:131], v[20:23], v[92:95]
s_waitcnt lgkmcnt(12)
v_mfma_f32_16x16x32_bf16 v[96:99], v[132:135], v[20:23], v[96:99]
s_waitcnt lgkmcnt(10)
v_mfma_f32_16x16x32_bf16 v[100:103], v[136:139], v[20:23], v[100:103]
s_waitcnt lgkmcnt(8)
v_mfma_f32_16x16x32_bf16 v[104:107], v[140:143], v[20:23], v[104:107]
s_waitcnt lgkmcnt(6)
v_mfma_f32_16x16x32_bf16 v[108:111], v[144:147], v[20:23], v[108:111]
s_waitcnt lgkmcnt(4)
v_mfma_f32_16x16x32_bf16 v[112:115], v[148:151], v[20:23], v[112:115]
s_waitcnt lgkmcnt(2)
v_mfma_f32_16x16x32_bf16 v[116:119], v[152:155], v[20:23], v[116:119]
s_waitcnt lgkmcnt(0)
v_mfma_f32_16x16x32_bf16 v[120:123], v[156:159], v[20:23], v[120:123]
s_waitcnt vmcnt(9)
s_barrier
s_mul_i32 s28, s17, 9216
s_add_u32 s29, s28, 147456
s_add_u32 s28, s28, 36864
s_mov_b32 m0, s28
s_add_u32 s28, s28, 1024
buffer_load_dwordx4 v0, s[12:15], s29 offen lds
s_add_u32 s29, s29, 1024
s_mov_b32 m0, s28
s_add_u32 s28, s28, 1024
buffer_load_dwordx4 v0, s[12:15], s29 offen lds
s_add_u32 s29, s29, 1024
s_mov_b32 m0, s28
s_add_u32 s28, s28, 1024
buffer_load_dwordx4 v0, s[12:15], s29 offen lds
s_add_u32 s29, s29, 1024
s_mov_b32 m0, s28
s_add_u32 s28, s28, 1024
buffer_load_dwordx4 v0, s[12:15], s29 offen lds
s_add_u32 s29, s29, 1024
s_mov_b32 m0, s28
s_add_u32 s28, s28, 1024
buffer_load_dwordx4 v0, s[12:15], s29 offen lds
s_add_u32 s29, s29, 1024
s_mov_b32 m0, s28
s_add_u32 s28, s28, 1024
buffer_load_dwordx4 v0, s[12:15], s29 offen lds
s_add_u32 s29, s29, 1024
s_mov_b32 m0, s28
s_add_u32 s28, s28, 1024
buffer_load_dwordx4 v0, s[12:15], s29 offen lds
s_add_u32 s29, s29, 1024
s_mov_b32 m0, s28
s_add_u32 s28, s28, 1024
buffer_load_dwordx4 v0, s[12:15], s29 offen lds
s_add_u32 s29, s29, 1024
s_mov_b32 m0, s28
s_add_u32 s28, s28, 1024
buffer_load_dwordx4 v0, s[12:15], s29 offen lds
s_add_u32 s29, s29, 1024
ds_read_b64_tr_b16 v[124:125], v4 offset:0
ds_read_b64_tr_b16 v[126:127], v4 offset:4608
ds_read_b64_tr_b16 v[128:129], v4 offset:32
ds_read_b64_tr_b16 v[130:131], v4 offset:4640
ds_read_b64_tr_b16 v[132:133], v4 offset:64
ds_read_b64_tr_b16 v[134:135], v4 offset:4672
ds_read_b64_tr_b16 v[136:137], v4 offset:96
ds_read_b64_tr_b16 v[138:139], v4 offset:4704
ds_read_b64_tr_b16 v[140:141], v4 offset:128
ds_read_b64_tr_b16 v[142:143], v4 offset:4736
ds_read_b64_tr_b16 v[144:145], v4 offset:160
ds_read_b64_tr_b16 v[146:147], v4 offset:4768
ds_read_b64_tr_b16 v[148:149], v4 offset:192
ds_read_b64_tr_b16 v[150:151], v4 offset:4800
ds_read_b64_tr_b16 v[152:153], v4 offset:224
ds_read_b64_tr_b16 v[154:155], v4 offset:4832
ds_read_b64_tr_b16 v[156:157], v4 offset:256
ds_read_b64_tr_b16 v[158:159], v4 offset:4864
s_waitcnt lgkmcnt(15)
v_mfma_f32_16x16x32_bf16 v[88:91], v[124:127], v[24:27], v[88:91]
s_waitcnt lgkmcnt(14)
v_mfma_f32_16x16x32_bf16 v[92:95], v[128:131], v[24:27], v[92:95]
s_waitcnt lgkmcnt(12)
v_mfma_f32_16x16x32_bf16 v[96:99], v[132:135], v[24:27], v[96:99]
s_waitcnt lgkmcnt(10)
v_mfma_f32_16x16x32_bf16 v[100:103], v[136:139], v[24:27], v[100:103]
s_waitcnt lgkmcnt(8)
v_mfma_f32_16x16x32_bf16 v[104:107], v[140:143], v[24:27], v[104:107]
s_waitcnt lgkmcnt(6)
v_mfma_f32_16x16x32_bf16 v[108:111], v[144:147], v[24:27], v[108:111]
s_waitcnt lgkmcnt(4)
v_mfma_f32_16x16x32_bf16 v[112:115], v[148:151], v[24:27], v[112:115]
s_waitcnt lgkmcnt(2)
v_mfma_f32_16x16x32_bf16 v[116:119], v[152:155], v[24:27], v[116:119]
s_waitcnt lgkmcnt(0)
v_mfma_f32_16x16x32_bf16 v[120:123], v[156:159], v[24:27], v[120:123]
s_waitcnt vmcnt(9)
s_barrier
s_mul_i32 s28, s17, 9216
s_add_u32 s29, s28, 184320
s_add_u32 s28, s28, 73728
s_mov_b32 m0, s28
s_add_u32 s28, s28, 1024
buffer_load_dwordx4 v0, s[12:15], s29 offen lds
s_add_u32 s29, s29, 1024
s_mov_b32 m0, s28
s_add_u32 s28, s28, 1024
buffer_load_dwordx4 v0, s[12:15], s29 offen lds
s_add_u32 s29, s29, 1024
s_mov_b32 m0, s28
s_add_u32 s28, s28, 1024
buffer_load_dwordx4 v0, s[12:15], s29 offen lds
s_add_u32 s29, s29, 1024
s_mov_b32 m0, s28
s_add_u32 s28, s28, 1024
buffer_load_dwordx4 v0, s[12:15], s29 offen lds
s_add_u32 s29, s29, 1024
s_mov_b32 m0, s28
s_add_u32 s28, s28, 1024
buffer_load_dwordx4 v0, s[12:15], s29 offen lds
s_add_u32 s29, s29, 1024
s_mov_b32 m0, s28
s_add_u32 s28, s28, 1024
buffer_load_dwordx4 v0, s[12:15], s29 offen lds
s_add_u32 s29, s29, 1024
s_mov_b32 m0, s28
s_add_u32 s28, s28, 1024
buffer_load_dwordx4 v0, s[12:15], s29 offen lds
s_add_u32 s29, s29, 1024
s_mov_b32 m0, s28
s_add_u32 s28, s28, 1024
buffer_load_dwordx4 v0, s[12:15], s29 offen lds
s_add_u32 s29, s29, 1024
s_mov_b32 m0, s28
s_add_u32 s28, s28, 1024
buffer_load_dwordx4 v0, s[12:15], s29 offen lds
s_add_u32 s29, s29, 1024
ds_read_b64_tr_b16 v[124:125], v2 offset:0
ds_read_b64_tr_b16 v[126:127], v2 offset:4608
ds_read_b64_tr_b16 v[128:129], v2 offset:32
ds_read_b64_tr_b16 v[130:131], v2 offset:4640
ds_read_b64_tr_b16 v[132:133], v2 offset:64
ds_read_b64_tr_b16 v[134:135], v2 offset:4672
ds_read_b64_tr_b16 v[136:137], v2 offset:96
ds_read_b64_tr_b16 v[138:139], v2 offset:4704
ds_read_b64_tr_b16 v[140:141], v2 offset:128
ds_read_b64_tr_b16 v[142:143], v2 offset:4736
ds_read_b64_tr_b16 v[144:145], v2 offset:160
ds_read_b64_tr_b16 v[146:147], v2 offset:4768
ds_read_b64_tr_b16 v[148:149], v2 offset:192
ds_read_b64_tr_b16 v[150:151], v2 offset:4800
ds_read_b64_tr_b16 v[152:153], v2 offset:224
ds_read_b64_tr_b16 v[154:155], v2 offset:4832
ds_read_b64_tr_b16 v[156:157], v2 offset:256
ds_read_b64_tr_b16 v[158:159], v2 offset:4864
s_waitcnt lgkmcnt(15)
v_mfma_f32_16x16x32_bf16 v[88:91], v[124:127], v[28:31], v[88:91]
s_waitcnt lgkmcnt(14)
v_mfma_f32_16x16x32_bf16 v[92:95], v[128:131], v[28:31], v[92:95]
s_waitcnt lgkmcnt(12)
v_mfma_f32_16x16x32_bf16 v[96:99], v[132:135], v[28:31], v[96:99]
s_waitcnt lgkmcnt(10)
v_mfma_f32_16x16x32_bf16 v[100:103], v[136:139], v[28:31], v[100:103]
s_waitcnt lgkmcnt(8)
v_mfma_f32_16x16x32_bf16 v[104:107], v[140:143], v[28:31], v[104:107]
s_waitcnt lgkmcnt(6)
v_mfma_f32_16x16x32_bf16 v[108:111], v[144:147], v[28:31], v[108:111]
s_waitcnt lgkmcnt(4)
v_mfma_f32_16x16x32_bf16 v[112:115], v[148:151], v[28:31], v[112:115]
s_waitcnt lgkmcnt(2)
v_mfma_f32_16x16x32_bf16 v[116:119], v[152:155], v[28:31], v[116:119]
s_waitcnt lgkmcnt(0)
v_mfma_f32_16x16x32_bf16 v[120:123], v[156:159], v[28:31], v[120:123]
s_waitcnt vmcnt(9)
s_barrier
s_mul_i32 s28, s17, 9216
s_add_u32 s29, s28, 221184
s_add_u32 s28, s28, 0
s_mov_b32 m0, s28
s_add_u32 s28, s28, 1024
buffer_load_dwordx4 v0, s[12:15], s29 offen lds
s_add_u32 s29, s29, 1024
s_mov_b32 m0, s28
s_add_u32 s28, s28, 1024
buffer_load_dwordx4 v0, s[12:15], s29 offen lds
s_add_u32 s29, s29, 1024
s_mov_b32 m0, s28
s_add_u32 s28, s28, 1024
buffer_load_dwordx4 v0, s[12:15], s29 offen lds
s_add_u32 s29, s29, 1024
s_mov_b32 m0, s28
s_add_u32 s28, s28, 1024
buffer_load_dwordx4 v0, s[12:15], s29 offen lds
s_add_u32 s29, s29, 1024
s_mov_b32 m0, s28
s_add_u32 s28, s28, 1024
buffer_load_dwordx4 v0, s[12:15], s29 offen lds
s_add_u32 s29, s29, 1024
s_mov_b32 m0, s28
s_add_u32 s28, s28, 1024
buffer_load_dwordx4 v0, s[12:15], s29 offen lds
s_add_u32 s29, s29, 1024
s_mov_b32 m0, s28
s_add_u32 s28, s28, 1024
buffer_load_dwordx4 v0, s[12:15], s29 offen lds
s_add_u32 s29, s29, 1024
s_mov_b32 m0, s28
s_add_u32 s28, s28, 1024
buffer_load_dwordx4 v0, s[12:15], s29 offen lds
s_add_u32 s29, s29, 1024
s_mov_b32 m0, s28
s_add_u32 s28, s28, 1024
buffer_load_dwordx4 v0, s[12:15], s29 offen lds
s_add_u32 s29, s29, 1024
ds_read_b64_tr_b16 v[124:125], v3 offset:0
ds_read_b64_tr_b16 v[126:127], v3 offset:4608
ds_read_b64_tr_b16 v[128:129], v3 offset:32
ds_read_b64_tr_b16 v[130:131], v3 offset:4640
ds_read_b64_tr_b16 v[132:133], v3 offset:64
ds_read_b64_tr_b16 v[134:135], v3 offset:4672
ds_read_b64_tr_b16 v[136:137], v3 offset:96
ds_read_b64_tr_b16 v[138:139], v3 offset:4704
ds_read_b64_tr_b16 v[140:141], v3 offset:128
ds_read_b64_tr_b16 v[142:143], v3 offset:4736
ds_read_b64_tr_b16 v[144:145], v3 offset:160
ds_read_b64_tr_b16 v[146:147], v3 offset:4768
ds_read_b64_tr_b16 v[148:149], v3 offset:192
ds_read_b64_tr_b16 v[150:151], v3 offset:4800
ds_read_b64_tr_b16 v[152:153], v3 offset:224
ds_read_b64_tr_b16 v[154:155], v3 offset:4832
ds_read_b64_tr_b16 v[156:157], v3 offset:256
ds_read_b64_tr_b16 v[158:159], v3 offset:4864
s_waitcnt lgkmcnt(15)
v_mfma_f32_16x16x32_bf16 v[88:91], v[124:127], v[32:35], v[88:91]
s_waitcnt lgkmcnt(14)
v_mfma_f32_16x16x32_bf16 v[92:95], v[128:131], v[32:35], v[92:95]
s_waitcnt lgkmcnt(12)
v_mfma_f32_16x16x32_bf16 v[96:99], v[132:135], v[32:35], v[96:99]
s_waitcnt lgkmcnt(10)
v_mfma_f32_16x16x32_bf16 v[100:103], v[136:139], v[32:35], v[100:103]
s_waitcnt lgkmcnt(8)
v_mfma_f32_16x16x32_bf16 v[104:107], v[140:143], v[32:35], v[104:107]
s_waitcnt lgkmcnt(6)
v_mfma_f32_16x16x32_bf16 v[108:111], v[144:147], v[32:35], v[108:111]
s_waitcnt lgkmcnt(4)
v_mfma_f32_16x16x32_bf16 v[112:115], v[148:151], v[32:35], v[112:115]
s_waitcnt lgkmcnt(2)
v_mfma_f32_16x16x32_bf16 v[116:119], v[152:155], v[32:35], v[116:119]
s_waitcnt lgkmcnt(0)
v_mfma_f32_16x16x32_bf16 v[120:123], v[156:159], v[32:35], v[120:123]
s_waitcnt vmcnt(9)
s_barrier
s_mul_i32 s28, s17, 9216
s_add_u32 s29, s28, 258048
s_add_u32 s28, s28, 36864
s_mov_b32 m0, s28
s_add_u32 s28, s28, 1024
buffer_load_dwordx4 v0, s[12:15], s29 offen lds
s_add_u32 s29, s29, 1024
s_mov_b32 m0, s28
s_add_u32 s28, s28, 1024
buffer_load_dwordx4 v0, s[12:15], s29 offen lds
s_add_u32 s29, s29, 1024
s_mov_b32 m0, s28
s_add_u32 s28, s28, 1024
buffer_load_dwordx4 v0, s[12:15], s29 offen lds
s_add_u32 s29, s29, 1024
s_mov_b32 m0, s28
s_add_u32 s28, s28, 1024
buffer_load_dwordx4 v0, s[12:15], s29 offen lds
s_add_u32 s29, s29, 1024
s_mov_b32 m0, s28
s_add_u32 s28, s28, 1024
buffer_load_dwordx4 v0, s[12:15], s29 offen lds
s_add_u32 s29, s29, 1024
s_mov_b32 m0, s28
s_add_u32 s28, s28, 1024
buffer_load_dwordx4 v0, s[12:15], s29 offen lds
s_add_u32 s29, s29, 1024
s_mov_b32 m0, s28
s_add_u32 s28, s28, 1024
buffer_load_dwordx4 v0, s[12:15], s29 offen lds
s_add_u32 s29, s29, 1024
s_mov_b32 m0, s28
s_add_u32 s28, s28, 1024
buffer_load_dwordx4 v0, s[12:15], s29 offen lds
s_add_u32 s29, s29, 1024
s_mov_b32 m0, s28
s_add_u32 s28, s28, 1024
buffer_load_dwordx4 v0, s[12:15], s29 offen lds
s_add_u32 s29, s29, 1024
ds_read_b64_tr_b16 v[124:125], v4 offset:0
ds_read_b64_tr_b16 v[126:127], v4 offset:4608
ds_read_b64_tr_b16 v[128:129], v4 offset:32
ds_read_b64_tr_b16 v[130:131], v4 offset:4640
ds_read_b64_tr_b16 v[132:133], v4 offset:64
ds_read_b64_tr_b16 v[134:135], v4 offset:4672
ds_read_b64_tr_b16 v[136:137], v4 offset:96
ds_read_b64_tr_b16 v[138:139], v4 offset:4704
ds_read_b64_tr_b16 v[140:141], v4 offset:128
ds_read_b64_tr_b16 v[142:143], v4 offset:4736
ds_read_b64_tr_b16 v[144:145], v4 offset:160
ds_read_b64_tr_b16 v[146:147], v4 offset:4768
ds_read_b64_tr_b16 v[148:149], v4 offset:192
ds_read_b64_tr_b16 v[150:151], v4 offset:4800
ds_read_b64_tr_b16 v[152:153], v4 offset:224
ds_read_b64_tr_b16 v[154:155], v4 offset:4832
ds_read_b64_tr_b16 v[156:157], v4 offset:256
ds_read_b64_tr_b16 v[158:159], v4 offset:4864
s_waitcnt lgkmcnt(15)
v_mfma_f32_16x16x32_bf16 v[88:91], v[124:127], v[36:39], v[88:91]
s_waitcnt lgkmcnt(14)
v_mfma_f32_16x16x32_bf16 v[92:95], v[128:131], v[36:39], v[92:95]
s_waitcnt lgkmcnt(12)
v_mfma_f32_16x16x32_bf16 v[96:99], v[132:135], v[36:39], v[96:99]
s_waitcnt lgkmcnt(10)
v_mfma_f32_16x16x32_bf16 v[100:103], v[136:139], v[36:39], v[100:103]
s_waitcnt lgkmcnt(8)
v_mfma_f32_16x16x32_bf16 v[104:107], v[140:143], v[36:39], v[104:107]
s_waitcnt lgkmcnt(6)
v_mfma_f32_16x16x32_bf16 v[108:111], v[144:147], v[36:39], v[108:111]
s_waitcnt lgkmcnt(4)
v_mfma_f32_16x16x32_bf16 v[112:115], v[148:151], v[36:39], v[112:115]
s_waitcnt lgkmcnt(2)
v_mfma_f32_16x16x32_bf16 v[116:119], v[152:155], v[36:39], v[116:119]
s_waitcnt lgkmcnt(0)
v_mfma_f32_16x16x32_bf16 v[120:123], v[156:159], v[36:39], v[120:123]
s_waitcnt vmcnt(9)
s_barrier
s_mul_i32 s28, s17, 9216
s_add_u32 s29, s28, 294912
s_add_u32 s28, s28, 73728
s_mov_b32 m0, s28
s_add_u32 s28, s28, 1024
buffer_load_dwordx4 v0, s[12:15], s29 offen lds
s_add_u32 s29, s29, 1024
s_mov_b32 m0, s28
s_add_u32 s28, s28, 1024
buffer_load_dwordx4 v0, s[12:15], s29 offen lds
s_add_u32 s29, s29, 1024
s_mov_b32 m0, s28
s_add_u32 s28, s28, 1024
buffer_load_dwordx4 v0, s[12:15], s29 offen lds
s_add_u32 s29, s29, 1024
s_mov_b32 m0, s28
s_add_u32 s28, s28, 1024
buffer_load_dwordx4 v0, s[12:15], s29 offen lds
s_add_u32 s29, s29, 1024
s_mov_b32 m0, s28
s_add_u32 s28, s28, 1024
buffer_load_dwordx4 v0, s[12:15], s29 offen lds
s_add_u32 s29, s29, 1024
s_mov_b32 m0, s28
s_add_u32 s28, s28, 1024
buffer_load_dwordx4 v0, s[12:15], s29 offen lds
s_add_u32 s29, s29, 1024
s_mov_b32 m0, s28
s_add_u32 s28, s28, 1024
buffer_load_dwordx4 v0, s[12:15], s29 offen lds
s_add_u32 s29, s29, 1024
s_mov_b32 m0, s28
s_add_u32 s28, s28, 1024
buffer_load_dwordx4 v0, s[12:15], s29 offen lds
s_add_u32 s29, s29, 1024
s_mov_b32 m0, s28
s_add_u32 s28, s28, 1024
buffer_load_dwordx4 v0, s[12:15], s29 offen lds
s_add_u32 s29, s29, 1024
ds_read_b64_tr_b16 v[124:125], v2 offset:0
ds_read_b64_tr_b16 v[126:127], v2 offset:4608
ds_read_b64_tr_b16 v[128:129], v2 offset:32
ds_read_b64_tr_b16 v[130:131], v2 offset:4640
ds_read_b64_tr_b16 v[132:133], v2 offset:64
ds_read_b64_tr_b16 v[134:135], v2 offset:4672
ds_read_b64_tr_b16 v[136:137], v2 offset:96
ds_read_b64_tr_b16 v[138:139], v2 offset:4704
ds_read_b64_tr_b16 v[140:141], v2 offset:128
ds_read_b64_tr_b16 v[142:143], v2 offset:4736
ds_read_b64_tr_b16 v[144:145], v2 offset:160
ds_read_b64_tr_b16 v[146:147], v2 offset:4768
ds_read_b64_tr_b16 v[148:149], v2 offset:192
ds_read_b64_tr_b16 v[150:151], v2 offset:4800
ds_read_b64_tr_b16 v[152:153], v2 offset:224
ds_read_b64_tr_b16 v[154:155], v2 offset:4832
ds_read_b64_tr_b16 v[156:157], v2 offset:256
ds_read_b64_tr_b16 v[158:159], v2 offset:4864
s_waitcnt lgkmcnt(15)
v_mfma_f32_16x16x32_bf16 v[88:91], v[124:127], v[40:43], v[88:91]
s_waitcnt lgkmcnt(14)
v_mfma_f32_16x16x32_bf16 v[92:95], v[128:131], v[40:43], v[92:95]
s_waitcnt lgkmcnt(12)
v_mfma_f32_16x16x32_bf16 v[96:99], v[132:135], v[40:43], v[96:99]
s_waitcnt lgkmcnt(10)
v_mfma_f32_16x16x32_bf16 v[100:103], v[136:139], v[40:43], v[100:103]
s_waitcnt lgkmcnt(8)
v_mfma_f32_16x16x32_bf16 v[104:107], v[140:143], v[40:43], v[104:107]
s_waitcnt lgkmcnt(6)
v_mfma_f32_16x16x32_bf16 v[108:111], v[144:147], v[40:43], v[108:111]
s_waitcnt lgkmcnt(4)
v_mfma_f32_16x16x32_bf16 v[112:115], v[148:151], v[40:43], v[112:115]
s_waitcnt lgkmcnt(2)
v_mfma_f32_16x16x32_bf16 v[116:119], v[152:155], v[40:43], v[116:119]
s_waitcnt lgkmcnt(0)
v_mfma_f32_16x16x32_bf16 v[120:123], v[156:159], v[40:43], v[120:123]
s_waitcnt vmcnt(9)
s_barrier
s_mul_i32 s28, s17, 9216
s_add_u32 s29, s28, 331776
s_add_u32 s28, s28, 0
s_mov_b32 m0, s28
s_add_u32 s28, s28, 1024
buffer_load_dwordx4 v0, s[12:15], s29 offen lds
s_add_u32 s29, s29, 1024
s_mov_b32 m0, s28
s_add_u32 s28, s28, 1024
buffer_load_dwordx4 v0, s[12:15], s29 offen lds
s_add_u32 s29, s29, 1024
s_mov_b32 m0, s28
s_add_u32 s28, s28, 1024
buffer_load_dwordx4 v0, s[12:15], s29 offen lds
s_add_u32 s29, s29, 1024
s_mov_b32 m0, s28
s_add_u32 s28, s28, 1024
buffer_load_dwordx4 v0, s[12:15], s29 offen lds
s_add_u32 s29, s29, 1024
s_mov_b32 m0, s28
s_add_u32 s28, s28, 1024
buffer_load_dwordx4 v0, s[12:15], s29 offen lds
s_add_u32 s29, s29, 1024
s_mov_b32 m0, s28
s_add_u32 s28, s28, 1024
buffer_load_dwordx4 v0, s[12:15], s29 offen lds
s_add_u32 s29, s29, 1024
s_mov_b32 m0, s28
s_add_u32 s28, s28, 1024
buffer_load_dwordx4 v0, s[12:15], s29 offen lds
s_add_u32 s29, s29, 1024
s_mov_b32 m0, s28
s_add_u32 s28, s28, 1024
buffer_load_dwordx4 v0, s[12:15], s29 offen lds
s_add_u32 s29, s29, 1024
s_mov_b32 m0, s28
s_add_u32 s28, s28, 1024
buffer_load_dwordx4 v0, s[12:15], s29 offen lds
s_add_u32 s29, s29, 1024
ds_read_b64_tr_b16 v[124:125], v3 offset:0
ds_read_b64_tr_b16 v[126:127], v3 offset:4608
ds_read_b64_tr_b16 v[128:129], v3 offset:32
ds_read_b64_tr_b16 v[130:131], v3 offset:4640
ds_read_b64_tr_b16 v[132:133], v3 offset:64
ds_read_b64_tr_b16 v[134:135], v3 offset:4672
ds_read_b64_tr_b16 v[136:137], v3 offset:96
ds_read_b64_tr_b16 v[138:139], v3 offset:4704
ds_read_b64_tr_b16 v[140:141], v3 offset:128
ds_read_b64_tr_b16 v[142:143], v3 offset:4736
ds_read_b64_tr_b16 v[144:145], v3 offset:160
ds_read_b64_tr_b16 v[146:147], v3 offset:4768
ds_read_b64_tr_b16 v[148:149], v3 offset:192
ds_read_b64_tr_b16 v[150:151], v3 offset:4800
ds_read_b64_tr_b16 v[152:153], v3 offset:224
ds_read_b64_tr_b16 v[154:155], v3 offset:4832
ds_read_b64_tr_b16 v[156:157], v3 offset:256
ds_read_b64_tr_b16 v[158:159], v3 offset:4864
s_waitcnt lgkmcnt(15)
v_mfma_f32_16x16x32_bf16 v[88:91], v[124:127], v[44:47], v[88:91]
s_waitcnt lgkmcnt(14)
v_mfma_f32_16x16x32_bf16 v[92:95], v[128:131], v[44:47], v[92:95]
s_waitcnt lgkmcnt(12)
v_mfma_f32_16x16x32_bf16 v[96:99], v[132:135], v[44:47], v[96:99]
s_waitcnt lgkmcnt(10)
v_mfma_f32_16x16x32_bf16 v[100:103], v[136:139], v[44:47], v[100:103]
s_waitcnt lgkmcnt(8)
v_mfma_f32_16x16x32_bf16 v[104:107], v[140:143], v[44:47], v[104:107]
s_waitcnt lgkmcnt(6)
v_mfma_f32_16x16x32_bf16 v[108:111], v[144:147], v[44:47], v[108:111]
s_waitcnt lgkmcnt(4)
v_mfma_f32_16x16x32_bf16 v[112:115], v[148:151], v[44:47], v[112:115]
s_waitcnt lgkmcnt(2)
v_mfma_f32_16x16x32_bf16 v[116:119], v[152:155], v[44:47], v[116:119]
s_waitcnt lgkmcnt(0)
v_mfma_f32_16x16x32_bf16 v[120:123], v[156:159], v[44:47], v[120:123]
s_waitcnt vmcnt(9)
s_barrier
s_mul_i32 s28, s17, 9216
s_add_u32 s29, s28, 368640
s_add_u32 s28, s28, 36864
s_mov_b32 m0, s28
s_add_u32 s28, s28, 1024
buffer_load_dwordx4 v0, s[12:15], s29 offen lds
s_add_u32 s29, s29, 1024
s_mov_b32 m0, s28
s_add_u32 s28, s28, 1024
buffer_load_dwordx4 v0, s[12:15], s29 offen lds
s_add_u32 s29, s29, 1024
s_mov_b32 m0, s28
s_add_u32 s28, s28, 1024
buffer_load_dwordx4 v0, s[12:15], s29 offen lds
s_add_u32 s29, s29, 1024
s_mov_b32 m0, s28
s_add_u32 s28, s28, 1024
buffer_load_dwordx4 v0, s[12:15], s29 offen lds
s_add_u32 s29, s29, 1024
s_mov_b32 m0, s28
s_add_u32 s28, s28, 1024
buffer_load_dwordx4 v0, s[12:15], s29 offen lds
s_add_u32 s29, s29, 1024
s_mov_b32 m0, s28
s_add_u32 s28, s28, 1024
buffer_load_dwordx4 v0, s[12:15], s29 offen lds
s_add_u32 s29, s29, 1024
s_mov_b32 m0, s28
s_add_u32 s28, s28, 1024
buffer_load_dwordx4 v0, s[12:15], s29 offen lds
s_add_u32 s29, s29, 1024
s_mov_b32 m0, s28
s_add_u32 s28, s28, 1024
buffer_load_dwordx4 v0, s[12:15], s29 offen lds
s_add_u32 s29, s29, 1024
s_mov_b32 m0, s28
s_add_u32 s28, s28, 1024
buffer_load_dwordx4 v0, s[12:15], s29 offen lds
s_add_u32 s29, s29, 1024
ds_read_b64_tr_b16 v[124:125], v4 offset:0
ds_read_b64_tr_b16 v[126:127], v4 offset:4608
ds_read_b64_tr_b16 v[128:129], v4 offset:32
ds_read_b64_tr_b16 v[130:131], v4 offset:4640
ds_read_b64_tr_b16 v[132:133], v4 offset:64
ds_read_b64_tr_b16 v[134:135], v4 offset:4672
ds_read_b64_tr_b16 v[136:137], v4 offset:96
ds_read_b64_tr_b16 v[138:139], v4 offset:4704
ds_read_b64_tr_b16 v[140:141], v4 offset:128
ds_read_b64_tr_b16 v[142:143], v4 offset:4736
ds_read_b64_tr_b16 v[144:145], v4 offset:160
ds_read_b64_tr_b16 v[146:147], v4 offset:4768
ds_read_b64_tr_b16 v[148:149], v4 offset:192
ds_read_b64_tr_b16 v[150:151], v4 offset:4800
ds_read_b64_tr_b16 v[152:153], v4 offset:224
ds_read_b64_tr_b16 v[154:155], v4 offset:4832
ds_read_b64_tr_b16 v[156:157], v4 offset:256
ds_read_b64_tr_b16 v[158:159], v4 offset:4864
s_waitcnt lgkmcnt(15)
v_mfma_f32_16x16x32_bf16 v[88:91], v[124:127], v[48:51], v[88:91]
s_waitcnt lgkmcnt(14)
v_mfma_f32_16x16x32_bf16 v[92:95], v[128:131], v[48:51], v[92:95]
s_waitcnt lgkmcnt(12)
v_mfma_f32_16x16x32_bf16 v[96:99], v[132:135], v[48:51], v[96:99]
s_waitcnt lgkmcnt(10)
v_mfma_f32_16x16x32_bf16 v[100:103], v[136:139], v[48:51], v[100:103]
s_waitcnt lgkmcnt(8)
v_mfma_f32_16x16x32_bf16 v[104:107], v[140:143], v[48:51], v[104:107]
s_waitcnt lgkmcnt(6)
v_mfma_f32_16x16x32_bf16 v[108:111], v[144:147], v[48:51], v[108:111]
s_waitcnt lgkmcnt(4)
v_mfma_f32_16x16x32_bf16 v[112:115], v[148:151], v[48:51], v[112:115]
s_waitcnt lgkmcnt(2)
v_mfma_f32_16x16x32_bf16 v[116:119], v[152:155], v[48:51], v[116:119]
s_waitcnt lgkmcnt(0)
v_mfma_f32_16x16x32_bf16 v[120:123], v[156:159], v[48:51], v[120:123]
s_waitcnt vmcnt(9)
s_barrier
s_mul_i32 s28, s17, 9216
s_add_u32 s29, s28, 405504
s_add_u32 s28, s28, 73728
s_mov_b32 m0, s28
s_add_u32 s28, s28, 1024
buffer_load_dwordx4 v0, s[12:15], s29 offen lds
s_add_u32 s29, s29, 1024
s_mov_b32 m0, s28
s_add_u32 s28, s28, 1024
buffer_load_dwordx4 v0, s[12:15], s29 offen lds
s_add_u32 s29, s29, 1024
s_mov_b32 m0, s28
s_add_u32 s28, s28, 1024
buffer_load_dwordx4 v0, s[12:15], s29 offen lds
s_add_u32 s29, s29, 1024
s_mov_b32 m0, s28
s_add_u32 s28, s28, 1024
buffer_load_dwordx4 v0, s[12:15], s29 offen lds
s_add_u32 s29, s29, 1024
s_mov_b32 m0, s28
s_add_u32 s28, s28, 1024
buffer_load_dwordx4 v0, s[12:15], s29 offen lds
s_add_u32 s29, s29, 1024
s_mov_b32 m0, s28
s_add_u32 s28, s28, 1024
buffer_load_dwordx4 v0, s[12:15], s29 offen lds
s_add_u32 s29, s29, 1024
s_mov_b32 m0, s28
s_add_u32 s28, s28, 1024
buffer_load_dwordx4 v0, s[12:15], s29 offen lds
s_add_u32 s29, s29, 1024
s_mov_b32 m0, s28
s_add_u32 s28, s28, 1024
buffer_load_dwordx4 v0, s[12:15], s29 offen lds
s_add_u32 s29, s29, 1024
s_mov_b32 m0, s28
s_add_u32 s28, s28, 1024
buffer_load_dwordx4 v0, s[12:15], s29 offen lds
s_add_u32 s29, s29, 1024
ds_read_b64_tr_b16 v[124:125], v2 offset:0
ds_read_b64_tr_b16 v[126:127], v2 offset:4608
ds_read_b64_tr_b16 v[128:129], v2 offset:32
ds_read_b64_tr_b16 v[130:131], v2 offset:4640
ds_read_b64_tr_b16 v[132:133], v2 offset:64
ds_read_b64_tr_b16 v[134:135], v2 offset:4672
ds_read_b64_tr_b16 v[136:137], v2 offset:96
ds_read_b64_tr_b16 v[138:139], v2 offset:4704
ds_read_b64_tr_b16 v[140:141], v2 offset:128
ds_read_b64_tr_b16 v[142:143], v2 offset:4736
ds_read_b64_tr_b16 v[144:145], v2 offset:160
ds_read_b64_tr_b16 v[146:147], v2 offset:4768
ds_read_b64_tr_b16 v[148:149], v2 offset:192
ds_read_b64_tr_b16 v[150:151], v2 offset:4800
ds_read_b64_tr_b16 v[152:153], v2 offset:224
ds_read_b64_tr_b16 v[154:155], v2 offset:4832
ds_read_b64_tr_b16 v[156:157], v2 offset:256
ds_read_b64_tr_b16 v[158:159], v2 offset:4864
s_waitcnt lgkmcnt(15)
v_mfma_f32_16x16x32_bf16 v[88:91], v[124:127], v[52:55], v[88:91]
s_waitcnt lgkmcnt(14)
v_mfma_f32_16x16x32_bf16 v[92:95], v[128:131], v[52:55], v[92:95]
s_waitcnt lgkmcnt(12)
v_mfma_f32_16x16x32_bf16 v[96:99], v[132:135], v[52:55], v[96:99]
s_waitcnt lgkmcnt(10)
v_mfma_f32_16x16x32_bf16 v[100:103], v[136:139], v[52:55], v[100:103]
s_waitcnt lgkmcnt(8)
v_mfma_f32_16x16x32_bf16 v[104:107], v[140:143], v[52:55], v[104:107]
s_waitcnt lgkmcnt(6)
v_mfma_f32_16x16x32_bf16 v[108:111], v[144:147], v[52:55], v[108:111]
s_waitcnt lgkmcnt(4)
v_mfma_f32_16x16x32_bf16 v[112:115], v[148:151], v[52:55], v[112:115]
s_waitcnt lgkmcnt(2)
v_mfma_f32_16x16x32_bf16 v[116:119], v[152:155], v[52:55], v[116:119]
s_waitcnt lgkmcnt(0)
v_mfma_f32_16x16x32_bf16 v[120:123], v[156:159], v[52:55], v[120:123]
s_waitcnt vmcnt(9)
s_barrier
s_mul_i32 s28, s17, 9216
s_add_u32 s29, s28, 442368
s_add_u32 s28, s28, 0
s_mov_b32 m0, s28
s_add_u32 s28, s28, 1024
buffer_load_dwordx4 v0, s[12:15], s29 offen lds
s_add_u32 s29, s29, 1024
s_mov_b32 m0, s28
s_add_u32 s28, s28, 1024
buffer_load_dwordx4 v0, s[12:15], s29 offen lds
s_add_u32 s29, s29, 1024
s_mov_b32 m0, s28
s_add_u32 s28, s28, 1024
buffer_load_dwordx4 v0, s[12:15], s29 offen lds
s_add_u32 s29, s29, 1024
s_mov_b32 m0, s28
s_add_u32 s28, s28, 1024
buffer_load_dwordx4 v0, s[12:15], s29 offen lds
s_add_u32 s29, s29, 1024
s_mov_b32 m0, s28
s_add_u32 s28, s28, 1024
buffer_load_dwordx4 v0, s[12:15], s29 offen lds
s_add_u32 s29, s29, 1024
s_mov_b32 m0, s28
s_add_u32 s28, s28, 1024
buffer_load_dwordx4 v0, s[12:15], s29 offen lds
s_add_u32 s29, s29, 1024
s_mov_b32 m0, s28
s_add_u32 s28, s28, 1024
buffer_load_dwordx4 v0, s[12:15], s29 offen lds
s_add_u32 s29, s29, 1024
s_mov_b32 m0, s28
s_add_u32 s28, s28, 1024
buffer_load_dwordx4 v0, s[12:15], s29 offen lds
s_add_u32 s29, s29, 1024
s_mov_b32 m0, s28
s_add_u32 s28, s28, 1024
buffer_load_dwordx4 v0, s[12:15], s29 offen lds
s_add_u32 s29, s29, 1024
ds_read_b64_tr_b16 v[124:125], v3 offset:0
ds_read_b64_tr_b16 v[126:127], v3 offset:4608
ds_read_b64_tr_b16 v[128:129], v3 offset:32
ds_read_b64_tr_b16 v[130:131], v3 offset:4640
ds_read_b64_tr_b16 v[132:133], v3 offset:64
ds_read_b64_tr_b16 v[134:135], v3 offset:4672
ds_read_b64_tr_b16 v[136:137], v3 offset:96
ds_read_b64_tr_b16 v[138:139], v3 offset:4704
ds_read_b64_tr_b16 v[140:141], v3 offset:128
ds_read_b64_tr_b16 v[142:143], v3 offset:4736
ds_read_b64_tr_b16 v[144:145], v3 offset:160
ds_read_b64_tr_b16 v[146:147], v3 offset:4768
ds_read_b64_tr_b16 v[148:149], v3 offset:192
ds_read_b64_tr_b16 v[150:151], v3 offset:4800
ds_read_b64_tr_b16 v[152:153], v3 offset:224
ds_read_b64_tr_b16 v[154:155], v3 offset:4832
ds_read_b64_tr_b16 v[156:157], v3 offset:256
ds_read_b64_tr_b16 v[158:159], v3 offset:4864
s_waitcnt lgkmcnt(15)
v_mfma_f32_16x16x32_bf16 v[88:91], v[124:127], v[56:59], v[88:91]
s_waitcnt lgkmcnt(14)
v_mfma_f32_16x16x32_bf16 v[92:95], v[128:131], v[56:59], v[92:95]
s_waitcnt lgkmcnt(12)
v_mfma_f32_16x16x32_bf16 v[96:99], v[132:135], v[56:59], v[96:99]
s_waitcnt lgkmcnt(10)
v_mfma_f32_16x16x32_bf16 v[100:103], v[136:139], v[56:59], v[100:103]
s_waitcnt lgkmcnt(8)
v_mfma_f32_16x16x32_bf16 v[104:107], v[140:143], v[56:59], v[104:107]
s_waitcnt lgkmcnt(6)
v_mfma_f32_16x16x32_bf16 v[108:111], v[144:147], v[56:59], v[108:111]
s_waitcnt lgkmcnt(4)
v_mfma_f32_16x16x32_bf16 v[112:115], v[148:151], v[56:59], v[112:115]
s_waitcnt lgkmcnt(2)
v_mfma_f32_16x16x32_bf16 v[116:119], v[152:155], v[56:59], v[116:119]
s_waitcnt lgkmcnt(0)
v_mfma_f32_16x16x32_bf16 v[120:123], v[156:159], v[56:59], v[120:123]
s_waitcnt vmcnt(9)
s_barrier
s_mul_i32 s28, s17, 9216
s_add_u32 s29, s28, 479232
s_add_u32 s28, s28, 36864
s_mov_b32 m0, s28
s_add_u32 s28, s28, 1024
buffer_load_dwordx4 v0, s[12:15], s29 offen lds
s_add_u32 s29, s29, 1024
s_mov_b32 m0, s28
s_add_u32 s28, s28, 1024
buffer_load_dwordx4 v0, s[12:15], s29 offen lds
s_add_u32 s29, s29, 1024
s_mov_b32 m0, s28
s_add_u32 s28, s28, 1024
buffer_load_dwordx4 v0, s[12:15], s29 offen lds
s_add_u32 s29, s29, 1024
s_mov_b32 m0, s28
s_add_u32 s28, s28, 1024
buffer_load_dwordx4 v0, s[12:15], s29 offen lds
s_add_u32 s29, s29, 1024
s_mov_b32 m0, s28
s_add_u32 s28, s28, 1024
buffer_load_dwordx4 v0, s[12:15], s29 offen lds
s_add_u32 s29, s29, 1024
s_mov_b32 m0, s28
s_add_u32 s28, s28, 1024
buffer_load_dwordx4 v0, s[12:15], s29 offen lds
s_add_u32 s29, s29, 1024
s_mov_b32 m0, s28
s_add_u32 s28, s28, 1024
buffer_load_dwordx4 v0, s[12:15], s29 offen lds
s_add_u32 s29, s29, 1024
s_mov_b32 m0, s28
s_add_u32 s28, s28, 1024
buffer_load_dwordx4 v0, s[12:15], s29 offen lds
s_add_u32 s29, s29, 1024
s_mov_b32 m0, s28
s_add_u32 s28, s28, 1024
buffer_load_dwordx4 v0, s[12:15], s29 offen lds
s_add_u32 s29, s29, 1024
ds_read_b64_tr_b16 v[124:125], v4 offset:0
ds_read_b64_tr_b16 v[126:127], v4 offset:4608
ds_read_b64_tr_b16 v[128:129], v4 offset:32
ds_read_b64_tr_b16 v[130:131], v4 offset:4640
ds_read_b64_tr_b16 v[132:133], v4 offset:64
ds_read_b64_tr_b16 v[134:135], v4 offset:4672
ds_read_b64_tr_b16 v[136:137], v4 offset:96
ds_read_b64_tr_b16 v[138:139], v4 offset:4704
ds_read_b64_tr_b16 v[140:141], v4 offset:128
ds_read_b64_tr_b16 v[142:143], v4 offset:4736
ds_read_b64_tr_b16 v[144:145], v4 offset:160
ds_read_b64_tr_b16 v[146:147], v4 offset:4768
ds_read_b64_tr_b16 v[148:149], v4 offset:192
ds_read_b64_tr_b16 v[150:151], v4 offset:4800
ds_read_b64_tr_b16 v[152:153], v4 offset:224
ds_read_b64_tr_b16 v[154:155], v4 offset:4832
ds_read_b64_tr_b16 v[156:157], v4 offset:256
ds_read_b64_tr_b16 v[158:159], v4 offset:4864
s_waitcnt lgkmcnt(15)
v_mfma_f32_16x16x32_bf16 v[88:91], v[124:127], v[60:63], v[88:91]
s_waitcnt lgkmcnt(14)
v_mfma_f32_16x16x32_bf16 v[92:95], v[128:131], v[60:63], v[92:95]
s_waitcnt lgkmcnt(12)
v_mfma_f32_16x16x32_bf16 v[96:99], v[132:135], v[60:63], v[96:99]
s_waitcnt lgkmcnt(10)
v_mfma_f32_16x16x32_bf16 v[100:103], v[136:139], v[60:63], v[100:103]
s_waitcnt lgkmcnt(8)
v_mfma_f32_16x16x32_bf16 v[104:107], v[140:143], v[60:63], v[104:107]
s_waitcnt lgkmcnt(6)
v_mfma_f32_16x16x32_bf16 v[108:111], v[144:147], v[60:63], v[108:111]
s_waitcnt lgkmcnt(4)
v_mfma_f32_16x16x32_bf16 v[112:115], v[148:151], v[60:63], v[112:115]
s_waitcnt lgkmcnt(2)
v_mfma_f32_16x16x32_bf16 v[116:119], v[152:155], v[60:63], v[116:119]
s_waitcnt lgkmcnt(0)
v_mfma_f32_16x16x32_bf16 v[120:123], v[156:159], v[60:63], v[120:123]
s_waitcnt vmcnt(9)
s_barrier
s_mul_i32 s28, s17, 9216
s_add_u32 s29, s28, 516096
s_add_u32 s28, s28, 73728
s_mov_b32 m0, s28
s_add_u32 s28, s28, 1024
buffer_load_dwordx4 v0, s[12:15], s29 offen lds
s_add_u32 s29, s29, 1024
s_mov_b32 m0, s28
s_add_u32 s28, s28, 1024
buffer_load_dwordx4 v0, s[12:15], s29 offen lds
s_add_u32 s29, s29, 1024
s_mov_b32 m0, s28
s_add_u32 s28, s28, 1024
buffer_load_dwordx4 v0, s[12:15], s29 offen lds
s_add_u32 s29, s29, 1024
s_mov_b32 m0, s28
s_add_u32 s28, s28, 1024
buffer_load_dwordx4 v0, s[12:15], s29 offen lds
s_add_u32 s29, s29, 1024
s_mov_b32 m0, s28
s_add_u32 s28, s28, 1024
buffer_load_dwordx4 v0, s[12:15], s29 offen lds
s_add_u32 s29, s29, 1024
s_mov_b32 m0, s28
s_add_u32 s28, s28, 1024
buffer_load_dwordx4 v0, s[12:15], s29 offen lds
s_add_u32 s29, s29, 1024
s_mov_b32 m0, s28
s_add_u32 s28, s28, 1024
buffer_load_dwordx4 v0, s[12:15], s29 offen lds
s_add_u32 s29, s29, 1024
s_mov_b32 m0, s28
s_add_u32 s28, s28, 1024
buffer_load_dwordx4 v0, s[12:15], s29 offen lds
s_add_u32 s29, s29, 1024
s_mov_b32 m0, s28
s_add_u32 s28, s28, 1024
buffer_load_dwordx4 v0, s[12:15], s29 offen lds
s_add_u32 s29, s29, 1024
ds_read_b64_tr_b16 v[124:125], v2 offset:0
ds_read_b64_tr_b16 v[126:127], v2 offset:4608
ds_read_b64_tr_b16 v[128:129], v2 offset:32
ds_read_b64_tr_b16 v[130:131], v2 offset:4640
ds_read_b64_tr_b16 v[132:133], v2 offset:64
ds_read_b64_tr_b16 v[134:135], v2 offset:4672
ds_read_b64_tr_b16 v[136:137], v2 offset:96
ds_read_b64_tr_b16 v[138:139], v2 offset:4704
ds_read_b64_tr_b16 v[140:141], v2 offset:128
ds_read_b64_tr_b16 v[142:143], v2 offset:4736
ds_read_b64_tr_b16 v[144:145], v2 offset:160
ds_read_b64_tr_b16 v[146:147], v2 offset:4768
ds_read_b64_tr_b16 v[148:149], v2 offset:192
ds_read_b64_tr_b16 v[150:151], v2 offset:4800
ds_read_b64_tr_b16 v[152:153], v2 offset:224
ds_read_b64_tr_b16 v[154:155], v2 offset:4832
ds_read_b64_tr_b16 v[156:157], v2 offset:256
ds_read_b64_tr_b16 v[158:159], v2 offset:4864
s_waitcnt lgkmcnt(15)
v_mfma_f32_16x16x32_bf16 v[88:91], v[124:127], v[64:67], v[88:91]
s_waitcnt lgkmcnt(14)
v_mfma_f32_16x16x32_bf16 v[92:95], v[128:131], v[64:67], v[92:95]
s_waitcnt lgkmcnt(12)
v_mfma_f32_16x16x32_bf16 v[96:99], v[132:135], v[64:67], v[96:99]
s_waitcnt lgkmcnt(10)
v_mfma_f32_16x16x32_bf16 v[100:103], v[136:139], v[64:67], v[100:103]
s_waitcnt lgkmcnt(8)
v_mfma_f32_16x16x32_bf16 v[104:107], v[140:143], v[64:67], v[104:107]
s_waitcnt lgkmcnt(6)
v_mfma_f32_16x16x32_bf16 v[108:111], v[144:147], v[64:67], v[108:111]
s_waitcnt lgkmcnt(4)
v_mfma_f32_16x16x32_bf16 v[112:115], v[148:151], v[64:67], v[112:115]
s_waitcnt lgkmcnt(2)
v_mfma_f32_16x16x32_bf16 v[116:119], v[152:155], v[64:67], v[116:119]
s_waitcnt lgkmcnt(0)
v_mfma_f32_16x16x32_bf16 v[120:123], v[156:159], v[64:67], v[120:123]
s_waitcnt vmcnt(9)
s_barrier
s_mul_i32 s28, s17, 9216
s_add_u32 s29, s28, 552960
s_add_u32 s28, s28, 0
s_mov_b32 m0, s28
s_add_u32 s28, s28, 1024
buffer_load_dwordx4 v0, s[12:15], s29 offen lds
s_add_u32 s29, s29, 1024
s_mov_b32 m0, s28
s_add_u32 s28, s28, 1024
buffer_load_dwordx4 v0, s[12:15], s29 offen lds
s_add_u32 s29, s29, 1024
s_mov_b32 m0, s28
s_add_u32 s28, s28, 1024
buffer_load_dwordx4 v0, s[12:15], s29 offen lds
s_add_u32 s29, s29, 1024
s_mov_b32 m0, s28
s_add_u32 s28, s28, 1024
buffer_load_dwordx4 v0, s[12:15], s29 offen lds
s_add_u32 s29, s29, 1024
s_mov_b32 m0, s28
s_add_u32 s28, s28, 1024
buffer_load_dwordx4 v0, s[12:15], s29 offen lds
s_add_u32 s29, s29, 1024
s_mov_b32 m0, s28
s_add_u32 s28, s28, 1024
buffer_load_dwordx4 v0, s[12:15], s29 offen lds
s_add_u32 s29, s29, 1024
s_mov_b32 m0, s28
s_add_u32 s28, s28, 1024
buffer_load_dwordx4 v0, s[12:15], s29 offen lds
s_add_u32 s29, s29, 1024
s_mov_b32 m0, s28
s_add_u32 s28, s28, 1024
buffer_load_dwordx4 v0, s[12:15], s29 offen lds
s_add_u32 s29, s29, 1024
s_mov_b32 m0, s28
s_add_u32 s28, s28, 1024
buffer_load_dwordx4 v0, s[12:15], s29 offen lds
s_add_u32 s29, s29, 1024
ds_read_b64_tr_b16 v[124:125], v3 offset:0
ds_read_b64_tr_b16 v[126:127], v3 offset:4608
ds_read_b64_tr_b16 v[128:129], v3 offset:32
ds_read_b64_tr_b16 v[130:131], v3 offset:4640
ds_read_b64_tr_b16 v[132:133], v3 offset:64
ds_read_b64_tr_b16 v[134:135], v3 offset:4672
ds_read_b64_tr_b16 v[136:137], v3 offset:96
ds_read_b64_tr_b16 v[138:139], v3 offset:4704
ds_read_b64_tr_b16 v[140:141], v3 offset:128
ds_read_b64_tr_b16 v[142:143], v3 offset:4736
ds_read_b64_tr_b16 v[144:145], v3 offset:160
ds_read_b64_tr_b16 v[146:147], v3 offset:4768
ds_read_b64_tr_b16 v[148:149], v3 offset:192
ds_read_b64_tr_b16 v[150:151], v3 offset:4800
ds_read_b64_tr_b16 v[152:153], v3 offset:224
ds_read_b64_tr_b16 v[154:155], v3 offset:4832
ds_read_b64_tr_b16 v[156:157], v3 offset:256
ds_read_b64_tr_b16 v[158:159], v3 offset:4864
s_waitcnt lgkmcnt(15)
v_mfma_f32_16x16x32_bf16 v[88:91], v[124:127], v[68:71], v[88:91]
s_waitcnt lgkmcnt(14)
v_mfma_f32_16x16x32_bf16 v[92:95], v[128:131], v[68:71], v[92:95]
s_waitcnt lgkmcnt(12)
v_mfma_f32_16x16x32_bf16 v[96:99], v[132:135], v[68:71], v[96:99]
s_waitcnt lgkmcnt(10)
v_mfma_f32_16x16x32_bf16 v[100:103], v[136:139], v[68:71], v[100:103]
s_waitcnt lgkmcnt(8)
v_mfma_f32_16x16x32_bf16 v[104:107], v[140:143], v[68:71], v[104:107]
s_waitcnt lgkmcnt(6)
v_mfma_f32_16x16x32_bf16 v[108:111], v[144:147], v[68:71], v[108:111]
s_waitcnt lgkmcnt(4)
v_mfma_f32_16x16x32_bf16 v[112:115], v[148:151], v[68:71], v[112:115]
s_waitcnt lgkmcnt(2)
v_mfma_f32_16x16x32_bf16 v[116:119], v[152:155], v[68:71], v[116:119]
s_waitcnt lgkmcnt(0)
v_mfma_f32_16x16x32_bf16 v[120:123], v[156:159], v[68:71], v[120:123]
s_waitcnt vmcnt(9)
s_barrier
s_mul_i32 s28, s17, 9216
s_add_u32 s29, s28, 589824
s_add_u32 s28, s28, 36864
s_mov_b32 m0, s28
s_add_u32 s28, s28, 1024
buffer_load_dwordx4 v0, s[12:15], s29 offen lds
s_add_u32 s29, s29, 1024
s_mov_b32 m0, s28
s_add_u32 s28, s28, 1024
buffer_load_dwordx4 v0, s[12:15], s29 offen lds
s_add_u32 s29, s29, 1024
s_mov_b32 m0, s28
s_add_u32 s28, s28, 1024
buffer_load_dwordx4 v0, s[12:15], s29 offen lds
s_add_u32 s29, s29, 1024
s_mov_b32 m0, s28
s_add_u32 s28, s28, 1024
buffer_load_dwordx4 v0, s[12:15], s29 offen lds
s_add_u32 s29, s29, 1024
s_mov_b32 m0, s28
s_add_u32 s28, s28, 1024
buffer_load_dwordx4 v0, s[12:15], s29 offen lds
s_add_u32 s29, s29, 1024
s_mov_b32 m0, s28
s_add_u32 s28, s28, 1024
buffer_load_dwordx4 v0, s[12:15], s29 offen lds
s_add_u32 s29, s29, 1024
s_mov_b32 m0, s28
s_add_u32 s28, s28, 1024
buffer_load_dwordx4 v0, s[12:15], s29 offen lds
s_add_u32 s29, s29, 1024
s_mov_b32 m0, s28
s_add_u32 s28, s28, 1024
buffer_load_dwordx4 v0, s[12:15], s29 offen lds
s_add_u32 s29, s29, 1024
s_mov_b32 m0, s28
s_add_u32 s28, s28, 1024
buffer_load_dwordx4 v0, s[12:15], s29 offen lds
s_add_u32 s29, s29, 1024
ds_read_b64_tr_b16 v[124:125], v4 offset:0
ds_read_b64_tr_b16 v[126:127], v4 offset:4608
ds_read_b64_tr_b16 v[128:129], v4 offset:32
ds_read_b64_tr_b16 v[130:131], v4 offset:4640
ds_read_b64_tr_b16 v[132:133], v4 offset:64
ds_read_b64_tr_b16 v[134:135], v4 offset:4672
ds_read_b64_tr_b16 v[136:137], v4 offset:96
ds_read_b64_tr_b16 v[138:139], v4 offset:4704
ds_read_b64_tr_b16 v[140:141], v4 offset:128
ds_read_b64_tr_b16 v[142:143], v4 offset:4736
ds_read_b64_tr_b16 v[144:145], v4 offset:160
ds_read_b64_tr_b16 v[146:147], v4 offset:4768
ds_read_b64_tr_b16 v[148:149], v4 offset:192
ds_read_b64_tr_b16 v[150:151], v4 offset:4800
ds_read_b64_tr_b16 v[152:153], v4 offset:224
ds_read_b64_tr_b16 v[154:155], v4 offset:4832
ds_read_b64_tr_b16 v[156:157], v4 offset:256
ds_read_b64_tr_b16 v[158:159], v4 offset:4864
s_waitcnt lgkmcnt(15)
v_mfma_f32_16x16x32_bf16 v[88:91], v[124:127], v[72:75], v[88:91]
s_waitcnt lgkmcnt(14)
v_mfma_f32_16x16x32_bf16 v[92:95], v[128:131], v[72:75], v[92:95]
s_waitcnt lgkmcnt(12)
v_mfma_f32_16x16x32_bf16 v[96:99], v[132:135], v[72:75], v[96:99]
s_waitcnt lgkmcnt(10)
v_mfma_f32_16x16x32_bf16 v[100:103], v[136:139], v[72:75], v[100:103]
s_waitcnt lgkmcnt(8)
v_mfma_f32_16x16x32_bf16 v[104:107], v[140:143], v[72:75], v[104:107]
s_waitcnt lgkmcnt(6)
v_mfma_f32_16x16x32_bf16 v[108:111], v[144:147], v[72:75], v[108:111]
s_waitcnt lgkmcnt(4)
v_mfma_f32_16x16x32_bf16 v[112:115], v[148:151], v[72:75], v[112:115]
s_waitcnt lgkmcnt(2)
v_mfma_f32_16x16x32_bf16 v[116:119], v[152:155], v[72:75], v[116:119]
s_waitcnt lgkmcnt(0)
v_mfma_f32_16x16x32_bf16 v[120:123], v[156:159], v[72:75], v[120:123]
s_waitcnt vmcnt(9)
s_barrier
s_mul_i32 s28, s17, 9216
s_add_u32 s29, s28, 626688
s_add_u32 s28, s28, 73728
s_mov_b32 m0, s28
s_add_u32 s28, s28, 1024
buffer_load_dwordx4 v0, s[12:15], s29 offen lds
s_add_u32 s29, s29, 1024
s_mov_b32 m0, s28
s_add_u32 s28, s28, 1024
buffer_load_dwordx4 v0, s[12:15], s29 offen lds
s_add_u32 s29, s29, 1024
s_mov_b32 m0, s28
s_add_u32 s28, s28, 1024
buffer_load_dwordx4 v0, s[12:15], s29 offen lds
s_add_u32 s29, s29, 1024
s_mov_b32 m0, s28
s_add_u32 s28, s28, 1024
buffer_load_dwordx4 v0, s[12:15], s29 offen lds
s_add_u32 s29, s29, 1024
s_mov_b32 m0, s28
s_add_u32 s28, s28, 1024
buffer_load_dwordx4 v0, s[12:15], s29 offen lds
s_add_u32 s29, s29, 1024
s_mov_b32 m0, s28
s_add_u32 s28, s28, 1024
buffer_load_dwordx4 v0, s[12:15], s29 offen lds
s_add_u32 s29, s29, 1024
s_mov_b32 m0, s28
s_add_u32 s28, s28, 1024
buffer_load_dwordx4 v0, s[12:15], s29 offen lds
s_add_u32 s29, s29, 1024
s_mov_b32 m0, s28
s_add_u32 s28, s28, 1024
buffer_load_dwordx4 v0, s[12:15], s29 offen lds
s_add_u32 s29, s29, 1024
s_mov_b32 m0, s28
s_add_u32 s28, s28, 1024
buffer_load_dwordx4 v0, s[12:15], s29 offen lds
s_add_u32 s29, s29, 1024
ds_read_b64_tr_b16 v[124:125], v2 offset:0
ds_read_b64_tr_b16 v[126:127], v2 offset:4608
ds_read_b64_tr_b16 v[128:129], v2 offset:32
ds_read_b64_tr_b16 v[130:131], v2 offset:4640
ds_read_b64_tr_b16 v[132:133], v2 offset:64
ds_read_b64_tr_b16 v[134:135], v2 offset:4672
ds_read_b64_tr_b16 v[136:137], v2 offset:96
ds_read_b64_tr_b16 v[138:139], v2 offset:4704
ds_read_b64_tr_b16 v[140:141], v2 offset:128
ds_read_b64_tr_b16 v[142:143], v2 offset:4736
ds_read_b64_tr_b16 v[144:145], v2 offset:160
ds_read_b64_tr_b16 v[146:147], v2 offset:4768
ds_read_b64_tr_b16 v[148:149], v2 offset:192
ds_read_b64_tr_b16 v[150:151], v2 offset:4800
ds_read_b64_tr_b16 v[152:153], v2 offset:224
ds_read_b64_tr_b16 v[154:155], v2 offset:4832
ds_read_b64_tr_b16 v[156:157], v2 offset:256
ds_read_b64_tr_b16 v[158:159], v2 offset:4864
s_waitcnt lgkmcnt(15)
v_mfma_f32_16x16x32_bf16 v[88:91], v[124:127], v[76:79], v[88:91]
s_waitcnt lgkmcnt(14)
v_mfma_f32_16x16x32_bf16 v[92:95], v[128:131], v[76:79], v[92:95]
s_waitcnt lgkmcnt(12)
v_mfma_f32_16x16x32_bf16 v[96:99], v[132:135], v[76:79], v[96:99]
s_waitcnt lgkmcnt(10)
v_mfma_f32_16x16x32_bf16 v[100:103], v[136:139], v[76:79], v[100:103]
s_waitcnt lgkmcnt(8)
v_mfma_f32_16x16x32_bf16 v[104:107], v[140:143], v[76:79], v[104:107]
s_waitcnt lgkmcnt(6)
v_mfma_f32_16x16x32_bf16 v[108:111], v[144:147], v[76:79], v[108:111]
s_waitcnt lgkmcnt(4)
v_mfma_f32_16x16x32_bf16 v[112:115], v[148:151], v[76:79], v[112:115]
s_waitcnt lgkmcnt(2)
v_mfma_f32_16x16x32_bf16 v[116:119], v[152:155], v[76:79], v[116:119]
s_waitcnt lgkmcnt(0)
v_mfma_f32_16x16x32_bf16 v[120:123], v[156:159], v[76:79], v[120:123]
s_waitcnt vmcnt(9)
s_barrier
ds_read_b64_tr_b16 v[124:125], v3 offset:0
ds_read_b64_tr_b16 v[126:127], v3 offset:4608
ds_read_b64_tr_b16 v[128:129], v3 offset:32
ds_read_b64_tr_b16 v[130:131], v3 offset:4640
ds_read_b64_tr_b16 v[132:133], v3 offset:64
ds_read_b64_tr_b16 v[134:135], v3 offset:4672
ds_read_b64_tr_b16 v[136:137], v3 offset:96
ds_read_b64_tr_b16 v[138:139], v3 offset:4704
ds_read_b64_tr_b16 v[140:141], v3 offset:128
ds_read_b64_tr_b16 v[142:143], v3 offset:4736
ds_read_b64_tr_b16 v[144:145], v3 offset:160
ds_read_b64_tr_b16 v[146:147], v3 offset:4768
ds_read_b64_tr_b16 v[148:149], v3 offset:192
ds_read_b64_tr_b16 v[150:151], v3 offset:4800
ds_read_b64_tr_b16 v[152:153], v3 offset:224
ds_read_b64_tr_b16 v[154:155], v3 offset:4832
ds_read_b64_tr_b16 v[156:157], v3 offset:256
ds_read_b64_tr_b16 v[158:159], v3 offset:4864
s_waitcnt lgkmcnt(15)
v_mfma_f32_16x16x32_bf16 v[88:91], v[124:127], v[80:83], v[88:91]
s_waitcnt lgkmcnt(14)
v_mfma_f32_16x16x32_bf16 v[92:95], v[128:131], v[80:83], v[92:95]
s_waitcnt lgkmcnt(12)
v_mfma_f32_16x16x32_bf16 v[96:99], v[132:135], v[80:83], v[96:99]
s_waitcnt lgkmcnt(10)
v_mfma_f32_16x16x32_bf16 v[100:103], v[136:139], v[80:83], v[100:103]
s_waitcnt lgkmcnt(8)
v_mfma_f32_16x16x32_bf16 v[104:107], v[140:143], v[80:83], v[104:107]
s_waitcnt lgkmcnt(6)
v_mfma_f32_16x16x32_bf16 v[108:111], v[144:147], v[80:83], v[108:111]
s_waitcnt lgkmcnt(4)
v_mfma_f32_16x16x32_bf16 v[112:115], v[148:151], v[80:83], v[112:115]
s_waitcnt lgkmcnt(2)
v_mfma_f32_16x16x32_bf16 v[116:119], v[152:155], v[80:83], v[116:119]
s_waitcnt lgkmcnt(0)
v_mfma_f32_16x16x32_bf16 v[120:123], v[156:159], v[80:83], v[120:123]
s_waitcnt vmcnt(0)
s_barrier
ds_read_b64_tr_b16 v[124:125], v4 offset:0
ds_read_b64_tr_b16 v[126:127], v4 offset:4608
ds_read_b64_tr_b16 v[128:129], v4 offset:32
ds_read_b64_tr_b16 v[130:131], v4 offset:4640
ds_read_b64_tr_b16 v[132:133], v4 offset:64
ds_read_b64_tr_b16 v[134:135], v4 offset:4672
ds_read_b64_tr_b16 v[136:137], v4 offset:96
ds_read_b64_tr_b16 v[138:139], v4 offset:4704
ds_read_b64_tr_b16 v[140:141], v4 offset:128
ds_read_b64_tr_b16 v[142:143], v4 offset:4736
ds_read_b64_tr_b16 v[144:145], v4 offset:160
ds_read_b64_tr_b16 v[146:147], v4 offset:4768
ds_read_b64_tr_b16 v[148:149], v4 offset:192
ds_read_b64_tr_b16 v[150:151], v4 offset:4800
ds_read_b64_tr_b16 v[152:153], v4 offset:224
ds_read_b64_tr_b16 v[154:155], v4 offset:4832
ds_read_b64_tr_b16 v[156:157], v4 offset:256
ds_read_b64_tr_b16 v[158:159], v4 offset:4864
s_waitcnt lgkmcnt(15)
v_mfma_f32_16x16x32_bf16 v[88:91], v[124:127], v[84:87], v[88:91]
s_waitcnt lgkmcnt(14)
v_mfma_f32_16x16x32_bf16 v[92:95], v[128:131], v[84:87], v[92:95]
s_waitcnt lgkmcnt(12)
v_mfma_f32_16x16x32_bf16 v[96:99], v[132:135], v[84:87], v[96:99]
s_waitcnt lgkmcnt(10)
v_mfma_f32_16x16x32_bf16 v[100:103], v[136:139], v[84:87], v[100:103]
s_waitcnt lgkmcnt(8)
v_mfma_f32_16x16x32_bf16 v[104:107], v[140:143], v[84:87], v[104:107]
s_waitcnt lgkmcnt(6)
v_mfma_f32_16x16x32_bf16 v[108:111], v[144:147], v[84:87], v[108:111]
s_waitcnt lgkmcnt(4)
v_mfma_f32_16x16x32_bf16 v[112:115], v[148:151], v[84:87], v[112:115]
s_waitcnt lgkmcnt(2)
v_mfma_f32_16x16x32_bf16 v[116:119], v[152:155], v[84:87], v[116:119]
s_waitcnt lgkmcnt(0)
v_mfma_f32_16x16x32_bf16 v[120:123], v[156:159], v[84:87], v[120:123]
s_nop 7
v_bfe_u32 v5, v0, 4, 4
v_lshlrev_b32 v5, 11, v5
v_add_u32 v5, 110592, v5
v_lshrrev_b32 v6, 8, v0
v_lshlrev_b32 v6, 2, v6
s_mul_i32 s28, s17, 144
v_add_u32 v6, s28, v6
s_mov_b32 s29, 3641
v_cvt_pk_bf16_f32 v88, v88, v89
v_cvt_pk_bf16_f32 v89, v90, v91
v_add_u32 v7, 0, v6
v_mul_u32_u24 v8, s29, v7
v_lshrrev_b32 v8, 16, v8
v_mul_u32_u24 v8, 28, v8
v_lshl_add_u32 v8, v7, 1, v8
v_add_u32 v8, v8, v5
ds_write_b16 v8, v88
v_add_u32 v7, 1, v6
v_mul_u32_u24 v8, s29, v7
v_lshrrev_b32 v8, 16, v8
v_mul_u32_u24 v8, 28, v8
v_lshl_add_u32 v8, v7, 1, v8
v_add_u32 v8, v8, v5
ds_write_b16_d16_hi v8, v88
v_add_u32 v7, 2, v6
v_mul_u32_u24 v8, s29, v7
v_lshrrev_b32 v8, 16, v8
v_mul_u32_u24 v8, 28, v8
v_lshl_add_u32 v8, v7, 1, v8
v_add_u32 v8, v8, v5
ds_write_b16 v8, v89
v_add_u32 v7, 3, v6
v_mul_u32_u24 v8, s29, v7
v_lshrrev_b32 v8, 16, v8
v_mul_u32_u24 v8, 28, v8
v_lshl_add_u32 v8, v7, 1, v8
v_add_u32 v8, v8, v5
ds_write_b16_d16_hi v8, v89
v_cvt_pk_bf16_f32 v92, v92, v93
v_cvt_pk_bf16_f32 v93, v94, v95
v_add_u32 v7, 16, v6
v_mul_u32_u24 v8, s29, v7
v_lshrrev_b32 v8, 16, v8
v_mul_u32_u24 v8, 28, v8
v_lshl_add_u32 v8, v7, 1, v8
v_add_u32 v8, v8, v5
ds_write_b16 v8, v92
v_add_u32 v7, 17, v6
v_mul_u32_u24 v8, s29, v7
v_lshrrev_b32 v8, 16, v8
v_mul_u32_u24 v8, 28, v8
v_lshl_add_u32 v8, v7, 1, v8
v_add_u32 v8, v8, v5
ds_write_b16_d16_hi v8, v92
v_add_u32 v7, 18, v6
v_mul_u32_u24 v8, s29, v7
v_lshrrev_b32 v8, 16, v8
v_mul_u32_u24 v8, 28, v8
v_lshl_add_u32 v8, v7, 1, v8
v_add_u32 v8, v8, v5
ds_write_b16 v8, v93
v_add_u32 v7, 19, v6
v_mul_u32_u24 v8, s29, v7
v_lshrrev_b32 v8, 16, v8
v_mul_u32_u24 v8, 28, v8
v_lshl_add_u32 v8, v7, 1, v8
v_add_u32 v8, v8, v5
ds_write_b16_d16_hi v8, v93
v_cvt_pk_bf16_f32 v96, v96, v97
v_cvt_pk_bf16_f32 v97, v98, v99
v_add_u32 v7, 32, v6
v_mul_u32_u24 v8, s29, v7
v_lshrrev_b32 v8, 16, v8
v_mul_u32_u24 v8, 28, v8
v_lshl_add_u32 v8, v7, 1, v8
v_add_u32 v8, v8, v5
ds_write_b16 v8, v96
v_add_u32 v7, 33, v6
v_mul_u32_u24 v8, s29, v7
v_lshrrev_b32 v8, 16, v8
v_mul_u32_u24 v8, 28, v8
v_lshl_add_u32 v8, v7, 1, v8
v_add_u32 v8, v8, v5
ds_write_b16_d16_hi v8, v96
v_add_u32 v7, 34, v6
v_mul_u32_u24 v8, s29, v7
v_lshrrev_b32 v8, 16, v8
v_mul_u32_u24 v8, 28, v8
v_lshl_add_u32 v8, v7, 1, v8
v_add_u32 v8, v8, v5
ds_write_b16 v8, v97
v_add_u32 v7, 35, v6
v_mul_u32_u24 v8, s29, v7
v_lshrrev_b32 v8, 16, v8
v_mul_u32_u24 v8, 28, v8
v_lshl_add_u32 v8, v7, 1, v8
v_add_u32 v8, v8, v5
ds_write_b16_d16_hi v8, v97
v_cvt_pk_bf16_f32 v100, v100, v101
v_cvt_pk_bf16_f32 v101, v102, v103
v_add_u32 v7, 48, v6
v_mul_u32_u24 v8, s29, v7
v_lshrrev_b32 v8, 16, v8
v_mul_u32_u24 v8, 28, v8
v_lshl_add_u32 v8, v7, 1, v8
v_add_u32 v8, v8, v5
ds_write_b16 v8, v100
v_add_u32 v7, 49, v6
v_mul_u32_u24 v8, s29, v7
v_lshrrev_b32 v8, 16, v8
v_mul_u32_u24 v8, 28, v8
v_lshl_add_u32 v8, v7, 1, v8
v_add_u32 v8, v8, v5
ds_write_b16_d16_hi v8, v100
v_add_u32 v7, 50, v6
v_mul_u32_u24 v8, s29, v7
v_lshrrev_b32 v8, 16, v8
v_mul_u32_u24 v8, 28, v8
v_lshl_add_u32 v8, v7, 1, v8
v_add_u32 v8, v8, v5
ds_write_b16 v8, v101
v_add_u32 v7, 51, v6
v_mul_u32_u24 v8, s29, v7
v_lshrrev_b32 v8, 16, v8
v_mul_u32_u24 v8, 28, v8
v_lshl_add_u32 v8, v7, 1, v8
v_add_u32 v8, v8, v5
ds_write_b16_d16_hi v8, v101
v_cvt_pk_bf16_f32 v104, v104, v105
v_cvt_pk_bf16_f32 v105, v106, v107
v_add_u32 v7, 64, v6
v_mul_u32_u24 v8, s29, v7
v_lshrrev_b32 v8, 16, v8
v_mul_u32_u24 v8, 28, v8
v_lshl_add_u32 v8, v7, 1, v8
v_add_u32 v8, v8, v5
ds_write_b16 v8, v104
v_add_u32 v7, 65, v6
v_mul_u32_u24 v8, s29, v7
v_lshrrev_b32 v8, 16, v8
v_mul_u32_u24 v8, 28, v8
v_lshl_add_u32 v8, v7, 1, v8
v_add_u32 v8, v8, v5
ds_write_b16_d16_hi v8, v104
v_add_u32 v7, 66, v6
v_mul_u32_u24 v8, s29, v7
v_lshrrev_b32 v8, 16, v8
v_mul_u32_u24 v8, 28, v8
v_lshl_add_u32 v8, v7, 1, v8
v_add_u32 v8, v8, v5
ds_write_b16 v8, v105
v_add_u32 v7, 67, v6
v_mul_u32_u24 v8, s29, v7
v_lshrrev_b32 v8, 16, v8
v_mul_u32_u24 v8, 28, v8
v_lshl_add_u32 v8, v7, 1, v8
v_add_u32 v8, v8, v5
ds_write_b16_d16_hi v8, v105
v_cvt_pk_bf16_f32 v108, v108, v109
v_cvt_pk_bf16_f32 v109, v110, v111
v_add_u32 v7, 80, v6
v_mul_u32_u24 v8, s29, v7
v_lshrrev_b32 v8, 16, v8
v_mul_u32_u24 v8, 28, v8
v_lshl_add_u32 v8, v7, 1, v8
v_add_u32 v8, v8, v5
ds_write_b16 v8, v108
v_add_u32 v7, 81, v6
v_mul_u32_u24 v8, s29, v7
v_lshrrev_b32 v8, 16, v8
v_mul_u32_u24 v8, 28, v8
v_lshl_add_u32 v8, v7, 1, v8
v_add_u32 v8, v8, v5
ds_write_b16_d16_hi v8, v108
v_add_u32 v7, 82, v6
v_mul_u32_u24 v8, s29, v7
v_lshrrev_b32 v8, 16, v8
v_mul_u32_u24 v8, 28, v8
v_lshl_add_u32 v8, v7, 1, v8
v_add_u32 v8, v8, v5
ds_write_b16 v8, v109
v_add_u32 v7, 83, v6
v_mul_u32_u24 v8, s29, v7
v_lshrrev_b32 v8, 16, v8
v_mul_u32_u24 v8, 28, v8
v_lshl_add_u32 v8, v7, 1, v8
v_add_u32 v8, v8, v5
ds_write_b16_d16_hi v8, v109
v_cvt_pk_bf16_f32 v112, v112, v113
v_cvt_pk_bf16_f32 v113, v114, v115
v_add_u32 v7, 96, v6
v_mul_u32_u24 v8, s29, v7
v_lshrrev_b32 v8, 16, v8
v_mul_u32_u24 v8, 28, v8
v_lshl_add_u32 v8, v7, 1, v8
v_add_u32 v8, v8, v5
ds_write_b16 v8, v112
v_add_u32 v7, 97, v6
v_mul_u32_u24 v8, s29, v7
v_lshrrev_b32 v8, 16, v8
v_mul_u32_u24 v8, 28, v8
v_lshl_add_u32 v8, v7, 1, v8
v_add_u32 v8, v8, v5
ds_write_b16_d16_hi v8, v112
v_add_u32 v7, 98, v6
v_mul_u32_u24 v8, s29, v7
v_lshrrev_b32 v8, 16, v8
v_mul_u32_u24 v8, 28, v8
v_lshl_add_u32 v8, v7, 1, v8
v_add_u32 v8, v8, v5
ds_write_b16 v8, v113
v_add_u32 v7, 99, v6
v_mul_u32_u24 v8, s29, v7
v_lshrrev_b32 v8, 16, v8
v_mul_u32_u24 v8, 28, v8
v_lshl_add_u32 v8, v7, 1, v8
v_add_u32 v8, v8, v5
ds_write_b16_d16_hi v8, v113
v_cvt_pk_bf16_f32 v116, v116, v117
v_cvt_pk_bf16_f32 v117, v118, v119
v_add_u32 v7, 112, v6
v_mul_u32_u24 v8, s29, v7
v_lshrrev_b32 v8, 16, v8
v_mul_u32_u24 v8, 28, v8
v_lshl_add_u32 v8, v7, 1, v8
v_add_u32 v8, v8, v5
ds_write_b16 v8, v116
v_add_u32 v7, 113, v6
v_mul_u32_u24 v8, s29, v7
v_lshrrev_b32 v8, 16, v8
v_mul_u32_u24 v8, 28, v8
v_lshl_add_u32 v8, v7, 1, v8
v_add_u32 v8, v8, v5
ds_write_b16_d16_hi v8, v116
v_add_u32 v7, 114, v6
v_mul_u32_u24 v8, s29, v7
v_lshrrev_b32 v8, 16, v8
v_mul_u32_u24 v8, 28, v8
v_lshl_add_u32 v8, v7, 1, v8
v_add_u32 v8, v8, v5
ds_write_b16 v8, v117
v_add_u32 v7, 115, v6
v_mul_u32_u24 v8, s29, v7
v_lshrrev_b32 v8, 16, v8
v_mul_u32_u24 v8, 28, v8
v_lshl_add_u32 v8, v7, 1, v8
v_add_u32 v8, v8, v5
ds_write_b16_d16_hi v8, v117
v_cvt_pk_bf16_f32 v120, v120, v121
v_cvt_pk_bf16_f32 v121, v122, v123
v_add_u32 v7, 128, v6
v_mul_u32_u24 v8, s29, v7
v_lshrrev_b32 v8, 16, v8
v_mul_u32_u24 v8, 28, v8
v_lshl_add_u32 v8, v7, 1, v8
v_add_u32 v8, v8, v5
ds_write_b16 v8, v120
v_add_u32 v7, 129, v6
v_mul_u32_u24 v8, s29, v7
v_lshrrev_b32 v8, 16, v8
v_mul_u32_u24 v8, 28, v8
v_lshl_add_u32 v8, v7, 1, v8
v_add_u32 v8, v8, v5
ds_write_b16_d16_hi v8, v120
v_add_u32 v7, 130, v6
v_mul_u32_u24 v8, s29, v7
v_lshrrev_b32 v8, 16, v8
v_mul_u32_u24 v8, 28, v8
v_lshl_add_u32 v8, v7, 1, v8
v_add_u32 v8, v8, v5
ds_write_b16 v8, v121
v_add_u32 v7, 131, v6
v_mul_u32_u24 v8, s29, v7
v_lshrrev_b32 v8, 16, v8
v_mul_u32_u24 v8, 28, v8
v_lshl_add_u32 v8, v7, 1, v8
v_add_u32 v8, v8, v5
ds_write_b16_d16_hi v8, v121
s_waitcnt lgkmcnt(0)
s_barrier
s_mov_b32 s28, 835584
s_mov_b32 s26, 2000000
v_lshrrev_b32 v2, 2, v0
v_and_b32 v2, 31, v2
BW_44:
buffer_load_dword v3, v2, s[8:11], s28 offen sc1
s_waitcnt vmcnt(0)
v_cmp_ne_u32 vcc, s7, v3
s_cbranch_vccz BW_44k
s_sub_u32 s26, s26, 1
s_cbranch_scc1 BF_42
s_sleep 8
s_branch BW_44
BW_44k:
s_lshl_b32 s28, s17, 15
s_add_u32 s29, s28, 52576256
s_add_u32 s28, s28, 52445184
buffer_load_dwordx4 a[0:3], v0, s[8:11], s28 offen offset:0
buffer_load_dwordx4 a[8:11], v0, s[8:11], s29 offen offset:0
buffer_load_dwordx4 a[4:7], v0, s[8:11], s28 offen offset:1024
buffer_load_dwordx4 a[12:15], v0, s[8:11], s29 offen offset:1024
s_add_u32 s28, s28, 2048
s_add_u32 s29, s29, 2048
buffer_load_dwordx4 a[16:19], v0, s[8:11], s28 offen offset:0
buffer_load_dwordx4 a[24:27], v0, s[8:11], s29 offen offset:0
buffer_load_dwordx4 a[20:23], v0, s[8:11], s28 offen offset:1024
buffer_load_dwordx4 a[28:31], v0, s[8:11], s29 offen offset:1024
s_add_u32 s28, s28, 2048
s_add_u32 s29, s29, 2048
buffer_load_dwordx4 a[32:35], v0, s[8:11], s28 offen offset:0
buffer_load_dwordx4 a[40:43], v0, s[8:11], s29 offen offset:0
buffer_load_dwordx4 a[36:39], v0, s[8:11], s28 offen offset:1024
buffer_load_dwordx4 a[44:47], v0, s[8:11], s29 offen offset:1024
s_add_u32 s28, s28, 2048
s_add_u32 s29, s29, 2048
buffer_load_dwordx4 a[48:51], v0, s[8:11], s28 offen offset:0
buffer_load_dwordx4 a[56:59], v0, s[8:11], s29 offen offset:0
buffer_load_dwordx4 a[52:55], v0, s[8:11], s28 offen offset:1024
buffer_load_dwordx4 a[60:63], v0, s[8:11], s29 offen offset:1024
s_add_u32 s28, s28, 2048
s_add_u32 s29, s29, 2048
s_waitcnt vmcnt(0)
buffer_load_dwordx4 a[64:67], v0, s[8:11], s28 offen offset:0
buffer_load_dwordx4 a[72:75], v0, s[8:11], s29 offen offset:0
buffer_load_dwordx4 a[68:71], v0, s[8:11], s28 offen offset:1024
buffer_load_dwordx4 a[76:79], v0, s[8:11], s29 offen offset:1024
s_add_u32 s28, s28, 2048
s_add_u32 s29, s29, 2048
buffer_load_dwordx4 a[80:83], v0, s[8:11], s28 offen offset:0
buffer_load_dwordx4 a[88:91], v0, s[8:11], s29 offen offset:0
buffer_load_dwordx4 a[84:87], v0, s[8:11], s28 offen offset:1024
buffer_load_dwordx4 a[92:95], v0, s[8:11], s29 offen offset:1024
s_add_u32 s28, s28, 2048
s_add_u32 s29, s29, 2048
buffer_load_dwordx4 a[96:99], v0, s[8:11], s28 offen offset:0
buffer_load_dwordx4 a[104:107], v0, s[8:11], s29 offen offset:0
buffer_load_dwordx4 a[100:103], v0, s[8:11], s28 offen offset:1024
buffer_load_dwordx4 a[108:111], v0, s[8:11], s29 offen offset:1024
s_add_u32 s28, s28, 2048
s_add_u32 s29, s29, 2048
buffer_load_dwordx4 a[112:115], v0, s[8:11], s28 offen offset:0
buffer_load_dwordx4 a[120:123], v0, s[8:11], s29 offen offset:0
buffer_load_dwordx4 a[116:119], v0, s[8:11], s28 offen offset:1024
buffer_load_dwordx4 a[124:127], v0, s[8:11], s29 offen offset:1024
s_add_u32 s28, s28, 2048
s_add_u32 s29, s29, 2048
s_waitcnt vmcnt(0)
buffer_load_dwordx4 a[128:131], v0, s[8:11], s28 offen offset:0
buffer_load_dwordx4 a[136:139], v0, s[8:11], s29 offen offset:0
buffer_load_dwordx4 a[132:135], v0, s[8:11], s28 offen offset:1024
buffer_load_dwordx4 a[140:143], v0, s[8:11], s29 offen offset:1024
s_add_u32 s28, s28, 2048
s_add_u32 s29, s29, 2048
buffer_load_dwordx4 a[144:147], v0, s[8:11], s28 offen offset:0
buffer_load_dwordx4 a[152:155], v0, s[8:11], s29 offen offset:0
buffer_load_dwordx4 a[148:151], v0, s[8:11], s28 offen offset:1024
buffer_load_dwordx4 a[156:159], v0, s[8:11], s29 offen offset:1024
s_add_u32 s28, s28, 2048
s_add_u32 s29, s29, 2048
buffer_load_dwordx4 a[160:163], v0, s[8:11], s28 offen offset:0
buffer_load_dwordx4 a[168:171], v0, s[8:11], s29 offen offset:0
buffer_load_dwordx4 a[164:167], v0, s[8:11], s28 offen offset:1024
buffer_load_dwordx4 a[172:175], v0, s[8:11], s29 offen offset:1024
s_add_u32 s28, s28, 2048
s_add_u32 s29, s29, 2048
buffer_load_dwordx4 a[176:179], v0, s[8:11], s28 offen offset:0
buffer_load_dwordx4 a[184:187], v0, s[8:11], s29 offen offset:0
buffer_load_dwordx4 a[180:183], v0, s[8:11], s28 offen offset:1024
buffer_load_dwordx4 a[188:191], v0, s[8:11], s29 offen offset:1024
s_add_u32 s28, s28, 2048
s_add_u32 s29, s29, 2048
s_waitcnt vmcnt(0)
buffer_load_dwordx4 a[192:195], v0, s[8:11], s28 offen offset:0
buffer_load_dwordx4 a[200:203], v0, s[8:11], s29 offen offset:0
buffer_load_dwordx4 a[196:199], v0, s[8:11], s28 offen offset:1024
buffer_load_dwordx4 a[204:207], v0, s[8:11], s29 offen offset:1024
s_add_u32 s28, s28, 2048
s_add_u32 s29, s29, 2048
buffer_load_dwordx4 a[208:211], v0, s[8:11], s28 offen offset:0
buffer_load_dwordx4 a[216:219], v0, s[8:11], s29 offen offset:0
buffer_load_dwordx4 a[212:215], v0, s[8:11], s28 offen offset:1024
buffer_load_dwordx4 a[220:223], v0, s[8:11], s29 offen offset:1024
s_add_u32 s28, s28, 2048
s_add_u32 s29, s29, 2048
buffer_load_dwordx4 a[224:227], v0, s[8:11], s28 offen offset:0
buffer_load_dwordx4 a[232:235], v0, s[8:11], s29 offen offset:0
buffer_load_dwordx4 a[228:231], v0, s[8:11], s28 offen offset:1024
buffer_load_dwordx4 a[236:239], v0, s[8:11], s29 offen offset:1024
s_add_u32 s28, s28, 2048
s_add_u32 s29, s29, 2048
buffer_load_dwordx4 a[240:243], v0, s[8:11], s28 offen offset:0
buffer_load_dwordx4 a[248:251], v0, s[8:11], s29 offen offset:0
buffer_load_dwordx4 a[244:247], v0, s[8:11], s28 offen offset:1024
buffer_load_dwordx4 a[252:255], v0, s[8:11], s29 offen offset:1024
s_add_u32 s28, s28, 2048
s_add_u32 s29, s29, 2048
s_waitcnt vmcnt(0)
v_bfe_u32 v2, v0, 4, 5
v_lshrrev_b32 v3, 9, v0
v_lshlrev_b32 v8, 6, v2
v_lshl_add_u32 v8, v3, 3, v8
v_add_u32 v8, 110592, v8
s_mul_i32 s28, s17, 3072
v_add_u32 v9, s28, v0
s_mul_i32 s28, s17, 12288
v_add_u32 v10, s28, v0
v_mul_u32_u24 v11, 36, v2
v_lshl_add_u32 v11, v3, 3, v11
v_add_u32 v11, 143360, v11
s_mov_b32 s40, 0x21800000
s_mov_b32 s41, 0x5f800000
s_mov_b32 s42, 0
v_mov_b32 v15, 0
BG_45:
s_mov_b32 s44, 0
v_mov_b32 v3, v9
BJ_48:
s_lshl_b32 s28, s42, 2
s_add_u32 s28, s28, s44
s_lshl_b32 s43, s28, 11
v_add_u32 v12, s43, v8
ds_read2_b64 v[72:75], v12 offset0:0 offset1:2
ds_read2_b64 v[76:79], v12 offset0:4 offset1:6
s_waitcnt lgkmcnt(0)
v_mfma_f32_32x32x16_bf16 v[16:31], a[0:3], v[72:75], 0
v_mfma_f32_32x32x16_bf16 v[16:31], a[4:7], v[76:79], v[16:31]
s_nop 7
v_mfma_f32_32x32x16_bf16 v[32:47], a[16:19], v[72:75], 0
v_mfma_f32_32x32x16_bf16 v[32:47], a[20:23], v[76:79], v[32:47]
s_nop 3
v_exp_f32 v16, v16
v_exp_f32 v17, v17
v_exp_f32 v18, v18
v_exp_f32 v19, v19
v_exp_f32 v20, v20
v_exp_f32 v21, v21
v_exp_f32 v22, v22
v_exp_f32 v23, v23
v_exp_f32 v24, v24
v_exp_f32 v25, v25
v_exp_f32 v26, v26
v_exp_f32 v27, v27
v_exp_f32 v28, v28
v_exp_f32 v29, v29
v_exp_f32 v30, v30
v_exp_f32 v31, v31
v_cvt_pk_bf16_f32 v48, v16, v17
v_cvt_pk_bf16_f32 v49, v18, v19
v_cvt_pk_bf16_f32 v50, v20, v21
v_cvt_pk_bf16_f32 v51, v22, v23
v_cvt_pk_bf16_f32 v52, v24, v25
v_cvt_pk_bf16_f32 v53, v26, v27
v_cvt_pk_bf16_f32 v54, v28, v29
v_cvt_pk_bf16_f32 v55, v30, v31
s_nop 1
v_mfma_f32_32x32x16_bf16 v[56:71], a[8:11], v[48:51], 0
v_mfma_f32_32x32x16_bf16 v[56:71], a[12:15], v[52:55], v[56:71]
v_mfma_f32_32x32x16_bf16 v[16:31], a[32:35], v[72:75], 0
v_mfma_f32_32x32x16_bf16 v[16:31], a[36:39], v[76:79], v[16:31]
v_exp_f32 v32, v32
v_exp_f32 v33, v33
v_exp_f32 v34, v34
v_exp_f32 v35, v35
v_exp_f32 v36, v36
v_exp_f32 v37, v37
v_exp_f32 v38, v38
v_exp_f32 v39, v39
v_exp_f32 v40, v40
v_exp_f32 v41, v41
v_exp_f32 v42, v42
v_exp_f32 v43, v43
v_exp_f32 v44, v44
v_exp_f32 v45, v45
v_exp_f32 v46, v46
v_exp_f32 v47, v47
v_cvt_pk_bf16_f32 v48, v32, v33
v_cvt_pk_bf16_f32 v49, v34, v35
v_cvt_pk_bf16_f32 v50, v36, v37
v_cvt_pk_bf16_f32 v51, v38, v39
v_cvt_pk_bf16_f32 v52, v40, v41
v_cvt_pk_bf16_f32 v53, v42, v43
v_cvt_pk_bf16_f32 v54, v44, v45
v_cvt_pk_bf16_f32 v55, v46, v47
s_nop 1
v_mfma_f32_32x32x16_bf16 v[56:71], a[24:27], v[48:51], v[56:71]
v_mfma_f32_32x32x16_bf16 v[56:71], a[28:31], v[52:55], v[56:71]
v_mfma_f32_32x32x16_bf16 v[32:47], a[48:51], v[72:75], 0
v_mfma_f32_32x32x16_bf16 v[32:47], a[52:55], v[76:79], v[32:47]
v_exp_f32 v16, v16
v_exp_f32 v17, v17
v_exp_f32 v18, v18
v_exp_f32 v19, v19
v_exp_f32 v20, v20
v_exp_f32 v21, v21
v_exp_f32 v22, v22
v_exp_f32 v23, v23
v_exp_f32 v24, v24
v_exp_f32 v25, v25
v_exp_f32 v26, v26
v_exp_f32 v27, v27
v_exp_f32 v28, v28
v_exp_f32 v29, v29
v_exp_f32 v30, v30
v_exp_f32 v31, v31
v_cvt_pk_bf16_f32 v48, v16, v17
v_cvt_pk_bf16_f32 v49, v18, v19
v_cvt_pk_bf16_f32 v50, v20, v21
v_cvt_pk_bf16_f32 v51, v22, v23
v_cvt_pk_bf16_f32 v52, v24, v25
v_cvt_pk_bf16_f32 v53, v26, v27
v_cvt_pk_bf16_f32 v54, v28, v29
v_cvt_pk_bf16_f32 v55, v30, v31
s_nop 1
v_mfma_f32_32x32x16_bf16 v[56:71], a[40:43], v[48:51], v[56:71]
v_mfma_f32_32x32x16_bf16 v[56:71], a[44:47], v[52:55], v[56:71]
v_mfma_f32_32x32x16_bf16 v[16:31], a[64:67], v[72:75], 0
v_mfma_f32_32x32x16_bf16 v[16:31], a[68:71], v[76:79], v[16:31]
v_exp_f32 v32, v32
v_exp_f32 v33, v33
v_exp_f32 v34, v34
v_exp_f32 v35, v35
v_exp_f32 v36, v36
v_exp_f32 v37, v37
v_exp_f32 v38, v38
v_exp_f32 v39, v39
v_exp_f32 v40, v40
v_exp_f32 v41, v41
v_exp_f32 v42, v42
v_exp_f32 v43, v43
v_exp_f32 v44, v44
v_exp_f32 v45, v45
v_exp_f32 v46, v46
v_exp_f32 v47, v47
v_cvt_pk_bf16_f32 v48, v32, v33
v_cvt_pk_bf16_f32 v49, v34, v35
v_cvt_pk_bf16_f32 v50, v36, v37
v_cvt_pk_bf16_f32 v51, v38, v39
v_cvt_pk_bf16_f32 v52, v40, v41
v_cvt_pk_bf16_f32 v53, v42, v43
v_cvt_pk_bf16_f32 v54, v44, v45
v_cvt_pk_bf16_f32 v55, v46, v47
s_nop 1
v_mfma_f32_32x32x16_bf16 v[56:71], a[56:59], v[48:51], v[56:71]
v_mfma_f32_32x32x16_bf16 v[56:71], a[60:63], v[52:55], v[56:71]
v_mfma_f32_32x32x16_bf16 v[32:47], a[80:83], v[72:75], 0
v_mfma_f32_32x32x16_bf16 v[32:47], a[84:87], v[76:79], v[32:47]
v_exp_f32 v16, v16
v_exp_f32 v17, v17
v_exp_f32 v18, v18
v_exp_f32 v19, v19
v_exp_f32 v20, v20
v_exp_f32 v21, v21
v_exp_f32 v22, v22
v_exp_f32 v23, v23
v_exp_f32 v24, v24
v_exp_f32 v25, v25
v_exp_f32 v26, v26
v_exp_f32 v27, v27
v_exp_f32 v28, v28
v_exp_f32 v29, v29
v_exp_f32 v30, v30
v_exp_f32 v31, v31
v_cvt_pk_bf16_f32 v48, v16, v17
v_cvt_pk_bf16_f32 v49, v18, v19
v_cvt_pk_bf16_f32 v50, v20, v21
v_cvt_pk_bf16_f32 v51, v22, v23
v_cvt_pk_bf16_f32 v52, v24, v25
v_cvt_pk_bf16_f32 v53, v26, v27
v_cvt_pk_bf16_f32 v54, v28, v29
v_cvt_pk_bf16_f32 v55, v30, v31
s_nop 1
v_mfma_f32_32x32x16_bf16 v[56:71], a[72:75], v[48:51], v[56:71]
v_mfma_f32_32x32x16_bf16 v[56:71], a[76:79], v[52:55], v[56:71]
v_mfma_f32_32x32x16_bf16 v[16:31], a[96:99], v[72:75], 0
v_mfma_f32_32x32x16_bf16 v[16:31], a[100:103], v[76:79], v[16:31]
v_exp_f32 v32, v32
v_exp_f32 v33, v33
v_exp_f32 v34, v34
v_exp_f32 v35, v35
v_exp_f32 v36, v36
v_exp_f32 v37, v37
v_exp_f32 v38, v38
v_exp_f32 v39, v39
v_exp_f32 v40, v40
v_exp_f32 v41, v41
v_exp_f32 v42, v42
v_exp_f32 v43, v43
v_exp_f32 v44, v44
v_exp_f32 v45, v45
v_exp_f32 v46, v46
v_exp_f32 v47, v47
v_cvt_pk_bf16_f32 v48, v32, v33
v_cvt_pk_bf16_f32 v49, v34, v35
v_cvt_pk_bf16_f32 v50, v36, v37
v_cvt_pk_bf16_f32 v51, v38, v39
v_cvt_pk_bf16_f32 v52, v40, v41
v_cvt_pk_bf16_f32 v53, v42, v43
v_cvt_pk_bf16_f32 v54, v44, v45
v_cvt_pk_bf16_f32 v55, v46, v47
s_nop 1
v_mfma_f32_32x32x16_bf16 v[56:71], a[88:91], v[48:51], v[56:71]
v_mfma_f32_32x32x16_bf16 v[56:71], a[92:95], v[52:55], v[56:71]
v_mfma_f32_32x32x16_bf16 v[32:47], a[112:115], v[72:75], 0
v_mfma_f32_32x32x16_bf16 v[32:47], a[116:119], v[76:79], v[32:47]
v_exp_f32 v16, v16
v_exp_f32 v17, v17
v_exp_f32 v18, v18
v_exp_f32 v19, v19
v_exp_f32 v20, v20
v_exp_f32 v21, v21
v_exp_f32 v22, v22
v_exp_f32 v23, v23
v_exp_f32 v24, v24
v_exp_f32 v25, v25
v_exp_f32 v26, v26
v_exp_f32 v27, v27
v_exp_f32 v28, v28
v_exp_f32 v29, v29
v_exp_f32 v30, v30
v_exp_f32 v31, v31
v_cvt_pk_bf16_f32 v48, v16, v17
v_cvt_pk_bf16_f32 v49, v18, v19
v_cvt_pk_bf16_f32 v50, v20, v21
v_cvt_pk_bf16_f32 v51, v22, v23
v_cvt_pk_bf16_f32 v52, v24, v25
v_cvt_pk_bf16_f32 v53, v26, v27
v_cvt_pk_bf16_f32 v54, v28, v29
v_cvt_pk_bf16_f32 v55, v30, v31
s_nop 1
v_mfma_f32_32x32x16_bf16 v[56:71], a[104:107], v[48:51], v[56:71]
v_mfma_f32_32x32x16_bf16 v[56:71], a[108:111], v[52:55], v[56:71]
v_mfma_f32_32x32x16_bf16 v[16:31], a[128:131], v[72:75], 0
v_mfma_f32_32x32x16_bf16 v[16:31], a[132:135], v[76:79], v[16:31]
v_exp_f32 v32, v32
v_exp_f32 v33, v33
v_exp_f32 v34, v34
v_exp_f32 v35, v35
v_exp_f32 v36, v36
v_exp_f32 v37, v37
v_exp_f32 v38, v38
v_exp_f32 v39, v39
v_exp_f32 v40, v40
v_exp_f32 v41, v41
v_exp_f32 v42, v42
v_exp_f32 v43, v43
v_exp_f32 v44, v44
v_exp_f32 v45, v45
v_exp_f32 v46, v46
v_exp_f32 v47, v47
v_cvt_pk_bf16_f32 v48, v32, v33
v_cvt_pk_bf16_f32 v49, v34, v35
v_cvt_pk_bf16_f32 v50, v36, v37
v_cvt_pk_bf16_f32 v51, v38, v39
v_cvt_pk_bf16_f32 v52, v40, v41
v_cvt_pk_bf16_f32 v53, v42, v43
v_cvt_pk_bf16_f32 v54, v44, v45
v_cvt_pk_bf16_f32 v55, v46, v47
s_nop 1
v_mfma_f32_32x32x16_bf16 v[56:71], a[120:123], v[48:51], v[56:71]
v_mfma_f32_32x32x16_bf16 v[56:71], a[124:127], v[52:55], v[56:71]
v_mfma_f32_32x32x16_bf16 v[32:47], a[144:147], v[72:75], 0
v_mfma_f32_32x32x16_bf16 v[32:47], a[148:151], v[76:79], v[32:47]
v_exp_f32 v16, v16
v_exp_f32 v17, v17
v_exp_f32 v18, v18
v_exp_f32 v19, v19
v_exp_f32 v20, v20
v_exp_f32 v21, v21
v_exp_f32 v22, v22
v_exp_f32 v23, v23
v_exp_f32 v24, v24
v_exp_f32 v25, v25
v_exp_f32 v26, v26
v_exp_f32 v27, v27
v_exp_f32 v28, v28
v_exp_f32 v29, v29
v_exp_f32 v30, v30
v_exp_f32 v31, v31
v_cvt_pk_bf16_f32 v48, v16, v17
v_cvt_pk_bf16_f32 v49, v18, v19
v_cvt_pk_bf16_f32 v50, v20, v21
v_cvt_pk_bf16_f32 v51, v22, v23
v_cvt_pk_bf16_f32 v52, v24, v25
v_cvt_pk_bf16_f32 v53, v26, v27
v_cvt_pk_bf16_f32 v54, v28, v29
v_cvt_pk_bf16_f32 v55, v30, v31
s_nop 1
v_mfma_f32_32x32x16_bf16 v[56:71], a[136:139], v[48:51], v[56:71]
v_mfma_f32_32x32x16_bf16 v[56:71], a[140:143], v[52:55], v[56:71]
v_mfma_f32_32x32x16_bf16 v[16:31], a[160:163], v[72:75], 0
v_mfma_f32_32x32x16_bf16 v[16:31], a[164:167], v[76:79], v[16:31]
v_exp_f32 v32, v32
v_exp_f32 v33, v33
v_exp_f32 v34, v34
v_exp_f32 v35, v35
v_exp_f32 v36, v36
v_exp_f32 v37, v37
v_exp_f32 v38, v38
v_exp_f32 v39, v39
v_exp_f32 v40, v40
v_exp_f32 v41, v41
v_exp_f32 v42, v42
v_exp_f32 v43, v43
v_exp_f32 v44, v44
v_exp_f32 v45, v45
v_exp_f32 v46, v46
v_exp_f32 v47, v47
v_cvt_pk_bf16_f32 v48, v32, v33
v_cvt_pk_bf16_f32 v49, v34, v35
v_cvt_pk_bf16_f32 v50, v36, v37
v_cvt_pk_bf16_f32 v51, v38, v39
v_cvt_pk_bf16_f32 v52, v40, v41
v_cvt_pk_bf16_f32 v53, v42, v43
v_cvt_pk_bf16_f32 v54, v44, v45
v_cvt_pk_bf16_f32 v55, v46, v47
s_nop 1
v_mfma_f32_32x32x16_bf16 v[56:71], a[152:155], v[48:51], v[56:71]
v_mfma_f32_32x32x16_bf16 v[56:71], a[156:159], v[52:55], v[56:71]
v_mfma_f32_32x32x16_bf16 v[32:47], a[176:179], v[72:75], 0
v_mfma_f32_32x32x16_bf16 v[32:47], a[180:183], v[76:79], v[32:47]
v_exp_f32 v16, v16
v_exp_f32 v17, v17
v_exp_f32 v18, v18
v_exp_f32 v19, v19
v_exp_f32 v20, v20
v_exp_f32 v21, v21
v_exp_f32 v22, v22
v_exp_f32 v23, v23
v_exp_f32 v24, v24
v_exp_f32 v25, v25
v_exp_f32 v26, v26
v_exp_f32 v27, v27
v_exp_f32 v28, v28
v_exp_f32 v29, v29
v_exp_f32 v30, v30
v_exp_f32 v31, v31
v_cvt_pk_bf16_f32 v48, v16, v17
v_cvt_pk_bf16_f32 v49, v18, v19
v_cvt_pk_bf16_f32 v50, v20, v21
v_cvt_pk_bf16_f32 v51, v22, v23
v_cvt_pk_bf16_f32 v52, v24, v25
v_cvt_pk_bf16_f32 v53, v26, v27
v_cvt_pk_bf16_f32 v54, v28, v29
v_cvt_pk_bf16_f32 v55, v30, v31
s_nop 1
v_mfma_f32_32x32x16_bf16 v[56:71], a[168:171], v[48:51], v[56:71]
v_mfma_f32_32x32x16_bf16 v[56:71], a[172:175], v[52:55], v[56:71]
v_mfma_f32_32x32x16_bf16 v[16:31], a[192:195], v[72:75], 0
v_mfma_f32_32x32x16_bf16 v[16:31], a[196:199], v[76:79], v[16:31]
v_exp_f32 v32, v32
v_exp_f32 v33, v33
v_exp_f32 v34, v34
v_exp_f32 v35, v35
v_exp_f32 v36, v36
v_exp_f32 v37, v37
v_exp_f32 v38, v38
v_exp_f32 v39, v39
v_exp_f32 v40, v40
v_exp_f32 v41, v41
v_exp_f32 v42, v42
v_exp_f32 v43, v43
v_exp_f32 v44, v44
v_exp_f32 v45, v45
v_exp_f32 v46, v46
v_exp_f32 v47, v47
v_cvt_pk_bf16_f32 v48, v32, v33
v_cvt_pk_bf16_f32 v49, v34, v35
v_cvt_pk_bf16_f32 v50, v36, v37
v_cvt_pk_bf16_f32 v51, v38, v39
v_cvt_pk_bf16_f32 v52, v40, v41
v_cvt_pk_bf16_f32 v53, v42, v43
v_cvt_pk_bf16_f32 v54, v44, v45
v_cvt_pk_bf16_f32 v55, v46, v47
s_nop 1
v_mfma_f32_32x32x16_bf16 v[56:71], a[184:187], v[48:51], v[56:71]
v_mfma_f32_32x32x16_bf16 v[56:71], a[188:191], v[52:55], v[56:71]
v_mfma_f32_32x32x16_bf16 v[32:47], a[208:211], v[72:75], 0
v_mfma_f32_32x32x16_bf16 v[32:47], a[212:215], v[76:79], v[32:47]
v_exp_f32 v16, v16
v_exp_f32 v17, v17
v_exp_f32 v18, v18
v_exp_f32 v19, v19
v_exp_f32 v20, v20
v_exp_f32 v21, v21
v_exp_f32 v22, v22
v_exp_f32 v23, v23
v_exp_f32 v24, v24
v_exp_f32 v25, v25
v_exp_f32 v26, v26
v_exp_f32 v27, v27
v_exp_f32 v28, v28
v_exp_f32 v29, v29
v_exp_f32 v30, v30
v_exp_f32 v31, v31
v_cvt_pk_bf16_f32 v48, v16, v17
v_cvt_pk_bf16_f32 v49, v18, v19
v_cvt_pk_bf16_f32 v50, v20, v21
v_cvt_pk_bf16_f32 v51, v22, v23
v_cvt_pk_bf16_f32 v52, v24, v25
v_cvt_pk_bf16_f32 v53, v26, v27
v_cvt_pk_bf16_f32 v54, v28, v29
v_cvt_pk_bf16_f32 v55, v30, v31
s_nop 1
v_mfma_f32_32x32x16_bf16 v[56:71], a[200:203], v[48:51], v[56:71]
v_mfma_f32_32x32x16_bf16 v[56:71], a[204:207], v[52:55], v[56:71]
v_mfma_f32_32x32x16_bf16 v[16:31], a[224:227], v[72:75], 0
v_mfma_f32_32x32x16_bf16 v[16:31], a[228:231], v[76:79], v[16:31]
v_exp_f32 v32, v32
v_exp_f32 v33, v33
v_exp_f32 v34, v34
v_exp_f32 v35, v35
v_exp_f32 v36, v36
v_exp_f32 v37, v37
v_exp_f32 v38, v38
v_exp_f32 v39, v39
v_exp_f32 v40, v40
v_exp_f32 v41, v41
v_exp_f32 v42, v42
v_exp_f32 v43, v43
v_exp_f32 v44, v44
v_exp_f32 v45, v45
v_exp_f32 v46, v46
v_exp_f32 v47, v47
v_cvt_pk_bf16_f32 v48, v32, v33
v_cvt_pk_bf16_f32 v49, v34, v35
v_cvt_pk_bf16_f32 v50, v36, v37
v_cvt_pk_bf16_f32 v51, v38, v39
v_cvt_pk_bf16_f32 v52, v40, v41
v_cvt_pk_bf16_f32 v53, v42, v43
v_cvt_pk_bf16_f32 v54, v44, v45
v_cvt_pk_bf16_f32 v55, v46, v47
s_nop 1
v_mfma_f32_32x32x16_bf16 v[56:71], a[216:219], v[48:51], v[56:71]
v_mfma_f32_32x32x16_bf16 v[56:71], a[220:223], v[52:55], v[56:71]
v_mfma_f32_32x32x16_bf16 v[32:47], a[240:243], v[72:75], 0
v_mfma_f32_32x32x16_bf16 v[32:47], a[244:247], v[76:79], v[32:47]
v_exp_f32 v16, v16
v_exp_f32 v17, v17
v_exp_f32 v18, v18
v_exp_f32 v19, v19
v_exp_f32 v20, v20
v_exp_f32 v21, v21
v_exp_f32 v22, v22
v_exp_f32 v23, v23
v_exp_f32 v24, v24
v_exp_f32 v25, v25
v_exp_f32 v26, v26
v_exp_f32 v27, v27
v_exp_f32 v28, v28
v_exp_f32 v29, v29
v_exp_f32 v30, v30
v_exp_f32 v31, v31
v_cvt_pk_bf16_f32 v48, v16, v17
v_cvt_pk_bf16_f32 v49, v18, v19
v_cvt_pk_bf16_f32 v50, v20, v21
v_cvt_pk_bf16_f32 v51, v22, v23
v_cvt_pk_bf16_f32 v52, v24, v25
v_cvt_pk_bf16_f32 v53, v26, v27
v_cvt_pk_bf16_f32 v54, v28, v29
v_cvt_pk_bf16_f32 v55, v30, v31
s_nop 1
v_mfma_f32_32x32x16_bf16 v[56:71], a[232:235], v[48:51], v[56:71]
v_mfma_f32_32x32x16_bf16 v[56:71], a[236:239], v[52:55], v[56:71]
s_nop 3
v_exp_f32 v32, v32
v_exp_f32 v33, v33
v_exp_f32 v34, v34
v_exp_f32 v35, v35
v_exp_f32 v36, v36
v_exp_f32 v37, v37
v_exp_f32 v38, v38
v_exp_f32 v39, v39
v_exp_f32 v40, v40
v_exp_f32 v41, v41
v_exp_f32 v42, v42
v_exp_f32 v43, v43
v_exp_f32 v44, v44
v_exp_f32 v45, v45
v_exp_f32 v46, v46
v_exp_f32 v47, v47
v_cvt_pk_bf16_f32 v48, v32, v33
v_cvt_pk_bf16_f32 v49, v34, v35
v_cvt_pk_bf16_f32 v50, v36, v37
v_cvt_pk_bf16_f32 v51, v38, v39
v_cvt_pk_bf16_f32 v52, v40, v41
v_cvt_pk_bf16_f32 v53, v42, v43
v_cvt_pk_bf16_f32 v54, v44, v45
v_cvt_pk_bf16_f32 v55, v46, v47
s_nop 1
v_mfma_f32_32x32x16_bf16 v[56:71], a[248:251], v[48:51], v[56:71]
v_mfma_f32_32x32x16_bf16 v[56:71], a[252:255], v[52:55], v[56:71]
s_nop 15
ds_write_b128 v3, v[56:59] offset:0
ds_write_b128 v3, v[60:63] offset:1024
ds_write_b128 v3, v[64:67] offset:2048
v_add_u32 v3, 12288, v3
s_add_u32 s44, s44, 1
s_cmp_lt_u32 s44, 4
s_cbranch_scc1 BJ_48
s_waitcnt lgkmcnt(0)
s_barrier
ds_read_b128 v[80:83], v10 offset:0
ds_read_b128 v[84:87], v10 offset:1024
ds_read_b128 v[88:91], v10 offset:2048
ds_read_b128 v[92:95], v10 offset:3072
ds_read_b128 v[96:99], v10 offset:4096
ds_read_b128 v[100:103], v10 offset:5120
ds_read_b128 v[104:107], v10 offset:6144
ds_read_b128 v[108:111], v10 offset:7168
ds_read_b128 v[112:115], v10 offset:8192
ds_read_b128 v[116:119], v10 offset:9216
ds_read_b128 v[120:123], v10 offset:10240
ds_read_b128 v[124:127], v10 offset:11264
s_waitcnt lgkmcnt(0)
v_add_f32 v80, v80, v92
v_add_f32 v104, v104, v116
v_add_f32 v80, v80, v104
v_add_f32 v81, v81, v93
v_add_f32 v105, v105, v117
v_add_f32 v81, v81, v105
v_add_f32 v82, v82, v94
v_add_f32 v106, v106, v118
v_add_f32 v82, v82, v106
v_add_f32 v83, v83, v95
v_add_f32 v107, v107, v119
v_add_f32 v83, v83, v107
v_add_f32 v84, v84, v96
v_add_f32 v108, v108, v120
v_add_f32 v84, v84, v108
v_add_f32 v85, v85, v97
v_add_f32 v109, v109, v121
v_add_f32 v85, v85, v109
v_add_f32 v86, v86, v98
v_add_f32 v110, v110, v122
v_add_f32 v86, v86, v110
v_add_f32 v87, v87, v99
v_add_f32 v111, v111, v123
v_add_f32 v87, v87, v111
v_add_f32 v88, v88, v100
v_add_f32 v112, v112, v124
v_add_f32 v88, v88, v112
v_add_f32 v89, v89, v101
v_add_f32 v113, v113, v125
v_add_f32 v89, v89, v113
v_add_f32 v90, v90, v102
v_add_f32 v114, v114, v126
v_add_f32 v90, v90, v114
v_add_f32 v91, v91, v103
v_add_f32 v115, v115, v127
v_add_f32 v91, v91, v115
v_mov_b32 v13, v90
v_mov_b32 v14, v90
s_nop 1
v_permlane32_swap_b32 v13, v14
s_nop 1
v_mov_b32 v14, s41
v_med3_f32 v14, v13, s40, v14
v_cmp_neq_f32 vcc, v14, v13
s_cmp_lg_u64 vcc, 0
s_cselect_b32 s28, 1, 0
v_mov_b32 v14, s28
s_lshl_b32 s29, s17, 2
v_mov_b32 v12, s29
ds_write_b32 v12, v14 offset:49664
s_waitcnt lgkmcnt(0)
s_barrier
v_mov_b32 v12, 0
ds_read_b128 v[4:7], v12 offset:49664
s_waitcnt lgkmcnt(0)
v_or3_b32 v4, v4, v5, v6
v_or_b32 v4, v4, v7
s_nop 0
v_readfirstlane_b32 s28, v4
s_cmp_lg_u32 s28, 0
s_cbranch_scc1 BS_46
BN_47:
v_rcp_f32 v13, v13
s_nop 0
v_mul_f32 v80, v80, v13
v_mul_f32 v81, v81, v13
v_mul_f32 v82, v82, v13
v_mul_f32 v83, v83, v13
v_mul_f32 v84, v84, v13
v_mul_f32 v85, v85, v13
v_mul_f32 v86, v86, v13
v_mul_f32 v87, v87, v13
v_mul_f32 v88, v88, v13
v_mul_f32 v89, v89, v13
v_cvt_pk_bf16_f32 v80, v80, v81
v_cvt_pk_bf16_f32 v81, v82, v83
v_cvt_pk_bf16_f32 v82, v84, v85
v_cvt_pk_bf16_f32 v83, v86, v87
v_cvt_pk_bf16_f32 v84, v88, v89
s_lshl_b32 s28, s42, 2
s_add_u32 s28, s28, s17
s_mul_i32 s28, s28, 1152
v_add_u32 v12, s28, v11
ds_write2_b32 v12, v80, v81 offset0:0 offset1:1
ds_write2_b32 v12, v82, v83 offset0:4 offset1:5
s_mov_b32 exec_hi, 0
ds_write_b32 v12, v84 offset:32
s_mov_b32 exec_hi, -1
s_waitcnt lgkmcnt(0)
s_barrier
s_add_u32 s42, s42, 1
s_cmp_lt_u32 s42, 4
s_cbranch_scc1 BG_45
s_load_dwordx2 s[4:5], s[0:1], 88
s_waitcnt lgkmcnt(0)
s_mov_b32 s12, s4
s_mov_b32 s13, s5
s_mov_b32 s14, 663552
s_mov_b32 s15, 0x00020000
v_bfe_u32 v5, v0, 4, 4
v_mul_u32_u24 v5, 1152, v5
v_lshrrev_b32 v6, 8, v0
v_lshl_add_u32 v5, v6, 4, v5
v_add_u32 v5, 143360, v5
ds_read_b128 v[16:19], v5 offset:0
ds_read_b128 v[20:23], v5 offset:64
ds_read_b128 v[24:27], v5 offset:128
ds_read_b128 v[28:31], v5 offset:192
ds_read_b128 v[32:35], v5 offset:256
ds_read_b128 v[36:39], v5 offset:320
ds_read_b128 v[40:43], v5 offset:384
ds_read_b128 v[44:47], v5 offset:448
s_waitcnt lgkmcnt(0)
ds_read_b128 v[48:51], v5 offset:512
ds_read_b128 v[52:55], v5 offset:576
ds_read_b128 v[56:59], v5 offset:640
ds_read_b128 v[60:63], v5 offset:704
ds_read_b128 v[64:67], v5 offset:768
ds_read_b128 v[68:71], v5 offset:832
ds_read_b128 v[72:75], v5 offset:896
ds_read_b128 v[76:79], v5 offset:960
s_waitcnt lgkmcnt(0)
ds_read_b128 v[80:83], v5 offset:1024
ds_read_b128 v[84:87], v5 offset:1088
s_waitcnt lgkmcnt(0)
v_lshrrev_b32 v2, 8, v0
v_bfe_u32 v3, v0, 6, 2
v_bfe_u32 v4, v0, 4, 2
v_lshl_add_u32 v2, v2, 3, v3
v_mul_u32_u24 v2, 1152, v2
v_lshl_add_u32 v2, v4, 3, v2
s_mul_i32 s28, s17, 288
v_add_u32 v2, s28, v2
v_add_u32 v3, 36864, v2
v_add_u32 v4, 73728, v2
s_mul_i32 s28, s17, 9216
s_add_u32 s29, s28, 0
s_add_u32 s28, s28, 0
s_mov_b32 m0, s28
s_add_u32 s28, s28, 1024
buffer_load_dwordx4 v0, s[12:15], s29 offen lds
s_add_u32 s29, s29, 1024
s_mov_b32 m0, s28
s_add_u32 s28, s28, 1024
buffer_load_dwordx4 v0, s[12:15], s29 offen lds
s_add_u32 s29, s29, 1024
s_mov_b32 m0, s28
s_add_u32 s28, s28, 1024
buffer_load_dwordx4 v0, s[12:15], s29 offen lds
s_add_u32 s29, s29, 1024
s_mov_b32 m0, s28
s_add_u32 s28, s28, 1024
buffer_load_dwordx4 v0, s[12:15], s29 offen lds
s_add_u32 s29, s29, 1024
s_mov_b32 m0, s28
s_add_u32 s28, s28, 1024
buffer_load_dwordx4 v0, s[12:15], s29 offen lds
s_add_u32 s29, s29, 1024
s_mov_b32 m0, s28
s_add_u32 s28, s28, 1024
buffer_load_dwordx4 v0, s[12:15], s29 offen lds
s_add_u32 s29, s29, 1024
s_mov_b32 m0, s28
s_add_u32 s28, s28, 1024
buffer_load_dwordx4 v0, s[12:15], s29 offen lds
s_add_u32 s29, s29, 1024
s_mov_b32 m0, s28
s_add_u32 s28, s28, 1024
buffer_load_dwordx4 v0, s[12:15], s29 offen lds
s_add_u32 s29, s29, 1024
s_mov_b32 m0, s28
s_add_u32 s28, s28, 1024
buffer_load_dwordx4 v0, s[12:15], s29 offen lds
s_add_u32 s29, s29, 1024
s_mul_i32 s28, s17, 9216
s_add_u32 s29, s28, 36864
s_add_u32 s28, s28, 36864
s_mov_b32 m0, s28
s_add_u32 s28, s28, 1024
buffer_load_dwordx4 v0, s[12:15], s29 offen lds
s_add_u32 s29, s29, 1024
s_mov_b32 m0, s28
s_add_u32 s28, s28, 1024
buffer_load_dwordx4 v0, s[12:15], s29 offen lds
s_add_u32 s29, s29, 1024
s_mov_b32 m0, s28
s_add_u32 s28, s28, 1024
buffer_load_dwordx4 v0, s[12:15], s29 offen lds
s_add_u32 s29, s29, 1024
s_mov_b32 m0, s28
s_add_u32 s28, s28, 1024
buffer_load_dwordx4 v0, s[12:15], s29 offen lds
s_add_u32 s29, s29, 1024
s_mov_b32 m0, s28
s_add_u32 s28, s28, 1024
buffer_load_dwordx4 v0, s[12:15], s29 offen lds
s_add_u32 s29, s29, 1024
s_mov_b32 m0, s28
s_add_u32 s28, s28, 1024
buffer_load_dwordx4 v0, s[12:15], s29 offen lds
s_add_u32 s29, s29, 1024
s_mov_b32 m0, s28
s_add_u32 s28, s28, 1024
buffer_load_dwordx4 v0, s[12:15], s29 offen lds
s_add_u32 s29, s29, 1024
s_mov_b32 m0, s28
s_add_u32 s28, s28, 1024
buffer_load_dwordx4 v0, s[12:15], s29 offen lds
s_add_u32 s29, s29, 1024
s_mov_b32 m0, s28
s_add_u32 s28, s28, 1024
buffer_load_dwordx4 v0, s[12:15], s29 offen lds
s_add_u32 s29, s29, 1024
s_waitcnt vmcnt(9)
s_barrier
s_mul_i32 s28, s17, 9216
s_add_u32 s29, s28, 73728
s_add_u32 s28, s28, 73728
s_mov_b32 m0, s28
s_add_u32 s28, s28, 1024
buffer_load_dwordx4 v0, s[12:15], s29 offen lds
s_add_u32 s29, s29, 1024
s_mov_b32 m0, s28
s_add_u32 s28, s28, 1024
buffer_load_dwordx4 v0, s[12:15], s29 offen lds
s_add_u32 s29, s29, 1024
s_mov_b32 m0, s28
s_add_u32 s28, s28, 1024
buffer_load_dwordx4 v0, s[12:15], s29 offen lds
s_add_u32 s29, s29, 1024
s_mov_b32 m0, s28
s_add_u32 s28, s28, 1024
buffer_load_dwordx4 v0, s[12:15], s29 offen lds
s_add_u32 s29, s29, 1024
s_mov_b32 m0, s28
s_add_u32 s28, s28, 1024
buffer_load_dwordx4 v0, s[12:15], s29 offen lds
s_add_u32 s29, s29, 1024
s_mov_b32 m0, s28
s_add_u32 s28, s28, 1024
buffer_load_dwordx4 v0, s[12:15], s29 offen lds
s_add_u32 s29, s29, 1024
s_mov_b32 m0, s28
s_add_u32 s28, s28, 1024
buffer_load_dwordx4 v0, s[12:15], s29 offen lds
s_add_u32 s29, s29, 1024
s_mov_b32 m0, s28
s_add_u32 s28, s28, 1024
buffer_load_dwordx4 v0, s[12:15], s29 offen lds
s_add_u32 s29, s29, 1024
s_mov_b32 m0, s28
s_add_u32 s28, s28, 1024
buffer_load_dwordx4 v0, s[12:15], s29 offen lds
s_add_u32 s29, s29, 1024
ds_read_b64_tr_b16 v[124:125], v2 offset:0
ds_read_b64_tr_b16 v[126:127], v2 offset:4608
ds_read_b64_tr_b16 v[128:129], v2 offset:32
ds_read_b64_tr_b16 v[130:131], v2 offset:4640
ds_read_b64_tr_b16 v[132:133], v2 offset:64
ds_read_b64_tr_b16 v[134:135], v2 offset:4672
ds_read_b64_tr_b16 v[136:137], v2 offset:96
ds_read_b64_tr_b16 v[138:139], v2 offset:4704
ds_read_b64_tr_b16 v[140:141], v2 offset:128
ds_read_b64_tr_b16 v[142:143], v2 offset:4736
ds_read_b64_tr_b16 v[144:145], v2 offset:160
ds_read_b64_tr_b16 v[146:147], v2 offset:4768
ds_read_b64_tr_b16 v[148:149], v2 offset:192
ds_read_b64_tr_b16 v[150:151], v2 offset:4800
ds_read_b64_tr_b16 v[152:153], v2 offset:224
ds_read_b64_tr_b16 v[154:155], v2 offset:4832
ds_read_b64_tr_b16 v[156:157], v2 offset:256
ds_read_b64_tr_b16 v[158:159], v2 offset:4864
s_waitcnt lgkmcnt(15)
v_mfma_f32_16x16x32_bf16 v[88:91], v[124:127], v[16:19], 0
s_waitcnt lgkmcnt(14)
v_mfma_f32_16x16x32_bf16 v[92:95], v[128:131], v[16:19], 0
s_waitcnt lgkmcnt(12)
v_mfma_f32_16x16x32_bf16 v[96:99], v[132:135], v[16:19], 0
s_waitcnt lgkmcnt(10)
v_mfma_f32_16x16x32_bf16 v[100:103], v[136:139], v[16:19], 0
s_waitcnt lgkmcnt(8)
v_mfma_f32_16x16x32_bf16 v[104:107], v[140:143], v[16:19], 0
s_waitcnt lgkmcnt(6)
v_mfma_f32_16x16x32_bf16 v[108:111], v[144:147], v[16:19], 0
s_waitcnt lgkmcnt(4)
v_mfma_f32_16x16x32_bf16 v[112:115], v[148:151], v[16:19], 0
s_waitcnt lgkmcnt(2)
v_mfma_f32_16x16x32_bf16 v[116:119], v[152:155], v[16:19], 0
s_waitcnt lgkmcnt(0)
v_mfma_f32_16x16x32_bf16 v[120:123], v[156:159], v[16:19], 0
s_waitcnt vmcnt(9)
s_barrier
s_mul_i32 s28, s17, 9216
s_add_u32 s29, s28, 110592
s_add_u32 s28, s28, 0
s_mov_b32 m0, s28
s_add_u32 s28, s28, 1024
buffer_load_dwordx4 v0, s[12:15], s29 offen lds
s_add_u32 s29, s29, 1024
s_mov_b32 m0, s28
s_add_u32 s28, s28, 1024
buffer_load_dwordx4 v0, s[12:15], s29 offen lds
s_add_u32 s29, s29, 1024
s_mov_b32 m0, s28
s_add_u32 s28, s28, 1024
buffer_load_dwordx4 v0, s[12:15], s29 offen lds
s_add_u32 s29, s29, 1024
s_mov_b32 m0, s28
s_add_u32 s28, s28, 1024
buffer_load_dwordx4 v0, s[12:15], s29 offen lds
s_add_u32 s29, s29, 1024
s_mov_b32 m0, s28
s_add_u32 s28, s28, 1024
buffer_load_dwordx4 v0, s[12:15], s29 offen lds
s_add_u32 s29, s29, 1024
s_mov_b32 m0, s28
s_add_u32 s28, s28, 1024
buffer_load_dwordx4 v0, s[12:15], s29 offen lds
s_add_u32 s29, s29, 1024
s_mov_b32 m0, s28
s_add_u32 s28, s28, 1024
buffer_load_dwordx4 v0, s[12:15], s29 offen lds
s_add_u32 s29, s29, 1024
s_mov_b32 m0, s28
s_add_u32 s28, s28, 1024
buffer_load_dwordx4 v0, s[12:15], s29 offen lds
s_add_u32 s29, s29, 1024
s_mov_b32 m0, s28
s_add_u32 s28, s28, 1024
buffer_load_dwordx4 v0, s[12:15], s29 offen lds
s_add_u32 s29, s29, 1024
ds_read_b64_tr_b16 v[124:125], v3 offset:0
ds_read_b64_tr_b16 v[126:127], v3 offset:4608
ds_read_b64_tr_b16 v[128:129], v3 offset:32
ds_read_b64_tr_b16 v[130:131], v3 offset:4640
ds_read_b64_tr_b16 v[132:133], v3 offset:64
ds_read_b64_tr_b16 v[134:135], v3 offset:4672
ds_read_b64_tr_b16 v[136:137], v3 offset:96
ds_read_b64_tr_b16 v[138:139], v3 offset:4704
ds_read_b64_tr_b16 v[140:141], v3 offset:128
ds_read_b64_tr_b16 v[142:143], v3 offset:4736
ds_read_b64_tr_b16 v[144:145], v3 offset:160
ds_read_b64_tr_b16 v[146:147], v3 offset:4768
ds_read_b64_tr_b16 v[148:149], v3 offset:192
ds_read_b64_tr_b16 v[150:151], v3 offset:4800
ds_read_b64_tr_b16 v[152:153], v3 offset:224
ds_read_b64_tr_b16 v[154:155], v3 offset:4832
ds_read_b64_tr_b16 v[156:157], v3 offset:256
ds_read_b64_tr_b16 v[158:159], v3 offset:4864
s_waitcnt lgkmcnt(15)
v_mfma_f32_16x16x32_bf16 v[88:91], v[124:127], v[20:23], v[88:91]
s_waitcnt lgkmcnt(14)
v_mfma_f32_16x16x32_bf16 v[92:95], v[128:131], v[20:23], v[92:95]
s_waitcnt lgkmcnt(12)
v_mfma_f32_16x16x32_bf16 v[96:99], v[132:135], v[20:23], v[96:99]
s_waitcnt lgkmcnt(10)
v_mfma_f32_16x16x32_bf16 v[100:103], v[136:139], v[20:23], v[100:103]
s_waitcnt lgkmcnt(8)
v_mfma_f32_16x16x32_bf16 v[104:107], v[140:143], v[20:23], v[104:107]
s_waitcnt lgkmcnt(6)
v_mfma_f32_16x16x32_bf16 v[108:111], v[144:147], v[20:23], v[108:111]
s_waitcnt lgkmcnt(4)
v_mfma_f32_16x16x32_bf16 v[112:115], v[148:151], v[20:23], v[112:115]
s_waitcnt lgkmcnt(2)
v_mfma_f32_16x16x32_bf16 v[116:119], v[152:155], v[20:23], v[116:119]
s_waitcnt lgkmcnt(0)
v_mfma_f32_16x16x32_bf16 v[120:123], v[156:159], v[20:23], v[120:123]
s_waitcnt vmcnt(9)
s_barrier
s_mul_i32 s28, s17, 9216
s_add_u32 s29, s28, 147456
s_add_u32 s28, s28, 36864
s_mov_b32 m0, s28
s_add_u32 s28, s28, 1024
buffer_load_dwordx4 v0, s[12:15], s29 offen lds
s_add_u32 s29, s29, 1024
s_mov_b32 m0, s28
s_add_u32 s28, s28, 1024
buffer_load_dwordx4 v0, s[12:15], s29 offen lds
s_add_u32 s29, s29, 1024
s_mov_b32 m0, s28
s_add_u32 s28, s28, 1024
buffer_load_dwordx4 v0, s[12:15], s29 offen lds
s_add_u32 s29, s29, 1024
s_mov_b32 m0, s28
s_add_u32 s28, s28, 1024
buffer_load_dwordx4 v0, s[12:15], s29 offen lds
s_add_u32 s29, s29, 1024
s_mov_b32 m0, s28
s_add_u32 s28, s28, 1024
buffer_load_dwordx4 v0, s[12:15], s29 offen lds
s_add_u32 s29, s29, 1024
s_mov_b32 m0, s28
s_add_u32 s28, s28, 1024
buffer_load_dwordx4 v0, s[12:15], s29 offen lds
s_add_u32 s29, s29, 1024
s_mov_b32 m0, s28
s_add_u32 s28, s28, 1024
buffer_load_dwordx4 v0, s[12:15], s29 offen lds
s_add_u32 s29, s29, 1024
s_mov_b32 m0, s28
s_add_u32 s28, s28, 1024
buffer_load_dwordx4 v0, s[12:15], s29 offen lds
s_add_u32 s29, s29, 1024
s_mov_b32 m0, s28
s_add_u32 s28, s28, 1024
buffer_load_dwordx4 v0, s[12:15], s29 offen lds
s_add_u32 s29, s29, 1024
ds_read_b64_tr_b16 v[124:125], v4 offset:0
ds_read_b64_tr_b16 v[126:127], v4 offset:4608
ds_read_b64_tr_b16 v[128:129], v4 offset:32
ds_read_b64_tr_b16 v[130:131], v4 offset:4640
ds_read_b64_tr_b16 v[132:133], v4 offset:64
ds_read_b64_tr_b16 v[134:135], v4 offset:4672
ds_read_b64_tr_b16 v[136:137], v4 offset:96
ds_read_b64_tr_b16 v[138:139], v4 offset:4704
ds_read_b64_tr_b16 v[140:141], v4 offset:128
ds_read_b64_tr_b16 v[142:143], v4 offset:4736
ds_read_b64_tr_b16 v[144:145], v4 offset:160
ds_read_b64_tr_b16 v[146:147], v4 offset:4768
ds_read_b64_tr_b16 v[148:149], v4 offset:192
ds_read_b64_tr_b16 v[150:151], v4 offset:4800
ds_read_b64_tr_b16 v[152:153], v4 offset:224
ds_read_b64_tr_b16 v[154:155], v4 offset:4832
ds_read_b64_tr_b16 v[156:157], v4 offset:256
ds_read_b64_tr_b16 v[158:159], v4 offset:4864
s_waitcnt lgkmcnt(15)
v_mfma_f32_16x16x32_bf16 v[88:91], v[124:127], v[24:27], v[88:91]
s_waitcnt lgkmcnt(14)
v_mfma_f32_16x16x32_bf16 v[92:95], v[128:131], v[24:27], v[92:95]
s_waitcnt lgkmcnt(12)
v_mfma_f32_16x16x32_bf16 v[96:99], v[132:135], v[24:27], v[96:99]
s_waitcnt lgkmcnt(10)
v_mfma_f32_16x16x32_bf16 v[100:103], v[136:139], v[24:27], v[100:103]
s_waitcnt lgkmcnt(8)
v_mfma_f32_16x16x32_bf16 v[104:107], v[140:143], v[24:27], v[104:107]
s_waitcnt lgkmcnt(6)
v_mfma_f32_16x16x32_bf16 v[108:111], v[144:147], v[24:27], v[108:111]
s_waitcnt lgkmcnt(4)
v_mfma_f32_16x16x32_bf16 v[112:115], v[148:151], v[24:27], v[112:115]
s_waitcnt lgkmcnt(2)
v_mfma_f32_16x16x32_bf16 v[116:119], v[152:155], v[24:27], v[116:119]
s_waitcnt lgkmcnt(0)
v_mfma_f32_16x16x32_bf16 v[120:123], v[156:159], v[24:27], v[120:123]
s_waitcnt vmcnt(9)
s_barrier
s_mul_i32 s28, s17, 9216
s_add_u32 s29, s28, 184320
s_add_u32 s28, s28, 73728
s_mov_b32 m0, s28
s_add_u32 s28, s28, 1024
buffer_load_dwordx4 v0, s[12:15], s29 offen lds
s_add_u32 s29, s29, 1024
s_mov_b32 m0, s28
s_add_u32 s28, s28, 1024
buffer_load_dwordx4 v0, s[12:15], s29 offen lds
s_add_u32 s29, s29, 1024
s_mov_b32 m0, s28
s_add_u32 s28, s28, 1024
buffer_load_dwordx4 v0, s[12:15], s29 offen lds
s_add_u32 s29, s29, 1024
s_mov_b32 m0, s28
s_add_u32 s28, s28, 1024
buffer_load_dwordx4 v0, s[12:15], s29 offen lds
s_add_u32 s29, s29, 1024
s_mov_b32 m0, s28
s_add_u32 s28, s28, 1024
buffer_load_dwordx4 v0, s[12:15], s29 offen lds
s_add_u32 s29, s29, 1024
s_mov_b32 m0, s28
s_add_u32 s28, s28, 1024
buffer_load_dwordx4 v0, s[12:15], s29 offen lds
s_add_u32 s29, s29, 1024
s_mov_b32 m0, s28
s_add_u32 s28, s28, 1024
buffer_load_dwordx4 v0, s[12:15], s29 offen lds
s_add_u32 s29, s29, 1024
s_mov_b32 m0, s28
s_add_u32 s28, s28, 1024
buffer_load_dwordx4 v0, s[12:15], s29 offen lds
s_add_u32 s29, s29, 1024
s_mov_b32 m0, s28
s_add_u32 s28, s28, 1024
buffer_load_dwordx4 v0, s[12:15], s29 offen lds
s_add_u32 s29, s29, 1024
ds_read_b64_tr_b16 v[124:125], v2 offset:0
ds_read_b64_tr_b16 v[126:127], v2 offset:4608
ds_read_b64_tr_b16 v[128:129], v2 offset:32
ds_read_b64_tr_b16 v[130:131], v2 offset:4640
ds_read_b64_tr_b16 v[132:133], v2 offset:64
ds_read_b64_tr_b16 v[134:135], v2 offset:4672
ds_read_b64_tr_b16 v[136:137], v2 offset:96
ds_read_b64_tr_b16 v[138:139], v2 offset:4704
ds_read_b64_tr_b16 v[140:141], v2 offset:128
ds_read_b64_tr_b16 v[142:143], v2 offset:4736
ds_read_b64_tr_b16 v[144:145], v2 offset:160
ds_read_b64_tr_b16 v[146:147], v2 offset:4768
ds_read_b64_tr_b16 v[148:149], v2 offset:192
ds_read_b64_tr_b16 v[150:151], v2 offset:4800
ds_read_b64_tr_b16 v[152:153], v2 offset:224
ds_read_b64_tr_b16 v[154:155], v2 offset:4832
ds_read_b64_tr_b16 v[156:157], v2 offset:256
ds_read_b64_tr_b16 v[158:159], v2 offset:4864
s_waitcnt lgkmcnt(15)
v_mfma_f32_16x16x32_bf16 v[88:91], v[124:127], v[28:31], v[88:91]
s_waitcnt lgkmcnt(14)
v_mfma_f32_16x16x32_bf16 v[92:95], v[128:131], v[28:31], v[92:95]
s_waitcnt lgkmcnt(12)
v_mfma_f32_16x16x32_bf16 v[96:99], v[132:135], v[28:31], v[96:99]
s_waitcnt lgkmcnt(10)
v_mfma_f32_16x16x32_bf16 v[100:103], v[136:139], v[28:31], v[100:103]
s_waitcnt lgkmcnt(8)
v_mfma_f32_16x16x32_bf16 v[104:107], v[140:143], v[28:31], v[104:107]
s_waitcnt lgkmcnt(6)
v_mfma_f32_16x16x32_bf16 v[108:111], v[144:147], v[28:31], v[108:111]
s_waitcnt lgkmcnt(4)
v_mfma_f32_16x16x32_bf16 v[112:115], v[148:151], v[28:31], v[112:115]
s_waitcnt lgkmcnt(2)
v_mfma_f32_16x16x32_bf16 v[116:119], v[152:155], v[28:31], v[116:119]
s_waitcnt lgkmcnt(0)
v_mfma_f32_16x16x32_bf16 v[120:123], v[156:159], v[28:31], v[120:123]
s_waitcnt vmcnt(9)
s_barrier
s_mul_i32 s28, s17, 9216
s_add_u32 s29, s28, 221184
s_add_u32 s28, s28, 0
s_mov_b32 m0, s28
s_add_u32 s28, s28, 1024
buffer_load_dwordx4 v0, s[12:15], s29 offen lds
s_add_u32 s29, s29, 1024
s_mov_b32 m0, s28
s_add_u32 s28, s28, 1024
buffer_load_dwordx4 v0, s[12:15], s29 offen lds
s_add_u32 s29, s29, 1024
s_mov_b32 m0, s28
s_add_u32 s28, s28, 1024
buffer_load_dwordx4 v0, s[12:15], s29 offen lds
s_add_u32 s29, s29, 1024
s_mov_b32 m0, s28
s_add_u32 s28, s28, 1024
buffer_load_dwordx4 v0, s[12:15], s29 offen lds
s_add_u32 s29, s29, 1024
s_mov_b32 m0, s28
s_add_u32 s28, s28, 1024
buffer_load_dwordx4 v0, s[12:15], s29 offen lds
s_add_u32 s29, s29, 1024
s_mov_b32 m0, s28
s_add_u32 s28, s28, 1024
buffer_load_dwordx4 v0, s[12:15], s29 offen lds
s_add_u32 s29, s29, 1024
s_mov_b32 m0, s28
s_add_u32 s28, s28, 1024
buffer_load_dwordx4 v0, s[12:15], s29 offen lds
s_add_u32 s29, s29, 1024
s_mov_b32 m0, s28
s_add_u32 s28, s28, 1024
buffer_load_dwordx4 v0, s[12:15], s29 offen lds
s_add_u32 s29, s29, 1024
s_mov_b32 m0, s28
s_add_u32 s28, s28, 1024
buffer_load_dwordx4 v0, s[12:15], s29 offen lds
s_add_u32 s29, s29, 1024
ds_read_b64_tr_b16 v[124:125], v3 offset:0
ds_read_b64_tr_b16 v[126:127], v3 offset:4608
ds_read_b64_tr_b16 v[128:129], v3 offset:32
ds_read_b64_tr_b16 v[130:131], v3 offset:4640
ds_read_b64_tr_b16 v[132:133], v3 offset:64
ds_read_b64_tr_b16 v[134:135], v3 offset:4672
ds_read_b64_tr_b16 v[136:137], v3 offset:96
ds_read_b64_tr_b16 v[138:139], v3 offset:4704
ds_read_b64_tr_b16 v[140:141], v3 offset:128
ds_read_b64_tr_b16 v[142:143], v3 offset:4736
ds_read_b64_tr_b16 v[144:145], v3 offset:160
ds_read_b64_tr_b16 v[146:147], v3 offset:4768
ds_read_b64_tr_b16 v[148:149], v3 offset:192
ds_read_b64_tr_b16 v[150:151], v3 offset:4800
ds_read_b64_tr_b16 v[152:153], v3 offset:224
ds_read_b64_tr_b16 v[154:155], v3 offset:4832
ds_read_b64_tr_b16 v[156:157], v3 offset:256
ds_read_b64_tr_b16 v[158:159], v3 offset:4864
s_waitcnt lgkmcnt(15)
v_mfma_f32_16x16x32_bf16 v[88:91], v[124:127], v[32:35], v[88:91]
s_waitcnt lgkmcnt(14)
v_mfma_f32_16x16x32_bf16 v[92:95], v[128:131], v[32:35], v[92:95]
s_waitcnt lgkmcnt(12)
v_mfma_f32_16x16x32_bf16 v[96:99], v[132:135], v[32:35], v[96:99]
s_waitcnt lgkmcnt(10)
v_mfma_f32_16x16x32_bf16 v[100:103], v[136:139], v[32:35], v[100:103]
s_waitcnt lgkmcnt(8)
v_mfma_f32_16x16x32_bf16 v[104:107], v[140:143], v[32:35], v[104:107]
s_waitcnt lgkmcnt(6)
v_mfma_f32_16x16x32_bf16 v[108:111], v[144:147], v[32:35], v[108:111]
s_waitcnt lgkmcnt(4)
v_mfma_f32_16x16x32_bf16 v[112:115], v[148:151], v[32:35], v[112:115]
s_waitcnt lgkmcnt(2)
v_mfma_f32_16x16x32_bf16 v[116:119], v[152:155], v[32:35], v[116:119]
s_waitcnt lgkmcnt(0)
v_mfma_f32_16x16x32_bf16 v[120:123], v[156:159], v[32:35], v[120:123]
s_waitcnt vmcnt(9)
s_barrier
s_mul_i32 s28, s17, 9216
s_add_u32 s29, s28, 258048
s_add_u32 s28, s28, 36864
s_mov_b32 m0, s28
s_add_u32 s28, s28, 1024
buffer_load_dwordx4 v0, s[12:15], s29 offen lds
s_add_u32 s29, s29, 1024
s_mov_b32 m0, s28
s_add_u32 s28, s28, 1024
buffer_load_dwordx4 v0, s[12:15], s29 offen lds
s_add_u32 s29, s29, 1024
s_mov_b32 m0, s28
s_add_u32 s28, s28, 1024
buffer_load_dwordx4 v0, s[12:15], s29 offen lds
s_add_u32 s29, s29, 1024
s_mov_b32 m0, s28
s_add_u32 s28, s28, 1024
buffer_load_dwordx4 v0, s[12:15], s29 offen lds
s_add_u32 s29, s29, 1024
s_mov_b32 m0, s28
s_add_u32 s28, s28, 1024
buffer_load_dwordx4 v0, s[12:15], s29 offen lds
s_add_u32 s29, s29, 1024
s_mov_b32 m0, s28
s_add_u32 s28, s28, 1024
buffer_load_dwordx4 v0, s[12:15], s29 offen lds
s_add_u32 s29, s29, 1024
s_mov_b32 m0, s28
s_add_u32 s28, s28, 1024
buffer_load_dwordx4 v0, s[12:15], s29 offen lds
s_add_u32 s29, s29, 1024
s_mov_b32 m0, s28
s_add_u32 s28, s28, 1024
buffer_load_dwordx4 v0, s[12:15], s29 offen lds
s_add_u32 s29, s29, 1024
s_mov_b32 m0, s28
s_add_u32 s28, s28, 1024
buffer_load_dwordx4 v0, s[12:15], s29 offen lds
s_add_u32 s29, s29, 1024
ds_read_b64_tr_b16 v[124:125], v4 offset:0
ds_read_b64_tr_b16 v[126:127], v4 offset:4608
ds_read_b64_tr_b16 v[128:129], v4 offset:32
ds_read_b64_tr_b16 v[130:131], v4 offset:4640
ds_read_b64_tr_b16 v[132:133], v4 offset:64
ds_read_b64_tr_b16 v[134:135], v4 offset:4672
ds_read_b64_tr_b16 v[136:137], v4 offset:96
ds_read_b64_tr_b16 v[138:139], v4 offset:4704
ds_read_b64_tr_b16 v[140:141], v4 offset:128
ds_read_b64_tr_b16 v[142:143], v4 offset:4736
ds_read_b64_tr_b16 v[144:145], v4 offset:160
ds_read_b64_tr_b16 v[146:147], v4 offset:4768
ds_read_b64_tr_b16 v[148:149], v4 offset:192
ds_read_b64_tr_b16 v[150:151], v4 offset:4800
ds_read_b64_tr_b16 v[152:153], v4 offset:224
ds_read_b64_tr_b16 v[154:155], v4 offset:4832
ds_read_b64_tr_b16 v[156:157], v4 offset:256
ds_read_b64_tr_b16 v[158:159], v4 offset:4864
s_waitcnt lgkmcnt(15)
v_mfma_f32_16x16x32_bf16 v[88:91], v[124:127], v[36:39], v[88:91]
s_waitcnt lgkmcnt(14)
v_mfma_f32_16x16x32_bf16 v[92:95], v[128:131], v[36:39], v[92:95]
s_waitcnt lgkmcnt(12)
v_mfma_f32_16x16x32_bf16 v[96:99], v[132:135], v[36:39], v[96:99]
s_waitcnt lgkmcnt(10)
v_mfma_f32_16x16x32_bf16 v[100:103], v[136:139], v[36:39], v[100:103]
s_waitcnt lgkmcnt(8)
v_mfma_f32_16x16x32_bf16 v[104:107], v[140:143], v[36:39], v[104:107]
s_waitcnt lgkmcnt(6)
v_mfma_f32_16x16x32_bf16 v[108:111], v[144:147], v[36:39], v[108:111]
s_waitcnt lgkmcnt(4)
v_mfma_f32_16x16x32_bf16 v[112:115], v[148:151], v[36:39], v[112:115]
s_waitcnt lgkmcnt(2)
v_mfma_f32_16x16x32_bf16 v[116:119], v[152:155], v[36:39], v[116:119]
s_waitcnt lgkmcnt(0)
v_mfma_f32_16x16x32_bf16 v[120:123], v[156:159], v[36:39], v[120:123]
s_waitcnt vmcnt(9)
s_barrier
s_mul_i32 s28, s17, 9216
s_add_u32 s29, s28, 294912
s_add_u32 s28, s28, 73728
s_mov_b32 m0, s28
s_add_u32 s28, s28, 1024
buffer_load_dwordx4 v0, s[12:15], s29 offen lds
s_add_u32 s29, s29, 1024
s_mov_b32 m0, s28
s_add_u32 s28, s28, 1024
buffer_load_dwordx4 v0, s[12:15], s29 offen lds
s_add_u32 s29, s29, 1024
s_mov_b32 m0, s28
s_add_u32 s28, s28, 1024
buffer_load_dwordx4 v0, s[12:15], s29 offen lds
s_add_u32 s29, s29, 1024
s_mov_b32 m0, s28
s_add_u32 s28, s28, 1024
buffer_load_dwordx4 v0, s[12:15], s29 offen lds
s_add_u32 s29, s29, 1024
s_mov_b32 m0, s28
s_add_u32 s28, s28, 1024
buffer_load_dwordx4 v0, s[12:15], s29 offen lds
s_add_u32 s29, s29, 1024
s_mov_b32 m0, s28
s_add_u32 s28, s28, 1024
buffer_load_dwordx4 v0, s[12:15], s29 offen lds
s_add_u32 s29, s29, 1024
s_mov_b32 m0, s28
s_add_u32 s28, s28, 1024
buffer_load_dwordx4 v0, s[12:15], s29 offen lds
s_add_u32 s29, s29, 1024
s_mov_b32 m0, s28
s_add_u32 s28, s28, 1024
buffer_load_dwordx4 v0, s[12:15], s29 offen lds
s_add_u32 s29, s29, 1024
s_mov_b32 m0, s28
s_add_u32 s28, s28, 1024
buffer_load_dwordx4 v0, s[12:15], s29 offen lds
s_add_u32 s29, s29, 1024
ds_read_b64_tr_b16 v[124:125], v2 offset:0
ds_read_b64_tr_b16 v[126:127], v2 offset:4608
ds_read_b64_tr_b16 v[128:129], v2 offset:32
ds_read_b64_tr_b16 v[130:131], v2 offset:4640
ds_read_b64_tr_b16 v[132:133], v2 offset:64
ds_read_b64_tr_b16 v[134:135], v2 offset:4672
ds_read_b64_tr_b16 v[136:137], v2 offset:96
ds_read_b64_tr_b16 v[138:139], v2 offset:4704
ds_read_b64_tr_b16 v[140:141], v2 offset:128
ds_read_b64_tr_b16 v[142:143], v2 offset:4736
ds_read_b64_tr_b16 v[144:145], v2 offset:160
ds_read_b64_tr_b16 v[146:147], v2 offset:4768
ds_read_b64_tr_b16 v[148:149], v2 offset:192
ds_read_b64_tr_b16 v[150:151], v2 offset:4800
ds_read_b64_tr_b16 v[152:153], v2 offset:224
ds_read_b64_tr_b16 v[154:155], v2 offset:4832
ds_read_b64_tr_b16 v[156:157], v2 offset:256
ds_read_b64_tr_b16 v[158:159], v2 offset:4864
s_waitcnt lgkmcnt(15)
v_mfma_f32_16x16x32_bf16 v[88:91], v[124:127], v[40:43], v[88:91]
s_waitcnt lgkmcnt(14)
v_mfma_f32_16x16x32_bf16 v[92:95], v[128:131], v[40:43], v[92:95]
s_waitcnt lgkmcnt(12)
v_mfma_f32_16x16x32_bf16 v[96:99], v[132:135], v[40:43], v[96:99]
s_waitcnt lgkmcnt(10)
v_mfma_f32_16x16x32_bf16 v[100:103], v[136:139], v[40:43], v[100:103]
s_waitcnt lgkmcnt(8)
v_mfma_f32_16x16x32_bf16 v[104:107], v[140:143], v[40:43], v[104:107]
s_waitcnt lgkmcnt(6)
v_mfma_f32_16x16x32_bf16 v[108:111], v[144:147], v[40:43], v[108:111]
s_waitcnt lgkmcnt(4)
v_mfma_f32_16x16x32_bf16 v[112:115], v[148:151], v[40:43], v[112:115]
s_waitcnt lgkmcnt(2)
v_mfma_f32_16x16x32_bf16 v[116:119], v[152:155], v[40:43], v[116:119]
s_waitcnt lgkmcnt(0)
v_mfma_f32_16x16x32_bf16 v[120:123], v[156:159], v[40:43], v[120:123]
s_waitcnt vmcnt(9)
s_barrier
s_mul_i32 s28, s17, 9216
s_add_u32 s29, s28, 331776
s_add_u32 s28, s28, 0
s_mov_b32 m0, s28
s_add_u32 s28, s28, 1024
buffer_load_dwordx4 v0, s[12:15], s29 offen lds
s_add_u32 s29, s29, 1024
s_mov_b32 m0, s28
s_add_u32 s28, s28, 1024
buffer_load_dwordx4 v0, s[12:15], s29 offen lds
s_add_u32 s29, s29, 1024
s_mov_b32 m0, s28
s_add_u32 s28, s28, 1024
buffer_load_dwordx4 v0, s[12:15], s29 offen lds
s_add_u32 s29, s29, 1024
s_mov_b32 m0, s28
s_add_u32 s28, s28, 1024
buffer_load_dwordx4 v0, s[12:15], s29 offen lds
s_add_u32 s29, s29, 1024
s_mov_b32 m0, s28
s_add_u32 s28, s28, 1024
buffer_load_dwordx4 v0, s[12:15], s29 offen lds
s_add_u32 s29, s29, 1024
s_mov_b32 m0, s28
s_add_u32 s28, s28, 1024
buffer_load_dwordx4 v0, s[12:15], s29 offen lds
s_add_u32 s29, s29, 1024
s_mov_b32 m0, s28
s_add_u32 s28, s28, 1024
buffer_load_dwordx4 v0, s[12:15], s29 offen lds
s_add_u32 s29, s29, 1024
s_mov_b32 m0, s28
s_add_u32 s28, s28, 1024
buffer_load_dwordx4 v0, s[12:15], s29 offen lds
s_add_u32 s29, s29, 1024
s_mov_b32 m0, s28
s_add_u32 s28, s28, 1024
buffer_load_dwordx4 v0, s[12:15], s29 offen lds
s_add_u32 s29, s29, 1024
ds_read_b64_tr_b16 v[124:125], v3 offset:0
ds_read_b64_tr_b16 v[126:127], v3 offset:4608
ds_read_b64_tr_b16 v[128:129], v3 offset:32
ds_read_b64_tr_b16 v[130:131], v3 offset:4640
ds_read_b64_tr_b16 v[132:133], v3 offset:64
ds_read_b64_tr_b16 v[134:135], v3 offset:4672
ds_read_b64_tr_b16 v[136:137], v3 offset:96
ds_read_b64_tr_b16 v[138:139], v3 offset:4704
ds_read_b64_tr_b16 v[140:141], v3 offset:128
ds_read_b64_tr_b16 v[142:143], v3 offset:4736
ds_read_b64_tr_b16 v[144:145], v3 offset:160
ds_read_b64_tr_b16 v[146:147], v3 offset:4768
ds_read_b64_tr_b16 v[148:149], v3 offset:192
ds_read_b64_tr_b16 v[150:151], v3 offset:4800
ds_read_b64_tr_b16 v[152:153], v3 offset:224
ds_read_b64_tr_b16 v[154:155], v3 offset:4832
ds_read_b64_tr_b16 v[156:157], v3 offset:256
ds_read_b64_tr_b16 v[158:159], v3 offset:4864
s_waitcnt lgkmcnt(15)
v_mfma_f32_16x16x32_bf16 v[88:91], v[124:127], v[44:47], v[88:91]
s_waitcnt lgkmcnt(14)
v_mfma_f32_16x16x32_bf16 v[92:95], v[128:131], v[44:47], v[92:95]
s_waitcnt lgkmcnt(12)
v_mfma_f32_16x16x32_bf16 v[96:99], v[132:135], v[44:47], v[96:99]
s_waitcnt lgkmcnt(10)
v_mfma_f32_16x16x32_bf16 v[100:103], v[136:139], v[44:47], v[100:103]
s_waitcnt lgkmcnt(8)
v_mfma_f32_16x16x32_bf16 v[104:107], v[140:143], v[44:47], v[104:107]
s_waitcnt lgkmcnt(6)
v_mfma_f32_16x16x32_bf16 v[108:111], v[144:147], v[44:47], v[108:111]
s_waitcnt lgkmcnt(4)
v_mfma_f32_16x16x32_bf16 v[112:115], v[148:151], v[44:47], v[112:115]
s_waitcnt lgkmcnt(2)
v_mfma_f32_16x16x32_bf16 v[116:119], v[152:155], v[44:47], v[116:119]
s_waitcnt lgkmcnt(0)
v_mfma_f32_16x16x32_bf16 v[120:123], v[156:159], v[44:47], v[120:123]
s_waitcnt vmcnt(9)
s_barrier
s_mul_i32 s28, s17, 9216
s_add_u32 s29, s28, 368640
s_add_u32 s28, s28, 36864
s_mov_b32 m0, s28
s_add_u32 s28, s28, 1024
buffer_load_dwordx4 v0, s[12:15], s29 offen lds
s_add_u32 s29, s29, 1024
s_mov_b32 m0, s28
s_add_u32 s28, s28, 1024
buffer_load_dwordx4 v0, s[12:15], s29 offen lds
s_add_u32 s29, s29, 1024
s_mov_b32 m0, s28
s_add_u32 s28, s28, 1024
buffer_load_dwordx4 v0, s[12:15], s29 offen lds
s_add_u32 s29, s29, 1024
s_mov_b32 m0, s28
s_add_u32 s28, s28, 1024
buffer_load_dwordx4 v0, s[12:15], s29 offen lds
s_add_u32 s29, s29, 1024
s_mov_b32 m0, s28
s_add_u32 s28, s28, 1024
buffer_load_dwordx4 v0, s[12:15], s29 offen lds
s_add_u32 s29, s29, 1024
s_mov_b32 m0, s28
s_add_u32 s28, s28, 1024
buffer_load_dwordx4 v0, s[12:15], s29 offen lds
s_add_u32 s29, s29, 1024
s_mov_b32 m0, s28
s_add_u32 s28, s28, 1024
buffer_load_dwordx4 v0, s[12:15], s29 offen lds
s_add_u32 s29, s29, 1024
s_mov_b32 m0, s28
s_add_u32 s28, s28, 1024
buffer_load_dwordx4 v0, s[12:15], s29 offen lds
s_add_u32 s29, s29, 1024
s_mov_b32 m0, s28
s_add_u32 s28, s28, 1024
buffer_load_dwordx4 v0, s[12:15], s29 offen lds
s_add_u32 s29, s29, 1024
ds_read_b64_tr_b16 v[124:125], v4 offset:0
ds_read_b64_tr_b16 v[126:127], v4 offset:4608
ds_read_b64_tr_b16 v[128:129], v4 offset:32
ds_read_b64_tr_b16 v[130:131], v4 offset:4640
ds_read_b64_tr_b16 v[132:133], v4 offset:64
ds_read_b64_tr_b16 v[134:135], v4 offset:4672
ds_read_b64_tr_b16 v[136:137], v4 offset:96
ds_read_b64_tr_b16 v[138:139], v4 offset:4704
ds_read_b64_tr_b16 v[140:141], v4 offset:128
ds_read_b64_tr_b16 v[142:143], v4 offset:4736
ds_read_b64_tr_b16 v[144:145], v4 offset:160
ds_read_b64_tr_b16 v[146:147], v4 offset:4768
ds_read_b64_tr_b16 v[148:149], v4 offset:192
ds_read_b64_tr_b16 v[150:151], v4 offset:4800
ds_read_b64_tr_b16 v[152:153], v4 offset:224
ds_read_b64_tr_b16 v[154:155], v4 offset:4832
ds_read_b64_tr_b16 v[156:157], v4 offset:256
ds_read_b64_tr_b16 v[158:159], v4 offset:4864
s_waitcnt lgkmcnt(15)
v_mfma_f32_16x16x32_bf16 v[88:91], v[124:127], v[48:51], v[88:91]
s_waitcnt lgkmcnt(14)
v_mfma_f32_16x16x32_bf16 v[92:95], v[128:131], v[48:51], v[92:95]
s_waitcnt lgkmcnt(12)
v_mfma_f32_16x16x32_bf16 v[96:99], v[132:135], v[48:51], v[96:99]
s_waitcnt lgkmcnt(10)
v_mfma_f32_16x16x32_bf16 v[100:103], v[136:139], v[48:51], v[100:103]
s_waitcnt lgkmcnt(8)
v_mfma_f32_16x16x32_bf16 v[104:107], v[140:143], v[48:51], v[104:107]
s_waitcnt lgkmcnt(6)
v_mfma_f32_16x16x32_bf16 v[108:111], v[144:147], v[48:51], v[108:111]
s_waitcnt lgkmcnt(4)
v_mfma_f32_16x16x32_bf16 v[112:115], v[148:151], v[48:51], v[112:115]
s_waitcnt lgkmcnt(2)
v_mfma_f32_16x16x32_bf16 v[116:119], v[152:155], v[48:51], v[116:119]
s_waitcnt lgkmcnt(0)
v_mfma_f32_16x16x32_bf16 v[120:123], v[156:159], v[48:51], v[120:123]
s_waitcnt vmcnt(9)
s_barrier
s_mul_i32 s28, s17, 9216
s_add_u32 s29, s28, 405504
s_add_u32 s28, s28, 73728
s_mov_b32 m0, s28
s_add_u32 s28, s28, 1024
buffer_load_dwordx4 v0, s[12:15], s29 offen lds
s_add_u32 s29, s29, 1024
s_mov_b32 m0, s28
s_add_u32 s28, s28, 1024
buffer_load_dwordx4 v0, s[12:15], s29 offen lds
s_add_u32 s29, s29, 1024
s_mov_b32 m0, s28
s_add_u32 s28, s28, 1024
buffer_load_dwordx4 v0, s[12:15], s29 offen lds
s_add_u32 s29, s29, 1024
s_mov_b32 m0, s28
s_add_u32 s28, s28, 1024
buffer_load_dwordx4 v0, s[12:15], s29 offen lds
s_add_u32 s29, s29, 1024
s_mov_b32 m0, s28
s_add_u32 s28, s28, 1024
buffer_load_dwordx4 v0, s[12:15], s29 offen lds
s_add_u32 s29, s29, 1024
s_mov_b32 m0, s28
s_add_u32 s28, s28, 1024
buffer_load_dwordx4 v0, s[12:15], s29 offen lds
s_add_u32 s29, s29, 1024
s_mov_b32 m0, s28
s_add_u32 s28, s28, 1024
buffer_load_dwordx4 v0, s[12:15], s29 offen lds
s_add_u32 s29, s29, 1024
s_mov_b32 m0, s28
s_add_u32 s28, s28, 1024
buffer_load_dwordx4 v0, s[12:15], s29 offen lds
s_add_u32 s29, s29, 1024
s_mov_b32 m0, s28
s_add_u32 s28, s28, 1024
buffer_load_dwordx4 v0, s[12:15], s29 offen lds
s_add_u32 s29, s29, 1024
ds_read_b64_tr_b16 v[124:125], v2 offset:0
ds_read_b64_tr_b16 v[126:127], v2 offset:4608
ds_read_b64_tr_b16 v[128:129], v2 offset:32
ds_read_b64_tr_b16 v[130:131], v2 offset:4640
ds_read_b64_tr_b16 v[132:133], v2 offset:64
ds_read_b64_tr_b16 v[134:135], v2 offset:4672
ds_read_b64_tr_b16 v[136:137], v2 offset:96
ds_read_b64_tr_b16 v[138:139], v2 offset:4704
ds_read_b64_tr_b16 v[140:141], v2 offset:128
ds_read_b64_tr_b16 v[142:143], v2 offset:4736
ds_read_b64_tr_b16 v[144:145], v2 offset:160
ds_read_b64_tr_b16 v[146:147], v2 offset:4768
ds_read_b64_tr_b16 v[148:149], v2 offset:192
ds_read_b64_tr_b16 v[150:151], v2 offset:4800
ds_read_b64_tr_b16 v[152:153], v2 offset:224
ds_read_b64_tr_b16 v[154:155], v2 offset:4832
ds_read_b64_tr_b16 v[156:157], v2 offset:256
ds_read_b64_tr_b16 v[158:159], v2 offset:4864
s_waitcnt lgkmcnt(15)
v_mfma_f32_16x16x32_bf16 v[88:91], v[124:127], v[52:55], v[88:91]
s_waitcnt lgkmcnt(14)
v_mfma_f32_16x16x32_bf16 v[92:95], v[128:131], v[52:55], v[92:95]
s_waitcnt lgkmcnt(12)
v_mfma_f32_16x16x32_bf16 v[96:99], v[132:135], v[52:55], v[96:99]
s_waitcnt lgkmcnt(10)
v_mfma_f32_16x16x32_bf16 v[100:103], v[136:139], v[52:55], v[100:103]
s_waitcnt lgkmcnt(8)
v_mfma_f32_16x16x32_bf16 v[104:107], v[140:143], v[52:55], v[104:107]
s_waitcnt lgkmcnt(6)
v_mfma_f32_16x16x32_bf16 v[108:111], v[144:147], v[52:55], v[108:111]
s_waitcnt lgkmcnt(4)
v_mfma_f32_16x16x32_bf16 v[112:115], v[148:151], v[52:55], v[112:115]
s_waitcnt lgkmcnt(2)
v_mfma_f32_16x16x32_bf16 v[116:119], v[152:155], v[52:55], v[116:119]
s_waitcnt lgkmcnt(0)
v_mfma_f32_16x16x32_bf16 v[120:123], v[156:159], v[52:55], v[120:123]
s_waitcnt vmcnt(9)
s_barrier
s_mul_i32 s28, s17, 9216
s_add_u32 s29, s28, 442368
s_add_u32 s28, s28, 0
s_mov_b32 m0, s28
s_add_u32 s28, s28, 1024
buffer_load_dwordx4 v0, s[12:15], s29 offen lds
s_add_u32 s29, s29, 1024
s_mov_b32 m0, s28
s_add_u32 s28, s28, 1024
buffer_load_dwordx4 v0, s[12:15], s29 offen lds
s_add_u32 s29, s29, 1024
s_mov_b32 m0, s28
s_add_u32 s28, s28, 1024
buffer_load_dwordx4 v0, s[12:15], s29 offen lds
s_add_u32 s29, s29, 1024
s_mov_b32 m0, s28
s_add_u32 s28, s28, 1024
buffer_load_dwordx4 v0, s[12:15], s29 offen lds
s_add_u32 s29, s29, 1024
s_mov_b32 m0, s28
s_add_u32 s28, s28, 1024
buffer_load_dwordx4 v0, s[12:15], s29 offen lds
s_add_u32 s29, s29, 1024
s_mov_b32 m0, s28
s_add_u32 s28, s28, 1024
buffer_load_dwordx4 v0, s[12:15], s29 offen lds
s_add_u32 s29, s29, 1024
s_mov_b32 m0, s28
s_add_u32 s28, s28, 1024
buffer_load_dwordx4 v0, s[12:15], s29 offen lds
s_add_u32 s29, s29, 1024
s_mov_b32 m0, s28
s_add_u32 s28, s28, 1024
buffer_load_dwordx4 v0, s[12:15], s29 offen lds
s_add_u32 s29, s29, 1024
s_mov_b32 m0, s28
s_add_u32 s28, s28, 1024
buffer_load_dwordx4 v0, s[12:15], s29 offen lds
s_add_u32 s29, s29, 1024
ds_read_b64_tr_b16 v[124:125], v3 offset:0
ds_read_b64_tr_b16 v[126:127], v3 offset:4608
ds_read_b64_tr_b16 v[128:129], v3 offset:32
ds_read_b64_tr_b16 v[130:131], v3 offset:4640
ds_read_b64_tr_b16 v[132:133], v3 offset:64
ds_read_b64_tr_b16 v[134:135], v3 offset:4672
ds_read_b64_tr_b16 v[136:137], v3 offset:96
ds_read_b64_tr_b16 v[138:139], v3 offset:4704
ds_read_b64_tr_b16 v[140:141], v3 offset:128
ds_read_b64_tr_b16 v[142:143], v3 offset:4736
ds_read_b64_tr_b16 v[144:145], v3 offset:160
ds_read_b64_tr_b16 v[146:147], v3 offset:4768
ds_read_b64_tr_b16 v[148:149], v3 offset:192
ds_read_b64_tr_b16 v[150:151], v3 offset:4800
ds_read_b64_tr_b16 v[152:153], v3 offset:224
ds_read_b64_tr_b16 v[154:155], v3 offset:4832
ds_read_b64_tr_b16 v[156:157], v3 offset:256
ds_read_b64_tr_b16 v[158:159], v3 offset:4864
s_waitcnt lgkmcnt(15)
v_mfma_f32_16x16x32_bf16 v[88:91], v[124:127], v[56:59], v[88:91]
s_waitcnt lgkmcnt(14)
v_mfma_f32_16x16x32_bf16 v[92:95], v[128:131], v[56:59], v[92:95]
s_waitcnt lgkmcnt(12)
v_mfma_f32_16x16x32_bf16 v[96:99], v[132:135], v[56:59], v[96:99]
s_waitcnt lgkmcnt(10)
v_mfma_f32_16x16x32_bf16 v[100:103], v[136:139], v[56:59], v[100:103]
s_waitcnt lgkmcnt(8)
v_mfma_f32_16x16x32_bf16 v[104:107], v[140:143], v[56:59], v[104:107]
s_waitcnt lgkmcnt(6)
v_mfma_f32_16x16x32_bf16 v[108:111], v[144:147], v[56:59], v[108:111]
s_waitcnt lgkmcnt(4)
v_mfma_f32_16x16x32_bf16 v[112:115], v[148:151], v[56:59], v[112:115]
s_waitcnt lgkmcnt(2)
v_mfma_f32_16x16x32_bf16 v[116:119], v[152:155], v[56:59], v[116:119]
s_waitcnt lgkmcnt(0)
v_mfma_f32_16x16x32_bf16 v[120:123], v[156:159], v[56:59], v[120:123]
s_waitcnt vmcnt(9)
s_barrier
s_mul_i32 s28, s17, 9216
s_add_u32 s29, s28, 479232
s_add_u32 s28, s28, 36864
s_mov_b32 m0, s28
s_add_u32 s28, s28, 1024
buffer_load_dwordx4 v0, s[12:15], s29 offen lds
s_add_u32 s29, s29, 1024
s_mov_b32 m0, s28
s_add_u32 s28, s28, 1024
buffer_load_dwordx4 v0, s[12:15], s29 offen lds
s_add_u32 s29, s29, 1024
s_mov_b32 m0, s28
s_add_u32 s28, s28, 1024
buffer_load_dwordx4 v0, s[12:15], s29 offen lds
s_add_u32 s29, s29, 1024
s_mov_b32 m0, s28
s_add_u32 s28, s28, 1024
buffer_load_dwordx4 v0, s[12:15], s29 offen lds
s_add_u32 s29, s29, 1024
s_mov_b32 m0, s28
s_add_u32 s28, s28, 1024
buffer_load_dwordx4 v0, s[12:15], s29 offen lds
s_add_u32 s29, s29, 1024
s_mov_b32 m0, s28
s_add_u32 s28, s28, 1024
buffer_load_dwordx4 v0, s[12:15], s29 offen lds
s_add_u32 s29, s29, 1024
s_mov_b32 m0, s28
s_add_u32 s28, s28, 1024
buffer_load_dwordx4 v0, s[12:15], s29 offen lds
s_add_u32 s29, s29, 1024
s_mov_b32 m0, s28
s_add_u32 s28, s28, 1024
buffer_load_dwordx4 v0, s[12:15], s29 offen lds
s_add_u32 s29, s29, 1024
s_mov_b32 m0, s28
s_add_u32 s28, s28, 1024
buffer_load_dwordx4 v0, s[12:15], s29 offen lds
s_add_u32 s29, s29, 1024
ds_read_b64_tr_b16 v[124:125], v4 offset:0
ds_read_b64_tr_b16 v[126:127], v4 offset:4608
ds_read_b64_tr_b16 v[128:129], v4 offset:32
ds_read_b64_tr_b16 v[130:131], v4 offset:4640
ds_read_b64_tr_b16 v[132:133], v4 offset:64
ds_read_b64_tr_b16 v[134:135], v4 offset:4672
ds_read_b64_tr_b16 v[136:137], v4 offset:96
ds_read_b64_tr_b16 v[138:139], v4 offset:4704
ds_read_b64_tr_b16 v[140:141], v4 offset:128
ds_read_b64_tr_b16 v[142:143], v4 offset:4736
ds_read_b64_tr_b16 v[144:145], v4 offset:160
ds_read_b64_tr_b16 v[146:147], v4 offset:4768
ds_read_b64_tr_b16 v[148:149], v4 offset:192
ds_read_b64_tr_b16 v[150:151], v4 offset:4800
ds_read_b64_tr_b16 v[152:153], v4 offset:224
ds_read_b64_tr_b16 v[154:155], v4 offset:4832
ds_read_b64_tr_b16 v[156:157], v4 offset:256
ds_read_b64_tr_b16 v[158:159], v4 offset:4864
s_waitcnt lgkmcnt(15)
v_mfma_f32_16x16x32_bf16 v[88:91], v[124:127], v[60:63], v[88:91]
s_waitcnt lgkmcnt(14)
v_mfma_f32_16x16x32_bf16 v[92:95], v[128:131], v[60:63], v[92:95]
s_waitcnt lgkmcnt(12)
v_mfma_f32_16x16x32_bf16 v[96:99], v[132:135], v[60:63], v[96:99]
s_waitcnt lgkmcnt(10)
v_mfma_f32_16x16x32_bf16 v[100:103], v[136:139], v[60:63], v[100:103]
s_waitcnt lgkmcnt(8)
v_mfma_f32_16x16x32_bf16 v[104:107], v[140:143], v[60:63], v[104:107]
s_waitcnt lgkmcnt(6)
v_mfma_f32_16x16x32_bf16 v[108:111], v[144:147], v[60:63], v[108:111]
s_waitcnt lgkmcnt(4)
v_mfma_f32_16x16x32_bf16 v[112:115], v[148:151], v[60:63], v[112:115]
s_waitcnt lgkmcnt(2)
v_mfma_f32_16x16x32_bf16 v[116:119], v[152:155], v[60:63], v[116:119]
s_waitcnt lgkmcnt(0)
v_mfma_f32_16x16x32_bf16 v[120:123], v[156:159], v[60:63], v[120:123]
s_waitcnt vmcnt(9)
s_barrier
s_mul_i32 s28, s17, 9216
s_add_u32 s29, s28, 516096
s_add_u32 s28, s28, 73728
s_mov_b32 m0, s28
s_add_u32 s28, s28, 1024
buffer_load_dwordx4 v0, s[12:15], s29 offen lds
s_add_u32 s29, s29, 1024
s_mov_b32 m0, s28
s_add_u32 s28, s28, 1024
buffer_load_dwordx4 v0, s[12:15], s29 offen lds
s_add_u32 s29, s29, 1024
s_mov_b32 m0, s28
s_add_u32 s28, s28, 1024
buffer_load_dwordx4 v0, s[12:15], s29 offen lds
s_add_u32 s29, s29, 1024
s_mov_b32 m0, s28
s_add_u32 s28, s28, 1024
buffer_load_dwordx4 v0, s[12:15], s29 offen lds
s_add_u32 s29, s29, 1024
s_mov_b32 m0, s28
s_add_u32 s28, s28, 1024
buffer_load_dwordx4 v0, s[12:15], s29 offen lds
s_add_u32 s29, s29, 1024
s_mov_b32 m0, s28
s_add_u32 s28, s28, 1024
buffer_load_dwordx4 v0, s[12:15], s29 offen lds
s_add_u32 s29, s29, 1024
s_mov_b32 m0, s28
s_add_u32 s28, s28, 1024
buffer_load_dwordx4 v0, s[12:15], s29 offen lds
s_add_u32 s29, s29, 1024
s_mov_b32 m0, s28
s_add_u32 s28, s28, 1024
buffer_load_dwordx4 v0, s[12:15], s29 offen lds
s_add_u32 s29, s29, 1024
s_mov_b32 m0, s28
s_add_u32 s28, s28, 1024
buffer_load_dwordx4 v0, s[12:15], s29 offen lds
s_add_u32 s29, s29, 1024
ds_read_b64_tr_b16 v[124:125], v2 offset:0
ds_read_b64_tr_b16 v[126:127], v2 offset:4608
ds_read_b64_tr_b16 v[128:129], v2 offset:32
ds_read_b64_tr_b16 v[130:131], v2 offset:4640
ds_read_b64_tr_b16 v[132:133], v2 offset:64
ds_read_b64_tr_b16 v[134:135], v2 offset:4672
ds_read_b64_tr_b16 v[136:137], v2 offset:96
ds_read_b64_tr_b16 v[138:139], v2 offset:4704
ds_read_b64_tr_b16 v[140:141], v2 offset:128
ds_read_b64_tr_b16 v[142:143], v2 offset:4736
ds_read_b64_tr_b16 v[144:145], v2 offset:160
ds_read_b64_tr_b16 v[146:147], v2 offset:4768
ds_read_b64_tr_b16 v[148:149], v2 offset:192
ds_read_b64_tr_b16 v[150:151], v2 offset:4800
ds_read_b64_tr_b16 v[152:153], v2 offset:224
ds_read_b64_tr_b16 v[154:155], v2 offset:4832
ds_read_b64_tr_b16 v[156:157], v2 offset:256
ds_read_b64_tr_b16 v[158:159], v2 offset:4864
s_waitcnt lgkmcnt(15)
v_mfma_f32_16x16x32_bf16 v[88:91], v[124:127], v[64:67], v[88:91]
s_waitcnt lgkmcnt(14)
v_mfma_f32_16x16x32_bf16 v[92:95], v[128:131], v[64:67], v[92:95]
s_waitcnt lgkmcnt(12)
v_mfma_f32_16x16x32_bf16 v[96:99], v[132:135], v[64:67], v[96:99]
s_waitcnt lgkmcnt(10)
v_mfma_f32_16x16x32_bf16 v[100:103], v[136:139], v[64:67], v[100:103]
s_waitcnt lgkmcnt(8)
v_mfma_f32_16x16x32_bf16 v[104:107], v[140:143], v[64:67], v[104:107]
s_waitcnt lgkmcnt(6)
v_mfma_f32_16x16x32_bf16 v[108:111], v[144:147], v[64:67], v[108:111]
s_waitcnt lgkmcnt(4)
v_mfma_f32_16x16x32_bf16 v[112:115], v[148:151], v[64:67], v[112:115]
s_waitcnt lgkmcnt(2)
v_mfma_f32_16x16x32_bf16 v[116:119], v[152:155], v[64:67], v[116:119]
s_waitcnt lgkmcnt(0)
v_mfma_f32_16x16x32_bf16 v[120:123], v[156:159], v[64:67], v[120:123]
s_waitcnt vmcnt(9)
s_barrier
s_mul_i32 s28, s17, 9216
s_add_u32 s29, s28, 552960
s_add_u32 s28, s28, 0
s_mov_b32 m0, s28
s_add_u32 s28, s28, 1024
buffer_load_dwordx4 v0, s[12:15], s29 offen lds
s_add_u32 s29, s29, 1024
s_mov_b32 m0, s28
s_add_u32 s28, s28, 1024
buffer_load_dwordx4 v0, s[12:15], s29 offen lds
s_add_u32 s29, s29, 1024
s_mov_b32 m0, s28
s_add_u32 s28, s28, 1024
buffer_load_dwordx4 v0, s[12:15], s29 offen lds
s_add_u32 s29, s29, 1024
s_mov_b32 m0, s28
s_add_u32 s28, s28, 1024
buffer_load_dwordx4 v0, s[12:15], s29 offen lds
s_add_u32 s29, s29, 1024
s_mov_b32 m0, s28
s_add_u32 s28, s28, 1024
buffer_load_dwordx4 v0, s[12:15], s29 offen lds
s_add_u32 s29, s29, 1024
s_mov_b32 m0, s28
s_add_u32 s28, s28, 1024
buffer_load_dwordx4 v0, s[12:15], s29 offen lds
s_add_u32 s29, s29, 1024
s_mov_b32 m0, s28
s_add_u32 s28, s28, 1024
buffer_load_dwordx4 v0, s[12:15], s29 offen lds
s_add_u32 s29, s29, 1024
s_mov_b32 m0, s28
s_add_u32 s28, s28, 1024
buffer_load_dwordx4 v0, s[12:15], s29 offen lds
s_add_u32 s29, s29, 1024
s_mov_b32 m0, s28
s_add_u32 s28, s28, 1024
buffer_load_dwordx4 v0, s[12:15], s29 offen lds
s_add_u32 s29, s29, 1024
ds_read_b64_tr_b16 v[124:125], v3 offset:0
ds_read_b64_tr_b16 v[126:127], v3 offset:4608
ds_read_b64_tr_b16 v[128:129], v3 offset:32
ds_read_b64_tr_b16 v[130:131], v3 offset:4640
ds_read_b64_tr_b16 v[132:133], v3 offset:64
ds_read_b64_tr_b16 v[134:135], v3 offset:4672
ds_read_b64_tr_b16 v[136:137], v3 offset:96
ds_read_b64_tr_b16 v[138:139], v3 offset:4704
ds_read_b64_tr_b16 v[140:141], v3 offset:128
ds_read_b64_tr_b16 v[142:143], v3 offset:4736
ds_read_b64_tr_b16 v[144:145], v3 offset:160
ds_read_b64_tr_b16 v[146:147], v3 offset:4768
ds_read_b64_tr_b16 v[148:149], v3 offset:192
ds_read_b64_tr_b16 v[150:151], v3 offset:4800
ds_read_b64_tr_b16 v[152:153], v3 offset:224
ds_read_b64_tr_b16 v[154:155], v3 offset:4832
ds_read_b64_tr_b16 v[156:157], v3 offset:256
ds_read_b64_tr_b16 v[158:159], v3 offset:4864
s_waitcnt lgkmcnt(15)
v_mfma_f32_16x16x32_bf16 v[88:91], v[124:127], v[68:71], v[88:91]
s_waitcnt lgkmcnt(14)
v_mfma_f32_16x16x32_bf16 v[92:95], v[128:131], v[68:71], v[92:95]
s_waitcnt lgkmcnt(12)
v_mfma_f32_16x16x32_bf16 v[96:99], v[132:135], v[68:71], v[96:99]
s_waitcnt lgkmcnt(10)
v_mfma_f32_16x16x32_bf16 v[100:103], v[136:139], v[68:71], v[100:103]
s_waitcnt lgkmcnt(8)
v_mfma_f32_16x16x32_bf16 v[104:107], v[140:143], v[68:71], v[104:107]
s_waitcnt lgkmcnt(6)
v_mfma_f32_16x16x32_bf16 v[108:111], v[144:147], v[68:71], v[108:111]
s_waitcnt lgkmcnt(4)
v_mfma_f32_16x16x32_bf16 v[112:115], v[148:151], v[68:71], v[112:115]
s_waitcnt lgkmcnt(2)
v_mfma_f32_16x16x32_bf16 v[116:119], v[152:155], v[68:71], v[116:119]
s_waitcnt lgkmcnt(0)
v_mfma_f32_16x16x32_bf16 v[120:123], v[156:159], v[68:71], v[120:123]
s_waitcnt vmcnt(9)
s_barrier
s_mul_i32 s28, s17, 9216
s_add_u32 s29, s28, 589824
s_add_u32 s28, s28, 36864
s_mov_b32 m0, s28
s_add_u32 s28, s28, 1024
buffer_load_dwordx4 v0, s[12:15], s29 offen lds
s_add_u32 s29, s29, 1024
s_mov_b32 m0, s28
s_add_u32 s28, s28, 1024
buffer_load_dwordx4 v0, s[12:15], s29 offen lds
s_add_u32 s29, s29, 1024
s_mov_b32 m0, s28
s_add_u32 s28, s28, 1024
buffer_load_dwordx4 v0, s[12:15], s29 offen lds
s_add_u32 s29, s29, 1024
s_mov_b32 m0, s28
s_add_u32 s28, s28, 1024
buffer_load_dwordx4 v0, s[12:15], s29 offen lds
s_add_u32 s29, s29, 1024
s_mov_b32 m0, s28
s_add_u32 s28, s28, 1024
buffer_load_dwordx4 v0, s[12:15], s29 offen lds
s_add_u32 s29, s29, 1024
s_mov_b32 m0, s28
s_add_u32 s28, s28, 1024
buffer_load_dwordx4 v0, s[12:15], s29 offen lds
s_add_u32 s29, s29, 1024
s_mov_b32 m0, s28
s_add_u32 s28, s28, 1024
buffer_load_dwordx4 v0, s[12:15], s29 offen lds
s_add_u32 s29, s29, 1024
s_mov_b32 m0, s28
s_add_u32 s28, s28, 1024
buffer_load_dwordx4 v0, s[12:15], s29 offen lds
s_add_u32 s29, s29, 1024
s_mov_b32 m0, s28
s_add_u32 s28, s28, 1024
buffer_load_dwordx4 v0, s[12:15], s29 offen lds
s_add_u32 s29, s29, 1024
ds_read_b64_tr_b16 v[124:125], v4 offset:0
ds_read_b64_tr_b16 v[126:127], v4 offset:4608
ds_read_b64_tr_b16 v[128:129], v4 offset:32
ds_read_b64_tr_b16 v[130:131], v4 offset:4640
ds_read_b64_tr_b16 v[132:133], v4 offset:64
ds_read_b64_tr_b16 v[134:135], v4 offset:4672
ds_read_b64_tr_b16 v[136:137], v4 offset:96
ds_read_b64_tr_b16 v[138:139], v4 offset:4704
ds_read_b64_tr_b16 v[140:141], v4 offset:128
ds_read_b64_tr_b16 v[142:143], v4 offset:4736
ds_read_b64_tr_b16 v[144:145], v4 offset:160
ds_read_b64_tr_b16 v[146:147], v4 offset:4768
ds_read_b64_tr_b16 v[148:149], v4 offset:192
ds_read_b64_tr_b16 v[150:151], v4 offset:4800
ds_read_b64_tr_b16 v[152:153], v4 offset:224
ds_read_b64_tr_b16 v[154:155], v4 offset:4832
ds_read_b64_tr_b16 v[156:157], v4 offset:256
ds_read_b64_tr_b16 v[158:159], v4 offset:4864
s_waitcnt lgkmcnt(15)
v_mfma_f32_16x16x32_bf16 v[88:91], v[124:127], v[72:75], v[88:91]
s_waitcnt lgkmcnt(14)
v_mfma_f32_16x16x32_bf16 v[92:95], v[128:131], v[72:75], v[92:95]
s_waitcnt lgkmcnt(12)
v_mfma_f32_16x16x32_bf16 v[96:99], v[132:135], v[72:75], v[96:99]
s_waitcnt lgkmcnt(10)
v_mfma_f32_16x16x32_bf16 v[100:103], v[136:139], v[72:75], v[100:103]
s_waitcnt lgkmcnt(8)
v_mfma_f32_16x16x32_bf16 v[104:107], v[140:143], v[72:75], v[104:107]
s_waitcnt lgkmcnt(6)
v_mfma_f32_16x16x32_bf16 v[108:111], v[144:147], v[72:75], v[108:111]
s_waitcnt lgkmcnt(4)
v_mfma_f32_16x16x32_bf16 v[112:115], v[148:151], v[72:75], v[112:115]
s_waitcnt lgkmcnt(2)
v_mfma_f32_16x16x32_bf16 v[116:119], v[152:155], v[72:75], v[116:119]
s_waitcnt lgkmcnt(0)
v_mfma_f32_16x16x32_bf16 v[120:123], v[156:159], v[72:75], v[120:123]
s_waitcnt vmcnt(9)
s_barrier
s_mul_i32 s28, s17, 9216
s_add_u32 s29, s28, 626688
s_add_u32 s28, s28, 73728
s_mov_b32 m0, s28
s_add_u32 s28, s28, 1024
buffer_load_dwordx4 v0, s[12:15], s29 offen lds
s_add_u32 s29, s29, 1024
s_mov_b32 m0, s28
s_add_u32 s28, s28, 1024
buffer_load_dwordx4 v0, s[12:15], s29 offen lds
s_add_u32 s29, s29, 1024
s_mov_b32 m0, s28
s_add_u32 s28, s28, 1024
buffer_load_dwordx4 v0, s[12:15], s29 offen lds
s_add_u32 s29, s29, 1024
s_mov_b32 m0, s28
s_add_u32 s28, s28, 1024
buffer_load_dwordx4 v0, s[12:15], s29 offen lds
s_add_u32 s29, s29, 1024
s_mov_b32 m0, s28
s_add_u32 s28, s28, 1024
buffer_load_dwordx4 v0, s[12:15], s29 offen lds
s_add_u32 s29, s29, 1024
s_mov_b32 m0, s28
s_add_u32 s28, s28, 1024
buffer_load_dwordx4 v0, s[12:15], s29 offen lds
s_add_u32 s29, s29, 1024
s_mov_b32 m0, s28
s_add_u32 s28, s28, 1024
buffer_load_dwordx4 v0, s[12:15], s29 offen lds
s_add_u32 s29, s29, 1024
s_mov_b32 m0, s28
s_add_u32 s28, s28, 1024
buffer_load_dwordx4 v0, s[12:15], s29 offen lds
s_add_u32 s29, s29, 1024
s_mov_b32 m0, s28
s_add_u32 s28, s28, 1024
buffer_load_dwordx4 v0, s[12:15], s29 offen lds
s_add_u32 s29, s29, 1024
ds_read_b64_tr_b16 v[124:125], v2 offset:0
ds_read_b64_tr_b16 v[126:127], v2 offset:4608
ds_read_b64_tr_b16 v[128:129], v2 offset:32
ds_read_b64_tr_b16 v[130:131], v2 offset:4640
ds_read_b64_tr_b16 v[132:133], v2 offset:64
ds_read_b64_tr_b16 v[134:135], v2 offset:4672
ds_read_b64_tr_b16 v[136:137], v2 offset:96
ds_read_b64_tr_b16 v[138:139], v2 offset:4704
ds_read_b64_tr_b16 v[140:141], v2 offset:128
ds_read_b64_tr_b16 v[142:143], v2 offset:4736
ds_read_b64_tr_b16 v[144:145], v2 offset:160
ds_read_b64_tr_b16 v[146:147], v2 offset:4768
ds_read_b64_tr_b16 v[148:149], v2 offset:192
ds_read_b64_tr_b16 v[150:151], v2 offset:4800
ds_read_b64_tr_b16 v[152:153], v2 offset:224
ds_read_b64_tr_b16 v[154:155], v2 offset:4832
ds_read_b64_tr_b16 v[156:157], v2 offset:256
ds_read_b64_tr_b16 v[158:159], v2 offset:4864
s_waitcnt lgkmcnt(15)
v_mfma_f32_16x16x32_bf16 v[88:91], v[124:127], v[76:79], v[88:91]
s_waitcnt lgkmcnt(14)
v_mfma_f32_16x16x32_bf16 v[92:95], v[128:131], v[76:79], v[92:95]
s_waitcnt lgkmcnt(12)
v_mfma_f32_16x16x32_bf16 v[96:99], v[132:135], v[76:79], v[96:99]
s_waitcnt lgkmcnt(10)
v_mfma_f32_16x16x32_bf16 v[100:103], v[136:139], v[76:79], v[100:103]
s_waitcnt lgkmcnt(8)
v_mfma_f32_16x16x32_bf16 v[104:107], v[140:143], v[76:79], v[104:107]
s_waitcnt lgkmcnt(6)
v_mfma_f32_16x16x32_bf16 v[108:111], v[144:147], v[76:79], v[108:111]
s_waitcnt lgkmcnt(4)
v_mfma_f32_16x16x32_bf16 v[112:115], v[148:151], v[76:79], v[112:115]
s_waitcnt lgkmcnt(2)
v_mfma_f32_16x16x32_bf16 v[116:119], v[152:155], v[76:79], v[116:119]
s_waitcnt lgkmcnt(0)
v_mfma_f32_16x16x32_bf16 v[120:123], v[156:159], v[76:79], v[120:123]
s_waitcnt vmcnt(9)
s_barrier
ds_read_b64_tr_b16 v[124:125], v3 offset:0
ds_read_b64_tr_b16 v[126:127], v3 offset:4608
ds_read_b64_tr_b16 v[128:129], v3 offset:32
ds_read_b64_tr_b16 v[130:131], v3 offset:4640
ds_read_b64_tr_b16 v[132:133], v3 offset:64
ds_read_b64_tr_b16 v[134:135], v3 offset:4672
ds_read_b64_tr_b16 v[136:137], v3 offset:96
ds_read_b64_tr_b16 v[138:139], v3 offset:4704
ds_read_b64_tr_b16 v[140:141], v3 offset:128
ds_read_b64_tr_b16 v[142:143], v3 offset:4736
ds_read_b64_tr_b16 v[144:145], v3 offset:160
ds_read_b64_tr_b16 v[146:147], v3 offset:4768
ds_read_b64_tr_b16 v[148:149], v3 offset:192
ds_read_b64_tr_b16 v[150:151], v3 offset:4800
ds_read_b64_tr_b16 v[152:153], v3 offset:224
ds_read_b64_tr_b16 v[154:155], v3 offset:4832
ds_read_b64_tr_b16 v[156:157], v3 offset:256
ds_read_b64_tr_b16 v[158:159], v3 offset:4864
s_waitcnt lgkmcnt(15)
v_mfma_f32_16x16x32_bf16 v[88:91], v[124:127], v[80:83], v[88:91]
s_waitcnt lgkmcnt(14)
v_mfma_f32_16x16x32_bf16 v[92:95], v[128:131], v[80:83], v[92:95]
s_waitcnt lgkmcnt(12)
v_mfma_f32_16x16x32_bf16 v[96:99], v[132:135], v[80:83], v[96:99]
s_waitcnt lgkmcnt(10)
v_mfma_f32_16x16x32_bf16 v[100:103], v[136:139], v[80:83], v[100:103]
s_waitcnt lgkmcnt(8)
v_mfma_f32_16x16x32_bf16 v[104:107], v[140:143], v[80:83], v[104:107]
s_waitcnt lgkmcnt(6)
v_mfma_f32_16x16x32_bf16 v[108:111], v[144:147], v[80:83], v[108:111]
s_waitcnt lgkmcnt(4)
v_mfma_f32_16x16x32_bf16 v[112:115], v[148:151], v[80:83], v[112:115]
s_waitcnt lgkmcnt(2)
v_mfma_f32_16x16x32_bf16 v[116:119], v[152:155], v[80:83], v[116:119]
s_waitcnt lgkmcnt(0)
v_mfma_f32_16x16x32_bf16 v[120:123], v[156:159], v[80:83], v[120:123]
s_waitcnt vmcnt(0)
s_barrier
ds_read_b64_tr_b16 v[124:125], v4 offset:0
ds_read_b64_tr_b16 v[126:127], v4 offset:4608
ds_read_b64_tr_b16 v[128:129], v4 offset:32
ds_read_b64_tr_b16 v[130:131], v4 offset:4640
ds_read_b64_tr_b16 v[132:133], v4 offset:64
ds_read_b64_tr_b16 v[134:135], v4 offset:4672
ds_read_b64_tr_b16 v[136:137], v4 offset:96
ds_read_b64_tr_b16 v[138:139], v4 offset:4704
ds_read_b64_tr_b16 v[140:141], v4 offset:128
ds_read_b64_tr_b16 v[142:143], v4 offset:4736
ds_read_b64_tr_b16 v[144:145], v4 offset:160
ds_read_b64_tr_b16 v[146:147], v4 offset:4768
ds_read_b64_tr_b16 v[148:149], v4 offset:192
ds_read_b64_tr_b16 v[150:151], v4 offset:4800
ds_read_b64_tr_b16 v[152:153], v4 offset:224
ds_read_b64_tr_b16 v[154:155], v4 offset:4832
ds_read_b64_tr_b16 v[156:157], v4 offset:256
ds_read_b64_tr_b16 v[158:159], v4 offset:4864
s_waitcnt lgkmcnt(15)
v_mfma_f32_16x16x32_bf16 v[88:91], v[124:127], v[84:87], v[88:91]
s_waitcnt lgkmcnt(14)
v_mfma_f32_16x16x32_bf16 v[92:95], v[128:131], v[84:87], v[92:95]
s_waitcnt lgkmcnt(12)
v_mfma_f32_16x16x32_bf16 v[96:99], v[132:135], v[84:87], v[96:99]
s_waitcnt lgkmcnt(10)
v_mfma_f32_16x16x32_bf16 v[100:103], v[136:139], v[84:87], v[100:103]
s_waitcnt lgkmcnt(8)
v_mfma_f32_16x16x32_bf16 v[104:107], v[140:143], v[84:87], v[104:107]
s_waitcnt lgkmcnt(6)
v_mfma_f32_16x16x32_bf16 v[108:111], v[144:147], v[84:87], v[108:111]
s_waitcnt lgkmcnt(4)
v_mfma_f32_16x16x32_bf16 v[112:115], v[148:151], v[84:87], v[112:115]
s_waitcnt lgkmcnt(2)
v_mfma_f32_16x16x32_bf16 v[116:119], v[152:155], v[84:87], v[116:119]
s_waitcnt lgkmcnt(0)
v_mfma_f32_16x16x32_bf16 v[120:123], v[156:159], v[84:87], v[120:123]
s_nop 7
s_load_dwordx2 s[4:5], s[0:1], 96
s_waitcnt lgkmcnt(0)
s_mov_b32 s20, s4
s_mov_b32 s21, s5
s_mov_b32 s22, 4718592
s_mov_b32 s23, 0x00020000
v_bfe_u32 v5, v0, 4, 4
v_mul_u32_u24 v5, 2304, v5
v_lshrrev_b32 v6, 8, v0
v_lshl_add_u32 v5, v6, 3, v5
s_mul_i32 s28, s24, 36864
s_mul_i32 s29, s17, 288
s_add_u32 s28, s28, s29
s_add_u32 s28, s28, 1152
v_cvt_pk_bf16_f32 v88, v88, v89
v_cvt_pk_bf16_f32 v89, v90, v91
buffer_store_dwordx2 v[88:89], v5, s[20:23], s28 offen offset:0
v_cvt_pk_bf16_f32 v92, v92, v93
v_cvt_pk_bf16_f32 v93, v94, v95
buffer_store_dwordx2 v[92:93], v5, s[20:23], s28 offen offset:32
v_cvt_pk_bf16_f32 v96, v96, v97
v_cvt_pk_bf16_f32 v97, v98, v99
buffer_store_dwordx2 v[96:97], v5, s[20:23], s28 offen offset:64
v_cvt_pk_bf16_f32 v100, v100, v101
v_cvt_pk_bf16_f32 v101, v102, v103
buffer_store_dwordx2 v[100:101], v5, s[20:23], s28 offen offset:96
v_cvt_pk_bf16_f32 v104, v104, v105
v_cvt_pk_bf16_f32 v105, v106, v107
buffer_store_dwordx2 v[104:105], v5, s[20:23], s28 offen offset:128
v_cvt_pk_bf16_f32 v108, v108, v109
v_cvt_pk_bf16_f32 v109, v110, v111
buffer_store_dwordx2 v[108:109], v5, s[20:23], s28 offen offset:160
v_cvt_pk_bf16_f32 v112, v112, v113
v_cvt_pk_bf16_f32 v113, v114, v115
buffer_store_dwordx2 v[112:113], v5, s[20:23], s28 offen offset:192
v_cvt_pk_bf16_f32 v116, v116, v117
v_cvt_pk_bf16_f32 v117, v118, v119
buffer_store_dwordx2 v[116:117], v5, s[20:23], s28 offen offset:224
v_cvt_pk_bf16_f32 v120, v120, v121
v_cvt_pk_bf16_f32 v121, v122, v123
buffer_store_dwordx2 v[120:121], v5, s[20:23], s28 offen offset:256
s_branch BE_43
BS_46:
s_mov_b32 s44, 0
BM_49:
s_lshl_b32 s28, s42, 2
s_add_u32 s28, s28, s44
s_lshl_b32 s43, s28, 11
v_add_u32 v12, s43, v8
ds_read2_b64 v[72:75], v12 offset0:0 offset1:2
ds_read2_b64 v[76:79], v12 offset0:4 offset1:6
s_waitcnt lgkmcnt(0)
v_mov_b32 v13, 0xff800000
v_mfma_f32_32x32x16_bf16 v[16:31], a[0:3], v[72:75], 0
v_mfma_f32_32x32x16_bf16 v[16:31], a[4:7], v[76:79], v[16:31]
s_nop 15
v_max3_f32 v13, v16, v17, v13
v_max3_f32 v13, v18, v19, v13
v_max3_f32 v13, v20, v21, v13
v_max3_f32 v13, v22, v23, v13
v_max3_f32 v13, v24, v25, v13
v_max3_f32 v13, v26, v27, v13
v_max3_f32 v13, v28, v29, v13
v_max3_f32 v13, v30, v31, v13
v_mfma_f32_32x32x16_bf16 v[16:31], a[16:19], v[72:75], 0
v_mfma_f32_32x32x16_bf16 v[16:31], a[20:23], v[76:79], v[16:31]
s_nop 15
v_max3_f32 v13, v16, v17, v13
v_max3_f32 v13, v18, v19, v13
v_max3_f32 v13, v20, v21, v13
v_max3_f32 v13, v22, v23, v13
v_max3_f32 v13, v24, v25, v13
v_max3_f32 v13, v26, v27, v13
v_max3_f32 v13, v28, v29, v13
v_max3_f32 v13, v30, v31, v13
v_mfma_f32_32x32x16_bf16 v[16:31], a[32:35], v[72:75], 0
v_mfma_f32_32x32x16_bf16 v[16:31], a[36:39], v[76:79], v[16:31]
s_nop 15
v_max3_f32 v13, v16, v17, v13
v_max3_f32 v13, v18, v19, v13
v_max3_f32 v13, v20, v21, v13
v_max3_f32 v13, v22, v23, v13
v_max3_f32 v13, v24, v25, v13
v_max3_f32 v13, v26, v27, v13
v_max3_f32 v13, v28, v29, v13
v_max3_f32 v13, v30, v31, v13
v_mfma_f32_32x32x16_bf16 v[16:31], a[48:51], v[72:75], 0
v_mfma_f32_32x32x16_bf16 v[16:31], a[52:55], v[76:79], v[16:31]
s_nop 15
v_max3_f32 v13, v16, v17, v13
v_max3_f32 v13, v18, v19, v13
v_max3_f32 v13, v20, v21, v13
v_max3_f32 v13, v22, v23, v13
v_max3_f32 v13, v24, v25, v13
v_max3_f32 v13, v26, v27, v13
v_max3_f32 v13, v28, v29, v13
v_max3_f32 v13, v30, v31, v13
v_mfma_f32_32x32x16_bf16 v[16:31], a[64:67], v[72:75], 0
v_mfma_f32_32x32x16_bf16 v[16:31], a[68:71], v[76:79], v[16:31]
s_nop 15
v_max3_f32 v13, v16, v17, v13
v_max3_f32 v13, v18, v19, v13
v_max3_f32 v13, v20, v21, v13
v_max3_f32 v13, v22, v23, v13
v_max3_f32 v13, v24, v25, v13
v_max3_f32 v13, v26, v27, v13
v_max3_f32 v13, v28, v29, v13
v_max3_f32 v13, v30, v31, v13
v_mfma_f32_32x32x16_bf16 v[16:31], a[80:83], v[72:75], 0
v_mfma_f32_32x32x16_bf16 v[16:31], a[84:87], v[76:79], v[16:31]
s_nop 15
v_max3_f32 v13, v16, v17, v13
v_max3_f32 v13, v18, v19, v13
v_max3_f32 v13, v20, v21, v13
v_max3_f32 v13, v22, v23, v13
v_max3_f32 v13, v24, v25, v13
v_max3_f32 v13, v26, v27, v13
v_max3_f32 v13, v28, v29, v13
v_max3_f32 v13, v30, v31, v13
v_mfma_f32_32x32x16_bf16 v[16:31], a[96:99], v[72:75], 0
v_mfma_f32_32x32x16_bf16 v[16:31], a[100:103], v[76:79], v[16:31]
s_nop 15
v_max3_f32 v13, v16, v17, v13
v_max3_f32 v13, v18, v19, v13
v_max3_f32 v13, v20, v21, v13
v_max3_f32 v13, v22, v23, v13
v_max3_f32 v13, v24, v25, v13
v_max3_f32 v13, v26, v27, v13
v_max3_f32 v13, v28, v29, v13
v_max3_f32 v13, v30, v31, v13
v_mfma_f32_32x32x16_bf16 v[16:31], a[112:115], v[72:75], 0
v_mfma_f32_32x32x16_bf16 v[16:31], a[116:119], v[76:79], v[16:31]
s_nop 15
v_max3_f32 v13, v16, v17, v13
v_max3_f32 v13, v18, v19, v13
v_max3_f32 v13, v20, v21, v13
v_max3_f32 v13, v22, v23, v13
v_max3_f32 v13, v24, v25, v13
v_max3_f32 v13, v26, v27, v13
v_max3_f32 v13, v28, v29, v13
v_max3_f32 v13, v30, v31, v13
v_mfma_f32_32x32x16_bf16 v[16:31], a[128:131], v[72:75], 0
v_mfma_f32_32x32x16_bf16 v[16:31], a[132:135], v[76:79], v[16:31]
s_nop 15
v_max3_f32 v13, v16, v17, v13
v_max3_f32 v13, v18, v19, v13
v_max3_f32 v13, v20, v21, v13
v_max3_f32 v13, v22, v23, v13
v_max3_f32 v13, v24, v25, v13
v_max3_f32 v13, v26, v27, v13
v_max3_f32 v13, v28, v29, v13
v_max3_f32 v13, v30, v31, v13
v_mfma_f32_32x32x16_bf16 v[16:31], a[144:147], v[72:75], 0
v_mfma_f32_32x32x16_bf16 v[16:31], a[148:151], v[76:79], v[16:31]
s_nop 15
v_max3_f32 v13, v16, v17, v13
v_max3_f32 v13, v18, v19, v13
v_max3_f32 v13, v20, v21, v13
v_max3_f32 v13, v22, v23, v13
v_max3_f32 v13, v24, v25, v13
v_max3_f32 v13, v26, v27, v13
v_max3_f32 v13, v28, v29, v13
v_max3_f32 v13, v30, v31, v13
v_mfma_f32_32x32x16_bf16 v[16:31], a[160:163], v[72:75], 0
v_mfma_f32_32x32x16_bf16 v[16:31], a[164:167], v[76:79], v[16:31]
s_nop 15
v_max3_f32 v13, v16, v17, v13
v_max3_f32 v13, v18, v19, v13
v_max3_f32 v13, v20, v21, v13
v_max3_f32 v13, v22, v23, v13
v_max3_f32 v13, v24, v25, v13
v_max3_f32 v13, v26, v27, v13
v_max3_f32 v13, v28, v29, v13
v_max3_f32 v13, v30, v31, v13
v_mfma_f32_32x32x16_bf16 v[16:31], a[176:179], v[72:75], 0
v_mfma_f32_32x32x16_bf16 v[16:31], a[180:183], v[76:79], v[16:31]
s_nop 15
v_max3_f32 v13, v16, v17, v13
v_max3_f32 v13, v18, v19, v13
v_max3_f32 v13, v20, v21, v13
v_max3_f32 v13, v22, v23, v13
v_max3_f32 v13, v24, v25, v13
v_max3_f32 v13, v26, v27, v13
v_max3_f32 v13, v28, v29, v13
v_max3_f32 v13, v30, v31, v13
v_mfma_f32_32x32x16_bf16 v[16:31], a[192:195], v[72:75], 0
v_mfma_f32_32x32x16_bf16 v[16:31], a[196:199], v[76:79], v[16:31]
s_nop 15
v_max3_f32 v13, v16, v17, v13
v_max3_f32 v13, v18, v19, v13
v_max3_f32 v13, v20, v21, v13
v_max3_f32 v13, v22, v23, v13
v_max3_f32 v13, v24, v25, v13
v_max3_f32 v13, v26, v27, v13
v_max3_f32 v13, v28, v29, v13
v_max3_f32 v13, v30, v31, v13
v_mfma_f32_32x32x16_bf16 v[16:31], a[208:211], v[72:75], 0
v_mfma_f32_32x32x16_bf16 v[16:31], a[212:215], v[76:79], v[16:31]
s_nop 15
v_max3_f32 v13, v16, v17, v13
v_max3_f32 v13, v18, v19, v13
v_max3_f32 v13, v20, v21, v13
v_max3_f32 v13, v22, v23, v13
v_max3_f32 v13, v24, v25, v13
v_max3_f32 v13, v26, v27, v13
v_max3_f32 v13, v28, v29, v13
v_max3_f32 v13, v30, v31, v13
v_mfma_f32_32x32x16_bf16 v[16:31], a[224:227], v[72:75], 0
v_mfma_f32_32x32x16_bf16 v[16:31], a[228:231], v[76:79], v[16:31]
s_nop 15
v_max3_f32 v13, v16, v17, v13
v_max3_f32 v13, v18, v19, v13
v_max3_f32 v13, v20, v21, v13
v_max3_f32 v13, v22, v23, v13
v_max3_f32 v13, v24, v25, v13
v_max3_f32 v13, v26, v27, v13
v_max3_f32 v13, v28, v29, v13
v_max3_f32 v13, v30, v31, v13
v_mfma_f32_32x32x16_bf16 v[16:31], a[240:243], v[72:75], 0
v_mfma_f32_32x32x16_bf16 v[16:31], a[244:247], v[76:79], v[16:31]
s_nop 15
v_max3_f32 v13, v16, v17, v13
v_max3_f32 v13, v18, v19, v13
v_max3_f32 v13, v20, v21, v13
v_max3_f32 v13, v22, v23, v13
v_max3_f32 v13, v24, v25, v13
v_max3_f32 v13, v26, v27, v13
v_max3_f32 v13, v28, v29, v13
v_max3_f32 v13, v30, v31, v13
v_mov_b32 v14, v13
s_nop 1
v_permlane32_swap_b32 v13, v14
s_nop 1
v_max_f32 v13, v13, v14
v_bfe_u32 v12, v0, 4, 5
v_lshlrev_b32 v12, 2, v12
s_lshl_b32 s28, s17, 7
v_add_u32 v12, s28, v12
s_lshl_b32 s28, s44, 9
v_add_u32 v12, s28, v12
ds_write_b32 v12, v13 offset:50176
s_add_u32 s44, s44, 1
s_cmp_lt_u32 s44, 4
s_cbranch_scc1 BM_49
s_waitcnt lgkmcnt(0)
s_barrier
v_bfe_u32 v12, v0, 4, 5
v_lshlrev_b32 v12, 2, v12
s_lshl_b32 s28, s17, 9
v_add_u32 v13, s28, v12
ds_read_b32 v4, v13 offset:50176
ds_read_b32 v5, v13 offset:50304
ds_read_b32 v6, v13 offset:50432
ds_read_b32 v7, v13 offset:50560
s_waitcnt lgkmcnt(0)
v_max3_f32 v4, v4, v5, v6
v_max_f32 v4, v4, v7
s_lshl_b32 s28, s17, 7
v_add_u32 v12, s28, v12
ds_write_b32 v12, v4 offset:49152
s_waitcnt lgkmcnt(0)
s_barrier
s_mov_b32 s44, 0
v_mov_b32 v3, v9
BJ_50:
s_lshl_b32 s28, s42, 2
s_add_u32 s28, s28, s44
s_lshl_b32 s43, s28, 11
v_add_u32 v12, s43, v8
ds_read2_b64 v[72:75], v12 offset0:0 offset1:2
ds_read2_b64 v[76:79], v12 offset0:4 offset1:6
s_waitcnt lgkmcnt(0)
v_bfe_u32 v13, v0, 4, 5
v_lshlrev_b32 v13, 2, v13
s_lshl_b32 s28, s44, 7
v_add_u32 v13, s28, v13
ds_read_b32 v14, v13 offset:49152
s_waitcnt lgkmcnt(0)
v_sub_f32 v14, 0, v14
v_cvt_pk_bf16_f32 v14, v14, v15
s_mov_b32 exec_hi, 0
v_mov_b32 v77, v14
s_mov_b32 exec_hi, -1
s_nop 1
v_mfma_f32_32x32x16_bf16 v[16:31], a[0:3], v[72:75], 0
v_mfma_f32_32x32x16_bf16 v[16:31], a[4:7], v[76:79], v[16:31]
s_nop 7
v_mfma_f32_32x32x16_bf16 v[32:47], a[16:19], v[72:75], 0
v_mfma_f32_32x32x16_bf16 v[32:47], a[20:23], v[76:79], v[32:47]
s_nop 3
v_exp_f32 v16, v16
v_exp_f32 v17, v17
v_exp_f32 v18, v18
v_exp_f32 v19, v19
v_exp_f32 v20, v20
v_exp_f32 v21, v21
v_exp_f32 v22, v22
v_exp_f32 v23, v23
v_exp_f32 v24, v24
v_exp_f32 v25, v25
v_exp_f32 v26, v26
v_exp_f32 v27, v27
v_exp_f32 v28, v28
v_exp_f32 v29, v29
v_exp_f32 v30, v30
v_exp_f32 v31, v31
v_cvt_pk_bf16_f32 v48, v16, v17
v_cvt_pk_bf16_f32 v49, v18, v19
v_cvt_pk_bf16_f32 v50, v20, v21
v_cvt_pk_bf16_f32 v51, v22, v23
v_cvt_pk_bf16_f32 v52, v24, v25
v_cvt_pk_bf16_f32 v53, v26, v27
v_cvt_pk_bf16_f32 v54, v28, v29
v_cvt_pk_bf16_f32 v55, v30, v31
s_nop 1
v_mfma_f32_32x32x16_bf16 v[56:71], a[8:11], v[48:51], 0
v_mfma_f32_32x32x16_bf16 v[56:71], a[12:15], v[52:55], v[56:71]
v_mfma_f32_32x32x16_bf16 v[16:31], a[32:35], v[72:75], 0
v_mfma_f32_32x32x16_bf16 v[16:31], a[36:39], v[76:79], v[16:31]
v_exp_f32 v32, v32
v_exp_f32 v33, v33
v_exp_f32 v34, v34
v_exp_f32 v35, v35
v_exp_f32 v36, v36
v_exp_f32 v37, v37
v_exp_f32 v38, v38
v_exp_f32 v39, v39
v_exp_f32 v40, v40
v_exp_f32 v41, v41
v_exp_f32 v42, v42
v_exp_f32 v43, v43
v_exp_f32 v44, v44
v_exp_f32 v45, v45
v_exp_f32 v46, v46
v_exp_f32 v47, v47
v_cvt_pk_bf16_f32 v48, v32, v33
v_cvt_pk_bf16_f32 v49, v34, v35
v_cvt_pk_bf16_f32 v50, v36, v37
v_cvt_pk_bf16_f32 v51, v38, v39
v_cvt_pk_bf16_f32 v52, v40, v41
v_cvt_pk_bf16_f32 v53, v42, v43
v_cvt_pk_bf16_f32 v54, v44, v45
v_cvt_pk_bf16_f32 v55, v46, v47
s_nop 1
v_mfma_f32_32x32x16_bf16 v[56:71], a[24:27], v[48:51], v[56:71]
v_mfma_f32_32x32x16_bf16 v[56:71], a[28:31], v[52:55], v[56:71]
v_mfma_f32_32x32x16_bf16 v[32:47], a[48:51], v[72:75], 0
v_mfma_f32_32x32x16_bf16 v[32:47], a[52:55], v[76:79], v[32:47]
v_exp_f32 v16, v16
v_exp_f32 v17, v17
v_exp_f32 v18, v18
v_exp_f32 v19, v19
v_exp_f32 v20, v20
v_exp_f32 v21, v21
v_exp_f32 v22, v22
v_exp_f32 v23, v23
v_exp_f32 v24, v24
v_exp_f32 v25, v25
v_exp_f32 v26, v26
v_exp_f32 v27, v27
v_exp_f32 v28, v28
v_exp_f32 v29, v29
v_exp_f32 v30, v30
v_exp_f32 v31, v31
v_cvt_pk_bf16_f32 v48, v16, v17
v_cvt_pk_bf16_f32 v49, v18, v19
v_cvt_pk_bf16_f32 v50, v20, v21
v_cvt_pk_bf16_f32 v51, v22, v23
v_cvt_pk_bf16_f32 v52, v24, v25
v_cvt_pk_bf16_f32 v53, v26, v27
v_cvt_pk_bf16_f32 v54, v28, v29
v_cvt_pk_bf16_f32 v55, v30, v31
s_nop 1
v_mfma_f32_32x32x16_bf16 v[56:71], a[40:43], v[48:51], v[56:71]
v_mfma_f32_32x32x16_bf16 v[56:71], a[44:47], v[52:55], v[56:71]
v_mfma_f32_32x32x16_bf16 v[16:31], a[64:67], v[72:75], 0
v_mfma_f32_32x32x16_bf16 v[16:31], a[68:71], v[76:79], v[16:31]
v_exp_f32 v32, v32
v_exp_f32 v33, v33
v_exp_f32 v34, v34
v_exp_f32 v35, v35
v_exp_f32 v36, v36
v_exp_f32 v37, v37
v_exp_f32 v38, v38
v_exp_f32 v39, v39
v_exp_f32 v40, v40
v_exp_f32 v41, v41
v_exp_f32 v42, v42
v_exp_f32 v43, v43
v_exp_f32 v44, v44
v_exp_f32 v45, v45
v_exp_f32 v46, v46
v_exp_f32 v47, v47
v_cvt_pk_bf16_f32 v48, v32, v33
v_cvt_pk_bf16_f32 v49, v34, v35
v_cvt_pk_bf16_f32 v50, v36, v37
v_cvt_pk_bf16_f32 v51, v38, v39
v_cvt_pk_bf16_f32 v52, v40, v41
v_cvt_pk_bf16_f32 v53, v42, v43
v_cvt_pk_bf16_f32 v54, v44, v45
v_cvt_pk_bf16_f32 v55, v46, v47
s_nop 1
v_mfma_f32_32x32x16_bf16 v[56:71], a[56:59], v[48:51], v[56:71]
v_mfma_f32_32x32x16_bf16 v[56:71], a[60:63], v[52:55], v[56:71]
v_mfma_f32_32x32x16_bf16 v[32:47], a[80:83], v[72:75], 0
v_mfma_f32_32x32x16_bf16 v[32:47], a[84:87], v[76:79], v[32:47]
v_exp_f32 v16, v16
v_exp_f32 v17, v17
v_exp_f32 v18, v18
v_exp_f32 v19, v19
v_exp_f32 v20, v20
v_exp_f32 v21, v21
v_exp_f32 v22, v22
v_exp_f32 v23, v23
v_exp_f32 v24, v24
v_exp_f32 v25, v25
v_exp_f32 v26, v26
v_exp_f32 v27, v27
v_exp_f32 v28, v28
v_exp_f32 v29, v29
v_exp_f32 v30, v30
v_exp_f32 v31, v31
v_cvt_pk_bf16_f32 v48, v16, v17
v_cvt_pk_bf16_f32 v49, v18, v19
v_cvt_pk_bf16_f32 v50, v20, v21
v_cvt_pk_bf16_f32 v51, v22, v23
v_cvt_pk_bf16_f32 v52, v24, v25
v_cvt_pk_bf16_f32 v53, v26, v27
v_cvt_pk_bf16_f32 v54, v28, v29
v_cvt_pk_bf16_f32 v55, v30, v31
s_nop 1
v_mfma_f32_32x32x16_bf16 v[56:71], a[72:75], v[48:51], v[56:71]
v_mfma_f32_32x32x16_bf16 v[56:71], a[76:79], v[52:55], v[56:71]
v_mfma_f32_32x32x16_bf16 v[16:31], a[96:99], v[72:75], 0
v_mfma_f32_32x32x16_bf16 v[16:31], a[100:103], v[76:79], v[16:31]
v_exp_f32 v32, v32
v_exp_f32 v33, v33
v_exp_f32 v34, v34
v_exp_f32 v35, v35
v_exp_f32 v36, v36
v_exp_f32 v37, v37
v_exp_f32 v38, v38
v_exp_f32 v39, v39
v_exp_f32 v40, v40
v_exp_f32 v41, v41
v_exp_f32 v42, v42
v_exp_f32 v43, v43
v_exp_f32 v44, v44
v_exp_f32 v45, v45
v_exp_f32 v46, v46
v_exp_f32 v47, v47
v_cvt_pk_bf16_f32 v48, v32, v33
v_cvt_pk_bf16_f32 v49, v34, v35
v_cvt_pk_bf16_f32 v50, v36, v37
v_cvt_pk_bf16_f32 v51, v38, v39
v_cvt_pk_bf16_f32 v52, v40, v41
v_cvt_pk_bf16_f32 v53, v42, v43
v_cvt_pk_bf16_f32 v54, v44, v45
v_cvt_pk_bf16_f32 v55, v46, v47
s_nop 1
v_mfma_f32_32x32x16_bf16 v[56:71], a[88:91], v[48:51], v[56:71]
v_mfma_f32_32x32x16_bf16 v[56:71], a[92:95], v[52:55], v[56:71]
v_mfma_f32_32x32x16_bf16 v[32:47], a[112:115], v[72:75], 0
v_mfma_f32_32x32x16_bf16 v[32:47], a[116:119], v[76:79], v[32:47]
v_exp_f32 v16, v16
v_exp_f32 v17, v17
v_exp_f32 v18, v18
v_exp_f32 v19, v19
v_exp_f32 v20, v20
v_exp_f32 v21, v21
v_exp_f32 v22, v22
v_exp_f32 v23, v23
v_exp_f32 v24, v24
v_exp_f32 v25, v25
v_exp_f32 v26, v26
v_exp_f32 v27, v27
v_exp_f32 v28, v28
v_exp_f32 v29, v29
v_exp_f32 v30, v30
v_exp_f32 v31, v31
v_cvt_pk_bf16_f32 v48, v16, v17
v_cvt_pk_bf16_f32 v49, v18, v19
v_cvt_pk_bf16_f32 v50, v20, v21
v_cvt_pk_bf16_f32 v51, v22, v23
v_cvt_pk_bf16_f32 v52, v24, v25
v_cvt_pk_bf16_f32 v53, v26, v27
v_cvt_pk_bf16_f32 v54, v28, v29
v_cvt_pk_bf16_f32 v55, v30, v31
s_nop 1
v_mfma_f32_32x32x16_bf16 v[56:71], a[104:107], v[48:51], v[56:71]
v_mfma_f32_32x32x16_bf16 v[56:71], a[108:111], v[52:55], v[56:71]
v_mfma_f32_32x32x16_bf16 v[16:31], a[128:131], v[72:75], 0
v_mfma_f32_32x32x16_bf16 v[16:31], a[132:135], v[76:79], v[16:31]
v_exp_f32 v32, v32
v_exp_f32 v33, v33
v_exp_f32 v34, v34
v_exp_f32 v35, v35
v_exp_f32 v36, v36
v_exp_f32 v37, v37
v_exp_f32 v38, v38
v_exp_f32 v39, v39
v_exp_f32 v40, v40
v_exp_f32 v41, v41
v_exp_f32 v42, v42
v_exp_f32 v43, v43
v_exp_f32 v44, v44
v_exp_f32 v45, v45
v_exp_f32 v46, v46
v_exp_f32 v47, v47
v_cvt_pk_bf16_f32 v48, v32, v33
v_cvt_pk_bf16_f32 v49, v34, v35
v_cvt_pk_bf16_f32 v50, v36, v37
v_cvt_pk_bf16_f32 v51, v38, v39
v_cvt_pk_bf16_f32 v52, v40, v41
v_cvt_pk_bf16_f32 v53, v42, v43
v_cvt_pk_bf16_f32 v54, v44, v45
v_cvt_pk_bf16_f32 v55, v46, v47
s_nop 1
v_mfma_f32_32x32x16_bf16 v[56:71], a[120:123], v[48:51], v[56:71]
v_mfma_f32_32x32x16_bf16 v[56:71], a[124:127], v[52:55], v[56:71]
v_mfma_f32_32x32x16_bf16 v[32:47], a[144:147], v[72:75], 0
v_mfma_f32_32x32x16_bf16 v[32:47], a[148:151], v[76:79], v[32:47]
v_exp_f32 v16, v16
v_exp_f32 v17, v17
v_exp_f32 v18, v18
v_exp_f32 v19, v19
v_exp_f32 v20, v20
v_exp_f32 v21, v21
v_exp_f32 v22, v22
v_exp_f32 v23, v23
v_exp_f32 v24, v24
v_exp_f32 v25, v25
v_exp_f32 v26, v26
v_exp_f32 v27, v27
v_exp_f32 v28, v28
v_exp_f32 v29, v29
v_exp_f32 v30, v30
v_exp_f32 v31, v31
v_cvt_pk_bf16_f32 v48, v16, v17
v_cvt_pk_bf16_f32 v49, v18, v19
v_cvt_pk_bf16_f32 v50, v20, v21
v_cvt_pk_bf16_f32 v51, v22, v23
v_cvt_pk_bf16_f32 v52, v24, v25
v_cvt_pk_bf16_f32 v53, v26, v27
v_cvt_pk_bf16_f32 v54, v28, v29
v_cvt_pk_bf16_f32 v55, v30, v31
s_nop 1
v_mfma_f32_32x32x16_bf16 v[56:71], a[136:139], v[48:51], v[56:71]
v_mfma_f32_32x32x16_bf16 v[56:71], a[140:143], v[52:55], v[56:71]
v_mfma_f32_32x32x16_bf16 v[16:31], a[160:163], v[72:75], 0
v_mfma_f32_32x32x16_bf16 v[16:31], a[164:167], v[76:79], v[16:31]
v_exp_f32 v32, v32
v_exp_f32 v33, v33
v_exp_f32 v34, v34
v_exp_f32 v35, v35
v_exp_f32 v36, v36
v_exp_f32 v37, v37
v_exp_f32 v38, v38
v_exp_f32 v39, v39
v_exp_f32 v40, v40
v_exp_f32 v41, v41
v_exp_f32 v42, v42
v_exp_f32 v43, v43
v_exp_f32 v44, v44
v_exp_f32 v45, v45
v_exp_f32 v46, v46
v_exp_f32 v47, v47
v_cvt_pk_bf16_f32 v48, v32, v33
v_cvt_pk_bf16_f32 v49, v34, v35
v_cvt_pk_bf16_f32 v50, v36, v37
v_cvt_pk_bf16_f32 v51, v38, v39
v_cvt_pk_bf16_f32 v52, v40, v41
v_cvt_pk_bf16_f32 v53, v42, v43
v_cvt_pk_bf16_f32 v54, v44, v45
v_cvt_pk_bf16_f32 v55, v46, v47
s_nop 1
v_mfma_f32_32x32x16_bf16 v[56:71], a[152:155], v[48:51], v[56:71]
v_mfma_f32_32x32x16_bf16 v[56:71], a[156:159], v[52:55], v[56:71]
v_mfma_f32_32x32x16_bf16 v[32:47], a[176:179], v[72:75], 0
v_mfma_f32_32x32x16_bf16 v[32:47], a[180:183], v[76:79], v[32:47]
v_exp_f32 v16, v16
v_exp_f32 v17, v17
v_exp_f32 v18, v18
v_exp_f32 v19, v19
v_exp_f32 v20, v20
v_exp_f32 v21, v21
v_exp_f32 v22, v22
v_exp_f32 v23, v23
v_exp_f32 v24, v24
v_exp_f32 v25, v25
v_exp_f32 v26, v26
v_exp_f32 v27, v27
v_exp_f32 v28, v28
v_exp_f32 v29, v29
v_exp_f32 v30, v30
v_exp_f32 v31, v31
v_cvt_pk_bf16_f32 v48, v16, v17
v_cvt_pk_bf16_f32 v49, v18, v19
v_cvt_pk_bf16_f32 v50, v20, v21
v_cvt_pk_bf16_f32 v51, v22, v23
v_cvt_pk_bf16_f32 v52, v24, v25
v_cvt_pk_bf16_f32 v53, v26, v27
v_cvt_pk_bf16_f32 v54, v28, v29
v_cvt_pk_bf16_f32 v55, v30, v31
s_nop 1
v_mfma_f32_32x32x16_bf16 v[56:71], a[168:171], v[48:51], v[56:71]
v_mfma_f32_32x32x16_bf16 v[56:71], a[172:175], v[52:55], v[56:71]
v_mfma_f32_32x32x16_bf16 v[16:31], a[192:195], v[72:75], 0
v_mfma_f32_32x32x16_bf16 v[16:31], a[196:199], v[76:79], v[16:31]
v_exp_f32 v32, v32
v_exp_f32 v33, v33
v_exp_f32 v34, v34
v_exp_f32 v35, v35
v_exp_f32 v36, v36
v_exp_f32 v37, v37
v_exp_f32 v38, v38
v_exp_f32 v39, v39
v_exp_f32 v40, v40
v_exp_f32 v41, v41
v_exp_f32 v42, v42
v_exp_f32 v43, v43
v_exp_f32 v44, v44
v_exp_f32 v45, v45
v_exp_f32 v46, v46
v_exp_f32 v47, v47
v_cvt_pk_bf16_f32 v48, v32, v33
v_cvt_pk_bf16_f32 v49, v34, v35
v_cvt_pk_bf16_f32 v50, v36, v37
v_cvt_pk_bf16_f32 v51, v38, v39
v_cvt_pk_bf16_f32 v52, v40, v41
v_cvt_pk_bf16_f32 v53, v42, v43
v_cvt_pk_bf16_f32 v54, v44, v45
v_cvt_pk_bf16_f32 v55, v46, v47
s_nop 1
v_mfma_f32_32x32x16_bf16 v[56:71], a[184:187], v[48:51], v[56:71]
v_mfma_f32_32x32x16_bf16 v[56:71], a[188:191], v[52:55], v[56:71]
v_mfma_f32_32x32x16_bf16 v[32:47], a[208:211], v[72:75], 0
v_mfma_f32_32x32x16_bf16 v[32:47], a[212:215], v[76:79], v[32:47]
v_exp_f32 v16, v16
v_exp_f32 v17, v17
v_exp_f32 v18, v18
v_exp_f32 v19, v19
v_exp_f32 v20, v20
v_exp_f32 v21, v21
v_exp_f32 v22, v22
v_exp_f32 v23, v23
v_exp_f32 v24, v24
v_exp_f32 v25, v25
v_exp_f32 v26, v26
v_exp_f32 v27, v27
v_exp_f32 v28, v28
v_exp_f32 v29, v29
v_exp_f32 v30, v30
v_exp_f32 v31, v31
v_cvt_pk_bf16_f32 v48, v16, v17
v_cvt_pk_bf16_f32 v49, v18, v19
v_cvt_pk_bf16_f32 v50, v20, v21
v_cvt_pk_bf16_f32 v51, v22, v23
v_cvt_pk_bf16_f32 v52, v24, v25
v_cvt_pk_bf16_f32 v53, v26, v27
v_cvt_pk_bf16_f32 v54, v28, v29
v_cvt_pk_bf16_f32 v55, v30, v31
s_nop 1
v_mfma_f32_32x32x16_bf16 v[56:71], a[200:203], v[48:51], v[56:71]
v_mfma_f32_32x32x16_bf16 v[56:71], a[204:207], v[52:55], v[56:71]
v_mfma_f32_32x32x16_bf16 v[16:31], a[224:227], v[72:75], 0
v_mfma_f32_32x32x16_bf16 v[16:31], a[228:231], v[76:79], v[16:31]
v_exp_f32 v32, v32
v_exp_f32 v33, v33
v_exp_f32 v34, v34
v_exp_f32 v35, v35
v_exp_f32 v36, v36
v_exp_f32 v37, v37
v_exp_f32 v38, v38
v_exp_f32 v39, v39
v_exp_f32 v40, v40
v_exp_f32 v41, v41
v_exp_f32 v42, v42
v_exp_f32 v43, v43
v_exp_f32 v44, v44
v_exp_f32 v45, v45
v_exp_f32 v46, v46
v_exp_f32 v47, v47
v_cvt_pk_bf16_f32 v48, v32, v33
v_cvt_pk_bf16_f32 v49, v34, v35
v_cvt_pk_bf16_f32 v50, v36, v37
v_cvt_pk_bf16_f32 v51, v38, v39
v_cvt_pk_bf16_f32 v52, v40, v41
v_cvt_pk_bf16_f32 v53, v42, v43
v_cvt_pk_bf16_f32 v54, v44, v45
v_cvt_pk_bf16_f32 v55, v46, v47
s_nop 1
v_mfma_f32_32x32x16_bf16 v[56:71], a[216:219], v[48:51], v[56:71]
v_mfma_f32_32x32x16_bf16 v[56:71], a[220:223], v[52:55], v[56:71]
v_mfma_f32_32x32x16_bf16 v[32:47], a[240:243], v[72:75], 0
v_mfma_f32_32x32x16_bf16 v[32:47], a[244:247], v[76:79], v[32:47]
v_exp_f32 v16, v16
v_exp_f32 v17, v17
v_exp_f32 v18, v18
v_exp_f32 v19, v19
v_exp_f32 v20, v20
v_exp_f32 v21, v21
v_exp_f32 v22, v22
v_exp_f32 v23, v23
v_exp_f32 v24, v24
v_exp_f32 v25, v25
v_exp_f32 v26, v26
v_exp_f32 v27, v27
v_exp_f32 v28, v28
v_exp_f32 v29, v29
v_exp_f32 v30, v30
v_exp_f32 v31, v31
v_cvt_pk_bf16_f32 v48, v16, v17
v_cvt_pk_bf16_f32 v49, v18, v19
v_cvt_pk_bf16_f32 v50, v20, v21
v_cvt_pk_bf16_f32 v51, v22, v23
v_cvt_pk_bf16_f32 v52, v24, v25
v_cvt_pk_bf16_f32 v53, v26, v27
v_cvt_pk_bf16_f32 v54, v28, v29
v_cvt_pk_bf16_f32 v55, v30, v31
s_nop 1
v_mfma_f32_32x32x16_bf16 v[56:71], a[232:235], v[48:51], v[56:71]
v_mfma_f32_32x32x16_bf16 v[56:71], a[236:239], v[52:55], v[56:71]
s_nop 3
v_exp_f32 v32, v32
v_exp_f32 v33, v33
v_exp_f32 v34, v34
v_exp_f32 v35, v35
v_exp_f32 v36, v36
v_exp_f32 v37, v37
v_exp_f32 v38, v38
v_exp_f32 v39, v39
v_exp_f32 v40, v40
v_exp_f32 v41, v41
v_exp_f32 v42, v42
v_exp_f32 v43, v43
v_exp_f32 v44, v44
v_exp_f32 v45, v45
v_exp_f32 v46, v46
v_exp_f32 v47, v47
v_cvt_pk_bf16_f32 v48, v32, v33
v_cvt_pk_bf16_f32 v49, v34, v35
v_cvt_pk_bf16_f32 v50, v36, v37
v_cvt_pk_bf16_f32 v51, v38, v39
v_cvt_pk_bf16_f32 v52, v40, v41
v_cvt_pk_bf16_f32 v53, v42, v43
v_cvt_pk_bf16_f32 v54, v44, v45
v_cvt_pk_bf16_f32 v55, v46, v47
s_nop 1
v_mfma_f32_32x32x16_bf16 v[56:71], a[248:251], v[48:51], v[56:71]
v_mfma_f32_32x32x16_bf16 v[56:71], a[252:255], v[52:55], v[56:71]
s_nop 15
ds_write_b128 v3, v[56:59] offset:0
ds_write_b128 v3, v[60:63] offset:1024
ds_write_b128 v3, v[64:67] offset:2048
v_add_u32 v3, 12288, v3
s_add_u32 s44, s44, 1
s_cmp_lt_u32 s44, 4
s_cbranch_scc1 BJ_50
s_waitcnt lgkmcnt(0)
s_barrier
ds_read_b128 v[80:83], v10 offset:0
ds_read_b128 v[84:87], v10 offset:1024
ds_read_b128 v[88:91], v10 offset:2048
ds_read_b128 v[92:95], v10 offset:3072
ds_read_b128 v[96:99], v10 offset:4096
ds_read_b128 v[100:103], v10 offset:5120
ds_read_b128 v[104:107], v10 offset:6144
ds_read_b128 v[108:111], v10 offset:7168
ds_read_b128 v[112:115], v10 offset:8192
ds_read_b128 v[116:119], v10 offset:9216
ds_read_b128 v[120:123], v10 offset:10240
ds_read_b128 v[124:127], v10 offset:11264
s_waitcnt lgkmcnt(0)
v_add_f32 v80, v80, v92
v_add_f32 v104, v104, v116
v_add_f32 v80, v80, v104
v_add_f32 v81, v81, v93
v_add_f32 v105, v105, v117
v_add_f32 v81, v81, v105
v_add_f32 v82, v82, v94
v_add_f32 v106, v106, v118
v_add_f32 v82, v82, v106
v_add_f32 v83, v83, v95
v_add_f32 v107, v107, v119
v_add_f32 v83, v83, v107
v_add_f32 v84, v84, v96
v_add_f32 v108, v108, v120
v_add_f32 v84, v84, v108
v_add_f32 v85, v85, v97
v_add_f32 v109, v109, v121
v_add_f32 v85, v85, v109
v_add_f32 v86, v86, v98
v_add_f32 v110, v110, v122
v_add_f32 v86, v86, v110
v_add_f32 v87, v87, v99
v_add_f32 v111, v111, v123
v_add_f32 v87, v87, v111
v_add_f32 v88, v88, v100
v_add_f32 v112, v112, v124
v_add_f32 v88, v88, v112
v_add_f32 v89, v89, v101
v_add_f32 v113, v113, v125
v_add_f32 v89, v89, v113
v_add_f32 v90, v90, v102
v_add_f32 v114, v114, v126
v_add_f32 v90, v90, v114
v_add_f32 v91, v91, v103
v_add_f32 v115, v115, v127
v_add_f32 v91, v91, v115
v_mov_b32 v13, v90
v_mov_b32 v14, v90
s_nop 1
v_permlane32_swap_b32 v13, v14
s_nop 1
s_branch BN_47
BF_42:
s_mov_b32 s19, 1
BE_43:
s_cmp_lt_u32 s53, 96
s_cbranch_scc1 K_WH
s_endpgm
K_WH:
s_barrier
s_mul_i32 s54, s53, 21846
s_lshr_b32 s54, s54, 18
s_mul_i32 s55, s54, 12
s_sub_u32 s55, s53, s55
s_and_b32 s56, s54, 1
s_lshr_b32 s54, s54, 1
s_add_u32 s54, s54, 60
s_mov_b32 s24, s55
s_mov_b32 s25, s54
s_mov_b32 s19, 0
s_mul_i32 s28, s24, 96
s_mul_i32 s29, s17, 1179648
s_add_u32 s28, s28, s29
s_load_dwordx2 s[4:5], s[0:1], 40
s_waitcnt lgkmcnt(0)
s_add_u32 s12, s4, s28
s_addc_u32 s13, s5, 0
s_sub_u32 s14, 4718592, s28
s_mov_b32 s15, 0x00020000
v_lshrrev_b32 v2, 4, v0
s_mul_i32 s30, s17, 24576
v_lshrrev_b32 v4, 8, v0
v_bfe_u32 v5, v0, 6, 2
v_bfe_u32 v6, v0, 4, 2
v_lshl_add_u32 v4, v4, 2, v5
v_mul_u32_u24 v4, 96, v4
v_lshl_add_u32 v4, v6, 3, v4
v_add_u32 v4, s30, v4
v_add_u32 v3, 0, v2
v_mul_u32_u24 v5, 43691, v3
v_lshrrev_b32 v5, 18, v5
v_mul_u32_u24 v6, 6, v5
v_sub_u32 v6, v3, v6
v_mul_u32_u24 v5, 1152, v5
v_lshl_add_u32 v5, v6, 4, v5
s_add_u32 s31, s30, 0
s_mov_b32 m0, s31
s_mov_b32 s33, 0
buffer_load_dwordx4 v5, s[12:15], s33 offen lds
v_add_u32 v3, 64, v2
v_mul_u32_u24 v5, 43691, v3
v_lshrrev_b32 v5, 18, v5
v_mul_u32_u24 v6, 6, v5
v_sub_u32 v6, v3, v6
v_mul_u32_u24 v5, 1152, v5
v_lshl_add_u32 v5, v6, 4, v5
s_add_u32 s31, s30, 1024
s_mov_b32 m0, s31
s_mov_b32 s33, 0
buffer_load_dwordx4 v5, s[12:15], s33 offen lds
v_add_u32 v3, 128, v2
v_mul_u32_u24 v5, 43691, v3
v_lshrrev_b32 v5, 18, v5
v_mul_u32_u24 v6, 6, v5
v_sub_u32 v6, v3, v6
v_mul_u32_u24 v5, 1152, v5
v_lshl_add_u32 v5, v6, 4, v5
s_add_u32 s31, s30, 2048
s_mov_b32 m0, s31
s_mov_b32 s33, 0
buffer_load_dwordx4 v5, s[12:15], s33 offen lds
v_add_u32 v3, 192, v2
v_mul_u32_u24 v5, 43691, v3
v_lshrrev_b32 v5, 18, v5
v_mul_u32_u24 v6, 6, v5
v_sub_u32 v6, v3, v6
v_mul_u32_u24 v5, 1152, v5
v_lshl_add_u32 v5, v6, 4, v5
s_add_u32 s31, s30, 3072
s_mov_b32 m0, s31
s_mov_b32 s33, 0
buffer_load_dwordx4 v5, s[12:15], s33 offen lds
v_add_u32 v3, 256, v2
v_mul_u32_u24 v5, 43691, v3
v_lshrrev_b32 v5, 18, v5
v_mul_u32_u24 v6, 6, v5
v_sub_u32 v6, v3, v6
v_mul_u32_u24 v5, 1152, v5
v_lshl_add_u32 v5, v6, 4, v5
s_add_u32 s31, s30, 4096
s_mov_b32 m0, s31
s_mov_b32 s33, 0
buffer_load_dwordx4 v5, s[12:15], s33 offen lds
v_add_u32 v3, 320, v2
v_mul_u32_u24 v5, 43691, v3
v_lshrrev_b32 v5, 18, v5
v_mul_u32_u24 v6, 6, v5
v_sub_u32 v6, v3, v6
v_mul_u32_u24 v5, 1152, v5
v_lshl_add_u32 v5, v6, 4, v5
s_add_u32 s31, s30, 5120
s_mov_b32 m0, s31
s_mov_b32 s33, 0
buffer_load_dwordx4 v5, s[12:15], s33 offen lds
v_add_u32 v3, 384, v2
v_mul_u32_u24 v5, 43691, v3
v_lshrrev_b32 v5, 18, v5
v_mul_u32_u24 v6, 6, v5
v_sub_u32 v6, v3, v6
v_mul_u32_u24 v5, 1152, v5
v_lshl_add_u32 v5, v6, 4, v5
s_add_u32 s31, s30, 6144
s_mov_b32 m0, s31
s_mov_b32 s33, 0
buffer_load_dwordx4 v5, s[12:15], s33 offen lds
v_add_u32 v3, 448, v2
v_mul_u32_u24 v5, 43691, v3
v_lshrrev_b32 v5, 18, v5
v_mul_u32_u24 v6, 6, v5
v_sub_u32 v6, v3, v6
v_mul_u32_u24 v5, 1152, v5
v_lshl_add_u32 v5, v6, 4, v5
s_add_u32 s31, s30, 7168
s_mov_b32 m0, s31
s_mov_b32 s33, 0
buffer_load_dwordx4 v5, s[12:15], s33 offen lds
v_add_u32 v3, 512, v2
v_mul_u32_u24 v5, 43691, v3
v_lshrrev_b32 v5, 18, v5
v_mul_u32_u24 v6, 6, v5
v_sub_u32 v6, v3, v6
v_mul_u32_u24 v5, 1152, v5
v_lshl_add_u32 v5, v6, 4, v5
s_add_u32 s31, s30, 8192
s_mov_b32 m0, s31
s_mov_b32 s33, 0
buffer_load_dwordx4 v5, s[12:15], s33 offen lds
v_add_u32 v3, 576, v2
v_mul_u32_u24 v5, 43691, v3
v_lshrrev_b32 v5, 18, v5
v_mul_u32_u24 v6, 6, v5
v_sub_u32 v6, v3, v6
v_mul_u32_u24 v5, 1152, v5
v_lshl_add_u32 v5, v6, 4, v5
s_add_u32 s31, s30, 9216
s_mov_b32 m0, s31
s_mov_b32 s33, 0
buffer_load_dwordx4 v5, s[12:15], s33 offen lds
v_add_u32 v3, 640, v2
v_mul_u32_u24 v5, 43691, v3
v_lshrrev_b32 v5, 18, v5
v_mul_u32_u24 v6, 6, v5
v_sub_u32 v6, v3, v6
v_mul_u32_u24 v5, 1152, v5
v_lshl_add_u32 v5, v6, 4, v5
s_add_u32 s31, s30, 10240
s_mov_b32 m0, s31
s_mov_b32 s33, 0
buffer_load_dwordx4 v5, s[12:15], s33 offen lds
v_add_u32 v3, 704, v2
v_mul_u32_u24 v5, 43691, v3
v_lshrrev_b32 v5, 18, v5
v_mul_u32_u24 v6, 6, v5
v_sub_u32 v6, v3, v6
v_mul_u32_u24 v5, 1152, v5
v_lshl_add_u32 v5, v6, 4, v5
s_add_u32 s31, s30, 11264
s_mov_b32 m0, s31
s_mov_b32 s33, 0
buffer_load_dwordx4 v5, s[12:15], s33 offen lds
v_add_u32 v3, 768, v2
v_mul_u32_u24 v5, 43691, v3
v_lshrrev_b32 v5, 18, v5
v_mul_u32_u24 v6, 6, v5
v_sub_u32 v6, v3, v6
v_mul_u32_u24 v5, 1152, v5
v_lshl_add_u32 v5, v6, 4, v5
s_add_u32 s31, s30, 12288
s_mov_b32 m0, s31
s_mov_b32 s33, 0
buffer_load_dwordx4 v5, s[12:15], s33 offen lds
v_add_u32 v3, 832, v2
v_mul_u32_u24 v5, 43691, v3
v_lshrrev_b32 v5, 18, v5
v_mul_u32_u24 v6, 6, v5
v_sub_u32 v6, v3, v6
v_mul_u32_u24 v5, 1152, v5
v_lshl_add_u32 v5, v6, 4, v5
s_add_u32 s31, s30, 13312
s_mov_b32 m0, s31
s_mov_b32 s33, 0
buffer_load_dwordx4 v5, s[12:15], s33 offen lds
v_add_u32 v3, 896, v2
v_mul_u32_u24 v5, 43691, v3
v_lshrrev_b32 v5, 18, v5
v_mul_u32_u24 v6, 6, v5
v_sub_u32 v6, v3, v6
v_mul_u32_u24 v5, 1152, v5
v_lshl_add_u32 v5, v6, 4, v5
s_add_u32 s31, s30, 14336
s_mov_b32 m0, s31
s_mov_b32 s33, 0
buffer_load_dwordx4 v5, s[12:15], s33 offen lds
v_add_u32 v3, 960, v2
v_mul_u32_u24 v5, 43691, v3
v_lshrrev_b32 v5, 18, v5
v_mul_u32_u24 v6, 6, v5
v_sub_u32 v6, v3, v6
v_mul_u32_u24 v5, 1152, v5
v_lshl_add_u32 v5, v6, 4, v5
s_add_u32 s31, s30, 15360
s_mov_b32 m0, s31
s_mov_b32 s33, 0
buffer_load_dwordx4 v5, s[12:15], s33 offen lds
v_add_u32 v3, 1024, v2
v_mul_u32_u24 v5, 43691, v3
v_lshrrev_b32 v5, 18, v5
v_mul_u32_u24 v6, 6, v5
v_sub_u32 v6, v3, v6
v_mul_u32_u24 v5, 1152, v5
v_lshl_add_u32 v5, v6, 4, v5
s_add_u32 s31, s30, 16384
s_mov_b32 m0, s31
s_mov_b32 s33, 0
buffer_load_dwordx4 v5, s[12:15], s33 offen lds
v_add_u32 v3, 1088, v2
v_mul_u32_u24 v5, 43691, v3
v_lshrrev_b32 v5, 18, v5
v_mul_u32_u24 v6, 6, v5
v_sub_u32 v6, v3, v6
v_mul_u32_u24 v5, 1152, v5
v_lshl_add_u32 v5, v6, 4, v5
s_add_u32 s31, s30, 17408
s_mov_b32 m0, s31
s_mov_b32 s33, 0
buffer_load_dwordx4 v5, s[12:15], s33 offen lds
v_add_u32 v3, 1152, v2
v_mul_u32_u24 v5, 43691, v3
v_lshrrev_b32 v5, 18, v5
v_mul_u32_u24 v6, 6, v5
v_sub_u32 v6, v3, v6
v_mul_u32_u24 v5, 1152, v5
v_lshl_add_u32 v5, v6, 4, v5
s_add_u32 s31, s30, 18432
s_mov_b32 m0, s31
s_mov_b32 s33, 0
buffer_load_dwordx4 v5, s[12:15], s33 offen lds
v_add_u32 v3, 1216, v2
v_mul_u32_u24 v5, 43691, v3
v_lshrrev_b32 v5, 18, v5
v_mul_u32_u24 v6, 6, v5
v_sub_u32 v6, v3, v6
v_mul_u32_u24 v5, 1152, v5
v_lshl_add_u32 v5, v6, 4, v5
s_add_u32 s31, s30, 19456
s_mov_b32 m0, s31
s_mov_b32 s33, 0
buffer_load_dwordx4 v5, s[12:15], s33 offen lds
v_add_u32 v3, 1280, v2
v_mul_u32_u24 v5, 43691, v3
v_lshrrev_b32 v5, 18, v5
v_mul_u32_u24 v6, 6, v5
v_sub_u32 v6, v3, v6
v_mul_u32_u24 v5, 1152, v5
v_lshl_add_u32 v5, v6, 4, v5
s_add_u32 s31, s30, 20480
s_mov_b32 m0, s31
s_mov_b32 s33, 0
buffer_load_dwordx4 v5, s[12:15], s33 offen lds
v_add_u32 v3, 1344, v2
v_mul_u32_u24 v5, 43691, v3
v_lshrrev_b32 v5, 18, v5
v_mul_u32_u24 v6, 6, v5
v_sub_u32 v6, v3, v6
v_mul_u32_u24 v5, 1152, v5
v_lshl_add_u32 v5, v6, 4, v5
s_add_u32 s31, s30, 21504
s_mov_b32 m0, s31
s_mov_b32 s33, 0
buffer_load_dwordx4 v5, s[12:15], s33 offen lds
v_add_u32 v3, 1408, v2
v_mul_u32_u24 v5, 43691, v3
v_lshrrev_b32 v5, 18, v5
v_mul_u32_u24 v6, 6, v5
v_sub_u32 v6, v3, v6
v_mul_u32_u24 v5, 1152, v5
v_lshl_add_u32 v5, v6, 4, v5
s_add_u32 s31, s30, 22528
s_mov_b32 m0, s31
s_mov_b32 s33, 0
buffer_load_dwordx4 v5, s[12:15], s33 offen lds
v_add_u32 v3, 1472, v2
v_mul_u32_u24 v5, 43691, v3
v_lshrrev_b32 v5, 18, v5
v_mul_u32_u24 v6, 6, v5
v_sub_u32 v6, v3, v6
v_mul_u32_u24 v5, 1152, v5
v_lshl_add_u32 v5, v6, 4, v5
s_add_u32 s31, s30, 23552
s_mov_b32 m0, s31
s_mov_b32 s33, 0
buffer_load_dwordx4 v5, s[12:15], s33 offen lds
s_waitcnt vmcnt(0)
ds_read_b64_tr_b16 a[0:1], v4 offset:0
ds_read_b64_tr_b16 a[2:3], v4 offset:1536
ds_read_b64_tr_b16 a[128:129], v4 offset:32
ds_read_b64_tr_b16 a[130:131], v4 offset:1568
ds_read_b64_tr_b16 v[128:129], v4 offset:64
ds_read_b64_tr_b16 v[130:131], v4 offset:1600
s_waitcnt lgkmcnt(0)
ds_read_b64_tr_b16 a[4:5], v4 offset:3072
ds_read_b64_tr_b16 a[6:7], v4 offset:4608
ds_read_b64_tr_b16 a[132:133], v4 offset:3104
ds_read_b64_tr_b16 a[134:135], v4 offset:4640
ds_read_b64_tr_b16 v[132:133], v4 offset:3136
ds_read_b64_tr_b16 v[134:135], v4 offset:4672
s_waitcnt lgkmcnt(0)
ds_read_b64_tr_b16 a[8:9], v4 offset:6144
ds_read_b64_tr_b16 a[10:11], v4 offset:7680
ds_read_b64_tr_b16 a[136:137], v4 offset:6176
ds_read_b64_tr_b16 a[138:139], v4 offset:7712
ds_read_b64_tr_b16 v[136:137], v4 offset:6208
ds_read_b64_tr_b16 v[138:139], v4 offset:7744
s_waitcnt lgkmcnt(0)
ds_read_b64_tr_b16 a[12:13], v4 offset:9216
ds_read_b64_tr_b16 a[14:15], v4 offset:10752
ds_read_b64_tr_b16 a[140:141], v4 offset:9248
ds_read_b64_tr_b16 a[142:143], v4 offset:10784
ds_read_b64_tr_b16 v[140:141], v4 offset:9280
ds_read_b64_tr_b16 v[142:143], v4 offset:10816
s_waitcnt lgkmcnt(0)
ds_read_b64_tr_b16 a[16:17], v4 offset:12288
ds_read_b64_tr_b16 a[18:19], v4 offset:13824
ds_read_b64_tr_b16 a[144:145], v4 offset:12320
ds_read_b64_tr_b16 a[146:147], v4 offset:13856
ds_read_b64_tr_b16 v[144:145], v4 offset:12352
ds_read_b64_tr_b16 v[146:147], v4 offset:13888
s_waitcnt lgkmcnt(0)
ds_read_b64_tr_b16 a[20:21], v4 offset:15360
ds_read_b64_tr_b16 a[22:23], v4 offset:16896
ds_read_b64_tr_b16 a[148:149], v4 offset:15392
ds_read_b64_tr_b16 a[150:151], v4 offset:16928
ds_read_b64_tr_b16 v[148:149], v4 offset:15424
ds_read_b64_tr_b16 v[150:151], v4 offset:16960
s_waitcnt lgkmcnt(0)
ds_read_b64_tr_b16 a[24:25], v4 offset:18432
ds_read_b64_tr_b16 a[26:27], v4 offset:19968
ds_read_b64_tr_b16 a[152:153], v4 offset:18464
ds_read_b64_tr_b16 a[154:155], v4 offset:20000
ds_read_b64_tr_b16 v[152:153], v4 offset:18496
ds_read_b64_tr_b16 v[154:155], v4 offset:20032
s_waitcnt lgkmcnt(0)
ds_read_b64_tr_b16 a[28:29], v4 offset:21504
ds_read_b64_tr_b16 a[30:31], v4 offset:23040
ds_read_b64_tr_b16 a[156:157], v4 offset:21536
ds_read_b64_tr_b16 a[158:159], v4 offset:23072
ds_read_b64_tr_b16 v[156:157], v4 offset:21568
ds_read_b64_tr_b16 v[158:159], v4 offset:23104
s_waitcnt lgkmcnt(0)
v_add_u32 v3, 0, v2
v_mul_u32_u24 v5, 43691, v3
v_lshrrev_b32 v5, 18, v5
v_mul_u32_u24 v6, 6, v5
v_sub_u32 v6, v3, v6
v_mul_u32_u24 v5, 1152, v5
v_lshl_add_u32 v5, v6, 4, v5
s_add_u32 s31, s30, 0
s_mov_b32 m0, s31
s_mov_b32 s33, 294912
buffer_load_dwordx4 v5, s[12:15], s33 offen lds
v_add_u32 v3, 64, v2
v_mul_u32_u24 v5, 43691, v3
v_lshrrev_b32 v5, 18, v5
v_mul_u32_u24 v6, 6, v5
v_sub_u32 v6, v3, v6
v_mul_u32_u24 v5, 1152, v5
v_lshl_add_u32 v5, v6, 4, v5
s_add_u32 s31, s30, 1024
s_mov_b32 m0, s31
s_mov_b32 s33, 294912
buffer_load_dwordx4 v5, s[12:15], s33 offen lds
v_add_u32 v3, 128, v2
v_mul_u32_u24 v5, 43691, v3
v_lshrrev_b32 v5, 18, v5
v_mul_u32_u24 v6, 6, v5
v_sub_u32 v6, v3, v6
v_mul_u32_u24 v5, 1152, v5
v_lshl_add_u32 v5, v6, 4, v5
s_add_u32 s31, s30, 2048
s_mov_b32 m0, s31
s_mov_b32 s33, 294912
buffer_load_dwordx4 v5, s[12:15], s33 offen lds
v_add_u32 v3, 192, v2
v_mul_u32_u24 v5, 43691, v3
v_lshrrev_b32 v5, 18, v5
v_mul_u32_u24 v6, 6, v5
v_sub_u32 v6, v3, v6
v_mul_u32_u24 v5, 1152, v5
v_lshl_add_u32 v5, v6, 4, v5
s_add_u32 s31, s30, 3072
s_mov_b32 m0, s31
s_mov_b32 s33, 294912
buffer_load_dwordx4 v5, s[12:15], s33 offen lds
v_add_u32 v3, 256, v2
v_mul_u32_u24 v5, 43691, v3
v_lshrrev_b32 v5, 18, v5
v_mul_u32_u24 v6, 6, v5
v_sub_u32 v6, v3, v6
v_mul_u32_u24 v5, 1152, v5
v_lshl_add_u32 v5, v6, 4, v5
s_add_u32 s31, s30, 4096
s_mov_b32 m0, s31
s_mov_b32 s33, 294912
buffer_load_dwordx4 v5, s[12:15], s33 offen lds
v_add_u32 v3, 320, v2
v_mul_u32_u24 v5, 43691, v3
v_lshrrev_b32 v5, 18, v5
v_mul_u32_u24 v6, 6, v5
v_sub_u32 v6, v3, v6
v_mul_u32_u24 v5, 1152, v5
v_lshl_add_u32 v5, v6, 4, v5
s_add_u32 s31, s30, 5120
s_mov_b32 m0, s31
s_mov_b32 s33, 294912
buffer_load_dwordx4 v5, s[12:15], s33 offen lds
v_add_u32 v3, 384, v2
v_mul_u32_u24 v5, 43691, v3
v_lshrrev_b32 v5, 18, v5
v_mul_u32_u24 v6, 6, v5
v_sub_u32 v6, v3, v6
v_mul_u32_u24 v5, 1152, v5
v_lshl_add_u32 v5, v6, 4, v5
s_add_u32 s31, s30, 6144
s_mov_b32 m0, s31
s_mov_b32 s33, 294912
buffer_load_dwordx4 v5, s[12:15], s33 offen lds
v_add_u32 v3, 448, v2
v_mul_u32_u24 v5, 43691, v3
v_lshrrev_b32 v5, 18, v5
v_mul_u32_u24 v6, 6, v5
v_sub_u32 v6, v3, v6
v_mul_u32_u24 v5, 1152, v5
v_lshl_add_u32 v5, v6, 4, v5
s_add_u32 s31, s30, 7168
s_mov_b32 m0, s31
s_mov_b32 s33, 294912
buffer_load_dwordx4 v5, s[12:15], s33 offen lds
v_add_u32 v3, 512, v2
v_mul_u32_u24 v5, 43691, v3
v_lshrrev_b32 v5, 18, v5
v_mul_u32_u24 v6, 6, v5
v_sub_u32 v6, v3, v6
v_mul_u32_u24 v5, 1152, v5
v_lshl_add_u32 v5, v6, 4, v5
s_add_u32 s31, s30, 8192
s_mov_b32 m0, s31
s_mov_b32 s33, 294912
buffer_load_dwordx4 v5, s[12:15], s33 offen lds
v_add_u32 v3, 576, v2
v_mul_u32_u24 v5, 43691, v3
v_lshrrev_b32 v5, 18, v5
v_mul_u32_u24 v6, 6, v5
v_sub_u32 v6, v3, v6
v_mul_u32_u24 v5, 1152, v5
v_lshl_add_u32 v5, v6, 4, v5
s_add_u32 s31, s30, 9216
s_mov_b32 m0, s31
s_mov_b32 s33, 294912
buffer_load_dwordx4 v5, s[12:15], s33 offen lds
v_add_u32 v3, 640, v2
v_mul_u32_u24 v5, 43691, v3
v_lshrrev_b32 v5, 18, v5
v_mul_u32_u24 v6, 6, v5
v_sub_u32 v6, v3, v6
v_mul_u32_u24 v5, 1152, v5
v_lshl_add_u32 v5, v6, 4, v5
s_add_u32 s31, s30, 10240
s_mov_b32 m0, s31
s_mov_b32 s33, 294912
buffer_load_dwordx4 v5, s[12:15], s33 offen lds
v_add_u32 v3, 704, v2
v_mul_u32_u24 v5, 43691, v3
v_lshrrev_b32 v5, 18, v5
v_mul_u32_u24 v6, 6, v5
v_sub_u32 v6, v3, v6
v_mul_u32_u24 v5, 1152, v5
v_lshl_add_u32 v5, v6, 4, v5
s_add_u32 s31, s30, 11264
s_mov_b32 m0, s31
s_mov_b32 s33, 294912
buffer_load_dwordx4 v5, s[12:15], s33 offen lds
v_add_u32 v3, 768, v2
v_mul_u32_u24 v5, 43691, v3
v_lshrrev_b32 v5, 18, v5
v_mul_u32_u24 v6, 6, v5
v_sub_u32 v6, v3, v6
v_mul_u32_u24 v5, 1152, v5
v_lshl_add_u32 v5, v6, 4, v5
s_add_u32 s31, s30, 12288
s_mov_b32 m0, s31
s_mov_b32 s33, 294912
buffer_load_dwordx4 v5, s[12:15], s33 offen lds
v_add_u32 v3, 832, v2
v_mul_u32_u24 v5, 43691, v3
v_lshrrev_b32 v5, 18, v5
v_mul_u32_u24 v6, 6, v5
v_sub_u32 v6, v3, v6
v_mul_u32_u24 v5, 1152, v5
v_lshl_add_u32 v5, v6, 4, v5
s_add_u32 s31, s30, 13312
s_mov_b32 m0, s31
s_mov_b32 s33, 294912
buffer_load_dwordx4 v5, s[12:15], s33 offen lds
v_add_u32 v3, 896, v2
v_mul_u32_u24 v5, 43691, v3
v_lshrrev_b32 v5, 18, v5
v_mul_u32_u24 v6, 6, v5
v_sub_u32 v6, v3, v6
v_mul_u32_u24 v5, 1152, v5
v_lshl_add_u32 v5, v6, 4, v5
s_add_u32 s31, s30, 14336
s_mov_b32 m0, s31
s_mov_b32 s33, 294912
buffer_load_dwordx4 v5, s[12:15], s33 offen lds
v_add_u32 v3, 960, v2
v_mul_u32_u24 v5, 43691, v3
v_lshrrev_b32 v5, 18, v5
v_mul_u32_u24 v6, 6, v5
v_sub_u32 v6, v3, v6
v_mul_u32_u24 v5, 1152, v5
v_lshl_add_u32 v5, v6, 4, v5
s_add_u32 s31, s30, 15360
s_mov_b32 m0, s31
s_mov_b32 s33, 294912
buffer_load_dwordx4 v5, s[12:15], s33 offen lds
v_add_u32 v3, 1024, v2
v_mul_u32_u24 v5, 43691, v3
v_lshrrev_b32 v5, 18, v5
v_mul_u32_u24 v6, 6, v5
v_sub_u32 v6, v3, v6
v_mul_u32_u24 v5, 1152, v5
v_lshl_add_u32 v5, v6, 4, v5
s_add_u32 s31, s30, 16384
s_mov_b32 m0, s31
s_mov_b32 s33, 294912
buffer_load_dwordx4 v5, s[12:15], s33 offen lds
v_add_u32 v3, 1088, v2
v_mul_u32_u24 v5, 43691, v3
v_lshrrev_b32 v5, 18, v5
v_mul_u32_u24 v6, 6, v5
v_sub_u32 v6, v3, v6
v_mul_u32_u24 v5, 1152, v5
v_lshl_add_u32 v5, v6, 4, v5
s_add_u32 s31, s30, 17408
s_mov_b32 m0, s31
s_mov_b32 s33, 294912
buffer_load_dwordx4 v5, s[12:15], s33 offen lds
v_add_u32 v3, 1152, v2
v_mul_u32_u24 v5, 43691, v3
v_lshrrev_b32 v5, 18, v5
v_mul_u32_u24 v6, 6, v5
v_sub_u32 v6, v3, v6
v_mul_u32_u24 v5, 1152, v5
v_lshl_add_u32 v5, v6, 4, v5
s_add_u32 s31, s30, 18432
s_mov_b32 m0, s31
s_mov_b32 s33, 294912
buffer_load_dwordx4 v5, s[12:15], s33 offen lds
v_add_u32 v3, 1216, v2
v_mul_u32_u24 v5, 43691, v3
v_lshrrev_b32 v5, 18, v5
v_mul_u32_u24 v6, 6, v5
v_sub_u32 v6, v3, v6
v_mul_u32_u24 v5, 1152, v5
v_lshl_add_u32 v5, v6, 4, v5
s_add_u32 s31, s30, 19456
s_mov_b32 m0, s31
s_mov_b32 s33, 294912
buffer_load_dwordx4 v5, s[12:15], s33 offen lds
v_add_u32 v3, 1280, v2
v_mul_u32_u24 v5, 43691, v3
v_lshrrev_b32 v5, 18, v5
v_mul_u32_u24 v6, 6, v5
v_sub_u32 v6, v3, v6
v_mul_u32_u24 v5, 1152, v5
v_lshl_add_u32 v5, v6, 4, v5
s_add_u32 s31, s30, 20480
s_mov_b32 m0, s31
s_mov_b32 s33, 294912
buffer_load_dwordx4 v5, s[12:15], s33 offen lds
v_add_u32 v3, 1344, v2
v_mul_u32_u24 v5, 43691, v3
v_lshrrev_b32 v5, 18, v5
v_mul_u32_u24 v6, 6, v5
v_sub_u32 v6, v3, v6
v_mul_u32_u24 v5, 1152, v5
v_lshl_add_u32 v5, v6, 4, v5
s_add_u32 s31, s30, 21504
s_mov_b32 m0, s31
s_mov_b32 s33, 294912
buffer_load_dwordx4 v5, s[12:15], s33 offen lds
v_add_u32 v3, 1408, v2
v_mul_u32_u24 v5, 43691, v3
v_lshrrev_b32 v5, 18, v5
v_mul_u32_u24 v6, 6, v5
v_sub_u32 v6, v3, v6
v_mul_u32_u24 v5, 1152, v5
v_lshl_add_u32 v5, v6, 4, v5
s_add_u32 s31, s30, 22528
s_mov_b32 m0, s31
s_mov_b32 s33, 294912
buffer_load_dwordx4 v5, s[12:15], s33 offen lds
v_add_u32 v3, 1472, v2
v_mul_u32_u24 v5, 43691, v3
v_lshrrev_b32 v5, 18, v5
v_mul_u32_u24 v6, 6, v5
v_sub_u32 v6, v3, v6
v_mul_u32_u24 v5, 1152, v5
v_lshl_add_u32 v5, v6, 4, v5
s_add_u32 s31, s30, 23552
s_mov_b32 m0, s31
s_mov_b32 s33, 294912
buffer_load_dwordx4 v5, s[12:15], s33 offen lds
s_waitcnt vmcnt(0)
ds_read_b64_tr_b16 a[32:33], v4 offset:0
ds_read_b64_tr_b16 a[34:35], v4 offset:1536
ds_read_b64_tr_b16 a[160:161], v4 offset:32
ds_read_b64_tr_b16 a[162:163], v4 offset:1568
ds_read_b64_tr_b16 v[160:161], v4 offset:64
ds_read_b64_tr_b16 v[162:163], v4 offset:1600
s_waitcnt lgkmcnt(0)
ds_read_b64_tr_b16 a[36:37], v4 offset:3072
ds_read_b64_tr_b16 a[38:39], v4 offset:4608
ds_read_b64_tr_b16 a[164:165], v4 offset:3104
ds_read_b64_tr_b16 a[166:167], v4 offset:4640
ds_read_b64_tr_b16 v[164:165], v4 offset:3136
ds_read_b64_tr_b16 v[166:167], v4 offset:4672
s_waitcnt lgkmcnt(0)
ds_read_b64_tr_b16 a[40:41], v4 offset:6144
ds_read_b64_tr_b16 a[42:43], v4 offset:7680
ds_read_b64_tr_b16 a[168:169], v4 offset:6176
ds_read_b64_tr_b16 a[170:171], v4 offset:7712
ds_read_b64_tr_b16 v[168:169], v4 offset:6208
ds_read_b64_tr_b16 v[170:171], v4 offset:7744
s_waitcnt lgkmcnt(0)
ds_read_b64_tr_b16 a[44:45], v4 offset:9216
ds_read_b64_tr_b16 a[46:47], v4 offset:10752
ds_read_b64_tr_b16 a[172:173], v4 offset:9248
ds_read_b64_tr_b16 a[174:175], v4 offset:10784
ds_read_b64_tr_b16 v[172:173], v4 offset:9280
ds_read_b64_tr_b16 v[174:175], v4 offset:10816
s_waitcnt lgkmcnt(0)
ds_read_b64_tr_b16 a[48:49], v4 offset:12288
ds_read_b64_tr_b16 a[50:51], v4 offset:13824
ds_read_b64_tr_b16 a[176:177], v4 offset:12320
ds_read_b64_tr_b16 a[178:179], v4 offset:13856
ds_read_b64_tr_b16 v[176:177], v4 offset:12352
ds_read_b64_tr_b16 v[178:179], v4 offset:13888
s_waitcnt lgkmcnt(0)
ds_read_b64_tr_b16 a[52:53], v4 offset:15360
ds_read_b64_tr_b16 a[54:55], v4 offset:16896
ds_read_b64_tr_b16 a[180:181], v4 offset:15392
ds_read_b64_tr_b16 a[182:183], v4 offset:16928
ds_read_b64_tr_b16 v[180:181], v4 offset:15424
ds_read_b64_tr_b16 v[182:183], v4 offset:16960
s_waitcnt lgkmcnt(0)
ds_read_b64_tr_b16 a[56:57], v4 offset:18432
ds_read_b64_tr_b16 a[58:59], v4 offset:19968
ds_read_b64_tr_b16 a[184:185], v4 offset:18464
ds_read_b64_tr_b16 a[186:187], v4 offset:20000
ds_read_b64_tr_b16 v[184:185], v4 offset:18496
ds_read_b64_tr_b16 v[186:187], v4 offset:20032
s_waitcnt lgkmcnt(0)
ds_read_b64_tr_b16 a[60:61], v4 offset:21504
ds_read_b64_tr_b16 a[62:63], v4 offset:23040
ds_read_b64_tr_b16 a[188:189], v4 offset:21536
ds_read_b64_tr_b16 a[190:191], v4 offset:23072
ds_read_b64_tr_b16 v[188:189], v4 offset:21568
ds_read_b64_tr_b16 v[190:191], v4 offset:23104
s_waitcnt lgkmcnt(0)
v_add_u32 v3, 0, v2
v_mul_u32_u24 v5, 43691, v3
v_lshrrev_b32 v5, 18, v5
v_mul_u32_u24 v6, 6, v5
v_sub_u32 v6, v3, v6
v_mul_u32_u24 v5, 1152, v5
v_lshl_add_u32 v5, v6, 4, v5
s_add_u32 s31, s30, 0
s_mov_b32 m0, s31
s_mov_b32 s33, 589824
buffer_load_dwordx4 v5, s[12:15], s33 offen lds
v_add_u32 v3, 64, v2
v_mul_u32_u24 v5, 43691, v3
v_lshrrev_b32 v5, 18, v5
v_mul_u32_u24 v6, 6, v5
v_sub_u32 v6, v3, v6
v_mul_u32_u24 v5, 1152, v5
v_lshl_add_u32 v5, v6, 4, v5
s_add_u32 s31, s30, 1024
s_mov_b32 m0, s31
s_mov_b32 s33, 589824
buffer_load_dwordx4 v5, s[12:15], s33 offen lds
v_add_u32 v3, 128, v2
v_mul_u32_u24 v5, 43691, v3
v_lshrrev_b32 v5, 18, v5
v_mul_u32_u24 v6, 6, v5
v_sub_u32 v6, v3, v6
v_mul_u32_u24 v5, 1152, v5
v_lshl_add_u32 v5, v6, 4, v5
s_add_u32 s31, s30, 2048
s_mov_b32 m0, s31
s_mov_b32 s33, 589824
buffer_load_dwordx4 v5, s[12:15], s33 offen lds
v_add_u32 v3, 192, v2
v_mul_u32_u24 v5, 43691, v3
v_lshrrev_b32 v5, 18, v5
v_mul_u32_u24 v6, 6, v5
v_sub_u32 v6, v3, v6
v_mul_u32_u24 v5, 1152, v5
v_lshl_add_u32 v5, v6, 4, v5
s_add_u32 s31, s30, 3072
s_mov_b32 m0, s31
s_mov_b32 s33, 589824
buffer_load_dwordx4 v5, s[12:15], s33 offen lds
v_add_u32 v3, 256, v2
v_mul_u32_u24 v5, 43691, v3
v_lshrrev_b32 v5, 18, v5
v_mul_u32_u24 v6, 6, v5
v_sub_u32 v6, v3, v6
v_mul_u32_u24 v5, 1152, v5
v_lshl_add_u32 v5, v6, 4, v5
s_add_u32 s31, s30, 4096
s_mov_b32 m0, s31
s_mov_b32 s33, 589824
buffer_load_dwordx4 v5, s[12:15], s33 offen lds
v_add_u32 v3, 320, v2
v_mul_u32_u24 v5, 43691, v3
v_lshrrev_b32 v5, 18, v5
v_mul_u32_u24 v6, 6, v5
v_sub_u32 v6, v3, v6
v_mul_u32_u24 v5, 1152, v5
v_lshl_add_u32 v5, v6, 4, v5
s_add_u32 s31, s30, 5120
s_mov_b32 m0, s31
s_mov_b32 s33, 589824
buffer_load_dwordx4 v5, s[12:15], s33 offen lds
v_add_u32 v3, 384, v2
v_mul_u32_u24 v5, 43691, v3
v_lshrrev_b32 v5, 18, v5
v_mul_u32_u24 v6, 6, v5
v_sub_u32 v6, v3, v6
v_mul_u32_u24 v5, 1152, v5
v_lshl_add_u32 v5, v6, 4, v5
s_add_u32 s31, s30, 6144
s_mov_b32 m0, s31
s_mov_b32 s33, 589824
buffer_load_dwordx4 v5, s[12:15], s33 offen lds
v_add_u32 v3, 448, v2
v_mul_u32_u24 v5, 43691, v3
v_lshrrev_b32 v5, 18, v5
v_mul_u32_u24 v6, 6, v5
v_sub_u32 v6, v3, v6
v_mul_u32_u24 v5, 1152, v5
v_lshl_add_u32 v5, v6, 4, v5
s_add_u32 s31, s30, 7168
s_mov_b32 m0, s31
s_mov_b32 s33, 589824
buffer_load_dwordx4 v5, s[12:15], s33 offen lds
v_add_u32 v3, 512, v2
v_mul_u32_u24 v5, 43691, v3
v_lshrrev_b32 v5, 18, v5
v_mul_u32_u24 v6, 6, v5
v_sub_u32 v6, v3, v6
v_mul_u32_u24 v5, 1152, v5
v_lshl_add_u32 v5, v6, 4, v5
s_add_u32 s31, s30, 8192
s_mov_b32 m0, s31
s_mov_b32 s33, 589824
buffer_load_dwordx4 v5, s[12:15], s33 offen lds
v_add_u32 v3, 576, v2
v_mul_u32_u24 v5, 43691, v3
v_lshrrev_b32 v5, 18, v5
v_mul_u32_u24 v6, 6, v5
v_sub_u32 v6, v3, v6
v_mul_u32_u24 v5, 1152, v5
v_lshl_add_u32 v5, v6, 4, v5
s_add_u32 s31, s30, 9216
s_mov_b32 m0, s31
s_mov_b32 s33, 589824
buffer_load_dwordx4 v5, s[12:15], s33 offen lds
v_add_u32 v3, 640, v2
v_mul_u32_u24 v5, 43691, v3
v_lshrrev_b32 v5, 18, v5
v_mul_u32_u24 v6, 6, v5
v_sub_u32 v6, v3, v6
v_mul_u32_u24 v5, 1152, v5
v_lshl_add_u32 v5, v6, 4, v5
s_add_u32 s31, s30, 10240
s_mov_b32 m0, s31
s_mov_b32 s33, 589824
buffer_load_dwordx4 v5, s[12:15], s33 offen lds
v_add_u32 v3, 704, v2
v_mul_u32_u24 v5, 43691, v3
v_lshrrev_b32 v5, 18, v5
v_mul_u32_u24 v6, 6, v5
v_sub_u32 v6, v3, v6
v_mul_u32_u24 v5, 1152, v5
v_lshl_add_u32 v5, v6, 4, v5
s_add_u32 s31, s30, 11264
s_mov_b32 m0, s31
s_mov_b32 s33, 589824
buffer_load_dwordx4 v5, s[12:15], s33 offen lds
v_add_u32 v3, 768, v2
v_mul_u32_u24 v5, 43691, v3
v_lshrrev_b32 v5, 18, v5
v_mul_u32_u24 v6, 6, v5
v_sub_u32 v6, v3, v6
v_mul_u32_u24 v5, 1152, v5
v_lshl_add_u32 v5, v6, 4, v5
s_add_u32 s31, s30, 12288
s_mov_b32 m0, s31
s_mov_b32 s33, 589824
buffer_load_dwordx4 v5, s[12:15], s33 offen lds
v_add_u32 v3, 832, v2
v_mul_u32_u24 v5, 43691, v3
v_lshrrev_b32 v5, 18, v5
v_mul_u32_u24 v6, 6, v5
v_sub_u32 v6, v3, v6
v_mul_u32_u24 v5, 1152, v5
v_lshl_add_u32 v5, v6, 4, v5
s_add_u32 s31, s30, 13312
s_mov_b32 m0, s31
s_mov_b32 s33, 589824
buffer_load_dwordx4 v5, s[12:15], s33 offen lds
v_add_u32 v3, 896, v2
v_mul_u32_u24 v5, 43691, v3
v_lshrrev_b32 v5, 18, v5
v_mul_u32_u24 v6, 6, v5
v_sub_u32 v6, v3, v6
v_mul_u32_u24 v5, 1152, v5
v_lshl_add_u32 v5, v6, 4, v5
s_add_u32 s31, s30, 14336
s_mov_b32 m0, s31
s_mov_b32 s33, 589824
buffer_load_dwordx4 v5, s[12:15], s33 offen lds
v_add_u32 v3, 960, v2
v_mul_u32_u24 v5, 43691, v3
v_lshrrev_b32 v5, 18, v5
v_mul_u32_u24 v6, 6, v5
v_sub_u32 v6, v3, v6
v_mul_u32_u24 v5, 1152, v5
v_lshl_add_u32 v5, v6, 4, v5
s_add_u32 s31, s30, 15360
s_mov_b32 m0, s31
s_mov_b32 s33, 589824
buffer_load_dwordx4 v5, s[12:15], s33 offen lds
v_add_u32 v3, 1024, v2
v_mul_u32_u24 v5, 43691, v3
v_lshrrev_b32 v5, 18, v5
v_mul_u32_u24 v6, 6, v5
v_sub_u32 v6, v3, v6
v_mul_u32_u24 v5, 1152, v5
v_lshl_add_u32 v5, v6, 4, v5
s_add_u32 s31, s30, 16384
s_mov_b32 m0, s31
s_mov_b32 s33, 589824
buffer_load_dwordx4 v5, s[12:15], s33 offen lds
v_add_u32 v3, 1088, v2
v_mul_u32_u24 v5, 43691, v3
v_lshrrev_b32 v5, 18, v5
v_mul_u32_u24 v6, 6, v5
v_sub_u32 v6, v3, v6
v_mul_u32_u24 v5, 1152, v5
v_lshl_add_u32 v5, v6, 4, v5
s_add_u32 s31, s30, 17408
s_mov_b32 m0, s31
s_mov_b32 s33, 589824
buffer_load_dwordx4 v5, s[12:15], s33 offen lds
v_add_u32 v3, 1152, v2
v_mul_u32_u24 v5, 43691, v3
v_lshrrev_b32 v5, 18, v5
v_mul_u32_u24 v6, 6, v5
v_sub_u32 v6, v3, v6
v_mul_u32_u24 v5, 1152, v5
v_lshl_add_u32 v5, v6, 4, v5
s_add_u32 s31, s30, 18432
s_mov_b32 m0, s31
s_mov_b32 s33, 589824
buffer_load_dwordx4 v5, s[12:15], s33 offen lds
v_add_u32 v3, 1216, v2
v_mul_u32_u24 v5, 43691, v3
v_lshrrev_b32 v5, 18, v5
v_mul_u32_u24 v6, 6, v5
v_sub_u32 v6, v3, v6
v_mul_u32_u24 v5, 1152, v5
v_lshl_add_u32 v5, v6, 4, v5
s_add_u32 s31, s30, 19456
s_mov_b32 m0, s31
s_mov_b32 s33, 589824
buffer_load_dwordx4 v5, s[12:15], s33 offen lds
v_add_u32 v3, 1280, v2
v_mul_u32_u24 v5, 43691, v3
v_lshrrev_b32 v5, 18, v5
v_mul_u32_u24 v6, 6, v5
v_sub_u32 v6, v3, v6
v_mul_u32_u24 v5, 1152, v5
v_lshl_add_u32 v5, v6, 4, v5
s_add_u32 s31, s30, 20480
s_mov_b32 m0, s31
s_mov_b32 s33, 589824
buffer_load_dwordx4 v5, s[12:15], s33 offen lds
v_add_u32 v3, 1344, v2
v_mul_u32_u24 v5, 43691, v3
v_lshrrev_b32 v5, 18, v5
v_mul_u32_u24 v6, 6, v5
v_sub_u32 v6, v3, v6
v_mul_u32_u24 v5, 1152, v5
v_lshl_add_u32 v5, v6, 4, v5
s_add_u32 s31, s30, 21504
s_mov_b32 m0, s31
s_mov_b32 s33, 589824
buffer_load_dwordx4 v5, s[12:15], s33 offen lds
v_add_u32 v3, 1408, v2
v_mul_u32_u24 v5, 43691, v3
v_lshrrev_b32 v5, 18, v5
v_mul_u32_u24 v6, 6, v5
v_sub_u32 v6, v3, v6
v_mul_u32_u24 v5, 1152, v5
v_lshl_add_u32 v5, v6, 4, v5
s_add_u32 s31, s30, 22528
s_mov_b32 m0, s31
s_mov_b32 s33, 589824
buffer_load_dwordx4 v5, s[12:15], s33 offen lds
v_add_u32 v3, 1472, v2
v_mul_u32_u24 v5, 43691, v3
v_lshrrev_b32 v5, 18, v5
v_mul_u32_u24 v6, 6, v5
v_sub_u32 v6, v3, v6
v_mul_u32_u24 v5, 1152, v5
v_lshl_add_u32 v5, v6, 4, v5
s_add_u32 s31, s30, 23552
s_mov_b32 m0, s31
s_mov_b32 s33, 589824
buffer_load_dwordx4 v5, s[12:15], s33 offen lds
s_waitcnt vmcnt(0)
ds_read_b64_tr_b16 a[64:65], v4 offset:0
ds_read_b64_tr_b16 a[66:67], v4 offset:1536
ds_read_b64_tr_b16 a[192:193], v4 offset:32
ds_read_b64_tr_b16 a[194:195], v4 offset:1568
ds_read_b64_tr_b16 v[192:193], v4 offset:64
ds_read_b64_tr_b16 v[194:195], v4 offset:1600
s_waitcnt lgkmcnt(0)
ds_read_b64_tr_b16 a[68:69], v4 offset:3072
ds_read_b64_tr_b16 a[70:71], v4 offset:4608
ds_read_b64_tr_b16 a[196:197], v4 offset:3104
ds_read_b64_tr_b16 a[198:199], v4 offset:4640
ds_read_b64_tr_b16 v[196:197], v4 offset:3136
ds_read_b64_tr_b16 v[198:199], v4 offset:4672
s_waitcnt lgkmcnt(0)
ds_read_b64_tr_b16 a[72:73], v4 offset:6144
ds_read_b64_tr_b16 a[74:75], v4 offset:7680
ds_read_b64_tr_b16 a[200:201], v4 offset:6176
ds_read_b64_tr_b16 a[202:203], v4 offset:7712
ds_read_b64_tr_b16 v[200:201], v4 offset:6208
ds_read_b64_tr_b16 v[202:203], v4 offset:7744
s_waitcnt lgkmcnt(0)
ds_read_b64_tr_b16 a[76:77], v4 offset:9216
ds_read_b64_tr_b16 a[78:79], v4 offset:10752
ds_read_b64_tr_b16 a[204:205], v4 offset:9248
ds_read_b64_tr_b16 a[206:207], v4 offset:10784
ds_read_b64_tr_b16 v[204:205], v4 offset:9280
ds_read_b64_tr_b16 v[206:207], v4 offset:10816
s_waitcnt lgkmcnt(0)
ds_read_b64_tr_b16 a[80:81], v4 offset:12288
ds_read_b64_tr_b16 a[82:83], v4 offset:13824
ds_read_b64_tr_b16 a[208:209], v4 offset:12320
ds_read_b64_tr_b16 a[210:211], v4 offset:13856
ds_read_b64_tr_b16 v[208:209], v4 offset:12352
ds_read_b64_tr_b16 v[210:211], v4 offset:13888
s_waitcnt lgkmcnt(0)
ds_read_b64_tr_b16 a[84:85], v4 offset:15360
ds_read_b64_tr_b16 a[86:87], v4 offset:16896
ds_read_b64_tr_b16 a[212:213], v4 offset:15392
ds_read_b64_tr_b16 a[214:215], v4 offset:16928
ds_read_b64_tr_b16 v[212:213], v4 offset:15424
ds_read_b64_tr_b16 v[214:215], v4 offset:16960
s_waitcnt lgkmcnt(0)
ds_read_b64_tr_b16 a[88:89], v4 offset:18432
ds_read_b64_tr_b16 a[90:91], v4 offset:19968
ds_read_b64_tr_b16 a[216:217], v4 offset:18464
ds_read_b64_tr_b16 a[218:219], v4 offset:20000
ds_read_b64_tr_b16 v[216:217], v4 offset:18496
ds_read_b64_tr_b16 v[218:219], v4 offset:20032
s_waitcnt lgkmcnt(0)
ds_read_b64_tr_b16 a[92:93], v4 offset:21504
ds_read_b64_tr_b16 a[94:95], v4 offset:23040
ds_read_b64_tr_b16 a[220:221], v4 offset:21536
ds_read_b64_tr_b16 a[222:223], v4 offset:23072
ds_read_b64_tr_b16 v[220:221], v4 offset:21568
ds_read_b64_tr_b16 v[222:223], v4 offset:23104
s_waitcnt lgkmcnt(0)
v_add_u32 v3, 0, v2
v_mul_u32_u24 v5, 43691, v3
v_lshrrev_b32 v5, 18, v5
v_mul_u32_u24 v6, 6, v5
v_sub_u32 v6, v3, v6
v_mul_u32_u24 v5, 1152, v5
v_lshl_add_u32 v5, v6, 4, v5
s_add_u32 s31, s30, 0
s_mov_b32 m0, s31
s_mov_b32 s33, 884736
buffer_load_dwordx4 v5, s[12:15], s33 offen lds
v_add_u32 v3, 64, v2
v_mul_u32_u24 v5, 43691, v3
v_lshrrev_b32 v5, 18, v5
v_mul_u32_u24 v6, 6, v5
v_sub_u32 v6, v3, v6
v_mul_u32_u24 v5, 1152, v5
v_lshl_add_u32 v5, v6, 4, v5
s_add_u32 s31, s30, 1024
s_mov_b32 m0, s31
s_mov_b32 s33, 884736
buffer_load_dwordx4 v5, s[12:15], s33 offen lds
v_add_u32 v3, 128, v2
v_mul_u32_u24 v5, 43691, v3
v_lshrrev_b32 v5, 18, v5
v_mul_u32_u24 v6, 6, v5
v_sub_u32 v6, v3, v6
v_mul_u32_u24 v5, 1152, v5
v_lshl_add_u32 v5, v6, 4, v5
s_add_u32 s31, s30, 2048
s_mov_b32 m0, s31
s_mov_b32 s33, 884736
buffer_load_dwordx4 v5, s[12:15], s33 offen lds
v_add_u32 v3, 192, v2
v_mul_u32_u24 v5, 43691, v3
v_lshrrev_b32 v5, 18, v5
v_mul_u32_u24 v6, 6, v5
v_sub_u32 v6, v3, v6
v_mul_u32_u24 v5, 1152, v5
v_lshl_add_u32 v5, v6, 4, v5
s_add_u32 s31, s30, 3072
s_mov_b32 m0, s31
s_mov_b32 s33, 884736
buffer_load_dwordx4 v5, s[12:15], s33 offen lds
v_add_u32 v3, 256, v2
v_mul_u32_u24 v5, 43691, v3
v_lshrrev_b32 v5, 18, v5
v_mul_u32_u24 v6, 6, v5
v_sub_u32 v6, v3, v6
v_mul_u32_u24 v5, 1152, v5
v_lshl_add_u32 v5, v6, 4, v5
s_add_u32 s31, s30, 4096
s_mov_b32 m0, s31
s_mov_b32 s33, 884736
buffer_load_dwordx4 v5, s[12:15], s33 offen lds
v_add_u32 v3, 320, v2
v_mul_u32_u24 v5, 43691, v3
v_lshrrev_b32 v5, 18, v5
v_mul_u32_u24 v6, 6, v5
v_sub_u32 v6, v3, v6
v_mul_u32_u24 v5, 1152, v5
v_lshl_add_u32 v5, v6, 4, v5
s_add_u32 s31, s30, 5120
s_mov_b32 m0, s31
s_mov_b32 s33, 884736
buffer_load_dwordx4 v5, s[12:15], s33 offen lds
v_add_u32 v3, 384, v2
v_mul_u32_u24 v5, 43691, v3
v_lshrrev_b32 v5, 18, v5
v_mul_u32_u24 v6, 6, v5
v_sub_u32 v6, v3, v6
v_mul_u32_u24 v5, 1152, v5
v_lshl_add_u32 v5, v6, 4, v5
s_add_u32 s31, s30, 6144
s_mov_b32 m0, s31
s_mov_b32 s33, 884736
buffer_load_dwordx4 v5, s[12:15], s33 offen lds
v_add_u32 v3, 448, v2
v_mul_u32_u24 v5, 43691, v3
v_lshrrev_b32 v5, 18, v5
v_mul_u32_u24 v6, 6, v5
v_sub_u32 v6, v3, v6
v_mul_u32_u24 v5, 1152, v5
v_lshl_add_u32 v5, v6, 4, v5
s_add_u32 s31, s30, 7168
s_mov_b32 m0, s31
s_mov_b32 s33, 884736
buffer_load_dwordx4 v5, s[12:15], s33 offen lds
v_add_u32 v3, 512, v2
v_mul_u32_u24 v5, 43691, v3
v_lshrrev_b32 v5, 18, v5
v_mul_u32_u24 v6, 6, v5
v_sub_u32 v6, v3, v6
v_mul_u32_u24 v5, 1152, v5
v_lshl_add_u32 v5, v6, 4, v5
s_add_u32 s31, s30, 8192
s_mov_b32 m0, s31
s_mov_b32 s33, 884736
buffer_load_dwordx4 v5, s[12:15], s33 offen lds
v_add_u32 v3, 576, v2
v_mul_u32_u24 v5, 43691, v3
v_lshrrev_b32 v5, 18, v5
v_mul_u32_u24 v6, 6, v5
v_sub_u32 v6, v3, v6
v_mul_u32_u24 v5, 1152, v5
v_lshl_add_u32 v5, v6, 4, v5
s_add_u32 s31, s30, 9216
s_mov_b32 m0, s31
s_mov_b32 s33, 884736
buffer_load_dwordx4 v5, s[12:15], s33 offen lds
v_add_u32 v3, 640, v2
v_mul_u32_u24 v5, 43691, v3
v_lshrrev_b32 v5, 18, v5
v_mul_u32_u24 v6, 6, v5
v_sub_u32 v6, v3, v6
v_mul_u32_u24 v5, 1152, v5
v_lshl_add_u32 v5, v6, 4, v5
s_add_u32 s31, s30, 10240
s_mov_b32 m0, s31
s_mov_b32 s33, 884736
buffer_load_dwordx4 v5, s[12:15], s33 offen lds
v_add_u32 v3, 704, v2
v_mul_u32_u24 v5, 43691, v3
v_lshrrev_b32 v5, 18, v5
v_mul_u32_u24 v6, 6, v5
v_sub_u32 v6, v3, v6
v_mul_u32_u24 v5, 1152, v5
v_lshl_add_u32 v5, v6, 4, v5
s_add_u32 s31, s30, 11264
s_mov_b32 m0, s31
s_mov_b32 s33, 884736
buffer_load_dwordx4 v5, s[12:15], s33 offen lds
v_add_u32 v3, 768, v2
v_mul_u32_u24 v5, 43691, v3
v_lshrrev_b32 v5, 18, v5
v_mul_u32_u24 v6, 6, v5
v_sub_u32 v6, v3, v6
v_mul_u32_u24 v5, 1152, v5
v_lshl_add_u32 v5, v6, 4, v5
s_add_u32 s31, s30, 12288
s_mov_b32 m0, s31
s_mov_b32 s33, 884736
buffer_load_dwordx4 v5, s[12:15], s33 offen lds
v_add_u32 v3, 832, v2
v_mul_u32_u24 v5, 43691, v3
v_lshrrev_b32 v5, 18, v5
v_mul_u32_u24 v6, 6, v5
v_sub_u32 v6, v3, v6
v_mul_u32_u24 v5, 1152, v5
v_lshl_add_u32 v5, v6, 4, v5
s_add_u32 s31, s30, 13312
s_mov_b32 m0, s31
s_mov_b32 s33, 884736
buffer_load_dwordx4 v5, s[12:15], s33 offen lds
v_add_u32 v3, 896, v2
v_mul_u32_u24 v5, 43691, v3
v_lshrrev_b32 v5, 18, v5
v_mul_u32_u24 v6, 6, v5
v_sub_u32 v6, v3, v6
v_mul_u32_u24 v5, 1152, v5
v_lshl_add_u32 v5, v6, 4, v5
s_add_u32 s31, s30, 14336
s_mov_b32 m0, s31
s_mov_b32 s33, 884736
buffer_load_dwordx4 v5, s[12:15], s33 offen lds
v_add_u32 v3, 960, v2
v_mul_u32_u24 v5, 43691, v3
v_lshrrev_b32 v5, 18, v5
v_mul_u32_u24 v6, 6, v5
v_sub_u32 v6, v3, v6
v_mul_u32_u24 v5, 1152, v5
v_lshl_add_u32 v5, v6, 4, v5
s_add_u32 s31, s30, 15360
s_mov_b32 m0, s31
s_mov_b32 s33, 884736
buffer_load_dwordx4 v5, s[12:15], s33 offen lds
v_add_u32 v3, 1024, v2
v_mul_u32_u24 v5, 43691, v3
v_lshrrev_b32 v5, 18, v5
v_mul_u32_u24 v6, 6, v5
v_sub_u32 v6, v3, v6
v_mul_u32_u24 v5, 1152, v5
v_lshl_add_u32 v5, v6, 4, v5
s_add_u32 s31, s30, 16384
s_mov_b32 m0, s31
s_mov_b32 s33, 884736
buffer_load_dwordx4 v5, s[12:15], s33 offen lds
v_add_u32 v3, 1088, v2
v_mul_u32_u24 v5, 43691, v3
v_lshrrev_b32 v5, 18, v5
v_mul_u32_u24 v6, 6, v5
v_sub_u32 v6, v3, v6
v_mul_u32_u24 v5, 1152, v5
v_lshl_add_u32 v5, v6, 4, v5
s_add_u32 s31, s30, 17408
s_mov_b32 m0, s31
s_mov_b32 s33, 884736
buffer_load_dwordx4 v5, s[12:15], s33 offen lds
v_add_u32 v3, 1152, v2
v_mul_u32_u24 v5, 43691, v3
v_lshrrev_b32 v5, 18, v5
v_mul_u32_u24 v6, 6, v5
v_sub_u32 v6, v3, v6
v_mul_u32_u24 v5, 1152, v5
v_lshl_add_u32 v5, v6, 4, v5
s_add_u32 s31, s30, 18432
s_mov_b32 m0, s31
s_mov_b32 s33, 884736
buffer_load_dwordx4 v5, s[12:15], s33 offen lds
v_add_u32 v3, 1216, v2
v_mul_u32_u24 v5, 43691, v3
v_lshrrev_b32 v5, 18, v5
v_mul_u32_u24 v6, 6, v5
v_sub_u32 v6, v3, v6
v_mul_u32_u24 v5, 1152, v5
v_lshl_add_u32 v5, v6, 4, v5
s_add_u32 s31, s30, 19456
s_mov_b32 m0, s31
s_mov_b32 s33, 884736
buffer_load_dwordx4 v5, s[12:15], s33 offen lds
v_add_u32 v3, 1280, v2
v_mul_u32_u24 v5, 43691, v3
v_lshrrev_b32 v5, 18, v5
v_mul_u32_u24 v6, 6, v5
v_sub_u32 v6, v3, v6
v_mul_u32_u24 v5, 1152, v5
v_lshl_add_u32 v5, v6, 4, v5
s_add_u32 s31, s30, 20480
s_mov_b32 m0, s31
s_mov_b32 s33, 884736
buffer_load_dwordx4 v5, s[12:15], s33 offen lds
v_add_u32 v3, 1344, v2
v_mul_u32_u24 v5, 43691, v3
v_lshrrev_b32 v5, 18, v5
v_mul_u32_u24 v6, 6, v5
v_sub_u32 v6, v3, v6
v_mul_u32_u24 v5, 1152, v5
v_lshl_add_u32 v5, v6, 4, v5
s_add_u32 s31, s30, 21504
s_mov_b32 m0, s31
s_mov_b32 s33, 884736
buffer_load_dwordx4 v5, s[12:15], s33 offen lds
v_add_u32 v3, 1408, v2
v_mul_u32_u24 v5, 43691, v3
v_lshrrev_b32 v5, 18, v5
v_mul_u32_u24 v6, 6, v5
v_sub_u32 v6, v3, v6
v_mul_u32_u24 v5, 1152, v5
v_lshl_add_u32 v5, v6, 4, v5
s_add_u32 s31, s30, 22528
s_mov_b32 m0, s31
s_mov_b32 s33, 884736
buffer_load_dwordx4 v5, s[12:15], s33 offen lds
v_add_u32 v3, 1472, v2
v_mul_u32_u24 v5, 43691, v3
v_lshrrev_b32 v5, 18, v5
v_mul_u32_u24 v6, 6, v5
v_sub_u32 v6, v3, v6
v_mul_u32_u24 v5, 1152, v5
v_lshl_add_u32 v5, v6, 4, v5
s_add_u32 s31, s30, 23552
s_mov_b32 m0, s31
s_mov_b32 s33, 884736
buffer_load_dwordx4 v5, s[12:15], s33 offen lds
s_waitcnt vmcnt(0)
ds_read_b64_tr_b16 a[96:97], v4 offset:0
ds_read_b64_tr_b16 a[98:99], v4 offset:1536
ds_read_b64_tr_b16 a[224:225], v4 offset:32
ds_read_b64_tr_b16 a[226:227], v4 offset:1568
ds_read_b64_tr_b16 v[224:225], v4 offset:64
ds_read_b64_tr_b16 v[226:227], v4 offset:1600
s_waitcnt lgkmcnt(0)
ds_read_b64_tr_b16 a[100:101], v4 offset:3072
ds_read_b64_tr_b16 a[102:103], v4 offset:4608
ds_read_b64_tr_b16 a[228:229], v4 offset:3104
ds_read_b64_tr_b16 a[230:231], v4 offset:4640
ds_read_b64_tr_b16 v[228:229], v4 offset:3136
ds_read_b64_tr_b16 v[230:231], v4 offset:4672
s_waitcnt lgkmcnt(0)
ds_read_b64_tr_b16 a[104:105], v4 offset:6144
ds_read_b64_tr_b16 a[106:107], v4 offset:7680
ds_read_b64_tr_b16 a[232:233], v4 offset:6176
ds_read_b64_tr_b16 a[234:235], v4 offset:7712
ds_read_b64_tr_b16 v[232:233], v4 offset:6208
ds_read_b64_tr_b16 v[234:235], v4 offset:7744
s_waitcnt lgkmcnt(0)
ds_read_b64_tr_b16 a[108:109], v4 offset:9216
ds_read_b64_tr_b16 a[110:111], v4 offset:10752
ds_read_b64_tr_b16 a[236:237], v4 offset:9248
ds_read_b64_tr_b16 a[238:239], v4 offset:10784
ds_read_b64_tr_b16 v[236:237], v4 offset:9280
ds_read_b64_tr_b16 v[238:239], v4 offset:10816
s_waitcnt lgkmcnt(0)
ds_read_b64_tr_b16 a[112:113], v4 offset:12288
ds_read_b64_tr_b16 a[114:115], v4 offset:13824
ds_read_b64_tr_b16 a[240:241], v4 offset:12320
ds_read_b64_tr_b16 a[242:243], v4 offset:13856
ds_read_b64_tr_b16 v[240:241], v4 offset:12352
ds_read_b64_tr_b16 v[242:243], v4 offset:13888
s_waitcnt lgkmcnt(0)
ds_read_b64_tr_b16 a[116:117], v4 offset:15360
ds_read_b64_tr_b16 a[118:119], v4 offset:16896
ds_read_b64_tr_b16 a[244:245], v4 offset:15392
ds_read_b64_tr_b16 a[246:247], v4 offset:16928
ds_read_b64_tr_b16 v[244:245], v4 offset:15424
ds_read_b64_tr_b16 v[246:247], v4 offset:16960
s_waitcnt lgkmcnt(0)
ds_read_b64_tr_b16 a[120:121], v4 offset:18432
ds_read_b64_tr_b16 a[122:123], v4 offset:19968
ds_read_b64_tr_b16 a[248:249], v4 offset:18464
ds_read_b64_tr_b16 a[250:251], v4 offset:20000
ds_read_b64_tr_b16 v[248:249], v4 offset:18496
ds_read_b64_tr_b16 v[250:251], v4 offset:20032
s_waitcnt lgkmcnt(0)
ds_read_b64_tr_b16 a[124:125], v4 offset:21504
ds_read_b64_tr_b16 a[126:127], v4 offset:23040
ds_read_b64_tr_b16 a[252:253], v4 offset:21536
ds_read_b64_tr_b16 a[254:255], v4 offset:23072
ds_read_b64_tr_b16 v[252:253], v4 offset:21568
ds_read_b64_tr_b16 v[254:255], v4 offset:23104
s_waitcnt lgkmcnt(0)
s_load_dwordx2 s[4:5], s[0:1], 96
s_waitcnt lgkmcnt(0)
s_mov_b32 s20, s4
s_mov_b32 s21, s5
s_mov_b32 s22, 4718592
s_mov_b32 s23, 0x00020000
v_bfe_u32 v2, v0, 4, 4
v_mul_u32_u24 v2, 2304, v2
v_lshrrev_b32 v3, 8, v0
v_lshl_add_u32 v7, v3, 3, v2
s_barrier
WL_51:
s_lshl_b32 s28, s25, 7
s_add_u32 s28, s28, 827392
s_mov_b32 s26, 2000000
v_lshrrev_b32 v2, 2, v0
v_and_b32 v2, 127, v2
WW_54:
buffer_load_dword v3, v2, s[8:11], s28 offen sc1
s_waitcnt vmcnt(0)
v_cmp_ne_u32 vcc, s7, v3
s_cbranch_vccz WW_54k
s_sub_u32 s26, s26, 1
s_cbranch_scc1 WF_53
s_sleep 2
s_branch WW_54
WW_54k:
s_lshl_b32 s28, s25, 8
s_lshl_b32 s29, s17, 5
s_add_u32 s28, s28, s29
s_lshl_b32 s28, s28, 10
s_add_u32 s28, s28, 35667968
s_add_u32 s29, s28, 131072
s_lshl_b32 s30, s56, 17
s_add_u32 s28, s28, s30
buffer_load_dwordx4 v[8:11], v0, s[8:11], s28 offen offset:0
buffer_load_dwordx4 v[16:19], v0, s[8:11], s28 offen offset:1024
buffer_load_dwordx4 v[24:27], v0, s[8:11], s28 offen offset:2048
buffer_load_dwordx4 v[32:35], v0, s[8:11], s28 offen offset:3072
s_add_u32 s28, s28, 4096
s_add_u32 s29, s29, 4096
buffer_load_dwordx4 v[40:43], v0, s[8:11], s28 offen offset:0
buffer_load_dwordx4 v[48:51], v0, s[8:11], s28 offen offset:1024
buffer_load_dwordx4 v[56:59], v0, s[8:11], s28 offen offset:2048
buffer_load_dwordx4 v[64:67], v0, s[8:11], s28 offen offset:3072
s_waitcnt vmcnt(7)
v_mfma_f32_16x16x32_bf16 v[72:75], a[0:3], v[8:11], 0
v_mfma_f32_16x16x32_bf16 v[80:83], a[128:131], v[8:11], 0
v_mfma_f32_16x16x32_bf16 v[88:91], v[128:131], v[8:11], 0
s_add_u32 s28, s28, 4096
s_add_u32 s29, s29, 4096
buffer_load_dwordx4 v[8:11], v0, s[8:11], s28 offen offset:0
s_waitcnt vmcnt(7)
v_mfma_f32_16x16x32_bf16 v[72:75], a[4:7], v[16:19], v[72:75]
v_mfma_f32_16x16x32_bf16 v[80:83], a[132:135], v[16:19], v[80:83]
v_mfma_f32_16x16x32_bf16 v[88:91], v[132:135], v[16:19], v[88:91]
buffer_load_dwordx4 v[16:19], v0, s[8:11], s28 offen offset:1024
s_waitcnt vmcnt(7)
v_mfma_f32_16x16x32_bf16 v[72:75], a[8:11], v[24:27], v[72:75]
v_mfma_f32_16x16x32_bf16 v[80:83], a[136:139], v[24:27], v[80:83]
v_mfma_f32_16x16x32_bf16 v[88:91], v[136:139], v[24:27], v[88:91]
buffer_load_dwordx4 v[24:27], v0, s[8:11], s28 offen offset:2048
s_waitcnt vmcnt(7)
v_mfma_f32_16x16x32_bf16 v[72:75], a[12:15], v[32:35], v[72:75]
v_mfma_f32_16x16x32_bf16 v[80:83], a[140:143], v[32:35], v[80:83]
v_mfma_f32_16x16x32_bf16 v[88:91], v[140:143], v[32:35], v[88:91]
buffer_load_dwordx4 v[32:35], v0, s[8:11], s28 offen offset:3072
s_waitcnt vmcnt(7)
v_mfma_f32_16x16x32_bf16 v[72:75], a[16:19], v[40:43], v[72:75]
v_mfma_f32_16x16x32_bf16 v[80:83], a[144:147], v[40:43], v[80:83]
v_mfma_f32_16x16x32_bf16 v[88:91], v[144:147], v[40:43], v[88:91]
s_add_u32 s28, s28, 4096
s_add_u32 s29, s29, 4096
buffer_load_dwordx4 v[40:43], v0, s[8:11], s28 offen offset:0
s_waitcnt vmcnt(7)
v_mfma_f32_16x16x32_bf16 v[72:75], a[20:23], v[48:51], v[72:75]
v_mfma_f32_16x16x32_bf16 v[80:83], a[148:151], v[48:51], v[80:83]
v_mfma_f32_16x16x32_bf16 v[88:91], v[148:151], v[48:51], v[88:91]
buffer_load_dwordx4 v[48:51], v0, s[8:11], s28 offen offset:1024
s_waitcnt vmcnt(7)
v_mfma_f32_16x16x32_bf16 v[72:75], a[24:27], v[56:59], v[72:75]
v_mfma_f32_16x16x32_bf16 v[80:83], a[152:155], v[56:59], v[80:83]
v_mfma_f32_16x16x32_bf16 v[88:91], v[152:155], v[56:59], v[88:91]
buffer_load_dwordx4 v[56:59], v0, s[8:11], s28 offen offset:2048
s_waitcnt vmcnt(7)
v_mfma_f32_16x16x32_bf16 v[72:75], a[28:31], v[64:67], v[72:75]
v_mfma_f32_16x16x32_bf16 v[80:83], a[156:159], v[64:67], v[80:83]
v_mfma_f32_16x16x32_bf16 v[88:91], v[156:159], v[64:67], v[88:91]
buffer_load_dwordx4 v[64:67], v0, s[8:11], s28 offen offset:3072
s_waitcnt vmcnt(7)
v_mfma_f32_16x16x32_bf16 v[72:75], a[32:35], v[8:11], v[72:75]
v_mfma_f32_16x16x32_bf16 v[80:83], a[160:163], v[8:11], v[80:83]
v_mfma_f32_16x16x32_bf16 v[88:91], v[160:163], v[8:11], v[88:91]
s_add_u32 s28, s28, 4096
s_add_u32 s29, s29, 4096
buffer_load_dwordx4 v[8:11], v0, s[8:11], s28 offen offset:0
s_waitcnt vmcnt(7)
v_mfma_f32_16x16x32_bf16 v[72:75], a[36:39], v[16:19], v[72:75]
v_mfma_f32_16x16x32_bf16 v[80:83], a[164:167], v[16:19], v[80:83]
v_mfma_f32_16x16x32_bf16 v[88:91], v[164:167], v[16:19], v[88:91]
buffer_load_dwordx4 v[16:19], v0, s[8:11], s28 offen offset:1024
s_waitcnt vmcnt(7)
v_mfma_f32_16x16x32_bf16 v[72:75], a[40:43], v[24:27], v[72:75]
v_mfma_f32_16x16x32_bf16 v[80:83], a[168:171], v[24:27], v[80:83]
v_mfma_f32_16x16x32_bf16 v[88:91], v[168:171], v[24:27], v[88:91]
buffer_load_dwordx4 v[24:27], v0, s[8:11], s28 offen offset:2048
s_waitcnt vmcnt(7)
v_mfma_f32_16x16x32_bf16 v[72:75], a[44:47], v[32:35], v[72:75]
v_mfma_f32_16x16x32_bf16 v[80:83], a[172:175], v[32:35], v[80:83]
v_mfma_f32_16x16x32_bf16 v[88:91], v[172:175], v[32:35], v[88:91]
buffer_load_dwordx4 v[32:35], v0, s[8:11], s28 offen offset:3072
s_waitcnt vmcnt(7)
v_mfma_f32_16x16x32_bf16 v[72:75], a[48:51], v[40:43], v[72:75]
v_mfma_f32_16x16x32_bf16 v[80:83], a[176:179], v[40:43], v[80:83]
v_mfma_f32_16x16x32_bf16 v[88:91], v[176:179], v[40:43], v[88:91]
s_add_u32 s28, s28, 4096
s_add_u32 s29, s29, 4096
buffer_load_dwordx4 v[40:43], v0, s[8:11], s28 offen offset:0
s_waitcnt vmcnt(7)
v_mfma_f32_16x16x32_bf16 v[72:75], a[52:55], v[48:51], v[72:75]
v_mfma_f32_16x16x32_bf16 v[80:83], a[180:183], v[48:51], v[80:83]
v_mfma_f32_16x16x32_bf16 v[88:91], v[180:183], v[48:51], v[88:91]
buffer_load_dwordx4 v[48:51], v0, s[8:11], s28 offen offset:1024
s_waitcnt vmcnt(7)
v_mfma_f32_16x16x32_bf16 v[72:75], a[56:59], v[56:59], v[72:75]
v_mfma_f32_16x16x32_bf16 v[80:83], a[184:187], v[56:59], v[80:83]
v_mfma_f32_16x16x32_bf16 v[88:91], v[184:187], v[56:59], v[88:91]
buffer_load_dwordx4 v[56:59], v0, s[8:11], s28 offen offset:2048
s_waitcnt vmcnt(7)
v_mfma_f32_16x16x32_bf16 v[72:75], a[60:63], v[64:67], v[72:75]
v_mfma_f32_16x16x32_bf16 v[80:83], a[188:191], v[64:67], v[80:83]
v_mfma_f32_16x16x32_bf16 v[88:91], v[188:191], v[64:67], v[88:91]
buffer_load_dwordx4 v[64:67], v0, s[8:11], s28 offen offset:3072
s_waitcnt vmcnt(7)
v_mfma_f32_16x16x32_bf16 v[72:75], a[64:67], v[8:11], v[72:75]
v_mfma_f32_16x16x32_bf16 v[80:83], a[192:195], v[8:11], v[80:83]
v_mfma_f32_16x16x32_bf16 v[88:91], v[192:195], v[8:11], v[88:91]
s_add_u32 s28, s28, 4096
s_add_u32 s29, s29, 4096
buffer_load_dwordx4 v[8:11], v0, s[8:11], s28 offen offset:0
s_waitcnt vmcnt(7)
v_mfma_f32_16x16x32_bf16 v[72:75], a[68:71], v[16:19], v[72:75]
v_mfma_f32_16x16x32_bf16 v[80:83], a[196:199], v[16:19], v[80:83]
v_mfma_f32_16x16x32_bf16 v[88:91], v[196:199], v[16:19], v[88:91]
buffer_load_dwordx4 v[16:19], v0, s[8:11], s28 offen offset:1024
s_waitcnt vmcnt(7)
v_mfma_f32_16x16x32_bf16 v[72:75], a[72:75], v[24:27], v[72:75]
v_mfma_f32_16x16x32_bf16 v[80:83], a[200:203], v[24:27], v[80:83]
v_mfma_f32_16x16x32_bf16 v[88:91], v[200:203], v[24:27], v[88:91]
buffer_load_dwordx4 v[24:27], v0, s[8:11], s28 offen offset:2048
s_waitcnt vmcnt(7)
v_mfma_f32_16x16x32_bf16 v[72:75], a[76:79], v[32:35], v[72:75]
v_mfma_f32_16x16x32_bf16 v[80:83], a[204:207], v[32:35], v[80:83]
v_mfma_f32_16x16x32_bf16 v[88:91], v[204:207], v[32:35], v[88:91]
buffer_load_dwordx4 v[32:35], v0, s[8:11], s28 offen offset:3072
s_waitcnt vmcnt(7)
v_mfma_f32_16x16x32_bf16 v[72:75], a[80:83], v[40:43], v[72:75]
v_mfma_f32_16x16x32_bf16 v[80:83], a[208:211], v[40:43], v[80:83]
v_mfma_f32_16x16x32_bf16 v[88:91], v[208:211], v[40:43], v[88:91]
s_add_u32 s28, s28, 4096
s_add_u32 s29, s29, 4096
buffer_load_dwordx4 v[40:43], v0, s[8:11], s28 offen offset:0
s_waitcnt vmcnt(7)
v_mfma_f32_16x16x32_bf16 v[72:75], a[84:87], v[48:51], v[72:75]
v_mfma_f32_16x16x32_bf16 v[80:83], a[212:215], v[48:51], v[80:83]
v_mfma_f32_16x16x32_bf16 v[88:91], v[212:215], v[48:51], v[88:91]
buffer_load_dwordx4 v[48:51], v0, s[8:11], s28 offen offset:1024
s_waitcnt vmcnt(7)
v_mfma_f32_16x16x32_bf16 v[72:75], a[88:91], v[56:59], v[72:75]
v_mfma_f32_16x16x32_bf16 v[80:83], a[216:219], v[56:59], v[80:83]
v_mfma_f32_16x16x32_bf16 v[88:91], v[216:219], v[56:59], v[88:91]
buffer_load_dwordx4 v[56:59], v0, s[8:11], s28 offen offset:2048
s_waitcnt vmcnt(7)
v_mfma_f32_16x16x32_bf16 v[72:75], a[92:95], v[64:67], v[72:75]
v_mfma_f32_16x16x32_bf16 v[80:83], a[220:223], v[64:67], v[80:83]
v_mfma_f32_16x16x32_bf16 v[88:91], v[220:223], v[64:67], v[88:91]
buffer_load_dwordx4 v[64:67], v0, s[8:11], s28 offen offset:3072
s_waitcnt vmcnt(7)
v_mfma_f32_16x16x32_bf16 v[72:75], a[96:99], v[8:11], v[72:75]
v_mfma_f32_16x16x32_bf16 v[80:83], a[224:227], v[8:11], v[80:83]
v_mfma_f32_16x16x32_bf16 v[88:91], v[224:227], v[8:11], v[88:91]
s_waitcnt vmcnt(6)
v_mfma_f32_16x16x32_bf16 v[72:75], a[100:103], v[16:19], v[72:75]
v_mfma_f32_16x16x32_bf16 v[80:83], a[228:231], v[16:19], v[80:83]
v_mfma_f32_16x16x32_bf16 v[88:91], v[228:231], v[16:19], v[88:91]
s_waitcnt vmcnt(5)
v_mfma_f32_16x16x32_bf16 v[72:75], a[104:107], v[24:27], v[72:75]
v_mfma_f32_16x16x32_bf16 v[80:83], a[232:235], v[24:27], v[80:83]
v_mfma_f32_16x16x32_bf16 v[88:91], v[232:235], v[24:27], v[88:91]
s_waitcnt vmcnt(4)
v_mfma_f32_16x16x32_bf16 v[72:75], a[108:111], v[32:35], v[72:75]
v_mfma_f32_16x16x32_bf16 v[80:83], a[236:239], v[32:35], v[80:83]
v_mfma_f32_16x16x32_bf16 v[88:91], v[236:239], v[32:35], v[88:91]
s_waitcnt vmcnt(3)
v_mfma_f32_16x16x32_bf16 v[72:75], a[112:115], v[40:43], v[72:75]
v_mfma_f32_16x16x32_bf16 v[80:83], a[240:243], v[40:43], v[80:83]
v_mfma_f32_16x16x32_bf16 v[88:91], v[240:243], v[40:43], v[88:91]
s_waitcnt vmcnt(2)
v_mfma_f32_16x16x32_bf16 v[72:75], a[116:119], v[48:51], v[72:75]
v_mfma_f32_16x16x32_bf16 v[80:83], a[244:247], v[48:51], v[80:83]
v_mfma_f32_16x16x32_bf16 v[88:91], v[244:247], v[48:51], v[88:91]
s_waitcnt vmcnt(1)
v_mfma_f32_16x16x32_bf16 v[72:75], a[120:123], v[56:59], v[72:75]
v_mfma_f32_16x16x32_bf16 v[80:83], a[248:251], v[56:59], v[80:83]
v_mfma_f32_16x16x32_bf16 v[88:91], v[248:251], v[56:59], v[88:91]
s_waitcnt vmcnt(0)
v_mfma_f32_16x16x32_bf16 v[72:75], a[124:127], v[64:67], v[72:75]
v_mfma_f32_16x16x32_bf16 v[80:83], a[252:255], v[64:67], v[80:83]
v_mfma_f32_16x16x32_bf16 v[88:91], v[252:255], v[64:67], v[88:91]
s_mul_i32 s28, s17, 6144
v_add_u32 v2, s28, v0
s_nop 5
ds_write_b128 v2, v[72:75] offset:0
ds_write_b128 v2, v[80:83] offset:2048
ds_write_b128 v2, v[88:91] offset:4096
s_waitcnt lgkmcnt(0)
s_barrier
s_cmp_lt_u32 s17, 3
s_cbranch_scc0 WN_55
s_lshl_b32 s28, s17, 11
v_add_u32 v2, s28, v0
ds_read_b128 v[96:99], v2 offset:0
ds_read_b128 v[100:103], v2 offset:6144
ds_read_b128 v[104:107], v2 offset:12288
ds_read_b128 v[108:111], v2 offset:18432
s_waitcnt lgkmcnt(0)
s_mul_i32 s28, s25, 73728
s_mul_i32 s29, s24, 96
s_add_u32 s28, s28, s29
s_lshl_b32 s29, s17, 5
s_add_u32 s28, s28, s29
s_mul_i32 s29, s56, 36864
s_add_u32 s28, s28, s29
v_add_f32 v96, v96, v100
v_add_f32 v104, v104, v108
v_add_f32 v96, v96, v104
v_add_f32 v97, v97, v101
v_add_f32 v105, v105, v109
v_add_f32 v97, v97, v105
v_add_f32 v98, v98, v102
v_add_f32 v106, v106, v110
v_add_f32 v98, v98, v106
v_add_f32 v99, v99, v103
v_add_f32 v107, v107, v111
v_add_f32 v99, v99, v107
v_cvt_pk_bf16_f32 v96, v96, v97
v_cvt_pk_bf16_f32 v97, v98, v99
buffer_store_dwordx2 v[96:97], v7, s[20:23], s28 offen
WN_55:
s_barrier
s_add_u32 s25, s25, 64
s_cmp_lt_u32 s25, 64
s_cbranch_scc1 WL_51
s_branch WE_52
WF_53:
s_mov_b32 s19, 1
WE_52:
s_endpgm
K_CHAIN:
s_mov_b32 s16, s22
v_lshrrev_b32 v0, 4, v0
s_lshl_b32 s28, s17, 6
v_add_u32 v0, s28, v0
s_mov_b32 s60, s12
s_mov_b32 s61, s13
s_mov_b32 s62, s14
s_mov_b32 s63, s15
v_lshrrev_b32 v24, 6, v0
v_and_b32 v25, 63, v0
s_nop 0
v_readfirstlane_b32 s17, v24
v_lshlrev_b32 v0, 4, v25
v_and_b32 v26, 15, v25
v_lshrrev_b32 v27, 4, v25
v_bfe_u32 v28, v26, 1, 1
v_mul_u32_u24 v29, 0xAAAA, v28
v_add_u32 v1, 0x4444, v29
s_lshl_b32 s28, s17, 10
s_add_u32 s28, s28, 9216
v_lshrrev_b32 v30, 2, v26
v_xor_b32 v30, v30, v27
v_lshlrev_b32 v29, 5, v26
v_lshl_add_u32 v29, v30, 3, v29
v_add_u32 v2, s28, v29
v_lshrrev_b32 v29, 2, v26
v_lshl_add_u32 v29, v27, 2, v29
v_lshlrev_b32 v29, 5, v29
v_and_b32 v30, 3, v26
v_xor_b32 v30, v30, v27
v_lshl_add_u32 v29, v30, 3, v29
v_add_u32 v3, 9216, v29
s_lshr_b32 s28, s17, 1
s_lshl_b32 s28, s28, 10
s_and_b32 s29, s17, 1
s_lshl_b32 s29, s29, 3
s_add_u32 s28, s28, s29
s_add_u32 s28, s28, 14304
v_add_u32 v4, s28, v0
s_lshl_b32 s28, s17, 3
v_lshrrev_b32 v29, 3, v26
v_lshl_add_u32 v29, v27, 1, v29
v_add_u32 v29, s28, v29
v_lshlrev_b32 v29, 12, v29
v_and_b32 v30, 7, v26
v_lshl_add_u32 v29, v30, 4, v29
s_lshl_b32 s28, s16, 7
v_add_u32 v5, s28, v29
s_lshl_b32 s51, s17, 5
s_add_u32 s51, s51, s16
s_lshl_b32 s29, s51, 12
v_lshl_add_u32 v29, v27, 1, v28
v_lshlrev_b32 v29, 7, v29
v_lshrrev_b32 v30, 2, v26
v_lshlrev_b32 v30, 1, v30
v_and_b32 v31, 1, v26
v_add_u32 v30, v30, v31
v_lshl_add_u32 v29, v30, 4, v29
v_add_u32 v6, s29, v29
v_lshrrev_b32 v29, 1, v0
v_add_u32 v9, 13312, v29
s_lshr_b32 s29, s51, 3
s_mul_i32 s29, s29, 768
s_and_b32 s30, s51, 7
s_lshl_b32 s30, s30, 5
s_add_u32 s29, s29, s30
v_bfe_u32 v29, v26, 1, 2
v_lshlrev_b32 v29, 8, v29
v_lshl_add_u32 v29, v31, 4, v29
v_lshl_add_u32 v29, v27, 2, v29
v_add_u32 v7, s29, v29
s_mul_i32 s28, s17, 36864
s_add_u32 s28, s28, 16384
v_add_u32 v8, s28, v0
v_mov_b32 v19, 0
s_mov_b32 s32, 0xcccccccc
s_mov_b32 s33, 0xcccccccc
s_mov_b32 s34, 0x003f003f
s_mov_b32 s35, 0x003f003f
s_lshr_b32 s36, s17, 1
s_lshl_b32 s36, s36, 9
s_lshl_b32 s31, s17, 10
v_mov_b32 v18, 0
s_mov_b32 s19, 0
s_mov_b32 s38, 0x21800000
s_mov_b32 s44, 0x5f800000
s_add_u32 s6, s16, 512
s_getpc_b64 s[4:5]
K_PC:
s_add_u32 s4, s4, K_M0_LOOP-K_PC
s_addc_u32 s5, s5, 0
v_lshlrev_b32 v14, 3, v0
global_load_dword v16, v14, s[4:5]
v_add_u32 v15, 8192, v14
global_load_dword v17, v15, s[4:5]
s_lshl_b32 s28, s16, 8
s_load_dwordx2 s[4:5], s[0:1], 16
s_waitcnt lgkmcnt(0)
s_add_u32 s52, s4, s28
s_addc_u32 s53, s5, 0
s_sub_u32 s54, 4718592, s28
s_mov_b32 s55, 0x00020000
s_load_dwordx2 s[4:5], s[0:1], 24
s_waitcnt lgkmcnt(0)
s_add_u32 s56, s4, s28
s_addc_u32 s57, s5, 0
s_sub_u32 s58, 4718592, s28
s_mov_b32 s59, 0x00020000
s_load_dwordx2 s[4:5], s[0:1], 32
s_waitcnt lgkmcnt(0)
s_add_u32 s84, s4, s28
s_addc_u32 s85, s5, 0
s_sub_u32 s86, 4718592, s28
s_mov_b32 s87, 0x00020000
v_lshrrev_b32 v24, 8, v0
v_and_b32 v25, 1, v24
s_lshl_b32 s28, s17, 1
v_or_b32 v25, s28, v25
v_bfe_u32 v26, v0, 5, 3
v_xor_b32 v26, v26, v25
v_lshlrev_b32 v26, 5, v26
v_lshl_add_u32 v26, v24, 13, v26
v_and_b32 v27, 16, v0
v_add_u32 v23, v26, v27
s_lshl_b32 s28, s17, 15
s_add_u32 s28, s28, 0
s_lshl_b32 s29, s17, 10
s_add_u32 s29, s29, 16384
s_mov_b32 s30, 0
DM_56:
s_mov_b32 m0, s29
s_add_u32 s29, s29, 4096
buffer_load_dwordx4 v23, s[52:55], s28 offen lds
s_add_u32 s28, s28, 131072
s_add_u32 s30, s30, 1
s_cmp_lt_u32 s30, 20
s_cbranch_scc1 DM_56
s_lshl_b32 s28, s17, 15
s_add_u32 s28, s28, 2621440
s_lshl_b32 s29, s17, 10
s_add_u32 s29, s29, 98304
s_mov_b32 s30, 0
DM_57:
s_mov_b32 m0, s29
s_add_u32 s29, s29, 4096
buffer_load_dwordx4 v23, s[52:55], s28 offen lds
s_add_u32 s28, s28, 131072
s_add_u32 s30, s30, 1
s_cmp_lt_u32 s30, 16
s_cbranch_scc1 DM_57
s_waitcnt vmcnt(16)
s_barrier
v_lshrrev_b32 v24, 8, v0
v_bfe_u32 v25, v0, 6, 2
v_bfe_u32 v26, v0, 4, 2
v_lshrrev_b32 v27, 1, v24
v_lshlrev_b32 v27, 4, v27
v_lshrrev_b32 v28, 1, v25
v_lshl_add_u32 v27, v28, 3, v27
v_and_b32 v29, 1, v24
v_lshl_add_u32 v27, v29, 2, v27
v_and_b32 v30, 1, v25
v_add_u32 v27, v27, v30
v_lshlrev_b32 v27, 8, v27
v_lshl_add_u32 v30, v29, 1, v30
v_lshl_add_u32 v30, v28, 2, v30
v_lshl_add_u32 v27, v26, 3, v27
v_add_u32 v27, 16384, v27
s_lshl_b32 s28, s17, 1
s_add_u32 s29, s28, 0
v_xor_b32 v31, s29, v30
v_lshl_add_u32 v31, v31, 5, v27
ds_read_b64_tr_b16 a[0:1], v31 offset:0
ds_read_b64_tr_b16 a[2:3], v31 offset:512
ds_read_b64_tr_b16 a[4:5], v31 offset:8192
ds_read_b64_tr_b16 a[6:7], v31 offset:8704
s_waitcnt lgkmcnt(0)
v_add_u32 v31, 16384, v31
ds_read_b64_tr_b16 a[8:9], v31 offset:0
ds_read_b64_tr_b16 a[10:11], v31 offset:512
ds_read_b64_tr_b16 a[12:13], v31 offset:8192
ds_read_b64_tr_b16 a[14:15], v31 offset:8704
s_waitcnt lgkmcnt(0)
v_add_u32 v31, 16384, v31
ds_read_b64_tr_b16 a[16:17], v31 offset:0
ds_read_b64_tr_b16 a[18:19], v31 offset:512
ds_read_b64_tr_b16 a[20:21], v31 offset:8192
ds_read_b64_tr_b16 a[22:23], v31 offset:8704
s_waitcnt lgkmcnt(0)
v_add_u32 v31, 16384, v31
ds_read_b64_tr_b16 a[24:25], v31 offset:0
ds_read_b64_tr_b16 a[26:27], v31 offset:512
ds_read_b64_tr_b16 a[28:29], v31 offset:8192
ds_read_b64_tr_b16 a[30:31], v31 offset:8704
s_waitcnt lgkmcnt(0)
v_add_u32 v31, 16384, v31
ds_read_b64_tr_b16 a[32:33], v31 offset:0
ds_read_b64_tr_b16 a[34:35], v31 offset:512
ds_read_b64_tr_b16 a[36:37], v31 offset:8192
ds_read_b64_tr_b16 a[38:39], v31 offset:8704
s_waitcnt lgkmcnt(0)
v_add_u32 v31, 16384, v31
s_add_u32 s29, s28, 1
v_xor_b32 v31, s29, v30
v_lshl_add_u32 v31, v31, 5, v27
ds_read_b64_tr_b16 a[72:73], v31 offset:0
ds_read_b64_tr_b16 a[74:75], v31 offset:512
ds_read_b64_tr_b16 a[76:77], v31 offset:8192
ds_read_b64_tr_b16 a[78:79], v31 offset:8704
s_waitcnt lgkmcnt(0)
v_add_u32 v31, 16384, v31
ds_read_b64_tr_b16 a[80:81], v31 offset:0
ds_read_b64_tr_b16 a[82:83], v31 offset:512
ds_read_b64_tr_b16 a[84:85], v31 offset:8192
ds_read_b64_tr_b16 a[86:87], v31 offset:8704
s_waitcnt lgkmcnt(0)
v_add_u32 v31, 16384, v31
ds_read_b64_tr_b16 a[88:89], v31 offset:0
ds_read_b64_tr_b16 a[90:91], v31 offset:512
ds_read_b64_tr_b16 a[92:93], v31 offset:8192
ds_read_b64_tr_b16 a[94:95], v31 offset:8704
s_waitcnt lgkmcnt(0)
v_add_u32 v31, 16384, v31
ds_read_b64_tr_b16 a[96:97], v31 offset:0
ds_read_b64_tr_b16 a[98:99], v31 offset:512
ds_read_b64_tr_b16 a[100:101], v31 offset:8192
ds_read_b64_tr_b16 a[102:103], v31 offset:8704
s_waitcnt lgkmcnt(0)
v_add_u32 v31, 16384, v31
ds_read_b64_tr_b16 a[104:105], v31 offset:0
ds_read_b64_tr_b16 a[106:107], v31 offset:512
ds_read_b64_tr_b16 a[108:109], v31 offset:8192
ds_read_b64_tr_b16 a[110:111], v31 offset:8704
s_waitcnt lgkmcnt(0)
v_add_u32 v31, 16384, v31
s_waitcnt lgkmcnt(0)
s_barrier
s_lshl_b32 s28, s17, 15
s_add_u32 s28, s28, 0
s_lshl_b32 s29, s17, 10
s_add_u32 s29, s29, 16384
s_mov_b32 s30, 0
DM_58:
s_mov_b32 m0, s29
s_add_u32 s29, s29, 4096
buffer_load_dwordx4 v23, s[56:59], s28 offen lds
s_add_u32 s28, s28, 131072
s_add_u32 s30, s30, 1
s_cmp_lt_u32 s30, 20
s_cbranch_scc1 DM_58
s_waitcnt vmcnt(20)
s_barrier
v_lshrrev_b32 v24, 8, v0
v_bfe_u32 v25, v0, 6, 2
v_bfe_u32 v26, v0, 4, 2
v_lshrrev_b32 v27, 1, v24
v_lshlrev_b32 v27, 4, v27
v_lshrrev_b32 v28, 1, v25
v_lshl_add_u32 v27, v28, 3, v27
v_and_b32 v29, 1, v24
v_lshl_add_u32 v27, v29, 2, v27
v_and_b32 v30, 1, v25
v_add_u32 v27, v27, v30
v_lshlrev_b32 v27, 8, v27
v_lshl_add_u32 v30, v29, 1, v30
v_lshl_add_u32 v30, v28, 2, v30
v_lshl_add_u32 v27, v26, 3, v27
v_add_u32 v27, 98304, v27
s_lshl_b32 s28, s17, 1
s_add_u32 s29, s28, 0
v_xor_b32 v31, s29, v30
v_lshl_add_u32 v31, v31, 5, v27
ds_read_b64_tr_b16 a[40:41], v31 offset:0
ds_read_b64_tr_b16 a[42:43], v31 offset:512
ds_read_b64_tr_b16 a[44:45], v31 offset:8192
ds_read_b64_tr_b16 a[46:47], v31 offset:8704
s_waitcnt lgkmcnt(0)
v_add_u32 v31, 16384, v31
ds_read_b64_tr_b16 a[48:49], v31 offset:0
ds_read_b64_tr_b16 a[50:51], v31 offset:512
ds_read_b64_tr_b16 a[52:53], v31 offset:8192
ds_read_b64_tr_b16 a[54:55], v31 offset:8704
s_waitcnt lgkmcnt(0)
v_add_u32 v31, 16384, v31
ds_read_b64_tr_b16 a[56:57], v31 offset:0
ds_read_b64_tr_b16 a[58:59], v31 offset:512
ds_read_b64_tr_b16 a[60:61], v31 offset:8192
ds_read_b64_tr_b16 a[62:63], v31 offset:8704
s_waitcnt lgkmcnt(0)
v_add_u32 v31, 16384, v31
ds_read_b64_tr_b16 a[64:65], v31 offset:0
ds_read_b64_tr_b16 a[66:67], v31 offset:512
ds_read_b64_tr_b16 a[68:69], v31 offset:8192
ds_read_b64_tr_b16 a[70:71], v31 offset:8704
s_waitcnt lgkmcnt(0)
v_add_u32 v31, 16384, v31
s_add_u32 s29, s28, 1
v_xor_b32 v31, s29, v30
v_lshl_add_u32 v31, v31, 5, v27
ds_read_b64_tr_b16 a[112:113], v31 offset:0
ds_read_b64_tr_b16 a[114:115], v31 offset:512
ds_read_b64_tr_b16 a[116:117], v31 offset:8192
ds_read_b64_tr_b16 a[118:119], v31 offset:8704
s_waitcnt lgkmcnt(0)
v_add_u32 v31, 16384, v31
ds_read_b64_tr_b16 a[120:121], v31 offset:0
ds_read_b64_tr_b16 a[122:123], v31 offset:512
ds_read_b64_tr_b16 a[124:125], v31 offset:8192
ds_read_b64_tr_b16 a[126:127], v31 offset:8704
s_waitcnt lgkmcnt(0)
v_add_u32 v31, 16384, v31
ds_read_b64_tr_b16 a[128:129], v31 offset:0
ds_read_b64_tr_b16 a[130:131], v31 offset:512
ds_read_b64_tr_b16 a[132:133], v31 offset:8192
ds_read_b64_tr_b16 a[134:135], v31 offset:8704
s_waitcnt lgkmcnt(0)
v_add_u32 v31, 16384, v31
ds_read_b64_tr_b16 a[136:137], v31 offset:0
ds_read_b64_tr_b16 a[138:139], v31 offset:512
ds_read_b64_tr_b16 a[140:141], v31 offset:8192
ds_read_b64_tr_b16 a[142:143], v31 offset:8704
s_waitcnt lgkmcnt(0)
v_add_u32 v31, 16384, v31
s_waitcnt lgkmcnt(0)
s_barrier
s_lshl_b32 s28, s17, 15
s_add_u32 s28, s28, 2621440
s_lshl_b32 s29, s17, 10
s_add_u32 s29, s29, 98304
s_mov_b32 s30, 0
DM_59:
s_mov_b32 m0, s29
s_add_u32 s29, s29, 4096
buffer_load_dwordx4 v23, s[56:59], s28 offen lds
s_add_u32 s28, s28, 131072
s_add_u32 s30, s30, 1
s_cmp_lt_u32 s30, 16
s_cbranch_scc1 DM_59
s_waitcnt vmcnt(16)
s_barrier
v_lshrrev_b32 v24, 8, v0
v_bfe_u32 v25, v0, 6, 2
v_bfe_u32 v26, v0, 4, 2
v_lshrrev_b32 v27, 1, v24
v_lshlrev_b32 v27, 4, v27
v_lshrrev_b32 v28, 1, v25
v_lshl_add_u32 v27, v28, 3, v27
v_and_b32 v29, 1, v24
v_lshl_add_u32 v27, v29, 2, v27
v_and_b32 v30, 1, v25
v_add_u32 v27, v27, v30
v_lshlrev_b32 v27, 8, v27
v_lshl_add_u32 v30, v29, 1, v30
v_lshl_add_u32 v30, v28, 2, v30
v_lshl_add_u32 v27, v26, 3, v27
v_add_u32 v27, 16384, v27
s_lshl_b32 s28, s17, 1
s_add_u32 s29, s28, 0
v_xor_b32 v31, s29, v30
v_lshl_add_u32 v31, v31, 5, v27
ds_read_b64_tr_b16 a[144:145], v31 offset:0
ds_read_b64_tr_b16 a[146:147], v31 offset:512
ds_read_b64_tr_b16 a[148:149], v31 offset:8192
ds_read_b64_tr_b16 a[150:151], v31 offset:8704
s_waitcnt lgkmcnt(0)
v_add_u32 v31, 16384, v31
ds_read_b64_tr_b16 a[152:153], v31 offset:0
ds_read_b64_tr_b16 a[154:155], v31 offset:512
ds_read_b64_tr_b16 a[156:157], v31 offset:8192
ds_read_b64_tr_b16 a[158:159], v31 offset:8704
s_waitcnt lgkmcnt(0)
v_add_u32 v31, 16384, v31
ds_read_b64_tr_b16 a[160:161], v31 offset:0
ds_read_b64_tr_b16 a[162:163], v31 offset:512
ds_read_b64_tr_b16 a[164:165], v31 offset:8192
ds_read_b64_tr_b16 a[166:167], v31 offset:8704
s_waitcnt lgkmcnt(0)
v_add_u32 v31, 16384, v31
ds_read_b64_tr_b16 a[168:169], v31 offset:0
ds_read_b64_tr_b16 a[170:171], v31 offset:512
ds_read_b64_tr_b16 a[172:173], v31 offset:8192
ds_read_b64_tr_b16 a[174:175], v31 offset:8704
s_waitcnt lgkmcnt(0)
v_add_u32 v31, 16384, v31
ds_read_b64_tr_b16 a[176:177], v31 offset:0
ds_read_b64_tr_b16 a[178:179], v31 offset:512
ds_read_b64_tr_b16 a[180:181], v31 offset:8192
ds_read_b64_tr_b16 a[182:183], v31 offset:8704
s_waitcnt lgkmcnt(0)
v_add_u32 v31, 16384, v31
s_add_u32 s29, s28, 1
v_xor_b32 v31, s29, v30
v_lshl_add_u32 v31, v31, 5, v27
ds_read_b64_tr_b16 a[216:217], v31 offset:0
ds_read_b64_tr_b16 a[218:219], v31 offset:512
ds_read_b64_tr_b16 a[220:221], v31 offset:8192
ds_read_b64_tr_b16 a[222:223], v31 offset:8704
s_waitcnt lgkmcnt(0)
v_add_u32 v31, 16384, v31
ds_read_b64_tr_b16 a[224:225], v31 offset:0
ds_read_b64_tr_b16 a[226:227], v31 offset:512
ds_read_b64_tr_b16 a[228:229], v31 offset:8192
ds_read_b64_tr_b16 a[230:231], v31 offset:8704
s_waitcnt lgkmcnt(0)
v_add_u32 v31, 16384, v31
ds_read_b64_tr_b16 a[232:233], v31 offset:0
ds_read_b64_tr_b16 a[234:235], v31 offset:512
ds_read_b64_tr_b16 a[236:237], v31 offset:8192
ds_read_b64_tr_b16 a[238:239], v31 offset:8704
s_waitcnt lgkmcnt(0)
v_add_u32 v31, 16384, v31
ds_read_b64_tr_b16 a[240:241], v31 offset:0
ds_read_b64_tr_b16 a[242:243], v31 offset:512
ds_read_b64_tr_b16 a[244:245], v31 offset:8192
ds_read_b64_tr_b16 a[246:247], v31 offset:8704
s_waitcnt lgkmcnt(0)
v_add_u32 v31, 16384, v31
ds_read_b64_tr_b16 a[248:249], v31 offset:0
ds_read_b64_tr_b16 a[250:251], v31 offset:512
ds_read_b64_tr_b16 a[252:253], v31 offset:8192
ds_read_b64_tr_b16 a[254:255], v31 offset:8704
s_waitcnt lgkmcnt(0)
v_add_u32 v31, 16384, v31
s_waitcnt lgkmcnt(0)
s_barrier
s_lshl_b32 s28, s17, 15
s_add_u32 s28, s28, 0
s_lshl_b32 s29, s17, 10
s_add_u32 s29, s29, 16384
s_mov_b32 s30, 0
DM_60:
s_mov_b32 m0, s29
s_add_u32 s29, s29, 4096
buffer_load_dwordx4 v23, s[84:87], s28 offen lds
s_add_u32 s28, s28, 131072
s_add_u32 s30, s30, 1
s_cmp_lt_u32 s30, 20
s_cbranch_scc1 DM_60
s_waitcnt vmcnt(20)
s_barrier
v_lshrrev_b32 v24, 8, v0
v_bfe_u32 v25, v0, 6, 2
v_bfe_u32 v26, v0, 4, 2
v_lshrrev_b32 v27, 1, v24
v_lshlrev_b32 v27, 4, v27
v_lshrrev_b32 v28, 1, v25
v_lshl_add_u32 v27, v28, 3, v27
v_and_b32 v29, 1, v24
v_lshl_add_u32 v27, v29, 2, v27
v_and_b32 v30, 1, v25
v_add_u32 v27, v27, v30
v_lshlrev_b32 v27, 8, v27
v_lshl_add_u32 v30, v29, 1, v30
v_lshl_add_u32 v30, v28, 2, v30
v_lshl_add_u32 v27, v26, 3, v27
v_add_u32 v27, 98304, v27
s_lshl_b32 s28, s17, 1
s_add_u32 s29, s28, 0
v_xor_b32 v31, s29, v30
v_lshl_add_u32 v31, v31, 5, v27
ds_read_b64_tr_b16 a[184:185], v31 offset:0
ds_read_b64_tr_b16 a[186:187], v31 offset:512
ds_read_b64_tr_b16 a[188:189], v31 offset:8192
ds_read_b64_tr_b16 a[190:191], v31 offset:8704
s_waitcnt lgkmcnt(0)
v_add_u32 v31, 16384, v31
ds_read_b64_tr_b16 a[192:193], v31 offset:0
ds_read_b64_tr_b16 a[194:195], v31 offset:512
ds_read_b64_tr_b16 a[196:197], v31 offset:8192
ds_read_b64_tr_b16 a[198:199], v31 offset:8704
s_waitcnt lgkmcnt(0)
v_add_u32 v31, 16384, v31
ds_read_b64_tr_b16 a[200:201], v31 offset:0
ds_read_b64_tr_b16 a[202:203], v31 offset:512
ds_read_b64_tr_b16 a[204:205], v31 offset:8192
ds_read_b64_tr_b16 a[206:207], v31 offset:8704
s_waitcnt lgkmcnt(0)
v_add_u32 v31, 16384, v31
ds_read_b64_tr_b16 a[208:209], v31 offset:0
ds_read_b64_tr_b16 a[210:211], v31 offset:512
ds_read_b64_tr_b16 a[212:213], v31 offset:8192
ds_read_b64_tr_b16 a[214:215], v31 offset:8704
s_waitcnt lgkmcnt(0)
v_add_u32 v31, 16384, v31
s_add_u32 s29, s28, 1
v_xor_b32 v31, s29, v30
v_lshl_add_u32 v31, v31, 5, v27
ds_read_b64_tr_b16 v[80:81], v31 offset:0
ds_read_b64_tr_b16 v[82:83], v31 offset:512
ds_read_b64_tr_b16 v[84:85], v31 offset:8192
ds_read_b64_tr_b16 v[86:87], v31 offset:8704
s_waitcnt lgkmcnt(0)
v_add_u32 v31, 16384, v31
ds_read_b64_tr_b16 v[88:89], v31 offset:0
ds_read_b64_tr_b16 v[90:91], v31 offset:512
ds_read_b64_tr_b16 v[92:93], v31 offset:8192
ds_read_b64_tr_b16 v[94:95], v31 offset:8704
s_waitcnt lgkmcnt(0)
v_add_u32 v31, 16384, v31
ds_read_b64_tr_b16 v[96:97], v31 offset:0
ds_read_b64_tr_b16 v[98:99], v31 offset:512
ds_read_b64_tr_b16 v[100:101], v31 offset:8192
ds_read_b64_tr_b16 v[102:103], v31 offset:8704
s_waitcnt lgkmcnt(0)
v_add_u32 v31, 16384, v31
ds_read_b64_tr_b16 v[104:105], v31 offset:0
ds_read_b64_tr_b16 v[106:107], v31 offset:512
ds_read_b64_tr_b16 v[108:109], v31 offset:8192
ds_read_b64_tr_b16 v[110:111], v31 offset:8704
s_waitcnt lgkmcnt(0)
v_add_u32 v31, 16384, v31
s_waitcnt lgkmcnt(0)
s_barrier
s_lshl_b32 s28, s17, 15
s_add_u32 s28, s28, 2621440
s_lshl_b32 s29, s17, 10
s_add_u32 s29, s29, 98304
s_mov_b32 s30, 0
DM_61:
s_mov_b32 m0, s29
s_add_u32 s29, s29, 4096
buffer_load_dwordx4 v23, s[84:87], s28 offen lds
s_add_u32 s28, s28, 131072
s_add_u32 s30, s30, 1
s_cmp_lt_u32 s30, 16
s_cbranch_scc1 DM_61
s_waitcnt vmcnt(16)
s_barrier
v_lshrrev_b32 v24, 8, v0
v_bfe_u32 v25, v0, 6, 2
v_bfe_u32 v26, v0, 4, 2
v_lshrrev_b32 v27, 1, v24
v_lshlrev_b32 v27, 4, v27
v_lshrrev_b32 v28, 1, v25
v_lshl_add_u32 v27, v28, 3, v27
v_and_b32 v29, 1, v24
v_lshl_add_u32 v27, v29, 2, v27
v_and_b32 v30, 1, v25
v_add_u32 v27, v27, v30
v_lshlrev_b32 v27, 8, v27
v_lshl_add_u32 v30, v29, 1, v30
v_lshl_add_u32 v30, v28, 2, v30
v_lshl_add_u32 v27, v26, 3, v27
v_add_u32 v27, 16384, v27
s_lshl_b32 s28, s17, 1
s_add_u32 s29, s28, 0
v_xor_b32 v31, s29, v30
v_lshl_add_u32 v31, v31, 5, v27
ds_read_b64_tr_b16 v[112:113], v31 offset:0
ds_read_b64_tr_b16 v[114:115], v31 offset:512
ds_read_b64_tr_b16 v[116:117], v31 offset:8192
ds_read_b64_tr_b16 v[118:119], v31 offset:8704
s_waitcnt lgkmcnt(0)
v_add_u32 v31, 16384, v31
ds_read_b64_tr_b16 v[120:121], v31 offset:0
ds_read_b64_tr_b16 v[122:123], v31 offset:512
ds_read_b64_tr_b16 v[124:125], v31 offset:8192
ds_read_b64_tr_b16 v[126:127], v31 offset:8704
s_waitcnt lgkmcnt(0)
v_add_u32 v31, 16384, v31
ds_read_b64_tr_b16 v[128:129], v31 offset:0
ds_read_b64_tr_b16 v[130:131], v31 offset:512
ds_read_b64_tr_b16 v[132:133], v31 offset:8192
ds_read_b64_tr_b16 v[134:135], v31 offset:8704
s_waitcnt lgkmcnt(0)
v_add_u32 v31, 16384, v31
ds_read_b64_tr_b16 v[136:137], v31 offset:0
ds_read_b64_tr_b16 v[138:139], v31 offset:512
ds_read_b64_tr_b16 v[140:141], v31 offset:8192
ds_read_b64_tr_b16 v[142:143], v31 offset:8704
s_waitcnt lgkmcnt(0)
v_add_u32 v31, 16384, v31
ds_read_b64_tr_b16 v[144:145], v31 offset:0
ds_read_b64_tr_b16 v[146:147], v31 offset:512
ds_read_b64_tr_b16 v[148:149], v31 offset:8192
ds_read_b64_tr_b16 v[150:151], v31 offset:8704
s_waitcnt lgkmcnt(0)
v_add_u32 v31, 16384, v31
s_add_u32 s29, s28, 1
v_xor_b32 v31, s29, v30
v_lshl_add_u32 v31, v31, 5, v27
ds_read_b64_tr_b16 v[184:185], v31 offset:0
ds_read_b64_tr_b16 v[186:187], v31 offset:512
ds_read_b64_tr_b16 v[188:189], v31 offset:8192
ds_read_b64_tr_b16 v[190:191], v31 offset:8704
s_waitcnt lgkmcnt(0)
v_add_u32 v31, 16384, v31
ds_read_b64_tr_b16 v[192:193], v31 offset:0
ds_read_b64_tr_b16 v[194:195], v31 offset:512
ds_read_b64_tr_b16 v[196:197], v31 offset:8192
ds_read_b64_tr_b16 v[198:199], v31 offset:8704
s_waitcnt lgkmcnt(0)
v_add_u32 v31, 16384, v31
ds_read_b64_tr_b16 v[200:201], v31 offset:0
ds_read_b64_tr_b16 v[202:203], v31 offset:512
ds_read_b64_tr_b16 v[204:205], v31 offset:8192
ds_read_b64_tr_b16 v[206:207], v31 offset:8704
s_waitcnt lgkmcnt(0)
v_add_u32 v31, 16384, v31
ds_read_b64_tr_b16 v[208:209], v31 offset:0
ds_read_b64_tr_b16 v[210:211], v31 offset:512
ds_read_b64_tr_b16 v[212:213], v31 offset:8192
ds_read_b64_tr_b16 v[214:215], v31 offset:8704
s_waitcnt lgkmcnt(0)
v_add_u32 v31, 16384, v31
ds_read_b64_tr_b16 v[216:217], v31 offset:0
ds_read_b64_tr_b16 v[218:219], v31 offset:512
ds_read_b64_tr_b16 v[220:221], v31 offset:8192
ds_read_b64_tr_b16 v[222:223], v31 offset:8704
s_waitcnt lgkmcnt(0)
v_add_u32 v31, 16384, v31
s_waitcnt lgkmcnt(0)
s_barrier
s_waitcnt vmcnt(0)
s_barrier
v_lshrrev_b32 v24, 8, v0
v_bfe_u32 v25, v0, 6, 2
v_bfe_u32 v26, v0, 4, 2
v_lshrrev_b32 v27, 1, v24
v_lshlrev_b32 v27, 4, v27
v_lshrrev_b32 v28, 1, v25
v_lshl_add_u32 v27, v28, 3, v27
v_and_b32 v29, 1, v24
v_lshl_add_u32 v27, v29, 2, v27
v_and_b32 v30, 1, v25
v_add_u32 v27, v27, v30
v_lshlrev_b32 v27, 8, v27
v_lshl_add_u32 v30, v29, 1, v30
v_lshl_add_u32 v30, v28, 2, v30
v_lshl_add_u32 v27, v26, 3, v27
v_add_u32 v27, 98304, v27
s_lshl_b32 s28, s17, 1
s_add_u32 s29, s28, 0
v_xor_b32 v31, s29, v30
v_lshl_add_u32 v31, v31, 5, v27
ds_read_b64_tr_b16 v[152:153], v31 offset:0
ds_read_b64_tr_b16 v[154:155], v31 offset:512
ds_read_b64_tr_b16 v[156:157], v31 offset:8192
ds_read_b64_tr_b16 v[158:159], v31 offset:8704
s_waitcnt lgkmcnt(0)
v_add_u32 v31, 16384, v31
ds_read_b64_tr_b16 v[160:161], v31 offset:0
ds_read_b64_tr_b16 v[162:163], v31 offset:512
ds_read_b64_tr_b16 v[164:165], v31 offset:8192
ds_read_b64_tr_b16 v[166:167], v31 offset:8704
s_waitcnt lgkmcnt(0)
v_add_u32 v31, 16384, v31
ds_read_b64_tr_b16 v[168:169], v31 offset:0
ds_read_b64_tr_b16 v[170:171], v31 offset:512
ds_read_b64_tr_b16 v[172:173], v31 offset:8192
ds_read_b64_tr_b16 v[174:175], v31 offset:8704
s_waitcnt lgkmcnt(0)
v_add_u32 v31, 16384, v31
ds_read_b64_tr_b16 v[176:177], v31 offset:0
ds_read_b64_tr_b16 v[178:179], v31 offset:512
ds_read_b64_tr_b16 v[180:181], v31 offset:8192
ds_read_b64_tr_b16 v[182:183], v31 offset:8704
s_waitcnt lgkmcnt(0)
v_add_u32 v31, 16384, v31
s_add_u32 s29, s28, 1
v_xor_b32 v31, s29, v30
v_lshl_add_u32 v31, v31, 5, v27
ds_read_b64_tr_b16 v[224:225], v31 offset:0
ds_read_b64_tr_b16 v[226:227], v31 offset:512
ds_read_b64_tr_b16 v[228:229], v31 offset:8192
ds_read_b64_tr_b16 v[230:231], v31 offset:8704
s_waitcnt lgkmcnt(0)
v_add_u32 v31, 16384, v31
ds_read_b64_tr_b16 v[232:233], v31 offset:0
ds_read_b64_tr_b16 v[234:235], v31 offset:512
ds_read_b64_tr_b16 v[236:237], v31 offset:8192
ds_read_b64_tr_b16 v[238:239], v31 offset:8704
s_waitcnt lgkmcnt(0)
v_add_u32 v31, 16384, v31
ds_read_b64_tr_b16 v[240:241], v31 offset:0
ds_read_b64_tr_b16 v[242:243], v31 offset:512
ds_read_b64_tr_b16 v[244:245], v31 offset:8192
ds_read_b64_tr_b16 v[246:247], v31 offset:8704
s_waitcnt lgkmcnt(0)
v_add_u32 v31, 16384, v31
ds_read_b64_tr_b16 v[248:249], v31 offset:0
ds_read_b64_tr_b16 v[250:251], v31 offset:512
ds_read_b64_tr_b16 v[252:253], v31 offset:8192
ds_read_b64_tr_b16 v[254:255], v31 offset:8704
s_waitcnt lgkmcnt(0)
v_add_u32 v31, 16384, v31
s_waitcnt lgkmcnt(0)
s_barrier
s_load_dwordx2 s[4:5], s[0:1], 40
s_waitcnt lgkmcnt(0)
s_mul_i32 s28, s16, 147456
s_add_u32 s12, s4, s28
s_addc_u32 s13, s5, 0
s_mov_b32 s14, 147456
s_mov_b32 s15, 0x00020000
v_lshrrev_b32 v24, 5, v0
v_mul_u32_u24 v24, 1152, v24
v_and_b32 v25, 16, v0
v_add_u32 v24, v24, v25
s_mul_i32 s28, s17, 96
s_add_u32 s28, s28, 0
s_mul_i32 s29, s17, 36864
s_add_u32 s29, s29, 16384
s_mov_b32 m0, s29
s_nop 0
buffer_load_dwordx4 v24, s[12:15], s28 offen lds
s_mul_i32 s28, s17, 96
s_add_u32 s28, s28, 36864
s_mul_i32 s29, s17, 36864
s_add_u32 s29, s29, 17408
s_mov_b32 m0, s29
s_nop 0
buffer_load_dwordx4 v24, s[12:15], s28 offen lds
s_mul_i32 s28, s17, 96
s_add_u32 s28, s28, 73728
s_mul_i32 s29, s17, 36864
s_add_u32 s29, s29, 18432
s_mov_b32 m0, s29
s_nop 0
buffer_load_dwordx4 v24, s[12:15], s28 offen lds
s_mul_i32 s28, s17, 96
s_add_u32 s28, s28, 110592
s_mul_i32 s29, s17, 36864
s_add_u32 s29, s29, 19456
s_mov_b32 m0, s29
s_nop 0
buffer_load_dwordx4 v24, s[12:15], s28 offen lds
s_mul_i32 s28, s17, 96
s_add_u32 s28, s28, 32
s_mul_i32 s29, s17, 36864
s_add_u32 s29, s29, 20480
s_mov_b32 m0, s29
s_nop 0
buffer_load_dwordx4 v24, s[12:15], s28 offen lds
s_mul_i32 s28, s17, 96
s_add_u32 s28, s28, 36896
s_mul_i32 s29, s17, 36864
s_add_u32 s29, s29, 21504
s_mov_b32 m0, s29
s_nop 0
buffer_load_dwordx4 v24, s[12:15], s28 offen lds
s_mul_i32 s28, s17, 96
s_add_u32 s28, s28, 73760
s_mul_i32 s29, s17, 36864
s_add_u32 s29, s29, 22528
s_mov_b32 m0, s29
s_nop 0
buffer_load_dwordx4 v24, s[12:15], s28 offen lds
s_mul_i32 s28, s17, 96
s_add_u32 s28, s28, 110624
s_mul_i32 s29, s17, 36864
s_add_u32 s29, s29, 23552
s_mov_b32 m0, s29
s_nop 0
buffer_load_dwordx4 v24, s[12:15], s28 offen lds
s_mul_i32 s28, s17, 96
s_add_u32 s28, s28, 64
s_mul_i32 s29, s17, 36864
s_add_u32 s29, s29, 24576
s_mov_b32 m0, s29
s_nop 0
buffer_load_dwordx4 v24, s[12:15], s28 offen lds
s_mul_i32 s28, s17, 96
s_add_u32 s28, s28, 36928
s_mul_i32 s29, s17, 36864
s_add_u32 s29, s29, 25600
s_mov_b32 m0, s29
s_nop 0
buffer_load_dwordx4 v24, s[12:15], s28 offen lds
s_mul_i32 s28, s17, 96
s_add_u32 s28, s28, 73792
s_mul_i32 s29, s17, 36864
s_add_u32 s29, s29, 26624
s_mov_b32 m0, s29
s_nop 0
buffer_load_dwordx4 v24, s[12:15], s28 offen lds
s_mul_i32 s28, s17, 96
s_add_u32 s28, s28, 110656
s_mul_i32 s29, s17, 36864
s_add_u32 s29, s29, 27648
s_mov_b32 m0, s29
s_nop 0
buffer_load_dwordx4 v24, s[12:15], s28 offen lds
s_mul_i32 s28, s17, 96
s_add_u32 s28, s28, 384
s_mul_i32 s29, s17, 36864
s_add_u32 s29, s29, 28672
s_mov_b32 m0, s29
s_nop 0
buffer_load_dwordx4 v24, s[12:15], s28 offen lds
s_mul_i32 s28, s17, 96
s_add_u32 s28, s28, 37248
s_mul_i32 s29, s17, 36864
s_add_u32 s29, s29, 29696
s_mov_b32 m0, s29
s_nop 0
buffer_load_dwordx4 v24, s[12:15], s28 offen lds
s_mul_i32 s28, s17, 96
s_add_u32 s28, s28, 74112
s_mul_i32 s29, s17, 36864
s_add_u32 s29, s29, 30720
s_mov_b32 m0, s29
s_nop 0
buffer_load_dwordx4 v24, s[12:15], s28 offen lds
s_mul_i32 s28, s17, 96
s_add_u32 s28, s28, 110976
s_mul_i32 s29, s17, 36864
s_add_u32 s29, s29, 31744
s_mov_b32 m0, s29
s_nop 0
buffer_load_dwordx4 v24, s[12:15], s28 offen lds
s_mul_i32 s28, s17, 96
s_add_u32 s28, s28, 416
s_mul_i32 s29, s17, 36864
s_add_u32 s29, s29, 32768
s_mov_b32 m0, s29
s_nop 0
buffer_load_dwordx4 v24, s[12:15], s28 offen lds
s_mul_i32 s28, s17, 96
s_add_u32 s28, s28, 37280
s_mul_i32 s29, s17, 36864
s_add_u32 s29, s29, 33792
s_mov_b32 m0, s29
s_nop 0
buffer_load_dwordx4 v24, s[12:15], s28 offen lds
s_mul_i32 s28, s17, 96
s_add_u32 s28, s28, 74144
s_mul_i32 s29, s17, 36864
s_add_u32 s29, s29, 34816
s_mov_b32 m0, s29
s_nop 0
buffer_load_dwordx4 v24, s[12:15], s28 offen lds
s_mul_i32 s28, s17, 96
s_add_u32 s28, s28, 111008
s_mul_i32 s29, s17, 36864
s_add_u32 s29, s29, 35840
s_mov_b32 m0, s29
s_nop 0
buffer_load_dwordx4 v24, s[12:15], s28 offen lds
s_mul_i32 s28, s17, 96
s_add_u32 s28, s28, 448
s_mul_i32 s29, s17, 36864
s_add_u32 s29, s29, 36864
s_mov_b32 m0, s29
s_nop 0
buffer_load_dwordx4 v24, s[12:15], s28 offen lds
s_mul_i32 s28, s17, 96
s_add_u32 s28, s28, 37312
s_mul_i32 s29, s17, 36864
s_add_u32 s29, s29, 37888
s_mov_b32 m0, s29
s_nop 0
buffer_load_dwordx4 v24, s[12:15], s28 offen lds
s_mul_i32 s28, s17, 96
s_add_u32 s28, s28, 74176
s_mul_i32 s29, s17, 36864
s_add_u32 s29, s29, 38912
s_mov_b32 m0, s29
s_nop 0
buffer_load_dwordx4 v24, s[12:15], s28 offen lds
s_mul_i32 s28, s17, 96
s_add_u32 s28, s28, 111040
s_mul_i32 s29, s17, 36864
s_add_u32 s29, s29, 39936
s_mov_b32 m0, s29
s_nop 0
buffer_load_dwordx4 v24, s[12:15], s28 offen lds
s_mul_i32 s28, s17, 96
s_add_u32 s28, s28, 768
s_mul_i32 s29, s17, 36864
s_add_u32 s29, s29, 40960
s_mov_b32 m0, s29
s_nop 0
buffer_load_dwordx4 v24, s[12:15], s28 offen lds
s_mul_i32 s28, s17, 96
s_add_u32 s28, s28, 37632
s_mul_i32 s29, s17, 36864
s_add_u32 s29, s29, 41984
s_mov_b32 m0, s29
s_nop 0
buffer_load_dwordx4 v24, s[12:15], s28 offen lds
s_mul_i32 s28, s17, 96
s_add_u32 s28, s28, 74496
s_mul_i32 s29, s17, 36864
s_add_u32 s29, s29, 43008
s_mov_b32 m0, s29
s_nop 0
buffer_load_dwordx4 v24, s[12:15], s28 offen lds
s_mul_i32 s28, s17, 96
s_add_u32 s28, s28, 111360
s_mul_i32 s29, s17, 36864
s_add_u32 s29, s29, 44032
s_mov_b32 m0, s29
s_nop 0
buffer_load_dwordx4 v24, s[12:15], s28 offen lds
s_mul_i32 s28, s17, 96
s_add_u32 s28, s28, 800
s_mul_i32 s29, s17, 36864
s_add_u32 s29, s29, 45056
s_mov_b32 m0, s29
s_nop 0
buffer_load_dwordx4 v24, s[12:15], s28 offen lds
s_mul_i32 s28, s17, 96
s_add_u32 s28, s28, 37664
s_mul_i32 s29, s17, 36864
s_add_u32 s29, s29, 46080
s_mov_b32 m0, s29
s_nop 0
buffer_load_dwordx4 v24, s[12:15], s28 offen lds
s_mul_i32 s28, s17, 96
s_add_u32 s28, s28, 74528
s_mul_i32 s29, s17, 36864
s_add_u32 s29, s29, 47104
s_mov_b32 m0, s29
s_nop 0
buffer_load_dwordx4 v24, s[12:15], s28 offen lds
s_mul_i32 s28, s17, 96
s_add_u32 s28, s28, 111392
s_mul_i32 s29, s17, 36864
s_add_u32 s29, s29, 48128
s_mov_b32 m0, s29
s_nop 0
buffer_load_dwordx4 v24, s[12:15], s28 offen lds
s_mul_i32 s28, s17, 96
s_add_u32 s28, s28, 832
s_mul_i32 s29, s17, 36864
s_add_u32 s29, s29, 49152
s_mov_b32 m0, s29
s_nop 0
buffer_load_dwordx4 v24, s[12:15], s28 offen lds
s_mul_i32 s28, s17, 96
s_add_u32 s28, s28, 37696
s_mul_i32 s29, s17, 36864
s_add_u32 s29, s29, 50176
s_mov_b32 m0, s29
s_nop 0
buffer_load_dwordx4 v24, s[12:15], s28 offen lds
s_mul_i32 s28, s17, 96
s_add_u32 s28, s28, 74560
s_mul_i32 s29, s17, 36864
s_add_u32 s29, s29, 51200
s_mov_b32 m0, s29
s_nop 0
buffer_load_dwordx4 v24, s[12:15], s28 offen lds
s_mul_i32 s28, s17, 96
s_add_u32 s28, s28, 111424
s_mul_i32 s29, s17, 36864
s_add_u32 s29, s29, 52224
s_mov_b32 m0, s29
s_nop 0
buffer_load_dwordx4 v24, s[12:15], s28 offen lds
s_waitcnt vmcnt(0)
v_lshrrev_b32 v24, 8, v0
v_bfe_u32 v25, v0, 6, 2
v_bfe_u32 v26, v0, 4, 2
v_and_b32 v27, 1, v24
v_lshlrev_b32 v27, 5, v27
v_lshrrev_b32 v28, 1, v25
v_lshl_add_u32 v27, v28, 4, v27
v_lshrrev_b32 v28, 1, v24
v_lshl_add_u32 v27, v28, 2, v27
v_and_b32 v28, 1, v25
v_add_u32 v27, v27, v28
v_lshlrev_b32 v27, 5, v27
v_lshl_add_u32 v27, v26, 3, v27
s_mul_i32 s29, s17, 36864
s_add_u32 s29, s29, 16384
v_add_u32 v27, s29, v27
ds_read_b64_tr_b16 v[32:33], v27 offset:0
ds_read_b64_tr_b16 v[34:35], v27 offset:64
ds_read_b64_tr_b16 v[36:37], v27 offset:256
ds_read_b64_tr_b16 v[38:39], v27 offset:320
ds_read_b64_tr_b16 v[40:41], v27 offset:2048
ds_read_b64_tr_b16 v[42:43], v27 offset:2112
ds_read_b64_tr_b16 v[44:45], v27 offset:2304
ds_read_b64_tr_b16 v[46:47], v27 offset:2368
s_waitcnt lgkmcnt(0)
ds_write_b128 v8, v[32:35] offset:0
ds_write_b128 v8, v[36:39] offset:1024
ds_write_b128 v8, v[40:43] offset:2048
ds_write_b128 v8, v[44:47] offset:3072
s_waitcnt lgkmcnt(0)
ds_read_b64_tr_b16 v[32:33], v27 offset:4096
ds_read_b64_tr_b16 v[34:35], v27 offset:4160
ds_read_b64_tr_b16 v[36:37], v27 offset:4352
ds_read_b64_tr_b16 v[38:39], v27 offset:4416
ds_read_b64_tr_b16 v[40:41], v27 offset:6144
ds_read_b64_tr_b16 v[42:43], v27 offset:6208
ds_read_b64_tr_b16 v[44:45], v27 offset:6400
ds_read_b64_tr_b16 v[46:47], v27 offset:6464
s_waitcnt lgkmcnt(0)
ds_write_b128 v8, v[32:35] offset:4096
ds_write_b128 v8, v[36:39] offset:5120
ds_write_b128 v8, v[40:43] offset:6144
ds_write_b128 v8, v[44:47] offset:7168
s_waitcnt lgkmcnt(0)
ds_read_b64_tr_b16 v[32:33], v27 offset:8192
ds_read_b64_tr_b16 v[34:35], v27 offset:8256
ds_read_b64_tr_b16 v[36:37], v27 offset:8448
ds_read_b64_tr_b16 v[38:39], v27 offset:8512
ds_read_b64_tr_b16 v[40:41], v27 offset:10240
ds_read_b64_tr_b16 v[42:43], v27 offset:10304
ds_read_b64_tr_b16 v[44:45], v27 offset:10496
ds_read_b64_tr_b16 v[46:47], v27 offset:10560
s_waitcnt lgkmcnt(0)
ds_write_b128 v8, v[32:35] offset:8192
ds_write_b128 v8, v[36:39] offset:9216
ds_write_b128 v8, v[40:43] offset:10240
ds_write_b128 v8, v[44:47] offset:11264
s_waitcnt lgkmcnt(0)
ds_read_b64_tr_b16 v[32:33], v27 offset:12288
ds_read_b64_tr_b16 v[34:35], v27 offset:12352
ds_read_b64_tr_b16 v[36:37], v27 offset:12544
ds_read_b64_tr_b16 v[38:39], v27 offset:12608
ds_read_b64_tr_b16 v[40:41], v27 offset:14336
ds_read_b64_tr_b16 v[42:43], v27 offset:14400
ds_read_b64_tr_b16 v[44:45], v27 offset:14592
ds_read_b64_tr_b16 v[46:47], v27 offset:14656
s_waitcnt lgkmcnt(0)
ds_write_b128 v8, v[32:35] offset:12288
ds_write_b128 v8, v[36:39] offset:13312
ds_write_b128 v8, v[40:43] offset:14336
ds_write_b128 v8, v[44:47] offset:15360
s_waitcnt lgkmcnt(0)
ds_read_b64_tr_b16 v[32:33], v27 offset:16384
ds_read_b64_tr_b16 v[34:35], v27 offset:16448
ds_read_b64_tr_b16 v[36:37], v27 offset:16640
ds_read_b64_tr_b16 v[38:39], v27 offset:16704
ds_read_b64_tr_b16 v[40:41], v27 offset:18432
ds_read_b64_tr_b16 v[42:43], v27 offset:18496
ds_read_b64_tr_b16 v[44:45], v27 offset:18688
ds_read_b64_tr_b16 v[46:47], v27 offset:18752
s_waitcnt lgkmcnt(0)
ds_write_b128 v8, v[32:35] offset:16384
ds_write_b128 v8, v[36:39] offset:17408
ds_write_b128 v8, v[40:43] offset:18432
ds_write_b128 v8, v[44:47] offset:19456
s_waitcnt lgkmcnt(0)
ds_read_b64_tr_b16 v[32:33], v27 offset:20480
ds_read_b64_tr_b16 v[34:35], v27 offset:20544
ds_read_b64_tr_b16 v[36:37], v27 offset:20736
ds_read_b64_tr_b16 v[38:39], v27 offset:20800
ds_read_b64_tr_b16 v[40:41], v27 offset:22528
ds_read_b64_tr_b16 v[42:43], v27 offset:22592
ds_read_b64_tr_b16 v[44:45], v27 offset:22784
ds_read_b64_tr_b16 v[46:47], v27 offset:22848
s_waitcnt lgkmcnt(0)
ds_write_b128 v8, v[32:35] offset:20480
ds_write_b128 v8, v[36:39] offset:21504
ds_write_b128 v8, v[40:43] offset:22528
ds_write_b128 v8, v[44:47] offset:23552
s_waitcnt lgkmcnt(0)
ds_read_b64_tr_b16 v[32:33], v27 offset:24576
ds_read_b64_tr_b16 v[34:35], v27 offset:24640
ds_read_b64_tr_b16 v[36:37], v27 offset:24832
ds_read_b64_tr_b16 v[38:39], v27 offset:24896
ds_read_b64_tr_b16 v[40:41], v27 offset:26624
ds_read_b64_tr_b16 v[42:43], v27 offset:26688
ds_read_b64_tr_b16 v[44:45], v27 offset:26880
ds_read_b64_tr_b16 v[46:47], v27 offset:26944
s_waitcnt lgkmcnt(0)
ds_write_b128 v8, v[32:35] offset:24576
ds_write_b128 v8, v[36:39] offset:25600
ds_write_b128 v8, v[40:43] offset:26624
ds_write_b128 v8, v[44:47] offset:27648
s_waitcnt lgkmcnt(0)
ds_read_b64_tr_b16 v[32:33], v27 offset:28672
ds_read_b64_tr_b16 v[34:35], v27 offset:28736
ds_read_b64_tr_b16 v[36:37], v27 offset:28928
ds_read_b64_tr_b16 v[38:39], v27 offset:28992
ds_read_b64_tr_b16 v[40:41], v27 offset:30720
ds_read_b64_tr_b16 v[42:43], v27 offset:30784
ds_read_b64_tr_b16 v[44:45], v27 offset:30976
ds_read_b64_tr_b16 v[46:47], v27 offset:31040
s_waitcnt lgkmcnt(0)
ds_write_b128 v8, v[32:35] offset:28672
ds_write_b128 v8, v[36:39] offset:29696
ds_write_b128 v8, v[40:43] offset:30720
ds_write_b128 v8, v[44:47] offset:31744
s_waitcnt lgkmcnt(0)
ds_read_b64_tr_b16 v[32:33], v27 offset:32768
ds_read_b64_tr_b16 v[34:35], v27 offset:32832
ds_read_b64_tr_b16 v[36:37], v27 offset:33024
ds_read_b64_tr_b16 v[38:39], v27 offset:33088
ds_read_b64_tr_b16 v[40:41], v27 offset:34816
ds_read_b64_tr_b16 v[42:43], v27 offset:34880
ds_read_b64_tr_b16 v[44:45], v27 offset:35072
ds_read_b64_tr_b16 v[46:47], v27 offset:35136
s_waitcnt lgkmcnt(0)
ds_write_b128 v8, v[32:35] offset:32768
ds_write_b128 v8, v[36:39] offset:33792
ds_write_b128 v8, v[40:43] offset:34816
ds_write_b128 v8, v[44:47] offset:35840
s_waitcnt lgkmcnt(0)
s_barrier
v_mov_b32 v25, 0
s_mov_b32 s65, 4000000
K_MW:
buffer_load_dword v24, v25, s[60:63], 0 offen sc1
buffer_load_dword v26, v25, s[60:63], 0 offen offset:64 sc1
buffer_load_dword v27, v25, s[60:63], 0 offen offset:128 sc1
s_waitcnt vmcnt(0)
v_readfirstlane_b32 s28, v24
v_readfirstlane_b32 s29, v26
v_readfirstlane_b32 s7, v27
s_cmp_eq_u32 s7, 0
s_cbranch_scc1 K_MW2
s_mov_b32 s64, 0
s_cmp_ge_u32 s28, 32
s_cbranch_scc1 K_MK
s_mov_b32 s64, 1
s_cmp_gt_u32 s29, 224
s_cbranch_scc1 K_MK
K_MW2:
s_sub_u32 s65, s65, 1
s_cbranch_scc1 K_END
s_sleep 2
s_branch K_MW
K_MK:
s_cmp_eq_u32 s64, 1
s_cbranch_scc1 K_M1
s_lshl_b32 s42, s16, 5
s_add_u32 s42, s42, 819200
v_lshrrev_b32 v24, 2, v0
v_and_b32 v24, 4, v24
s_mov_b32 s65, 4000000
K_M0p:
buffer_load_dword v25, v24, s[8:11], s42 offen sc1
s_waitcnt vmcnt(0)
v_subrev_u32 v25, s7, v25
v_subrev_u32 v25, 1, v25
v_cmp_lt_u32 vcc, 15, v25
s_cbranch_vccz K_M0q
s_sub_u32 s65, s65, 1
s_cbranch_scc1 K_END
s_sleep 4
s_branch K_M0p
K_M0q:
s_mov_b32 s68, 2
s_mov_b32 s69, 0
s_add_u32 s51, s42, 8
s_and_b32 s39, s7, 0x3fff3f00
s_add_u32 s39, s39, 1
s_lshl_b32 s40, s39, 2
s_lshl_b32 s43, s16, 2
s_add_u32 s43, s43, 820224
K_M0_LOOP:
s_mov_b32 s18, 0
s_mov_b32 s20, 0
s_mov_b32 s21, 786432
s_mov_b32 s22, 795648
s_mov_b32 s23, 804864
s_lshl_b32 s28, s16, 14
s_add_u32 s24, s28, 1048576
s_mov_b32 s25, 34603008
s_add_u32 s45, s24, 524288
s_add_u32 s26, s45, 8192
s_cmp_eq_u32 s17, 3
s_cmp_eq_u32 s17, 2
s_cselect_b32 s28, 1, 0
s_cmp_lt_u32 s16, 9
s_cselect_b32 s29, s28, 0
s_cselect_b32 s62, s16, 0
s_and_b32 s29, s29, 1
s_lshl_b32 s62, s62, 10
s_mov_b32 s60, s29
s_mov_b32 s61, 0
s_sub_u32 s58, 0, s29
s_mov_b32 s59, s58
s_cmp_eq_u32 s17, 3
s_cselect_b32 s57, 1, s29
s_add_u32 s64, s25, s62
s_mov_b32 s63, s7
s_add_u32 s46, s21, 6144
s_lshl_b32 s28, s36, 3
s_add_u32 s47, s28, s24
s_lshl_b32 s28, s17, 11
s_add_u32 s28, s28, s24
s_add_u32 s49, s28, 8192
s_mov_b32 s37, 0x3e0293ee
s_mov_b32 s27, 400000
s_mov_b32 s12, 0x3f803f80
s_mov_b32 s13, 0x3f803f80
s_mov_b32 s50, 815104
v_add_u32 v18, s31, v0
s_cmp_eq_u32 s17, 3
s_cbranch_scc0 L3_63
v_lshlrev_b32 v6, 3, v0
L3_63:
buffer_load_dwordx4 v[64:67], v0, s[8:11], s47 offen offset:0
buffer_load_dwordx4 v[68:71], v0, s[8:11], s47 offen offset:1024
buffer_load_dwordx4 v[72:75], v0, s[8:11], s47 offen offset:2048
buffer_load_dwordx4 v[76:79], v0, s[8:11], s47 offen offset:3072
buffer_load_dwordx4 v[20:23], v0, s[8:11], s49 offen offset:0
buffer_load_dwordx4 v[10:13], v0, s[8:11], s49 offen offset:1024
s_waitcnt vmcnt(0)
v_mov_b64 v[40:41], 0
v_mov_b64 v[42:43], 0
v_mov_b64 v[44:45], 0
v_mov_b64 v[46:47], 0
v_mov_b64 v[56:57], 0
v_mov_b64 v[58:59], 0
v_mov_b64 v[60:61], 0
v_mov_b64 v[62:63], 0
STEP_65:
s_cmp_eq_u32 s17, 3
s_cbranch_scc1 JOIN_68
buffer_load_dwordx4 v[64:67], v18, s[8:11], s21 offen offset:0 sc1
buffer_load_dwordx4 v[68:71], v18, s[8:11], s21 offen offset:3072 sc1
buffer_load_dwordx4 v[72:75], v18, s[8:11], s46 offen offset:0 sc1
s_sleep 3
P0_70:
buffer_load_dwordx4 v[48:51], v18, s[8:11], s21 offen offset:0 sc1
buffer_load_dwordx4 v[52:55], v18, s[8:11], s21 offen offset:3072 sc1
buffer_load_dwordx4 v[76:79], v18, s[8:11], s46 offen offset:0 sc1
s_waitcnt vmcnt(3)
ds_write_b128 v18, v[64:67] offset:0
ds_write_b128 v18, v[68:71] offset:3072
ds_write_b128 v18, v[72:75] offset:6144
v_max3_u32 v14, v64, v65, v66
v_max3_u32 v14, v67, v68, v14
v_max3_u32 v14, v69, v70, v14
v_max3_u32 v14, v71, v72, v14
v_max3_u32 v14, v73, v74, v14
v_max_u32 v14, v75, v14
v_cmp_eq_u32 vcc, -1, v14
s_cbranch_vccz GOK_72
s_sub_u32 s27, s27, 1
s_cbranch_scc1 FAIL_66
buffer_load_dwordx4 v[64:67], v18, s[8:11], s21 offen offset:0 sc1
buffer_load_dwordx4 v[68:71], v18, s[8:11], s21 offen offset:3072 sc1
buffer_load_dwordx4 v[72:75], v18, s[8:11], s46 offen offset:0 sc1
s_waitcnt vmcnt(3)
ds_write_b128 v18, v[48:51] offset:0
ds_write_b128 v18, v[52:55] offset:3072
ds_write_b128 v18, v[76:79] offset:6144
v_max3_u32 v14, v48, v49, v50
v_max3_u32 v14, v51, v52, v14
v_max3_u32 v14, v53, v54, v14
v_max3_u32 v14, v55, v76, v14
v_max3_u32 v14, v77, v78, v14
v_max_u32 v14, v79, v14
v_cmp_eq_u32 vcc, -1, v14
s_cbranch_vccnz P0_70
GOK_72:
s_waitcnt lgkmcnt(0)
JOIN_68:
s_barrier
s_cmp_eq_u32 s18, 63
s_cbranch_scc1 FINAL_69
ds_read_b128 v[24:27], v0 offset:0
ds_read_b128 v[28:31], v0 offset:1024
ds_read_b128 v[32:35], v0 offset:2048
ds_read_b128 v[36:39], v0 offset:3072
s_waitcnt lgkmcnt(3)
v_smfmac_f32_16x16x64_bf16 v[40:43], v[24:27], a[0:7], v1
v_smfmac_f32_16x16x64_bf16 v[44:47], v[24:27], a[72:79], v1
ds_read_b128 v[24:27], v0 offset:4096
buffer_load_dwordx4 v[64:67], v0, s[8:11], s47 offen offset:0
s_waitcnt lgkmcnt(3)
v_smfmac_f32_16x16x64_bf16 v[40:43], v[28:31], a[8:15], v1
v_smfmac_f32_16x16x64_bf16 v[44:47], v[28:31], a[80:87], v1
ds_read_b128 v[28:31], v0 offset:5120
s_waitcnt lgkmcnt(3)
v_smfmac_f32_16x16x64_bf16 v[40:43], v[32:35], a[16:23], v1
v_smfmac_f32_16x16x64_bf16 v[44:47], v[32:35], a[88:95], v1
ds_read_b128 v[32:35], v0 offset:6144
buffer_load_dwordx4 v[68:71], v0, s[8:11], s47 offen offset:1024
s_waitcnt lgkmcnt(3)
v_smfmac_f32_16x16x64_bf16 v[40:43], v[36:39], a[24:31], v1
v_smfmac_f32_16x16x64_bf16 v[44:47], v[36:39], a[96:103], v1
ds_read_b128 v[36:39], v0 offset:7168
s_waitcnt lgkmcnt(3)
v_smfmac_f32_16x16x64_bf16 v[40:43], v[24:27], a[32:39], v1
v_smfmac_f32_16x16x64_bf16 v[44:47], v[24:27], a[104:111], v1
ds_read_b128 v[24:27], v0 offset:8192
buffer_load_dwordx4 v[72:75], v0, s[8:11], s47 offen offset:2048
s_waitcnt lgkmcnt(3)
v_smfmac_f32_16x16x64_bf16 v[40:43], v[28:31], a[40:47], v1
v_smfmac_f32_16x16x64_bf16 v[44:47], v[28:31], a[112:119], v1
ds_read_b128 v[28:31], v0 offset:0
s_waitcnt lgkmcnt(3)
v_smfmac_f32_16x16x64_bf16 v[40:43], v[32:35], a[48:55], v1
v_smfmac_f32_16x16x64_bf16 v[44:47], v[32:35], a[120:127], v1
ds_read_b128 v[32:35], v0 offset:1024
buffer_load_dwordx4 v[76:79], v0, s[8:11], s47 offen offset:3072
s_waitcnt lgkmcnt(3)
v_smfmac_f32_16x16x64_bf16 v[40:43], v[36:39], a[56:63], v1
v_smfmac_f32_16x16x64_bf16 v[44:47], v[36:39], a[128:135], v1
ds_read_b128 v[36:39], v0 offset:2048
s_waitcnt lgkmcnt(3)
v_smfmac_f32_16x16x64_bf16 v[40:43], v[24:27], a[64:71], v1
v_smfmac_f32_16x16x64_bf16 v[44:47], v[24:27], a[136:143], v1
ds_read_b128 v[24:27], v0 offset:3072
buffer_load_dwordx4 v[20:23], v0, s[8:11], s49 offen offset:0
s_waitcnt lgkmcnt(3)
v_smfmac_f32_16x16x64_bf16 v[56:59], v[28:31], a[144:151], v1
v_smfmac_f32_16x16x64_bf16 v[60:63], v[28:31], a[216:223], v1
ds_read_b128 v[28:31], v0 offset:4096
buffer_load_dwordx4 v[10:13], v0, s[8:11], s49 offen offset:1024
s_waitcnt lgkmcnt(3)
v_smfmac_f32_16x16x64_bf16 v[56:59], v[32:35], a[152:159], v1
v_smfmac_f32_16x16x64_bf16 v[60:63], v[32:35], a[224:231], v1
ds_read_b128 v[32:35], v0 offset:5120
v_add_f32 v40, v40, v42
v_add_f32 v41, v41, v43
s_waitcnt lgkmcnt(3)
v_smfmac_f32_16x16x64_bf16 v[56:59], v[36:39], a[160:167], v1
v_mul_f32 v40, s37, v40
v_mul_f32 v41, s37, v41
v_smfmac_f32_16x16x64_bf16 v[60:63], v[36:39], a[232:239], v1
ds_read_b128 v[36:39], v0 offset:6144
v_cvt_pk_bf16_f32 v14, v40, v41
v_add_f32 v44, v44, v46
s_waitcnt lgkmcnt(3)
v_smfmac_f32_16x16x64_bf16 v[56:59], v[24:27], a[168:175], v1
v_add_f32 v45, v45, v47
v_mul_f32 v44, s37, v44
v_smfmac_f32_16x16x64_bf16 v[60:63], v[24:27], a[240:247], v1
ds_read_b128 v[24:27], v0 offset:7168
v_mul_f32 v45, s37, v45
v_cvt_pk_bf16_f32 v15, v44, v45
ds_write2_b32 v2, v14, v15 offset0:1 offset1:129
s_waitcnt vmcnt(6)
v_add_u32 v18, s62, v0
ds_read_b128 v[48:51], v18 offset:0
s_waitcnt lgkmcnt(5)
v_smfmac_f32_16x16x64_bf16 v[56:59], v[28:31], a[176:183], v1
v_smfmac_f32_16x16x64_bf16 v[60:63], v[28:31], a[248:255], v1
ds_read_b128 v[28:31], v0 offset:8192
s_waitcnt lgkmcnt(1)
s_cmp_lg_u32 s58, 0
s_cbranch_scc1 PUBL_75
PUBb_76:
v_smfmac_f32_16x16x64_bf16 v[56:59], v[32:35], a[184:191], v1
v_smfmac_f32_16x16x64_bf16 v[60:63], v[32:35], v[80:87], v1
ds_read_b128 v[32:35], v0 offset:0
s_cmp_eq_u32 s17, 3
s_cbranch_scc1 PF3_73
PF3b_74:
s_cmp_lg_u32 s57, 0
s_cbranch_scc1 W2_77
s_waitcnt vmcnt(0)
W2b_78:
s_barrier
ds_read_b64_tr_b16 v[40:41], v3 offset:0
ds_read_b64_tr_b16 v[42:43], v3 offset:512
ds_read_b64_tr_b16 v[44:45], v3 offset:1024
ds_read_b64_tr_b16 v[46:47], v3 offset:1536
v_smfmac_f32_16x16x64_bf16 v[56:59], v[36:39], a[192:199], v1
ds_read_b64_tr_b16 v[48:49], v3 offset:2048
ds_read_b64_tr_b16 v[50:51], v3 offset:2560
v_smfmac_f32_16x16x64_bf16 v[60:63], v[36:39], v[88:95], v1
ds_read_b128 v[36:39], v0 offset:1024
ds_read_b64_tr_b16 v[52:53], v3 offset:3072
v_smfmac_f32_16x16x64_bf16 v[56:59], v[24:27], a[200:207], v1
ds_read_b64_tr_b16 v[54:55], v3 offset:3584
v_add_u32 v18, s36, v9
v_smfmac_f32_16x16x64_bf16 v[60:63], v[24:27], v[96:103], v1
ds_read_b128 v[24:27], v0 offset:2048
s_waitcnt lgkmcnt(11)
v_smfmac_f32_16x16x64_bf16 v[56:59], v[28:31], a[208:215], v1
v_smfmac_f32_16x16x64_bf16 v[60:63], v[28:31], v[104:111], v1
ds_read_b128 v[28:31], v0 offset:3072
s_waitcnt lgkmcnt(7)
v_mfma_f32_16x16x32_bf16 v[14:17], v[64:67], v[40:43], 0
v_mfma_f32_16x16x32_bf16 v[14:17], v[68:71], v[44:47], v[14:17]
s_waitcnt lgkmcnt(2)
v_mfma_f32_16x16x32_bf16 v[14:17], v[72:75], v[48:51], v[14:17]
v_mfma_f32_16x16x32_bf16 v[14:17], v[76:79], v[52:55], v[14:17]
v_mov_b64 v[64:65], 0
v_mov_b64 v[66:67], 0
v_mov_b64 v[68:69], 0
v_mov_b64 v[70:71], 0
s_nop 0
v_smfmac_f32_16x16x64_bf16 v[64:67], v[32:35], v[112:119], v1
v_add_f32 v56, v56, v58
v_smfmac_f32_16x16x64_bf16 v[68:71], v[32:35], v[184:191], v1
ds_read_b128 v[32:35], v0 offset:4096
v_add_f32 v57, v57, v59
v_smfmac_f32_16x16x64_bf16 v[64:67], v[36:39], v[120:127], v1
v_add_f32 v60, v60, v62
v_smfmac_f32_16x16x64_bf16 v[68:71], v[36:39], v[192:199], v1
ds_read_b128 v[36:39], v0 offset:5120
v_add_f32 v61, v61, v63
s_waitcnt lgkmcnt(3)
v_smfmac_f32_16x16x64_bf16 v[64:67], v[24:27], v[128:135], v1
v_cvt_pk_bf16_f32 v56, v56, v57
v_smfmac_f32_16x16x64_bf16 v[68:71], v[24:27], v[200:207], v1
ds_read_b128 v[24:27], v0 offset:6144
v_cvt_pk_bf16_f32 v60, v60, v61
ds_write2_b32 v2, v56, v60 offset0:0 offset1:128
s_waitcnt lgkmcnt(4)
v_smfmac_f32_16x16x64_bf16 v[64:67], v[28:31], v[136:143], v1
v_exp_f32 v14, v14
v_smfmac_f32_16x16x64_bf16 v[68:71], v[28:31], v[208:215], v1
ds_read_b128 v[28:31], v0 offset:7168
v_exp_f32 v15, v15
s_waitcnt lgkmcnt(4)
v_smfmac_f32_16x16x64_bf16 v[64:67], v[32:35], v[144:151], v1
v_exp_f32 v16, v16
v_smfmac_f32_16x16x64_bf16 v[68:71], v[32:35], v[216:223], v1
ds_read_b128 v[32:35], v0 offset:8192
v_exp_f32 v17, v17
s_waitcnt lgkmcnt(2)
s_barrier
v_cvt_pk_bf16_f32 v14, v14, v15
v_cvt_pk_bf16_f32 v15, v16, v17
ds_write_b64 v18, v[14:15]
v_smfmac_f32_16x16x64_bf16 v[64:67], v[36:39], v[152:159], v1
ds_read_b64_tr_b16 v[40:41], v3 offset:0
ds_read_b64_tr_b16 v[42:43], v3 offset:512
v_smfmac_f32_16x16x64_bf16 v[68:71], v[36:39], v[224:231], v1
ds_read_b64_tr_b16 v[44:45], v3 offset:1024
ds_read_b64_tr_b16 v[46:47], v3 offset:1536
v_smfmac_f32_16x16x64_bf16 v[64:67], v[24:27], v[160:167], v1
ds_read_b64_tr_b16 v[48:49], v3 offset:2048
ds_read_b64_tr_b16 v[50:51], v3 offset:2560
v_smfmac_f32_16x16x64_bf16 v[68:71], v[24:27], v[232:239], v1
ds_read_b64_tr_b16 v[52:53], v3 offset:3072
ds_read_b64_tr_b16 v[54:55], v3 offset:3584
s_waitcnt lgkmcnt(10)
v_smfmac_f32_16x16x64_bf16 v[64:67], v[28:31], v[168:175], v1
v_smfmac_f32_16x16x64_bf16 v[68:71], v[28:31], v[240:247], v1
s_waitcnt lgkmcnt(8)
s_barrier
ds_read2_b64 v[56:59], v9 offset0:0 offset1:64
v_smfmac_f32_16x16x64_bf16 v[64:67], v[32:35], v[176:183], v1
v_mov_b64 v[14:15], s[12:13]
v_smfmac_f32_16x16x64_bf16 v[68:71], v[32:35], v[248:255], v1
v_mov_b64 v[16:17], s[12:13]
s_waitcnt lgkmcnt(5)
v_mfma_f32_16x16x32_bf16 v[60:63], v[40:43], v[40:43], 0
v_mfma_f32_16x16x32_bf16 v[60:63], v[44:47], v[44:47], v[60:63]
s_waitcnt lgkmcnt(1)
v_mfma_f32_16x16x32_bf16 v[60:63], v[48:51], v[48:51], v[60:63]
v_mfma_f32_16x16x32_bf16 v[60:63], v[52:55], v[52:55], v[60:63]
ds_read_b128 v[72:75], v8 offset:0
ds_read_b128 v[76:79], v8 offset:1024
s_waitcnt lgkmcnt(2)
v_mfma_f32_16x16x32_bf16 v[48:51], v[14:17], v[56:59], 0
v_add_f32 v64, v64, v66
v_add_f32 v65, v65, v67
v_mfma_f32_16x16x32_bf16 v[40:43], v[20:23], v[56:59], 0
v_cvt_pk_bf16_f32 v64, v64, v65
v_mov_b32 v65, 0
v_mfma_f32_16x16x32_bf16 v[44:47], v[10:13], v[56:59], 0
v_add_f32 v68, v68, v70
v_add_f32 v69, v69, v71
v_exp_f32 v60, v60
v_exp_f32 v61, v61
v_cvt_pk_bf16_f32 v68, v68, v69
v_mov_b32 v69, 0
v_cvt_pk_bf16_f32 v18, v60, v61
ds_read_b128 v[24:27], v8 offset:2048
ds_read_b128 v[28:31], v8 offset:3072
v_mfma_f32_16x16x16_bf16 v[48:51], v[14:15], v[18:19], v[48:51]
v_mfma_f32_16x16x16_bf16 v[40:43], v[64:65], v[18:19], v[40:43]
v_mfma_f32_16x16x16_bf16 v[44:47], v[68:69], v[18:19], v[44:47]
ds_read_b128 v[32:35], v8 offset:4096
ds_read_b128 v[36:39], v8 offset:5120
v_mov_b32 v66, s44
s_nop 2
v_med3_f32 v66, v48, s38, v66
v_cmp_neq_f32 vcc, v66, v48
v_rcp_f32 v66, v48
s_and_b64 vcc, vcc, s[32:33]
s_cbranch_vccnz SLOW_79
BACK_80:
s_cmp_eq_u32 s18, 63
s_cbranch_scc1 LAST_81
s_nop 0
v_pk_mul_f32 v[40:41], v[40:41], v[66:67] op_sel_hi:[1,0]
v_pk_mul_f32 v[42:43], v[42:43], v[66:67] op_sel_hi:[1,0]
v_cvt_pk_bf16_f32 v40, v40, v41
v_cvt_pk_bf16_f32 v41, v42, v43
v_pk_mul_f32 v[44:45], v[44:45], v[66:67] op_sel_hi:[1,0]
v_pk_mul_f32 v[46:47], v[46:47], v[66:67] op_sel_hi:[1,0]
v_cvt_pk_bf16_f32 v44, v44, v45
v_cvt_pk_bf16_f32 v45, v46, v47
s_mov_b64 exec, s[32:33]
ds_write2_b64 v4, v[40:41], v[44:45] offset0:0 offset1:4
s_mov_b64 exec, -1
v_mov_b64 v[20:21], 0
v_mov_b64 v[22:23], 0
v_mov_b64 v[10:11], 0
v_mov_b64 v[12:13], 0
v_mov_b32 v17, s39
s_waitcnt lgkmcnt(0)
s_barrier
ds_read_b128 v[48:51], v0 offset:14336
ds_read_b128 v[52:55], v0 offset:15360
ds_read_b128 v[56:59], v8 offset:6144
ds_read_b128 v[60:63], v8 offset:7168
ds_read_b128 v[40:43], v8 offset:8192
ds_read_b128 v[44:47], v8 offset:9216
ds_read_b128 v[64:67], v8 offset:10240
ds_read_b128 v[68:71], v8 offset:11264
s_waitcnt lgkmcnt(6)
v_smfmac_f32_16x16x64_bf16 v[20:23], v[48:51], v[72:79], v1
ds_read_b128 v[72:75], v8 offset:12288
ds_read_b128 v[76:79], v8 offset:13312
v_smfmac_f32_16x16x64_bf16 v[20:23], v[52:55], v[24:31], v1
ds_read_b128 v[24:27], v8 offset:14336
ds_read_b128 v[28:31], v8 offset:15360
s_waitcnt lgkmcnt(8)
v_smfmac_f32_16x16x64_bf16 v[10:13], v[48:51], v[32:39], v1
ds_read_b128 v[32:35], v8 offset:16384
ds_read_b128 v[36:39], v8 offset:17408
s_nop 3
v_add_f32 v20, v20, v22
v_smfmac_f32_16x16x64_bf16 v[10:13], v[52:55], v[56:63], v1
ds_read_b128 v[56:59], v8 offset:18432
ds_read_b128 v[60:63], v8 offset:19456
v_add_f32 v21, v21, v23
v_cvt_pk_bf16_f32 v14, v20, v21
v_mov_b64 v[20:21], 0
v_mov_b64 v[22:23], 0
s_nop 0
s_waitcnt lgkmcnt(8)
v_smfmac_f32_16x16x64_bf16 v[20:23], v[48:51], v[40:47], v1
ds_read_b128 v[40:43], v8 offset:20480
ds_read_b128 v[44:47], v8 offset:21504
v_add_f32 v10, v10, v12
v_smfmac_f32_16x16x64_bf16 v[20:23], v[52:55], v[64:71], v1
ds_read_b128 v[64:67], v8 offset:22528
v_add_f32 v11, v11, v13
v_cvt_pk_bf16_f32 v15, v10, v11
v_mov_b64 v[10:11], 0
v_mov_b64 v[12:13], 0
s_nop 0
s_waitcnt lgkmcnt(7)
v_smfmac_f32_16x16x64_bf16 v[10:13], v[48:51], v[72:79], v1
ds_read_b128 v[68:71], v8 offset:23552
ds_read_b128 v[72:75], v8 offset:24576
v_add_f32 v20, v20, v22
v_smfmac_f32_16x16x64_bf16 v[10:13], v[52:55], v[24:31], v1
ds_read_b128 v[76:79], v8 offset:25600
v_add_f32 v21, v21, v23
v_cvt_pk_bf16_f32 v16, v20, v21
v_mov_b64 v[20:21], 0
v_mov_b64 v[22:23], 0
s_add_u32 s28, s20, 0
buffer_store_dwordx4 v[14:17], v5, s[8:11], s28 offen
s_nop 0
s_waitcnt lgkmcnt(6)
v_smfmac_f32_16x16x64_bf16 v[20:23], v[48:51], v[32:39], v1
ds_read_b128 v[24:27], v8 offset:26624
ds_read_b128 v[28:31], v8 offset:27648
v_add_f32 v10, v10, v12
v_smfmac_f32_16x16x64_bf16 v[20:23], v[52:55], v[56:63], v1
ds_read_b128 v[32:35], v8 offset:28672
v_add_f32 v11, v11, v13
v_cvt_pk_bf16_f32 v14, v10, v11
v_mov_b64 v[10:11], 0
v_mov_b64 v[12:13], 0
s_nop 0
s_waitcnt lgkmcnt(5)
v_smfmac_f32_16x16x64_bf16 v[10:13], v[48:51], v[40:47], v1
ds_read_b128 v[36:39], v8 offset:29696
ds_read_b128 v[56:59], v8 offset:30720
v_add_f32 v20, v20, v22
v_smfmac_f32_16x16x64_bf16 v[10:13], v[52:55], v[64:71], v1
ds_read_b128 v[60:63], v8 offset:31744
v_add_f32 v21, v21, v23
v_cvt_pk_bf16_f32 v15, v20, v21
v_mov_b64 v[20:21], 0
v_mov_b64 v[22:23], 0
s_nop 0
s_waitcnt lgkmcnt(4)
v_smfmac_f32_16x16x64_bf16 v[20:23], v[48:51], v[72:79], v1
ds_read_b128 v[40:43], v8 offset:32768
ds_read_b128 v[44:47], v8 offset:33792
v_add_f32 v10, v10, v12
v_smfmac_f32_16x16x64_bf16 v[20:23], v[52:55], v[24:31], v1
ds_read_b128 v[64:67], v8 offset:34816
v_add_f32 v11, v11, v13
v_cvt_pk_bf16_f32 v16, v10, v11
v_mov_b64 v[10:11], 0
v_mov_b64 v[12:13], 0
s_add_u32 s28, s20, 131072
buffer_store_dwordx4 v[14:17], v5, s[8:11], s28 offen
s_nop 0
s_waitcnt lgkmcnt(3)
v_smfmac_f32_16x16x64_bf16 v[10:13], v[48:51], v[32:39], v1
ds_read_b128 v[68:71], v8 offset:35840
s_nop 0
v_add_f32 v20, v20, v22
v_smfmac_f32_16x16x64_bf16 v[10:13], v[52:55], v[56:63], v1
v_add_f32 v21, v21, v23
v_cvt_pk_bf16_f32 v14, v20, v21
v_mov_b64 v[20:21], 0
v_mov_b64 v[22:23], 0
s_nop 0
s_waitcnt lgkmcnt(0)
v_smfmac_f32_16x16x64_bf16 v[20:23], v[48:51], v[40:47], v1
s_nop 1
v_add_f32 v10, v10, v12
v_smfmac_f32_16x16x64_bf16 v[20:23], v[52:55], v[64:71], v1
v_add_f32 v11, v11, v13
v_cvt_pk_bf16_f32 v15, v10, v11
s_nop 6
v_add_f32 v20, v20, v22
v_add_f32 v21, v21, v23
v_cvt_pk_bf16_f32 v16, v20, v21
s_add_u32 s28, s20, 262144
buffer_store_dwordx4 v[14:17], v5, s[8:11], s28 offen
s_cmp_eq_u32 s17, 3
s_cbranch_scc1 RW3_86
s_mov_b32 s29, s20
s_mov_b32 s30, s22
s_mov_b32 s53, s21
s_mov_b32 s41, s40
buffer_load_dwordx4 v[48:51], v0, s[8:11], s50 offen
s_xor_b32 s20, s20, 393216
s_mov_b32 s28, s21
s_mov_b32 s21, s22
s_mov_b32 s22, s23
s_mov_b32 s23, s28
s_add_u32 s24, s24, 524288
s_add_u32 s25, s25, 16384
s_add_u32 s18, s18, 1
s_add_u32 s39, s39, 1
s_add_u32 s40, s40, 4
s_add_u32 s46, s21, 6144
s_add_u32 s64, s64, 16384
s_add_u32 s63, s63, 1
s_add_u32 s47, s47, 524288
s_add_u32 s49, s49, 524288
v_mov_b64 v[40:41], 0
v_mov_b64 v[42:43], 0
v_mov_b64 v[44:45], 0
v_mov_b64 v[46:47], 0
s_sleep 1
s_cmp_eq_u32 s17, 0
s_cbranch_scc1 R0_83
s_sleep 2
s_cmp_eq_u32 s17, 1
s_cbranch_scc1 R0_83
s_sleep 2
R0_83:
buffer_load_dwordx4 v[24:27], v6, s[8:11], s29 offen offset:0 sc1
buffer_load_dwordx4 v[28:31], v6, s[8:11], s29 offen offset:1024 sc1
buffer_load_dwordx4 v[32:35], v6, s[8:11], s29 offen offset:2048 sc1
buffer_load_dwordx4 v[36:39], v6, s[8:11], s29 offen offset:3072 sc1
v_mov_b64 v[56:57], 0
v_mov_b64 v[58:59], 0
v_mov_b64 v[60:61], 0
v_mov_b64 v[62:63], 0
RB_85:
s_waitcnt vmcnt(3)
v_mfma_f32_16x16x32_bf16 v[14:17], v[24:27], v[48:51], 0
s_waitcnt vmcnt(2)
v_mfma_f32_16x16x32_bf16 v[14:17], v[28:31], v[48:51], v[14:17]
s_waitcnt vmcnt(1)
v_mfma_f32_16x16x32_bf16 v[14:17], v[32:35], v[48:51], v[14:17]
s_waitcnt vmcnt(0)
v_mfma_f32_16x16x32_bf16 v[14:17], v[36:39], v[48:51], v[14:17]
v_add3_u32 v18, v27, v31, v35
v_add_u32 v18, v18, v39
v_cmp_ne_u32 vcc, s41, v18
s_cbranch_vccz FIN_87
s_sub_u32 s27, s27, 1
s_cbranch_scc1 FAIL_66
buffer_load_dwordx4 v[24:27], v6, s[8:11], s29 offen offset:0 sc1
buffer_load_dwordx4 v[28:31], v6, s[8:11], s29 offen offset:1024 sc1
buffer_load_dwordx4 v[32:35], v6, s[8:11], s29 offen offset:2048 sc1
buffer_load_dwordx4 v[36:39], v6, s[8:11], s29 offen offset:3072 sc1
s_branch RB_85
FIN_87:
v_mov_b32 v18, -1
s_mov_b64 exec, s[34:35]
s_nop 1
v_add_f32 v14, v14, v16
v_add_f32 v15, v15, v17
v_cvt_pk_bf16_f32 v14, v14, v15
buffer_store_dword v14, v7, s[8:11], s30 offen
buffer_store_dword v18, v7, s[8:11], s53 offen
s_mov_b64 exec, -1
s_cmp_eq_u32 s17, 2
s_cbranch_scc1 NR_82
s_sleep 5
NR_82:
v_add_u32 v18, s31, v0
s_mov_b32 s27, 400000
s_branch STEP_65
RW3_86:
s_xor_b32 s20, s20, 393216
s_mov_b32 s28, s21
s_mov_b32 s21, s22
s_mov_b32 s22, s23
s_mov_b32 s23, s28
s_add_u32 s24, s24, 524288
s_add_u32 s25, s25, 16384
s_add_u32 s18, s18, 1
s_add_u32 s39, s39, 1
s_add_u32 s40, s40, 4
s_add_u32 s46, s21, 6144
s_add_u32 s64, s64, 16384
s_add_u32 s63, s63, 1
s_add_u32 s47, s47, 524288
s_add_u32 s49, s49, 524288
v_mov_b64 v[40:41], 0
v_mov_b64 v[42:43], 0
v_mov_b64 v[44:45], 0
v_mov_b64 v[46:47], 0
v_mov_b64 v[56:57], 0
v_mov_b64 v[58:59], 0
v_mov_b64 v[60:61], 0
v_mov_b64 v[62:63], 0
s_waitcnt vmcnt(3)
s_cmp_lt_u32 s18, 62
s_cbranch_scc0 PK_90
PW_89:
v_readfirstlane_b32 s29, v7
s_sub_u32 s29, s29, s7
s_sub_u32 s29, s29, 1
s_cmp_lt_u32 s29, 16
s_cbranch_scc0 PW_89n
s_cmp_ge_u32 s29, s69
s_cbranch_scc1 PK_90
PW_89n:
s_sub_u32 s27, s27, 1
s_cbranch_scc1 FAIL_66
s_sleep 8
buffer_load_dword v7, v19, s[8:11], s51 offen sc1
s_waitcnt vmcnt(0)
s_branch PW_89
PK_90:
s_add_u32 s68, s68, 1
s_cmp_eq_u32 s68, 7
s_cselect_b32 s28, 1, 0
s_cselect_b32 s68, 0, s68
s_add_u32 s69, s69, s28
s_lshl_b32 s51, s68, 2
s_add_u32 s51, s51, s42
s_add_u32 s45, s24, 524288
s_add_u32 s26, s45, 8192
s_branch NR_82
PUBL_75:
s_mov_b64 exec, 1
v_mov_b32 v18, s63
buffer_store_dword v18, v19, s[8:11], s43 offen sc1
s_mov_b64 exec, -1
buffer_store_dwordx4 v[48:51], v0, s[8:11], s64 offen sc1
s_branch PUBb_76
PF3_73:
buffer_load_dword v7, v6, s[8:11], s45 offen
buffer_load_dword v7, v6, s[8:11], s26 offen
buffer_load_dword v7, v19, s[8:11], s51 offen sc1
s_branch PF3b_74
W2_77:
s_cmp_eq_u32 s17, 3
s_cbranch_scc0 W2_77m
s_waitcnt vmcnt(3)
s_branch W2b_78
W2_77m:
s_waitcnt vmcnt(2)
s_branch W2b_78
SLOW_79:
s_nop 7
ds_read_b64_tr_b16 v[40:41], v3 offset:0
ds_read_b64_tr_b16 v[42:43], v3 offset:512
ds_read_b64_tr_b16 v[44:45], v3 offset:1024
ds_read_b64_tr_b16 v[46:47], v3 offset:1536
ds_read_b64_tr_b16 v[48:49], v3 offset:2048
ds_read_b64_tr_b16 v[50:51], v3 offset:2560
ds_read_b64_tr_b16 v[52:53], v3 offset:3072
ds_read_b64_tr_b16 v[54:55], v3 offset:3584
s_add_u32 s28, s24, 0
buffer_load_dwordx4 v[24:27], v0, s[8:11], s28 offen offset:0
buffer_load_dwordx4 v[28:31], v0, s[8:11], s28 offen offset:1024
buffer_load_dwordx4 v[32:35], v0, s[8:11], s28 offen offset:2048
buffer_load_dwordx4 v[36:39], v0, s[8:11], s28 offen offset:3072
s_waitcnt vmcnt(0) lgkmcnt(0)
v_mfma_f32_16x16x32_bf16 v[56:59], v[24:27], v[40:43], 0
v_mfma_f32_16x16x32_bf16 v[56:59], v[28:31], v[44:47], v[56:59]
v_mfma_f32_16x16x32_bf16 v[56:59], v[32:35], v[48:51], v[56:59]
v_mfma_f32_16x16x32_bf16 v[56:59], v[36:39], v[52:55], v[56:59]
s_nop 7
s_add_u32 s28, s24, 4096
buffer_load_dwordx4 v[24:27], v0, s[8:11], s28 offen offset:0
buffer_load_dwordx4 v[28:31], v0, s[8:11], s28 offen offset:1024
buffer_load_dwordx4 v[32:35], v0, s[8:11], s28 offen offset:2048
buffer_load_dwordx4 v[36:39], v0, s[8:11], s28 offen offset:3072
s_waitcnt vmcnt(0) lgkmcnt(0)
v_mfma_f32_16x16x32_bf16 v[14:17], v[24:27], v[40:43], 0
v_mfma_f32_16x16x32_bf16 v[14:17], v[28:31], v[44:47], v[14:17]
v_mfma_f32_16x16x32_bf16 v[14:17], v[32:35], v[48:51], v[14:17]
v_mfma_f32_16x16x32_bf16 v[14:17], v[36:39], v[52:55], v[14:17]
s_nop 7
v_mfma_f32_16x16x32_bf16 v[60:63], v[40:43], v[40:43], 0
v_mfma_f32_16x16x32_bf16 v[60:63], v[44:47], v[44:47], v[60:63]
v_mfma_f32_16x16x32_bf16 v[60:63], v[48:51], v[48:51], v[60:63]
v_mfma_f32_16x16x32_bf16 v[60:63], v[52:55], v[52:55], v[60:63]
s_nop 7
s_nop 1
v_max3_f32 v18, v56, v57, v58
v_max3_f32 v18, v59, v14, v18
v_max3_f32 v18, v15, v16, v18
v_max3_f32 v18, v17, v60, v18
v_max_f32 v18, v61, v18
v_mov_b32 v52, v18
s_nop 1
v_permlane32_swap_b32 v52, v18
s_nop 1
v_max_f32 v18, v18, v52
v_mov_b32 v52, v18
s_nop 1
v_permlane16_swap_b32 v52, v18
s_nop 1
v_max_f32 v18, v18, v52
v_sub_f32 v56, v56, v18
v_sub_f32 v57, v57, v18
v_sub_f32 v58, v58, v18
v_sub_f32 v59, v59, v18
v_sub_f32 v14, v14, v18
v_sub_f32 v15, v15, v18
v_sub_f32 v16, v16, v18
v_sub_f32 v17, v17, v18
v_sub_f32 v60, v60, v18
v_sub_f32 v61, v61, v18
v_exp_f32 v56, v56
v_exp_f32 v57, v57
v_exp_f32 v58, v58
v_exp_f32 v59, v59
v_exp_f32 v14, v14
v_exp_f32 v15, v15
v_exp_f32 v16, v16
v_exp_f32 v17, v17
v_exp_f32 v60, v60
v_exp_f32 v61, v61
s_nop 0
v_cvt_pk_bf16_f32 v56, v56, v57
v_cvt_pk_bf16_f32 v57, v58, v59
v_cvt_pk_bf16_f32 v58, v14, v15
v_cvt_pk_bf16_f32 v59, v16, v17
v_cvt_pk_bf16_f32 v18, v60, v61
v_mov_b64 v[14:15], s[12:13]
v_mov_b64 v[16:17], s[12:13]
s_nop 1
v_mfma_f32_16x16x32_bf16 v[40:43], v[20:23], v[56:59], 0
v_mfma_f32_16x16x32_bf16 v[44:47], v[10:13], v[56:59], 0
v_mfma_f32_16x16x32_bf16 v[48:51], v[14:17], v[56:59], 0
s_nop 7
v_mfma_f32_16x16x16_bf16 v[48:51], v[14:15], v[18:19], v[48:51]
v_mfma_f32_16x16x16_bf16 v[40:43], v[64:65], v[18:19], v[40:43]
v_mfma_f32_16x16x16_bf16 v[44:47], v[68:69], v[18:19], v[44:47]
ds_read_b128 v[72:75], v8 offset:0
ds_read_b128 v[76:79], v8 offset:1024
ds_read_b128 v[24:27], v8 offset:2048
ds_read_b128 v[28:31], v8 offset:3072
ds_read_b128 v[32:35], v8 offset:4096
ds_read_b128 v[36:39], v8 offset:5120
s_waitcnt lgkmcnt(0)
s_nop 7
v_rcp_f32 v66, v48
s_branch BACK_80
LAST_81:
s_branch DONE_67
FINAL_69:
s_cmp_lg_u32 s58, 0
s_cbranch_scc0 DONE_67
s_lshl_b32 s28, s16, 10
v_add_u32 v18, s28, v0
ds_read_b128 v[48:51], v18 offset:0
s_add_u32 s28, s28, s25
s_waitcnt lgkmcnt(0)
buffer_store_dwordx4 v[48:51], v0, s[8:11], s28 offen sc1
s_waitcnt vmcnt(0)
s_add_u32 s28, s7, 64
v_mov_b32 v18, s28
s_mov_b64 exec, 1
buffer_store_dword v18, v19, s[8:11], s43 offen sc1
s_mov_b64 exec, -1
s_branch DONE_67
FAIL_66:
s_mov_b64 exec, -1
s_mov_b32 s19, 1
DONE_67:
s_endpgm
K_M1:
s_lshl_b32 s42, s16, 5
s_add_u32 s42, s42, 819200
v_lshrrev_b32 v24, 2, v0
v_and_b32 v24, 4, v24
s_mov_b32 s65, 4000000
K_M1p:
buffer_load_dword v25, v24, s[8:11], s42 offen sc1
s_waitcnt vmcnt(0)
v_subrev_u32 v25, s7, v25
v_subrev_u32 v25, 1, v25
v_cmp_lt_u32 vcc, 15, v25
s_cbranch_vccz K_M1q
s_sub_u32 s65, s65, 1
s_cbranch_scc1 K_END
s_sleep 4
s_branch K_M1p
K_M1q:
s_mov_b32 s68, 2
s_mov_b32 s69, 0
s_add_u32 s51, s42, 8
s_and_b32 s39, s7, 0x3fff3f00
s_add_u32 s39, s39, 1
s_lshl_b32 s40, s39, 2
s_lshl_b32 s43, s16, 2
s_add_u32 s43, s43, 820224
s_mov_b32 s18, 0
s_mov_b32 s20, 0
s_mov_b32 s21, 786432
s_mov_b32 s22, 795648
s_mov_b32 s23, 804864
s_lshl_b32 s28, s16, 14
s_add_u32 s24, s28, 1048576
s_mov_b32 s25, 34603008
s_add_u32 s45, s24, 524288
s_add_u32 s26, s45, 8192
s_cmp_eq_u32 s17, 3
s_cmp_eq_u32 s17, 2
s_cselect_b32 s28, 1, 0
s_cmp_lt_u32 s16, 9
s_cselect_b32 s29, s28, 0
s_cselect_b32 s62, s16, 0
s_and_b32 s29, s29, 1
s_lshl_b32 s62, s62, 10
s_mov_b32 s60, s29
s_mov_b32 s61, 0
s_sub_u32 s58, 0, s29
s_mov_b32 s59, s58
s_cmp_eq_u32 s17, 3
s_cselect_b32 s57, 1, s29
s_add_u32 s64, s25, s62
s_mov_b32 s63, s7
s_add_u32 s46, s21, 6144
s_lshl_b32 s28, s36, 3
s_add_u32 s47, s28, s24
s_lshl_b32 s28, s17, 11
s_add_u32 s28, s28, s24
s_add_u32 s49, s28, 8192
s_mov_b32 s37, 0x3e0293ee
s_mov_b32 s27, 400000
s_mov_b32 s12, 0x3f803f80
s_mov_b32 s13, 0x3f803f80
s_mov_b32 s50, 815104
v_add_u32 v18, s31, v0
s_cmp_eq_u32 s17, 3
s_cbranch_scc0 L3_91
v_lshlrev_b32 v6, 3, v0
L3_91:
buffer_load_dwordx4 v[64:67], v0, s[8:11], s47 offen offset:0
buffer_load_dwordx4 v[68:71], v0, s[8:11], s47 offen offset:1024
buffer_load_dwordx4 v[72:75], v0, s[8:11], s47 offen offset:2048
buffer_load_dwordx4 v[76:79], v0, s[8:11], s47 offen offset:3072
buffer_load_dwordx4 v[20:23], v0, s[8:11], s49 offen offset:0
buffer_load_dwordx4 v[10:13], v0, s[8:11], s49 offen offset:1024
s_waitcnt vmcnt(0)
v_mov_b64 v[40:41], 0
v_mov_b64 v[42:43], 0
v_mov_b64 v[44:45], 0
v_mov_b64 v[46:47], 0
v_mov_b64 v[56:57], 0
v_mov_b64 v[58:59], 0
v_mov_b64 v[60:61], 0
v_mov_b64 v[62:63], 0
STEP_93:
s_cmp_eq_u32 s17, 3
s_cbranch_scc1 JOIN_96
buffer_load_dwordx4 v[64:67], v18, s[8:11], s21 offen offset:0 sc1
buffer_load_dwordx4 v[68:71], v18, s[8:11], s21 offen offset:3072 sc1
buffer_load_dwordx4 v[72:75], v18, s[8:11], s46 offen offset:0 sc1
s_sleep 3
P0_98:
buffer_load_dwordx4 v[48:51], v18, s[8:11], s21 offen offset:0 sc1
buffer_load_dwordx4 v[52:55], v18, s[8:11], s21 offen offset:3072 sc1
buffer_load_dwordx4 v[76:79], v18, s[8:11], s46 offen offset:0 sc1
s_waitcnt vmcnt(3)
ds_write_b128 v18, v[64:67] offset:0
ds_write_b128 v18, v[68:71] offset:3072
ds_write_b128 v18, v[72:75] offset:6144
v_max3_u32 v14, v64, v65, v66
v_max3_u32 v14, v67, v68, v14
v_max3_u32 v14, v69, v70, v14
v_max3_u32 v14, v71, v72, v14
v_max3_u32 v14, v73, v74, v14
v_max_u32 v14, v75, v14
v_cmp_eq_u32 vcc, -1, v14
s_cbranch_vccz GOK_100
s_sub_u32 s27, s27, 1
s_cbranch_scc1 FAIL_94
buffer_load_dwordx4 v[64:67], v18, s[8:11], s21 offen offset:0 sc1
buffer_load_dwordx4 v[68:71], v18, s[8:11], s21 offen offset:3072 sc1
buffer_load_dwordx4 v[72:75], v18, s[8:11], s46 offen offset:0 sc1
s_waitcnt vmcnt(3)
ds_write_b128 v18, v[48:51] offset:0
ds_write_b128 v18, v[52:55] offset:3072
ds_write_b128 v18, v[76:79] offset:6144
v_max3_u32 v14, v48, v49, v50
v_max3_u32 v14, v51, v52, v14
v_max3_u32 v14, v53, v54, v14
v_max3_u32 v14, v55, v76, v14
v_max3_u32 v14, v77, v78, v14
v_max_u32 v14, v79, v14
v_cmp_eq_u32 vcc, -1, v14
s_cbranch_vccnz P0_98
GOK_100:
s_waitcnt lgkmcnt(0)
JOIN_96:
s_barrier
s_cmp_eq_u32 s18, 63
s_cbranch_scc1 FINAL_97
ds_read_b128 v[24:27], v0 offset:0
ds_read_b128 v[28:31], v0 offset:1024
ds_read_b128 v[32:35], v0 offset:2048
ds_read_b128 v[36:39], v0 offset:3072
s_waitcnt lgkmcnt(3)
v_smfmac_f32_16x16x64_bf16 v[40:43], v[24:27], a[0:7], v1
v_smfmac_f32_16x16x64_bf16 v[44:47], v[24:27], a[72:79], v1
ds_read_b128 v[24:27], v0 offset:4096
buffer_load_dwordx4 v[64:67], v0, s[8:11], s47 offen offset:0
s_waitcnt lgkmcnt(3)
v_smfmac_f32_16x16x64_bf16 v[40:43], v[28:31], a[8:15], v1
v_smfmac_f32_16x16x64_bf16 v[44:47], v[28:31], a[80:87], v1
ds_read_b128 v[28:31], v0 offset:5120
s_waitcnt lgkmcnt(3)
v_smfmac_f32_16x16x64_bf16 v[40:43], v[32:35], a[16:23], v1
v_smfmac_f32_16x16x64_bf16 v[44:47], v[32:35], a[88:95], v1
ds_read_b128 v[32:35], v0 offset:6144
buffer_load_dwordx4 v[68:71], v0, s[8:11], s47 offen offset:1024
s_waitcnt lgkmcnt(3)
v_smfmac_f32_16x16x64_bf16 v[40:43], v[36:39], a[24:31], v1
v_smfmac_f32_16x16x64_bf16 v[44:47], v[36:39], a[96:103], v1
ds_read_b128 v[36:39], v0 offset:7168
s_waitcnt lgkmcnt(3)
v_smfmac_f32_16x16x64_bf16 v[40:43], v[24:27], a[32:39], v1
v_smfmac_f32_16x16x64_bf16 v[44:47], v[24:27], a[104:111], v1
ds_read_b128 v[24:27], v0 offset:8192
buffer_load_dwordx4 v[72:75], v0, s[8:11], s47 offen offset:2048
s_waitcnt lgkmcnt(3)
v_smfmac_f32_16x16x64_bf16 v[40:43], v[28:31], a[40:47], v1
v_smfmac_f32_16x16x64_bf16 v[44:47], v[28:31], a[112:119], v1
ds_read_b128 v[28:31], v0 offset:0
s_waitcnt lgkmcnt(3)
v_smfmac_f32_16x16x64_bf16 v[40:43], v[32:35], a[48:55], v1
v_smfmac_f32_16x16x64_bf16 v[44:47], v[32:35], a[120:127], v1
ds_read_b128 v[32:35], v0 offset:1024
buffer_load_dwordx4 v[76:79], v0, s[8:11], s47 offen offset:3072
s_waitcnt lgkmcnt(3)
v_smfmac_f32_16x16x64_bf16 v[40:43], v[36:39], a[56:63], v1
v_smfmac_f32_16x16x64_bf16 v[44:47], v[36:39], a[128:135], v1
ds_read_b128 v[36:39], v0 offset:2048
s_waitcnt lgkmcnt(3)
v_smfmac_f32_16x16x64_bf16 v[40:43], v[24:27], a[64:71], v1
v_smfmac_f32_16x16x64_bf16 v[44:47], v[24:27], a[136:143], v1
ds_read_b128 v[24:27], v0 offset:3072
buffer_load_dwordx4 v[20:23], v0, s[8:11], s49 offen offset:0
s_waitcnt lgkmcnt(3)
v_smfmac_f32_16x16x64_bf16 v[56:59], v[28:31], a[144:151], v1
v_smfmac_f32_16x16x64_bf16 v[60:63], v[28:31], a[216:223], v1
ds_read_b128 v[28:31], v0 offset:4096
buffer_load_dwordx4 v[10:13], v0, s[8:11], s49 offen offset:1024
s_waitcnt lgkmcnt(3)
v_smfmac_f32_16x16x64_bf16 v[56:59], v[32:35], a[152:159], v1
v_smfmac_f32_16x16x64_bf16 v[60:63], v[32:35], a[224:231], v1
ds_read_b128 v[32:35], v0 offset:5120
v_add_f32 v40, v40, v42
v_add_f32 v41, v41, v43
s_waitcnt lgkmcnt(3)
v_smfmac_f32_16x16x64_bf16 v[56:59], v[36:39], a[160:167], v1
v_mul_f32 v40, s37, v40
v_mul_f32 v41, s37, v41
v_smfmac_f32_16x16x64_bf16 v[60:63], v[36:39], a[232:239], v1
ds_read_b128 v[36:39], v0 offset:6144
v_cvt_pk_bf16_f32 v14, v40, v41
v_add_f32 v44, v44, v46
s_waitcnt lgkmcnt(3)
v_smfmac_f32_16x16x64_bf16 v[56:59], v[24:27], a[168:175], v1
v_add_f32 v45, v45, v47
v_mul_f32 v44, s37, v44
v_smfmac_f32_16x16x64_bf16 v[60:63], v[24:27], a[240:247], v1
ds_read_b128 v[24:27], v0 offset:7168
v_mul_f32 v45, s37, v45
v_cvt_pk_bf16_f32 v15, v44, v45
ds_write2_b32 v2, v14, v15 offset0:1 offset1:129
s_waitcnt vmcnt(6)
v_add_u32 v18, s62, v0
ds_read_b128 v[48:51], v18 offset:0
s_waitcnt lgkmcnt(5)
v_smfmac_f32_16x16x64_bf16 v[56:59], v[28:31], a[176:183], v1
v_smfmac_f32_16x16x64_bf16 v[60:63], v[28:31], a[248:255], v1
ds_read_b128 v[28:31], v0 offset:8192
s_waitcnt lgkmcnt(1)
s_cmp_lg_u32 s58, 0
s_cbranch_scc1 PUBL_103
PUBb_104:
v_smfmac_f32_16x16x64_bf16 v[56:59], v[32:35], a[184:191], v1
v_smfmac_f32_16x16x64_bf16 v[60:63], v[32:35], v[80:87], v1
ds_read_b128 v[32:35], v0 offset:0
s_cmp_eq_u32 s17, 3
s_cbranch_scc1 PF3_101
PF3b_102:
s_cmp_lg_u32 s57, 0
s_cbranch_scc1 W2_105
s_waitcnt vmcnt(0)
W2b_106:
s_barrier
ds_read_b64_tr_b16 v[40:41], v3 offset:0
ds_read_b64_tr_b16 v[42:43], v3 offset:512
ds_read_b64_tr_b16 v[44:45], v3 offset:1024
ds_read_b64_tr_b16 v[46:47], v3 offset:1536
v_smfmac_f32_16x16x64_bf16 v[56:59], v[36:39], a[192:199], v1
ds_read_b64_tr_b16 v[48:49], v3 offset:2048
ds_read_b64_tr_b16 v[50:51], v3 offset:2560
v_smfmac_f32_16x16x64_bf16 v[60:63], v[36:39], v[88:95], v1
ds_read_b128 v[36:39], v0 offset:1024
ds_read_b64_tr_b16 v[52:53], v3 offset:3072
v_smfmac_f32_16x16x64_bf16 v[56:59], v[24:27], a[200:207], v1
ds_read_b64_tr_b16 v[54:55], v3 offset:3584
v_add_u32 v18, s36, v9
v_smfmac_f32_16x16x64_bf16 v[60:63], v[24:27], v[96:103], v1
ds_read_b128 v[24:27], v0 offset:2048
s_waitcnt lgkmcnt(11)
v_smfmac_f32_16x16x64_bf16 v[56:59], v[28:31], a[208:215], v1
v_smfmac_f32_16x16x64_bf16 v[60:63], v[28:31], v[104:111], v1
ds_read_b128 v[28:31], v0 offset:3072
s_waitcnt lgkmcnt(7)
v_mfma_f32_16x16x32_bf16 v[14:17], v[64:67], v[40:43], 0
v_mfma_f32_16x16x32_bf16 v[14:17], v[68:71], v[44:47], v[14:17]
s_waitcnt lgkmcnt(2)
v_mfma_f32_16x16x32_bf16 v[14:17], v[72:75], v[48:51], v[14:17]
v_mfma_f32_16x16x32_bf16 v[14:17], v[76:79], v[52:55], v[14:17]
v_mov_b64 v[64:65], 0
v_mov_b64 v[66:67], 0
v_mov_b64 v[68:69], 0
v_mov_b64 v[70:71], 0
s_nop 0
v_smfmac_f32_16x16x64_bf16 v[64:67], v[32:35], v[112:119], v1
v_add_f32 v56, v56, v58
v_smfmac_f32_16x16x64_bf16 v[68:71], v[32:35], v[184:191], v1
ds_read_b128 v[32:35], v0 offset:4096
v_add_f32 v57, v57, v59
v_smfmac_f32_16x16x64_bf16 v[64:67], v[36:39], v[120:127], v1
v_add_f32 v60, v60, v62
v_smfmac_f32_16x16x64_bf16 v[68:71], v[36:39], v[192:199], v1
ds_read_b128 v[36:39], v0 offset:5120
v_add_f32 v61, v61, v63
s_waitcnt lgkmcnt(3)
v_smfmac_f32_16x16x64_bf16 v[64:67], v[24:27], v[128:135], v1
v_cvt_pk_bf16_f32 v56, v56, v57
v_smfmac_f32_16x16x64_bf16 v[68:71], v[24:27], v[200:207], v1
ds_read_b128 v[24:27], v0 offset:6144
v_cvt_pk_bf16_f32 v60, v60, v61
ds_write2_b32 v2, v56, v60 offset0:0 offset1:128
s_waitcnt lgkmcnt(4)
v_smfmac_f32_16x16x64_bf16 v[64:67], v[28:31], v[136:143], v1
v_exp_f32 v14, v14
v_smfmac_f32_16x16x64_bf16 v[68:71], v[28:31], v[208:215], v1
ds_read_b128 v[28:31], v0 offset:7168
v_exp_f32 v15, v15
s_waitcnt lgkmcnt(4)
v_smfmac_f32_16x16x64_bf16 v[64:67], v[32:35], v[144:151], v1
v_exp_f32 v16, v16
v_smfmac_f32_16x16x64_bf16 v[68:71], v[32:35], v[216:223], v1
ds_read_b128 v[32:35], v0 offset:8192
v_exp_f32 v17, v17
s_waitcnt lgkmcnt(2)
s_barrier
v_cvt_pk_bf16_f32 v14, v14, v15
v_cvt_pk_bf16_f32 v15, v16, v17
ds_write_b64 v18, v[14:15]
v_smfmac_f32_16x16x64_bf16 v[64:67], v[36:39], v[152:159], v1
ds_read_b64_tr_b16 v[40:41], v3 offset:0
ds_read_b64_tr_b16 v[42:43], v3 offset:512
v_smfmac_f32_16x16x64_bf16 v[68:71], v[36:39], v[224:231], v1
ds_read_b64_tr_b16 v[44:45], v3 offset:1024
ds_read_b64_tr_b16 v[46:47], v3 offset:1536
v_smfmac_f32_16x16x64_bf16 v[64:67], v[24:27], v[160:167], v1
ds_read_b64_tr_b16 v[48:49], v3 offset:2048
ds_read_b64_tr_b16 v[50:51], v3 offset:2560
v_smfmac_f32_16x16x64_bf16 v[68:71], v[24:27], v[232:239], v1
ds_read_b64_tr_b16 v[52:53], v3 offset:3072
ds_read_b64_tr_b16 v[54:55], v3 offset:3584
s_waitcnt lgkmcnt(10)
v_smfmac_f32_16x16x64_bf16 v[64:67], v[28:31], v[168:175], v1
v_smfmac_f32_16x16x64_bf16 v[68:71], v[28:31], v[240:247], v1
s_waitcnt lgkmcnt(8)
s_barrier
ds_read2_b64 v[56:59], v9 offset0:0 offset1:64
v_smfmac_f32_16x16x64_bf16 v[64:67], v[32:35], v[176:183], v1
v_mov_b64 v[14:15], s[12:13]
v_smfmac_f32_16x16x64_bf16 v[68:71], v[32:35], v[248:255], v1
v_mov_b64 v[16:17], s[12:13]
s_waitcnt lgkmcnt(5)
v_mfma_f32_16x16x32_bf16 v[60:63], v[40:43], v[40:43], 0
v_mfma_f32_16x16x32_bf16 v[60:63], v[44:47], v[44:47], v[60:63]
s_waitcnt lgkmcnt(1)
v_mfma_f32_16x16x32_bf16 v[60:63], v[48:51], v[48:51], v[60:63]
v_mfma_f32_16x16x32_bf16 v[60:63], v[52:55], v[52:55], v[60:63]
ds_read_b128 v[72:75], v8 offset:0
ds_read_b128 v[76:79], v8 offset:1024
s_waitcnt lgkmcnt(2)
v_mfma_f32_16x16x32_bf16 v[48:51], v[14:17], v[56:59], 0
v_add_f32 v64, v64, v66
v_add_f32 v65, v65, v67
v_mfma_f32_16x16x32_bf16 v[40:43], v[20:23], v[56:59], 0
v_cvt_pk_bf16_f32 v64, v64, v65
v_mov_b32 v65, 0
v_mfma_f32_16x16x32_bf16 v[44:47], v[10:13], v[56:59], 0
v_add_f32 v68, v68, v70
v_add_f32 v69, v69, v71
v_exp_f32 v60, v60
v_exp_f32 v61, v61
v_cvt_pk_bf16_f32 v68, v68, v69
v_mov_b32 v69, 0
v_cvt_pk_bf16_f32 v18, v60, v61
ds_read_b128 v[24:27], v8 offset:2048
ds_read_b128 v[28:31], v8 offset:3072
v_mfma_f32_16x16x16_bf16 v[48:51], v[14:15], v[18:19], v[48:51]
v_mfma_f32_16x16x16_bf16 v[40:43], v[64:65], v[18:19], v[40:43]
v_mfma_f32_16x16x16_bf16 v[44:47], v[68:69], v[18:19], v[44:47]
ds_read_b128 v[32:35], v8 offset:4096
ds_read_b128 v[36:39], v8 offset:5120
v_mov_b32 v66, s44
s_nop 2
v_med3_f32 v66, v48, s38, v66
v_cmp_neq_f32 vcc, v66, v48
v_rcp_f32 v66, v48
s_and_b64 vcc, vcc, s[32:33]
s_cbranch_vccnz SLOW_107
BACK_108:
s_cmp_eq_u32 s18, 63
s_cbranch_scc1 LAST_109
s_nop 0
v_pk_mul_f32 v[40:41], v[40:41], v[66:67] op_sel_hi:[1,0]
v_pk_mul_f32 v[42:43], v[42:43], v[66:67] op_sel_hi:[1,0]
v_cvt_pk_bf16_f32 v40, v40, v41
v_cvt_pk_bf16_f32 v41, v42, v43
v_pk_mul_f32 v[44:45], v[44:45], v[66:67] op_sel_hi:[1,0]
v_pk_mul_f32 v[46:47], v[46:47], v[66:67] op_sel_hi:[1,0]
v_cvt_pk_bf16_f32 v44, v44, v45
v_cvt_pk_bf16_f32 v45, v46, v47
s_mov_b64 exec, s[32:33]
ds_write2_b64 v4, v[40:41], v[44:45] offset0:0 offset1:4
s_mov_b64 exec, -1
v_mov_b64 v[20:21], 0
v_mov_b64 v[22:23], 0
v_mov_b64 v[10:11], 0
v_mov_b64 v[12:13], 0
v_mov_b32 v17, s39
s_waitcnt lgkmcnt(0)
s_barrier
ds_read_b128 v[48:51], v0 offset:14336
ds_read_b128 v[52:55], v0 offset:15360
ds_read_b128 v[56:59], v8 offset:6144
ds_read_b128 v[60:63], v8 offset:7168
ds_read_b128 v[40:43], v8 offset:8192
ds_read_b128 v[44:47], v8 offset:9216
ds_read_b128 v[64:67], v8 offset:10240
ds_read_b128 v[68:71], v8 offset:11264
s_waitcnt lgkmcnt(6)
v_smfmac_f32_16x16x64_bf16 v[20:23], v[48:51], v[72:79], v1
ds_read_b128 v[72:75], v8 offset:12288
ds_read_b128 v[76:79], v8 offset:13312
v_smfmac_f32_16x16x64_bf16 v[20:23], v[52:55], v[24:31], v1
ds_read_b128 v[24:27], v8 offset:14336
ds_read_b128 v[28:31], v8 offset:15360
s_waitcnt lgkmcnt(8)
v_smfmac_f32_16x16x64_bf16 v[10:13], v[48:51], v[32:39], v1
ds_read_b128 v[32:35], v8 offset:16384
ds_read_b128 v[36:39], v8 offset:17408
s_nop 3
v_add_f32 v20, v20, v22
v_smfmac_f32_16x16x64_bf16 v[10:13], v[52:55], v[56:63], v1
ds_read_b128 v[56:59], v8 offset:18432
ds_read_b128 v[60:63], v8 offset:19456
v_add_f32 v21, v21, v23
v_cvt_pk_bf16_f32 v14, v20, v21
v_mov_b64 v[20:21], 0
v_mov_b64 v[22:23], 0
s_nop 0
s_waitcnt lgkmcnt(8)
v_smfmac_f32_16x16x64_bf16 v[20:23], v[48:51], v[40:47], v1
ds_read_b128 v[40:43], v8 offset:20480
ds_read_b128 v[44:47], v8 offset:21504
v_add_f32 v10, v10, v12
v_smfmac_f32_16x16x64_bf16 v[20:23], v[52:55], v[64:71], v1
ds_read_b128 v[64:67], v8 offset:22528
v_add_f32 v11, v11, v13
v_cvt_pk_bf16_f32 v15, v10, v11
v_mov_b64 v[10:11], 0
v_mov_b64 v[12:13], 0
s_nop 0
s_waitcnt lgkmcnt(7)
v_smfmac_f32_16x16x64_bf16 v[10:13], v[48:51], v[72:79], v1
ds_read_b128 v[68:71], v8 offset:23552
ds_read_b128 v[72:75], v8 offset:24576
v_add_f32 v20, v20, v22
v_smfmac_f32_16x16x64_bf16 v[10:13], v[52:55], v[24:31], v1
ds_read_b128 v[76:79], v8 offset:25600
v_add_f32 v21, v21, v23
v_cvt_pk_bf16_f32 v16, v20, v21
v_mov_b64 v[20:21], 0
v_mov_b64 v[22:23], 0
s_add_u32 s28, s20, 0
buffer_store_dwordx4 v[14:17], v5, s[8:11], s28 offen sc1
s_nop 0
s_waitcnt lgkmcnt(6)
v_smfmac_f32_16x16x64_bf16 v[20:23], v[48:51], v[32:39], v1
ds_read_b128 v[24:27], v8 offset:26624
ds_read_b128 v[28:31], v8 offset:27648
v_add_f32 v10, v10, v12
v_smfmac_f32_16x16x64_bf16 v[20:23], v[52:55], v[56:63], v1
ds_read_b128 v[32:35], v8 offset:28672
v_add_f32 v11, v11, v13
v_cvt_pk_bf16_f32 v14, v10, v11
v_mov_b64 v[10:11], 0
v_mov_b64 v[12:13], 0
s_nop 0
s_waitcnt lgkmcnt(5)
v_smfmac_f32_16x16x64_bf16 v[10:13], v[48:51], v[40:47], v1
ds_read_b128 v[36:39], v8 offset:29696
ds_read_b128 v[56:59], v8 offset:30720
v_add_f32 v20, v20, v22
v_smfmac_f32_16x16x64_bf16 v[10:13], v[52:55], v[64:71], v1
ds_read_b128 v[60:63], v8 offset:31744
v_add_f32 v21, v21, v23
v_cvt_pk_bf16_f32 v15, v20, v21
v_mov_b64 v[20:21], 0
v_mov_b64 v[22:23], 0
s_nop 0
s_waitcnt lgkmcnt(4)
v_smfmac_f32_16x16x64_bf16 v[20:23], v[48:51], v[72:79], v1
ds_read_b128 v[40:43], v8 offset:32768
ds_read_b128 v[44:47], v8 offset:33792
v_add_f32 v10, v10, v12
v_smfmac_f32_16x16x64_bf16 v[20:23], v[52:55], v[24:31], v1
ds_read_b128 v[64:67], v8 offset:34816
v_add_f32 v11, v11, v13
v_cvt_pk_bf16_f32 v16, v10, v11
v_mov_b64 v[10:11], 0
v_mov_b64 v[12:13], 0
s_add_u32 s28, s20, 131072
buffer_store_dwordx4 v[14:17], v5, s[8:11], s28 offen sc1
s_nop 0
s_waitcnt lgkmcnt(3)
v_smfmac_f32_16x16x64_bf16 v[10:13], v[48:51], v[32:39], v1
ds_read_b128 v[68:71], v8 offset:35840
s_nop 0
v_add_f32 v20, v20, v22
v_smfmac_f32_16x16x64_bf16 v[10:13], v[52:55], v[56:63], v1
v_add_f32 v21, v21, v23
v_cvt_pk_bf16_f32 v14, v20, v21
v_mov_b64 v[20:21], 0
v_mov_b64 v[22:23], 0
s_nop 0
s_waitcnt lgkmcnt(0)
v_smfmac_f32_16x16x64_bf16 v[20:23], v[48:51], v[40:47], v1
s_nop 1
v_add_f32 v10, v10, v12
v_smfmac_f32_16x16x64_bf16 v[20:23], v[52:55], v[64:71], v1
v_add_f32 v11, v11, v13
v_cvt_pk_bf16_f32 v15, v10, v11
s_nop 6
v_add_f32 v20, v20, v22
v_add_f32 v21, v21, v23
v_cvt_pk_bf16_f32 v16, v20, v21
s_add_u32 s28, s20, 262144
buffer_store_dwordx4 v[14:17], v5, s[8:11], s28 offen sc1
s_cmp_eq_u32 s17, 3
s_cbranch_scc1 RW3_114
s_mov_b32 s29, s20
s_mov_b32 s30, s22
s_mov_b32 s53, s21
s_mov_b32 s41, s40
buffer_load_dwordx4 v[48:51], v0, s[8:11], s50 offen
s_xor_b32 s20, s20, 393216
s_mov_b32 s28, s21
s_mov_b32 s21, s22
s_mov_b32 s22, s23
s_mov_b32 s23, s28
s_add_u32 s24, s24, 524288
s_add_u32 s25, s25, 16384
s_add_u32 s18, s18, 1
s_add_u32 s39, s39, 1
s_add_u32 s40, s40, 4
s_add_u32 s46, s21, 6144
s_add_u32 s64, s64, 16384
s_add_u32 s63, s63, 1
s_add_u32 s47, s47, 524288
s_add_u32 s49, s49, 524288
v_mov_b64 v[40:41], 0
v_mov_b64 v[42:43], 0
v_mov_b64 v[44:45], 0
v_mov_b64 v[46:47], 0
s_sleep 1
s_cmp_eq_u32 s17, 0
s_cbranch_scc1 R0_111
s_sleep 2
s_cmp_eq_u32 s17, 1
s_cbranch_scc1 R0_111
s_sleep 2
R0_111:
buffer_load_dwordx4 v[24:27], v6, s[8:11], s29 offen offset:0 sc1
buffer_load_dwordx4 v[28:31], v6, s[8:11], s29 offen offset:1024 sc1
buffer_load_dwordx4 v[32:35], v6, s[8:11], s29 offen offset:2048 sc1
buffer_load_dwordx4 v[36:39], v6, s[8:11], s29 offen offset:3072 sc1
v_mov_b64 v[56:57], 0
v_mov_b64 v[58:59], 0
v_mov_b64 v[60:61], 0
v_mov_b64 v[62:63], 0
RB_113:
s_waitcnt vmcnt(3)
v_mfma_f32_16x16x32_bf16 v[14:17], v[24:27], v[48:51], 0
s_waitcnt vmcnt(2)
v_mfma_f32_16x16x32_bf16 v[14:17], v[28:31], v[48:51], v[14:17]
s_waitcnt vmcnt(1)
v_mfma_f32_16x16x32_bf16 v[14:17], v[32:35], v[48:51], v[14:17]
s_waitcnt vmcnt(0)
v_mfma_f32_16x16x32_bf16 v[14:17], v[36:39], v[48:51], v[14:17]
v_add3_u32 v18, v27, v31, v35
v_add_u32 v18, v18, v39
v_cmp_ne_u32 vcc, s41, v18
s_cbranch_vccz FIN_115
s_sub_u32 s27, s27, 1
s_cbranch_scc1 FAIL_94
buffer_load_dwordx4 v[24:27], v6, s[8:11], s29 offen offset:0 sc1
buffer_load_dwordx4 v[28:31], v6, s[8:11], s29 offen offset:1024 sc1
buffer_load_dwordx4 v[32:35], v6, s[8:11], s29 offen offset:2048 sc1
buffer_load_dwordx4 v[36:39], v6, s[8:11], s29 offen offset:3072 sc1
s_branch RB_113
FIN_115:
v_mov_b32 v18, -1
s_mov_b64 exec, s[34:35]
s_nop 1
v_add_f32 v14, v14, v16
v_add_f32 v15, v15, v17
v_cvt_pk_bf16_f32 v14, v14, v15
buffer_store_dword v14, v7, s[8:11], s30 offen sc1
buffer_store_dword v18, v7, s[8:11], s53 offen sc1
s_mov_b64 exec, -1
s_cmp_eq_u32 s17, 2
s_cbranch_scc1 NR_110
s_sleep 5
NR_110:
v_add_u32 v18, s31, v0
s_mov_b32 s27, 400000
s_branch STEP_93
RW3_114:
s_xor_b32 s20, s20, 393216
s_mov_b32 s28, s21
s_mov_b32 s21, s22
s_mov_b32 s22, s23
s_mov_b32 s23, s28
s_add_u32 s24, s24, 524288
s_add_u32 s25, s25, 16384
s_add_u32 s18, s18, 1
s_add_u32 s39, s39, 1
s_add_u32 s40, s40, 4
s_add_u32 s46, s21, 6144
s_add_u32 s64, s64, 16384
s_add_u32 s63, s63, 1
s_add_u32 s47, s47, 524288
s_add_u32 s49, s49, 524288
v_mov_b64 v[40:41], 0
v_mov_b64 v[42:43], 0
v_mov_b64 v[44:45], 0
v_mov_b64 v[46:47], 0
v_mov_b64 v[56:57], 0
v_mov_b64 v[58:59], 0
v_mov_b64 v[60:61], 0
v_mov_b64 v[62:63], 0
s_waitcnt vmcnt(3)
s_cmp_lt_u32 s18, 62
s_cbranch_scc0 PK_118
PW_117:
v_readfirstlane_b32 s29, v7
s_sub_u32 s29, s29, s7
s_sub_u32 s29, s29, 1
s_cmp_lt_u32 s29, 16
s_cbranch_scc0 PW_117n
s_cmp_ge_u32 s29, s69
s_cbranch_scc1 PK_118
PW_117n:
s_sub_u32 s27, s27, 1
s_cbranch_scc1 FAIL_94
s_sleep 8
buffer_load_dword v7, v19, s[8:11], s51 offen sc1
s_waitcnt vmcnt(0)
s_branch PW_117
PK_118:
s_add_u32 s68, s68, 1
s_cmp_eq_u32 s68, 7
s_cselect_b32 s28, 1, 0
s_cselect_b32 s68, 0, s68
s_add_u32 s69, s69, s28
s_lshl_b32 s51, s68, 2
s_add_u32 s51, s51, s42
s_add_u32 s45, s24, 524288
s_add_u32 s26, s45, 8192
s_branch NR_110
PUBL_103:
s_mov_b64 exec, 1
v_mov_b32 v18, s63
buffer_store_dword v18, v19, s[8:11], s43 offen sc1
s_mov_b64 exec, -1
buffer_store_dwordx4 v[48:51], v0, s[8:11], s64 offen sc1
s_branch PUBb_104
PF3_101:
buffer_load_dword v7, v6, s[8:11], s45 offen
buffer_load_dword v7, v6, s[8:11], s26 offen
buffer_load_dword v7, v19, s[8:11], s51 offen sc1
s_branch PF3b_102
W2_105:
s_cmp_eq_u32 s17, 3
s_cbranch_scc0 W2_105m
s_waitcnt vmcnt(3)
s_branch W2b_106
W2_105m:
s_waitcnt vmcnt(2)
s_branch W2b_106
SLOW_107:
s_nop 7
ds_read_b64_tr_b16 v[40:41], v3 offset:0
ds_read_b64_tr_b16 v[42:43], v3 offset:512
ds_read_b64_tr_b16 v[44:45], v3 offset:1024
ds_read_b64_tr_b16 v[46:47], v3 offset:1536
ds_read_b64_tr_b16 v[48:49], v3 offset:2048
ds_read_b64_tr_b16 v[50:51], v3 offset:2560
ds_read_b64_tr_b16 v[52:53], v3 offset:3072
ds_read_b64_tr_b16 v[54:55], v3 offset:3584
s_add_u32 s28, s24, 0
buffer_load_dwordx4 v[24:27], v0, s[8:11], s28 offen offset:0
buffer_load_dwordx4 v[28:31], v0, s[8:11], s28 offen offset:1024
buffer_load_dwordx4 v[32:35], v0, s[8:11], s28 offen offset:2048
buffer_load_dwordx4 v[36:39], v0, s[8:11], s28 offen offset:3072
s_waitcnt vmcnt(0) lgkmcnt(0)
v_mfma_f32_16x16x32_bf16 v[56:59], v[24:27], v[40:43], 0
v_mfma_f32_16x16x32_bf16 v[56:59], v[28:31], v[44:47], v[56:59]
v_mfma_f32_16x16x32_bf16 v[56:59], v[32:35], v[48:51], v[56:59]
v_mfma_f32_16x16x32_bf16 v[56:59], v[36:39], v[52:55], v[56:59]
s_nop 7
s_add_u32 s28, s24, 4096
buffer_load_dwordx4 v[24:27], v0, s[8:11], s28 offen offset:0
buffer_load_dwordx4 v[28:31], v0, s[8:11], s28 offen offset:1024
buffer_load_dwordx4 v[32:35], v0, s[8:11], s28 offen offset:2048
buffer_load_dwordx4 v[36:39], v0, s[8:11], s28 offen offset:3072
s_waitcnt vmcnt(0) lgkmcnt(0)
v_mfma_f32_16x16x32_bf16 v[14:17], v[24:27], v[40:43], 0
v_mfma_f32_16x16x32_bf16 v[14:17], v[28:31], v[44:47], v[14:17]
v_mfma_f32_16x16x32_bf16 v[14:17], v[32:35], v[48:51], v[14:17]
v_mfma_f32_16x16x32_bf16 v[14:17], v[36:39], v[52:55], v[14:17]
s_nop 7
v_mfma_f32_16x16x32_bf16 v[60:63], v[40:43], v[40:43], 0
v_mfma_f32_16x16x32_bf16 v[60:63], v[44:47], v[44:47], v[60:63]
v_mfma_f32_16x16x32_bf16 v[60:63], v[48:51], v[48:51], v[60:63]
v_mfma_f32_16x16x32_bf16 v[60:63], v[52:55], v[52:55], v[60:63]
s_nop 7
s_nop 1
v_max3_f32 v18, v56, v57, v58
v_max3_f32 v18, v59, v14, v18
v_max3_f32 v18, v15, v16, v18
v_max3_f32 v18, v17, v60, v18
v_max_f32 v18, v61, v18
v_mov_b32 v52, v18
s_nop 1
v_permlane32_swap_b32 v52, v18
s_nop 1
v_max_f32 v18, v18, v52
v_mov_b32 v52, v18
s_nop 1
v_permlane16_swap_b32 v52, v18
s_nop 1
v_max_f32 v18, v18, v52
v_sub_f32 v56, v56, v18
v_sub_f32 v57, v57, v18
v_sub_f32 v58, v58, v18
v_sub_f32 v59, v59, v18
v_sub_f32 v14, v14, v18
v_sub_f32 v15, v15, v18
v_sub_f32 v16, v16, v18
v_sub_f32 v17, v17, v18
v_sub_f32 v60, v60, v18
v_sub_f32 v61, v61, v18
v_exp_f32 v56, v56
v_exp_f32 v57, v57
v_exp_f32 v58, v58
v_exp_f32 v59, v59
v_exp_f32 v14, v14
v_exp_f32 v15, v15
v_exp_f32 v16, v16
v_exp_f32 v17, v17
v_exp_f32 v60, v60
v_exp_f32 v61, v61
s_nop 0
v_cvt_pk_bf16_f32 v56, v56, v57
v_cvt_pk_bf16_f32 v57, v58, v59
v_cvt_pk_bf16_f32 v58, v14, v15
v_cvt_pk_bf16_f32 v59, v16, v17
v_cvt_pk_bf16_f32 v18, v60, v61
v_mov_b64 v[14:15], s[12:13]
v_mov_b64 v[16:17], s[12:13]
s_nop 1
v_mfma_f32_16x16x32_bf16 v[40:43], v[20:23], v[56:59], 0
v_mfma_f32_16x16x32_bf16 v[44:47], v[10:13], v[56:59], 0
v_mfma_f32_16x16x32_bf16 v[48:51], v[14:17], v[56:59], 0
s_nop 7
v_mfma_f32_16x16x16_bf16 v[48:51], v[14:15], v[18:19], v[48:51]
v_mfma_f32_16x16x16_bf16 v[40:43], v[64:65], v[18:19], v[40:43]
v_mfma_f32_16x16x16_bf16 v[44:47], v[68:69], v[18:19], v[44:47]
ds_read_b128 v[72:75], v8 offset:0
ds_read_b128 v[76:79], v8 offset:1024
ds_read_b128 v[24:27], v8 offset:2048
ds_read_b128 v[28:31], v8 offset:3072
ds_read_b128 v[32:35], v8 offset:4096
ds_read_b128 v[36:39], v8 offset:5120
s_waitcnt lgkmcnt(0)
s_nop 7
v_rcp_f32 v66, v48
s_branch BACK_108
LAST_109:
s_branch DONE_95
FINAL_97:
s_cmp_lg_u32 s58, 0
s_cbranch_scc0 DONE_95
s_lshl_b32 s28, s16, 10
v_add_u32 v18, s28, v0
ds_read_b128 v[48:51], v18 offset:0
s_add_u32 s28, s28, s25
s_waitcnt lgkmcnt(0)
buffer_store_dwordx4 v[48:51], v0, s[8:11], s28 offen sc1
s_waitcnt vmcnt(0)
s_add_u32 s28, s7, 64
v_mov_b32 v18, s28
s_mov_b64 exec, 1
buffer_store_dword v18, v19, s[8:11], s43 offen sc1
s_mov_b64 exec, -1
s_branch DONE_95
FAIL_94:
s_mov_b64 exec, -1
s_mov_b32 s19, 1
DONE_95:
s_endpgm
K_END:
s_endpgm
.section .rodata,"a"
.p2align 6
.amdhsa_kernel concat_heads__memory_aug_recurrent_mem_tr__grouped_kv_mqa__prompt_kernel
  .amdhsa_next_free_vgpr 512
  .amdhsa_next_free_sgpr 102
  .amdhsa_accum_offset 256
  .amdhsa_group_segment_fixed_size 0
  .amdhsa_kernarg_size 120
  .amdhsa_user_sgpr_count 2
  .amdhsa_user_sgpr_kernarg_segment_ptr 1
  .amdhsa_system_sgpr_workgroup_id_x 1
.end_amdhsa_kernel
```
